```python
import torch

def _softmax(x, axis=-1):
    return torch.softmax(x, dim=axis)
def _gelu(x):
    return torch.nn.functional.gelu(x, approximate="tanh")
def _silu(x):
    return torch.nn.functional.silu(x)
def _sigmoid(x):
    return torch.sigmoid(x)
def _layernorm(x, axis=-1, eps=1e-5):
    m = x.mean(dim=axis, keepdim=True)
    v = x.var(dim=axis, keepdim=True, unbiased=False)
    return (x - m) / torch.sqrt(v + eps)
def _scatter_add(tgt, idx, src, axis=0):
    return tgt.clone().index_add_(axis, idx, src)
def _segment_sum(src, seg, n):
    out = torch.zeros((n,) + src.shape[1:], dtype=src.dtype)
    return out.index_add_(0, seg, src)
def _pad(x, pw):
    flat = tuple(v for pair in reversed(pw) for v in pair)
    return torch.nn.functional.pad(x, flat)

kernel_name = 'standalone__cross_network_dcn__recsys'

def setup_inputs():

    _w = (lambda a: (lambda t: t.to(torch.bfloat16) if t.is_floating_point() else t)(torch.as_tensor(a)))
    B, F, D, L = 16384, 26, 32, 3
    Din = min(F * D, 1024)
    return {
        "x0": _w((lambda *s: torch.randn(*s, dtype=torch.bfloat16) * 0.05)(B, Din)),
        "ws": _w((lambda *s: torch.randn(*s, dtype=torch.bfloat16) * 0.4)(L, Din, Din) * (Din ** -0.5)),
        "bs": _w((lambda *s: torch.randn(*s, dtype=torch.bfloat16) * 3.2)(L, Din) * 0.01),
    }

def reference(x0, ws, bs):
    x = x0
    L = ws.shape[0]
    for l in range(L):
        proj = torch.einsum('bd,de->be', x, ws[l]) + bs[l]
        x = x0 * proj + x
    return x
```

```asm
; @launch kernel=dcn_prep_kernel grid=(26,12,1) block=(832,1,1) lds=0
; @launch kernel=standalone__cross_network_dcn__recsys_kernel grid=(256,1,1) block=(256,1,1) lds=124928
.amdgcn_target "amdgcn-amd-amdhsa--gfx950"
.text

.globl dcn_prep_kernel
.p2align 8
.type dcn_prep_kernel,@function
dcn_prep_kernel:
  s_cmp_ge_u32 s2, 26
  s_cbranch_scc1 Lprep_end

  s_load_dwordx2 s[4:5], s[0:1], 8
  s_load_dwordx2 s[6:7], s[0:1], 40
  v_lshrrev_b32 v1, 6, v0
  v_and_b32 v2, 63, v0
  v_and_b32 v3, 15, v2
  v_lshrrev_b32 v4, 4, v2
  s_nop 0
  v_readfirstlane_b32 s9, v1
  s_lshr_b32 s10, s3, 2
  s_and_b32 s11, s3, 3
  s_lshr_b32 s12, s2, 2
  s_mul_i32 s12, s12, 6
  s_and_b32 s13, s2, 3
  s_add_u32 s12, s12, s13
  s_sub_u32 s13, s2, 16
  s_lshr_b32 s14, s13, 1
  s_mul_i32 s14, s14, 6
  s_and_b32 s15, s13, 1
  s_add_u32 s14, s14, s15
  s_add_u32 s14, s14, 4
  s_cmp_lt_u32 s2, 16
  s_cselect_b32 s12, s12, s14
  s_cmp_lt_u32 s2, 24
  s_cselect_b32 s12, s12, s2
  s_mul_i32 s13, s11, 192
  s_lshr_b32 s14, s9, 1
  s_lshl_b32 s14, s14, 5
  s_add_u32 s13, s13, s14
  s_and_b32 s14, s9, 1
  s_lshl_b32 s14, s14, 2
  s_add_u32 s13, s13, s14
  s_lshl_b32 s14, s11, 4
  s_add_u32 s14, s14, 768
  s_cmp_lt_u32 s9, 12
  s_cselect_b32 s13, s13, s14
  v_lshrrev_b32 v5, 2, v3
  v_lshlrev_b32 v5, 3, v5
  v_and_b32 v6, 3, v3
  v_add_u32 v5, v5, v6
  v_cmp_gt_u32 vcc, 12, v1
  s_nop 1
  v_cndmask_b32 v5, v3, v5, vcc
  v_lshlrev_b32 v5, 1, v5
  v_mul_u32_u24 v6, 13312, v4
  v_add_u32 v5, v5, v6
  v_lshlrev_b32 v7, 4, v2
  s_waitcnt lgkmcnt(0)
  s_mov_b32 s24, s4
  s_and_b32 s25, s5, 0xffff
  s_mov_b32 s26, 4153344
  s_mov_b32 s27, 0x00020000
  s_mov_b32 s28, s6
  s_and_b32 s29, s7, 0xffff
  s_mov_b32 s30, 4153344
  s_mov_b32 s31, 0x00020000
  s_mul_i32 s14, s10, 1384448
  s_mul_i32 s15, s12, 53248
  s_add_u32 s14, s14, s15
  s_lshl_b32 s15, s13, 1
  s_add_u32 s32, s14, s15
  s_add_u32 s33, s32, 1664
  s_add_u32 s34, s33, 1664
  s_add_u32 s35, s34, 1664
  s_add_u32 s36, s35, 1664
  s_add_u32 s37, s36, 1664
  s_add_u32 s38, s37, 1664
  s_add_u32 s39, s38, 1664
  buffer_load_ushort v10, v5, s[24:27], s32 offen
  buffer_load_ushort v11, v5, s[24:27], s33 offen
  buffer_load_ushort v12, v5, s[24:27], s34 offen
  buffer_load_ushort v13, v5, s[24:27], s35 offen
  buffer_load_ushort v14, v5, s[24:27], s36 offen
  buffer_load_ushort v15, v5, s[24:27], s37 offen
  buffer_load_ushort v16, v5, s[24:27], s38 offen
  buffer_load_ushort v17, v5, s[24:27], s39 offen
  s_lshl_b32 s20, s2, 3
  s_add_u32 s20, s20, s9
  s_mul_i32 s21, s2, 5
  s_add_u32 s21, s21, s9
  s_add_u32 s21, s21, 200
  s_cmp_lt_u32 s9, 8
  s_cselect_b32 s20, s20, s21
  s_mul_i32 s21, s11, 1014
  s_add_u32 s20, s20, s21
  s_mul_i32 s21, s10, 338
  s_add_u32 s20, s20, s21
  s_lshl_b32 s20, s20, 10
  s_waitcnt vmcnt(0)
  v_lshl_or_b32 v20, v11, 16, v10
  v_lshl_or_b32 v21, v13, 16, v12
  v_lshl_or_b32 v22, v15, 16, v14
  v_lshl_or_b32 v23, v17, 16, v16
  buffer_store_dwordx4 v[20:23], v7, s[28:31], s20 offen

Lprep_end:
  s_endpgm

.globl standalone__cross_network_dcn__recsys_kernel
.p2align 8
.type standalone__cross_network_dcn__recsys_kernel,@function
standalone__cross_network_dcn__recsys_kernel:
  s_cmp_ge_u32 s2, 256
  s_cbranch_scc1 Lmain_end
  s_load_dwordx2 s[28:29], s[0:1], 0
  s_load_dwordx2 s[30:31], s[0:1], 16
  s_load_dwordx2 s[32:33], s[0:1], 24
  s_load_dwordx2 s[34:35], s[0:1], 40
  v_lshrrev_b32 v1, 6, v0
  v_and_b32 v2, 63, v0
  v_and_b32 v3, 15, v2
  v_lshrrev_b32 v4, 4, v2
  s_nop 0
  v_readfirstlane_b32 s21, v1
  s_mov_b32 s24, 26624
  s_mov_b32 s25, 53248
  s_mov_b32 s26, 79872
  s_mov_b32 s27, 0xffff0000
  s_mov_b32 s22, 4096
  s_mul_i32 s36, s2, 106496
  s_mul_i32 s20, s21, 1038336
  v_lshlrev_b32 v208, 4, v2
  v_xor_b32 v228, v4, v3
  v_lshlrev_b32 v228, 4, v228
  v_lshl_add_u32 v228, v3, 8, v228
  v_xor_b32 v209, 0, v228
  v_add_u32 v213, 0x10000, v209
  v_lshl_add_u32 v217, v1, 14, v209
  v_xor_b32 v210, 64, v228
  v_add_u32 v214, 0x10000, v210
  v_lshl_add_u32 v218, v1, 14, v210
  v_xor_b32 v211, 128, v228
  v_add_u32 v215, 0x10000, v211
  v_lshl_add_u32 v219, v1, 14, v211
  v_xor_b32 v212, 192, v228
  v_add_u32 v216, 0x10000, v212
  v_lshl_add_u32 v220, v1, 14, v212
  v_and_b32 v230, 1, v1
  v_lshlrev_b32 v230, 7, v230
  v_xor_b32 v230, v230, v228
  v_lshrrev_b32 v231, 1, v1
  v_add_u32 v231, 4, v231
  v_lshl_add_u32 v221, v231, 14, v230
  v_xor_b32 v222, 64, v221
  v_lshrrev_b32 v230, 1, v4
  v_lshl_add_u32 v230, v1, 1, v230
  v_xor_b32 v230, v230, v3
  v_lshlrev_b32 v230, 4, v230
  v_lshl_add_u32 v230, v3, 8, v230
  v_and_b32 v231, 1, v4
  v_lshl_add_u32 v230, v231, 3, v230
  v_add_u32 v223, 98304, v230
  v_mul_u32_u24 v230, 1664, v3
  v_lshl_add_u32 v231, v4, 4, v230
  v_mul_u32_u24 v224, 384, v1
  v_add_u32 v224, v224, v231
  v_lshl_add_u32 v231, v4, 3, v230
  v_lshl_add_u32 v231, v1, 5, v231
  v_add_u32 v225, 1536, v231
  v_mul_u32_u24 v230, 768, v1
  v_lshl_add_u32 v230, v4, 5, v230
  v_add_u32 v226, 114688, v230
  v_lshlrev_b32 v230, 6, v1
  v_lshl_add_u32 v230, v4, 4, v230
  v_add_u32 v227, 117760, v230
  v_lshrrev_b32 v232, 4, v0
  v_and_b32 v233, 15, v0
  v_mul_u32_u24 v230, 1664, v232
  v_lshl_add_u32 v234, v233, 4, v230
  v_add_u32 v235, 256, v234
  v_add_u32 v231, 512, v234
  v_cmp_gt_u32 vcc, 8, v233
  s_nop 1
  v_cndmask_b32 v235, v231, v235, vcc
  v_add_u32 v236, 1536, v234
  v_xor_b32 v230, v233, v232
  v_lshlrev_b32 v230, 4, v230
  v_lshl_add_u32 v237, v232, 8, v230
  v_add_u32 v238, 0x10000, v237
  v_lshlrev_b32 v239, 2, v0
  v_lshlrev_b32 v240, 3, v0
  v_add_u32 v240, 114688, v240
  s_waitcnt lgkmcnt(0)

  s_add_u32 s4, s28, s36
  s_addc_u32 s5, s29, 0
  s_and_b32 s5, s5, 0xffff
  s_mov_b32 s6, 106496
  s_mov_b32 s7, 0x00020000
  s_mov_b32 s8, s34
  s_and_b32 s9, s35, 0xffff
  s_mov_b32 s10, 4153344
  s_mov_b32 s11, 0x00020000
  s_add_u32 s12, s32, s36
  s_addc_u32 s13, s33, 0
  s_and_b32 s13, s13, 0xffff
  s_mov_b32 s14, 106496
  s_mov_b32 s15, 0x00020000
  s_mov_b32 s16, s30
  s_and_b32 s17, s31, 0xffff
  s_mov_b32 s18, 4992
  s_mov_b32 s19, 0x00020000
  buffer_load_dword v241, v239, s[16:19], 0 offen
  buffer_load_dword v242, v239, s[16:19], 0 offen offset:1024
  buffer_load_dword v243, v239, s[16:19], 0 offen offset:2048
  buffer_load_dword v244, v239, s[16:19], 0 offen offset:3072
  buffer_load_dword v245, v239, s[16:19], s22 offen
  buffer_load_dwordx4 a[240:243], v234, s[4:7], 0 offen nt
  buffer_load_dwordx4 a[244:247], v234, s[4:7], s24 offen nt
  buffer_load_dwordx4 a[248:251], v234, s[4:7], s25 offen nt
  buffer_load_dwordx4 a[252:255], v234, s[4:7], s26 offen nt
  buffer_load_dwordx4 a[0:3], v208, s[8:11], s20 offen
  buffer_load_dwordx4 a[4:7], v208, s[8:11], s20 offen offset:1024
  buffer_load_dwordx4 a[8:11], v208, s[8:11], s20 offen offset:2048
  buffer_load_dwordx4 a[12:15], v208, s[8:11], s20 offen offset:3072
  s_add_u32 s20, s20, 4096
  buffer_load_dwordx4 a[16:19], v208, s[8:11], s20 offen
  buffer_load_dwordx4 a[20:23], v208, s[8:11], s20 offen offset:1024
  buffer_load_dwordx4 a[24:27], v208, s[8:11], s20 offen offset:2048
  buffer_load_dwordx4 a[28:31], v208, s[8:11], s20 offen offset:3072
  s_add_u32 s20, s20, 4096
  buffer_load_dwordx4 a[32:35], v208, s[8:11], s20 offen
  buffer_load_dwordx4 a[36:39], v208, s[8:11], s20 offen offset:1024
  buffer_load_dwordx4 a[40:43], v208, s[8:11], s20 offen offset:2048
  buffer_load_dwordx4 a[44:47], v208, s[8:11], s20 offen offset:3072
  s_add_u32 s20, s20, 4096
  buffer_load_dwordx4 a[48:51], v208, s[8:11], s20 offen
  buffer_load_dwordx4 a[52:55], v208, s[8:11], s20 offen offset:1024
  buffer_load_dwordx4 a[56:59], v208, s[8:11], s20 offen offset:2048
  buffer_load_dwordx4 a[60:63], v208, s[8:11], s20 offen offset:3072
  s_add_u32 s20, s20, 4096
  buffer_load_dwordx4 a[64:67], v208, s[8:11], s20 offen
  buffer_load_dwordx4 a[68:71], v208, s[8:11], s20 offen offset:1024
  buffer_load_dwordx4 a[72:75], v208, s[8:11], s20 offen offset:2048
  buffer_load_dwordx4 a[76:79], v208, s[8:11], s20 offen offset:3072
  s_add_u32 s20, s20, 4096
  buffer_load_dwordx4 a[80:83], v208, s[8:11], s20 offen
  buffer_load_dwordx4 a[84:87], v208, s[8:11], s20 offen offset:1024
  buffer_load_dwordx4 a[88:91], v208, s[8:11], s20 offen offset:2048
  buffer_load_dwordx4 a[92:95], v208, s[8:11], s20 offen offset:3072
  s_add_u32 s20, s20, 4096
  buffer_load_dwordx4 a[96:99], v208, s[8:11], s20 offen
  buffer_load_dwordx4 a[100:103], v208, s[8:11], s20 offen offset:1024
  buffer_load_dwordx4 a[136:139], v208, s[8:11], s20 offen offset:2048
  buffer_load_dwordx4 a[140:143], v208, s[8:11], s20 offen offset:3072
  buffer_load_dwordx4 v[128:131], v234, s[4:7], 0 offen offset:384 nt
  buffer_load_dwordx4 v[132:135], v234, s[4:7], s24 offen offset:384 nt
  buffer_load_dwordx4 v[136:139], v234, s[4:7], s25 offen offset:384 nt
  buffer_load_dwordx4 v[140:143], v234, s[4:7], s26 offen offset:384 nt
  buffer_load_dwordx4 v[144:147], v234, s[4:7], 0 offen offset:768 nt
  buffer_load_dwordx4 v[148:151], v234, s[4:7], s24 offen offset:768 nt
  buffer_load_dwordx4 v[152:155], v234, s[4:7], s25 offen offset:768 nt
  buffer_load_dwordx4 v[156:159], v234, s[4:7], s26 offen offset:768 nt
  buffer_load_dwordx4 v[160:163], v234, s[4:7], 0 offen offset:1152 nt
  buffer_load_dwordx4 v[164:167], v234, s[4:7], s24 offen offset:1152 nt
  buffer_load_dwordx4 v[168:171], v234, s[4:7], s25 offen offset:1152 nt
  buffer_load_dwordx4 v[172:175], v234, s[4:7], s26 offen offset:1152 nt
  buffer_load_dwordx4 v[176:179], v235, s[4:7], 0 offen nt
  buffer_load_dwordx4 v[180:183], v235, s[4:7], s24 offen nt
  buffer_load_dwordx4 v[184:187], v235, s[4:7], s25 offen nt
  buffer_load_dwordx4 v[188:191], v235, s[4:7], s26 offen nt
  buffer_load_dwordx4 v[192:195], v235, s[4:7], 0 offen offset:768 nt
  buffer_load_dwordx4 v[196:199], v235, s[4:7], s24 offen offset:768 nt
  buffer_load_dwordx4 v[200:203], v235, s[4:7], s25 offen offset:768 nt
  buffer_load_dwordx4 v[204:207], v235, s[4:7], s26 offen offset:768 nt
  buffer_load_dwordx4 a[224:227], v236, s[4:7], 0 offen nt
  buffer_load_dwordx4 a[228:231], v236, s[4:7], s24 offen nt
  buffer_load_dwordx4 a[232:235], v236, s[4:7], s25 offen nt
  buffer_load_dwordx4 a[236:239], v236, s[4:7], s26 offen nt
  s_waitcnt vmcnt(55)
  ds_write_b128 v237, a[240:243]
  s_waitcnt vmcnt(54)
  ds_write_b128 v237, a[244:247] offset:4096
  s_waitcnt vmcnt(53)
  ds_write_b128 v237, a[248:251] offset:8192
  s_waitcnt vmcnt(52)
  ds_write_b128 v237, a[252:255] offset:12288
  v_lshlrev_b32 v228, 16, v241
  v_and_b32 v229, s27, v241
  ds_write_b64 v240, v[228:229]
  v_lshlrev_b32 v228, 16, v242
  v_and_b32 v229, s27, v242
  ds_write_b64 v240, v[228:229] offset:2048
  v_lshlrev_b32 v228, 16, v243
  v_and_b32 v229, s27, v243
  ds_write_b64 v240, v[228:229] offset:4096
  v_lshlrev_b32 v228, 16, v244
  v_and_b32 v229, s27, v244
  ds_write_b64 v240, v[228:229] offset:6144
  v_lshlrev_b32 v228, 16, v245
  v_and_b32 v229, s27, v245
  ds_write_b64 v240, v[228:229] offset:8192
  s_waitcnt lgkmcnt(0)
  s_barrier
  ds_read_b128 v[20:23], v226
  ds_read_b128 v[16:19], v226 offset:16
  ds_read_b128 v[52:55], v226 offset:128
  ds_read_b128 v[48:51], v226 offset:144
  ds_read_b128 v[84:87], v226 offset:256
  ds_read_b128 v[80:83], v226 offset:272
  ds_read_b128 v[116:119], v226 offset:384
  ds_read_b128 v[112:115], v226 offset:400
  ds_read_b128 a[104:107], v209
  ds_read_b128 a[108:111], v209 offset:4096
  ds_read_b128 a[112:115], v209 offset:8192
  ds_read_b128 a[116:119], v209 offset:12288
  s_waitcnt vmcnt(50) lgkmcnt(0)
  v_mfma_f32_16x16x32_bf16 v[12:15], a[0:3], a[116:119], v[20:23]
  v_mfma_f32_16x16x32_bf16 v[8:11], a[0:3], a[112:115], v[20:23]
  v_mfma_f32_16x16x32_bf16 v[4:7], a[0:3], a[108:111], v[20:23]
  v_mfma_f32_16x16x32_bf16 v[0:3], a[0:3], a[104:107], v[20:23]
  v_mfma_f32_16x16x32_bf16 v[28:31], a[4:7], a[116:119], v[16:19]
  s_add_u32 s20, s20, 4096
  buffer_load_dwordx4 a[144:147], v208, s[8:11], s20 offen
  buffer_load_dwordx4 a[148:151], v208, s[8:11], s20 offen offset:1024
  v_mfma_f32_16x16x32_bf16 v[24:27], a[4:7], a[112:115], v[16:19]
  ds_read_b128 a[120:123], v210
  v_mfma_f32_16x16x32_bf16 v[20:23], a[4:7], a[108:111], v[16:19]
  v_mfma_f32_16x16x32_bf16 v[16:19], a[4:7], a[104:107], v[16:19]
  s_waitcnt vmcnt(50)
  v_mfma_f32_16x16x32_bf16 v[44:47], a[8:11], a[116:119], v[52:55]
  buffer_load_dwordx4 a[152:155], v208, s[8:11], s20 offen offset:2048
  buffer_load_dwordx4 a[156:159], v208, s[8:11], s20 offen offset:3072
  v_mfma_f32_16x16x32_bf16 v[40:43], a[8:11], a[112:115], v[52:55]
  ds_read_b128 a[124:127], v210 offset:4096
  v_mfma_f32_16x16x32_bf16 v[36:39], a[8:11], a[108:111], v[52:55]
  v_mfma_f32_16x16x32_bf16 v[32:35], a[8:11], a[104:107], v[52:55]
  v_mfma_f32_16x16x32_bf16 v[60:63], a[12:15], a[116:119], v[48:51]
  s_add_u32 s20, s20, 4096
  buffer_load_dwordx4 a[160:163], v208, s[8:11], s20 offen
  buffer_load_dwordx4 a[164:167], v208, s[8:11], s20 offen offset:1024
  v_mfma_f32_16x16x32_bf16 v[56:59], a[12:15], a[112:115], v[48:51]
  ds_read_b128 a[128:131], v210 offset:8192
  v_mfma_f32_16x16x32_bf16 v[52:55], a[12:15], a[108:111], v[48:51]
  v_mfma_f32_16x16x32_bf16 v[48:51], a[12:15], a[104:107], v[48:51]
  s_waitcnt vmcnt(52)
  v_mfma_f32_16x16x32_bf16 v[76:79], a[16:19], a[116:119], v[84:87]
  buffer_load_dwordx4 a[168:171], v208, s[8:11], s20 offen offset:2048
  buffer_load_dwordx4 a[172:175], v208, s[8:11], s20 offen offset:3072
  v_mfma_f32_16x16x32_bf16 v[72:75], a[16:19], a[112:115], v[84:87]
  ds_read_b128 a[132:135], v210 offset:12288
  v_mfma_f32_16x16x32_bf16 v[68:71], a[16:19], a[108:111], v[84:87]
  v_mfma_f32_16x16x32_bf16 v[64:67], a[16:19], a[104:107], v[84:87]
  v_mfma_f32_16x16x32_bf16 v[92:95], a[20:23], a[116:119], v[80:83]
  s_add_u32 s20, s20, 4096
  buffer_load_dwordx4 a[176:179], v208, s[8:11], s20 offen
  buffer_load_dwordx4 a[180:183], v208, s[8:11], s20 offen offset:1024
  v_mfma_f32_16x16x32_bf16 v[88:91], a[20:23], a[112:115], v[80:83]
  v_mfma_f32_16x16x32_bf16 v[84:87], a[20:23], a[108:111], v[80:83]
  v_mfma_f32_16x16x32_bf16 v[80:83], a[20:23], a[104:107], v[80:83]
  s_waitcnt vmcnt(54)
  v_mfma_f32_16x16x32_bf16 v[108:111], a[24:27], a[116:119], v[116:119]
  buffer_load_dwordx4 a[184:187], v208, s[8:11], s20 offen offset:2048
  buffer_load_dwordx4 a[188:191], v208, s[8:11], s20 offen offset:3072
  v_mfma_f32_16x16x32_bf16 v[104:107], a[24:27], a[112:115], v[116:119]
  v_mfma_f32_16x16x32_bf16 v[100:103], a[24:27], a[108:111], v[116:119]
  v_mfma_f32_16x16x32_bf16 v[96:99], a[24:27], a[104:107], v[116:119]
  v_mfma_f32_16x16x32_bf16 v[124:127], a[28:31], a[116:119], v[112:115]
  s_add_u32 s20, s20, 4096
  buffer_load_dwordx4 a[192:195], v208, s[8:11], s20 offen
  buffer_load_dwordx4 a[196:199], v208, s[8:11], s20 offen offset:1024
  v_mfma_f32_16x16x32_bf16 v[120:123], a[28:31], a[112:115], v[112:115]
  v_mfma_f32_16x16x32_bf16 v[116:119], a[28:31], a[108:111], v[112:115]
  v_mfma_f32_16x16x32_bf16 v[112:115], a[28:31], a[104:107], v[112:115]
  s_waitcnt vmcnt(56) lgkmcnt(0)
  v_mfma_f32_16x16x32_bf16 v[0:3], a[32:35], a[120:123], v[0:3]
  buffer_load_dwordx4 a[200:203], v208, s[8:11], s20 offen offset:2048
  buffer_load_dwordx4 a[204:207], v208, s[8:11], s20 offen offset:3072
  v_mfma_f32_16x16x32_bf16 v[4:7], a[32:35], a[124:127], v[4:7]
  v_mfma_f32_16x16x32_bf16 v[8:11], a[32:35], a[128:131], v[8:11]
  v_mfma_f32_16x16x32_bf16 v[12:15], a[32:35], a[132:135], v[12:15]
  v_mfma_f32_16x16x32_bf16 v[16:19], a[36:39], a[120:123], v[16:19]
  s_add_u32 s20, s20, 4096
  buffer_load_dwordx4 a[208:211], v208, s[8:11], s20 offen
  buffer_load_dwordx4 a[212:215], v208, s[8:11], s20 offen offset:1024
  v_mfma_f32_16x16x32_bf16 v[20:23], a[36:39], a[124:127], v[20:23]
  ds_read_b128 a[104:107], v211
  v_mfma_f32_16x16x32_bf16 v[24:27], a[36:39], a[128:131], v[24:27]
  v_mfma_f32_16x16x32_bf16 v[28:31], a[36:39], a[132:135], v[28:31]
  s_waitcnt vmcnt(58)
  v_mfma_f32_16x16x32_bf16 v[32:35], a[40:43], a[120:123], v[32:35]
  buffer_load_dwordx4 a[216:219], v208, s[8:11], s20 offen offset:2048
  v_mfma_f32_16x16x32_bf16 v[36:39], a[40:43], a[124:127], v[36:39]
  ds_read_b128 a[108:111], v211 offset:4096
  v_mfma_f32_16x16x32_bf16 v[40:43], a[40:43], a[128:131], v[40:43]
  v_mfma_f32_16x16x32_bf16 v[44:47], a[40:43], a[132:135], v[44:47]
  v_mfma_f32_16x16x32_bf16 v[48:51], a[44:47], a[120:123], v[48:51]
  buffer_load_dwordx4 a[220:223], v208, s[8:11], s20 offen offset:3072
  s_add_u32 s20, s20, 4096
  buffer_load_dwordx4 a[0:3], v208, s[8:11], s20 offen
  v_mfma_f32_16x16x32_bf16 v[52:55], a[44:47], a[124:127], v[52:55]
  ds_read_b128 a[112:115], v211 offset:8192
  v_mfma_f32_16x16x32_bf16 v[56:59], a[44:47], a[128:131], v[56:59]
  v_mfma_f32_16x16x32_bf16 v[60:63], a[44:47], a[132:135], v[60:63]
  s_waitcnt vmcnt(59)
  v_mfma_f32_16x16x32_bf16 v[64:67], a[48:51], a[120:123], v[64:67]
  v_mfma_f32_16x16x32_bf16 v[68:71], a[48:51], a[124:127], v[68:71]
  ds_read_b128 a[116:119], v211 offset:12288
  v_mfma_f32_16x16x32_bf16 v[72:75], a[48:51], a[128:131], v[72:75]
  v_mfma_f32_16x16x32_bf16 v[76:79], a[48:51], a[132:135], v[76:79]
  v_mfma_f32_16x16x32_bf16 v[80:83], a[52:55], a[120:123], v[80:83]
  buffer_load_dwordx4 a[4:7], v208, s[8:11], s20 offen offset:1024
  buffer_load_dwordx4 a[8:11], v208, s[8:11], s20 offen offset:2048
  v_mfma_f32_16x16x32_bf16 v[84:87], a[52:55], a[124:127], v[84:87]
  v_mfma_f32_16x16x32_bf16 v[88:91], a[52:55], a[128:131], v[88:91]
  v_mfma_f32_16x16x32_bf16 v[92:95], a[52:55], a[132:135], v[92:95]
  s_waitcnt vmcnt(59)
  v_mfma_f32_16x16x32_bf16 v[96:99], a[56:59], a[120:123], v[96:99]
  v_mfma_f32_16x16x32_bf16 v[100:103], a[56:59], a[124:127], v[100:103]
  v_mfma_f32_16x16x32_bf16 v[104:107], a[56:59], a[128:131], v[104:107]
  v_mfma_f32_16x16x32_bf16 v[108:111], a[56:59], a[132:135], v[108:111]
  v_mfma_f32_16x16x32_bf16 v[112:115], a[60:63], a[120:123], v[112:115]
  buffer_load_dwordx4 a[12:15], v208, s[8:11], s20 offen offset:3072
  s_add_u32 s20, s20, 4096
  buffer_load_dwordx4 a[16:19], v208, s[8:11], s20 offen
  v_mfma_f32_16x16x32_bf16 v[116:119], a[60:63], a[124:127], v[116:119]
  v_mfma_f32_16x16x32_bf16 v[120:123], a[60:63], a[128:131], v[120:123]
  v_mfma_f32_16x16x32_bf16 v[124:127], a[60:63], a[132:135], v[124:127]
  s_waitcnt vmcnt(59) lgkmcnt(0)
  v_mfma_f32_16x16x32_bf16 v[0:3], a[64:67], a[104:107], v[0:3]
  v_mfma_f32_16x16x32_bf16 v[4:7], a[64:67], a[108:111], v[4:7]
  s_waitcnt vmcnt(48)
  ds_write_b128 v237, v[128:131] offset:16384
  v_mfma_f32_16x16x32_bf16 v[8:11], a[64:67], a[112:115], v[8:11]
  v_mfma_f32_16x16x32_bf16 v[12:15], a[64:67], a[116:119], v[12:15]
  v_mfma_f32_16x16x32_bf16 v[16:19], a[68:71], a[104:107], v[16:19]
  buffer_load_dwordx4 a[20:23], v208, s[8:11], s20 offen offset:1024
  buffer_load_dwordx4 a[24:27], v208, s[8:11], s20 offen offset:2048
  v_mfma_f32_16x16x32_bf16 v[20:23], a[68:71], a[108:111], v[20:23]
  ds_read_b128 a[120:123], v212
  s_waitcnt vmcnt(49)
  ds_write_b128 v237, v[132:135] offset:20480
  v_mfma_f32_16x16x32_bf16 v[24:27], a[68:71], a[112:115], v[24:27]
  v_mfma_f32_16x16x32_bf16 v[28:31], a[68:71], a[116:119], v[28:31]
  v_mfma_f32_16x16x32_bf16 v[32:35], a[72:75], a[104:107], v[32:35]
  v_mfma_f32_16x16x32_bf16 v[36:39], a[72:75], a[108:111], v[36:39]
  ds_read_b128 a[124:127], v212 offset:4096
  s_waitcnt vmcnt(48)
  ds_write_b128 v237, v[136:139] offset:24576
  v_mfma_f32_16x16x32_bf16 v[40:43], a[72:75], a[112:115], v[40:43]
  v_mfma_f32_16x16x32_bf16 v[44:47], a[72:75], a[116:119], v[44:47]
  v_mfma_f32_16x16x32_bf16 v[48:51], a[76:79], a[104:107], v[48:51]
  buffer_load_dwordx4 a[28:31], v208, s[8:11], s20 offen offset:3072
  s_add_u32 s20, s20, 4096
  buffer_load_dwordx4 a[32:35], v208, s[8:11], s20 offen
  v_mfma_f32_16x16x32_bf16 v[52:55], a[76:79], a[108:111], v[52:55]
  ds_read_b128 a[128:131], v212 offset:8192
  s_waitcnt vmcnt(49)
  ds_write_b128 v237, v[140:143] offset:28672
  v_mfma_f32_16x16x32_bf16 v[56:59], a[76:79], a[112:115], v[56:59]
  v_mfma_f32_16x16x32_bf16 v[60:63], a[76:79], a[116:119], v[60:63]
  v_mfma_f32_16x16x32_bf16 v[64:67], a[80:83], a[104:107], v[64:67]
  v_mfma_f32_16x16x32_bf16 v[68:71], a[80:83], a[108:111], v[68:71]
  ds_read_b128 a[132:135], v212 offset:12288
  v_mfma_f32_16x16x32_bf16 v[72:75], a[80:83], a[112:115], v[72:75]
  v_mfma_f32_16x16x32_bf16 v[76:79], a[80:83], a[116:119], v[76:79]
  v_mfma_f32_16x16x32_bf16 v[80:83], a[84:87], a[104:107], v[80:83]
  buffer_load_dwordx4 a[36:39], v208, s[8:11], s20 offen offset:1024
  buffer_load_dwordx4 a[40:43], v208, s[8:11], s20 offen offset:2048
  v_mfma_f32_16x16x32_bf16 v[84:87], a[84:87], a[108:111], v[84:87]
  v_mfma_f32_16x16x32_bf16 v[88:91], a[84:87], a[112:115], v[88:91]
  v_mfma_f32_16x16x32_bf16 v[92:95], a[84:87], a[116:119], v[92:95]
  v_mfma_f32_16x16x32_bf16 v[96:99], a[88:91], a[104:107], v[96:99]
  v_mfma_f32_16x16x32_bf16 v[100:103], a[88:91], a[108:111], v[100:103]
  v_mfma_f32_16x16x32_bf16 v[104:107], a[88:91], a[112:115], v[104:107]
  v_mfma_f32_16x16x32_bf16 v[108:111], a[88:91], a[116:119], v[108:111]
  v_mfma_f32_16x16x32_bf16 v[112:115], a[92:95], a[104:107], v[112:115]
  buffer_load_dwordx4 a[44:47], v208, s[8:11], s20 offen offset:3072
  s_add_u32 s20, s20, 4096
  buffer_load_dwordx4 a[48:51], v208, s[8:11], s20 offen
  v_mfma_f32_16x16x32_bf16 v[116:119], a[92:95], a[108:111], v[116:119]
  v_mfma_f32_16x16x32_bf16 v[120:123], a[92:95], a[112:115], v[120:123]
  v_mfma_f32_16x16x32_bf16 v[124:127], a[92:95], a[116:119], v[124:127]
  s_waitcnt lgkmcnt(0)
  s_barrier
  v_mfma_f32_16x16x32_bf16 v[0:3], a[96:99], a[120:123], v[0:3]
  v_mfma_f32_16x16x32_bf16 v[4:7], a[96:99], a[124:127], v[4:7]
  v_mfma_f32_16x16x32_bf16 v[8:11], a[96:99], a[128:131], v[8:11]
  v_mfma_f32_16x16x32_bf16 v[12:15], a[96:99], a[132:135], v[12:15]
  v_mfma_f32_16x16x32_bf16 v[16:19], a[100:103], a[120:123], v[16:19]
  buffer_load_dwordx4 a[52:55], v208, s[8:11], s20 offen offset:1024
  buffer_load_dwordx4 a[56:59], v208, s[8:11], s20 offen offset:2048
  v_mfma_f32_16x16x32_bf16 v[20:23], a[100:103], a[124:127], v[20:23]
  ds_read_b128 a[104:107], v209 offset:16384
  v_mfma_f32_16x16x32_bf16 v[24:27], a[100:103], a[128:131], v[24:27]
  v_mfma_f32_16x16x32_bf16 v[28:31], a[100:103], a[132:135], v[28:31]
  v_mfma_f32_16x16x32_bf16 v[32:35], a[136:139], a[120:123], v[32:35]
  v_mfma_f32_16x16x32_bf16 v[36:39], a[136:139], a[124:127], v[36:39]
  ds_read_b128 a[108:111], v209 offset:20480
  v_mfma_f32_16x16x32_bf16 v[40:43], a[136:139], a[128:131], v[40:43]
  v_mfma_f32_16x16x32_bf16 v[44:47], a[136:139], a[132:135], v[44:47]
  v_mfma_f32_16x16x32_bf16 v[48:51], a[140:143], a[120:123], v[48:51]
  buffer_load_dwordx4 a[60:63], v208, s[8:11], s20 offen offset:3072
  s_add_u32 s20, s20, 4096
  buffer_load_dwordx4 a[64:67], v208, s[8:11], s20 offen
  v_mfma_f32_16x16x32_bf16 v[52:55], a[140:143], a[124:127], v[52:55]
  ds_read_b128 a[112:115], v209 offset:24576
  v_mfma_f32_16x16x32_bf16 v[56:59], a[140:143], a[128:131], v[56:59]
  v_mfma_f32_16x16x32_bf16 v[60:63], a[140:143], a[132:135], v[60:63]
  s_waitcnt vmcnt(35)
  v_mfma_f32_16x16x32_bf16 v[64:67], a[144:147], a[120:123], v[64:67]
  v_mfma_f32_16x16x32_bf16 v[68:71], a[144:147], a[124:127], v[68:71]
  ds_read_b128 a[116:119], v209 offset:28672
  v_mfma_f32_16x16x32_bf16 v[72:75], a[144:147], a[128:131], v[72:75]
  v_mfma_f32_16x16x32_bf16 v[76:79], a[144:147], a[132:135], v[76:79]
  v_mfma_f32_16x16x32_bf16 v[80:83], a[148:151], a[120:123], v[80:83]
  buffer_load_dwordx4 a[68:71], v208, s[8:11], s20 offen offset:1024
  buffer_load_dwordx4 a[72:75], v208, s[8:11], s20 offen offset:2048
  v_mfma_f32_16x16x32_bf16 v[84:87], a[148:151], a[124:127], v[84:87]
  v_mfma_f32_16x16x32_bf16 v[88:91], a[148:151], a[128:131], v[88:91]
  v_mfma_f32_16x16x32_bf16 v[92:95], a[148:151], a[132:135], v[92:95]
  s_waitcnt vmcnt(35)
  v_mfma_f32_16x16x32_bf16 v[96:99], a[152:155], a[120:123], v[96:99]
  buffer_load_dwordx4 a[76:79], v208, s[8:11], s20 offen offset:3072
  s_add_u32 s20, s20, 4096
  buffer_load_dwordx4 a[80:83], v208, s[8:11], s20 offen
  v_mfma_f32_16x16x32_bf16 v[100:103], a[152:155], a[124:127], v[100:103]
  v_mfma_f32_16x16x32_bf16 v[104:107], a[152:155], a[128:131], v[104:107]
  v_mfma_f32_16x16x32_bf16 v[108:111], a[152:155], a[132:135], v[108:111]
  v_mfma_f32_16x16x32_bf16 v[112:115], a[156:159], a[120:123], v[112:115]
  buffer_load_dwordx4 a[84:87], v208, s[8:11], s20 offen offset:1024
  buffer_load_dwordx4 a[88:91], v208, s[8:11], s20 offen offset:2048
  v_mfma_f32_16x16x32_bf16 v[116:119], a[156:159], a[124:127], v[116:119]
  v_mfma_f32_16x16x32_bf16 v[120:123], a[156:159], a[128:131], v[120:123]
  v_mfma_f32_16x16x32_bf16 v[124:127], a[156:159], a[132:135], v[124:127]
  s_waitcnt vmcnt(37) lgkmcnt(0)
  v_mfma_f32_16x16x32_bf16 v[0:3], a[160:163], a[104:107], v[0:3]
  buffer_load_dwordx4 a[92:95], v208, s[8:11], s20 offen offset:3072
  s_add_u32 s20, s20, 4096
  buffer_load_dwordx4 a[96:99], v208, s[8:11], s20 offen
  v_mfma_f32_16x16x32_bf16 v[4:7], a[160:163], a[108:111], v[4:7]
  v_mfma_f32_16x16x32_bf16 v[8:11], a[160:163], a[112:115], v[8:11]
  v_mfma_f32_16x16x32_bf16 v[12:15], a[160:163], a[116:119], v[12:15]
  v_mfma_f32_16x16x32_bf16 v[16:19], a[164:167], a[104:107], v[16:19]
  buffer_load_dwordx4 a[100:103], v208, s[8:11], s20 offen offset:1024
  buffer_load_dwordx4 a[136:139], v208, s[8:11], s20 offen offset:2048
  v_mfma_f32_16x16x32_bf16 v[20:23], a[164:167], a[108:111], v[20:23]
  ds_read_b128 a[120:123], v210 offset:16384
  v_mfma_f32_16x16x32_bf16 v[24:27], a[164:167], a[112:115], v[24:27]
  v_mfma_f32_16x16x32_bf16 v[28:31], a[164:167], a[116:119], v[28:31]
  s_waitcnt vmcnt(39)
  v_mfma_f32_16x16x32_bf16 v[32:35], a[168:171], a[104:107], v[32:35]
  buffer_load_dwordx4 a[140:143], v208, s[8:11], s20 offen offset:3072
  s_add_u32 s20, s20, 4096
  buffer_load_dwordx4 a[144:147], v208, s[8:11], s20 offen
  v_mfma_f32_16x16x32_bf16 v[36:39], a[168:171], a[108:111], v[36:39]
  ds_read_b128 a[124:127], v210 offset:20480
  v_mfma_f32_16x16x32_bf16 v[40:43], a[168:171], a[112:115], v[40:43]
  v_mfma_f32_16x16x32_bf16 v[44:47], a[168:171], a[116:119], v[44:47]
  v_mfma_f32_16x16x32_bf16 v[48:51], a[172:175], a[104:107], v[48:51]
  buffer_load_dwordx4 a[148:151], v208, s[8:11], s20 offen offset:1024
  buffer_load_dwordx4 a[152:155], v208, s[8:11], s20 offen offset:2048
  v_mfma_f32_16x16x32_bf16 v[52:55], a[172:175], a[108:111], v[52:55]
  ds_read_b128 a[128:131], v210 offset:24576
  v_mfma_f32_16x16x32_bf16 v[56:59], a[172:175], a[112:115], v[56:59]
  v_mfma_f32_16x16x32_bf16 v[60:63], a[172:175], a[116:119], v[60:63]
  s_waitcnt vmcnt(41)
  v_mfma_f32_16x16x32_bf16 v[64:67], a[176:179], a[104:107], v[64:67]
  buffer_load_dwordx4 a[156:159], v208, s[8:11], s20 offen offset:3072
  s_add_u32 s20, s20, 4096
  buffer_load_dwordx4 a[160:163], v208, s[8:11], s20 offen
  v_mfma_f32_16x16x32_bf16 v[68:71], a[176:179], a[108:111], v[68:71]
  ds_read_b128 a[132:135], v210 offset:28672
  v_mfma_f32_16x16x32_bf16 v[72:75], a[176:179], a[112:115], v[72:75]
  v_mfma_f32_16x16x32_bf16 v[76:79], a[176:179], a[116:119], v[76:79]
  v_mfma_f32_16x16x32_bf16 v[80:83], a[180:183], a[104:107], v[80:83]
  buffer_load_dwordx4 a[164:167], v208, s[8:11], s20 offen offset:1024
  buffer_load_dwordx4 a[168:171], v208, s[8:11], s20 offen offset:2048
  v_mfma_f32_16x16x32_bf16 v[84:87], a[180:183], a[108:111], v[84:87]
  v_mfma_f32_16x16x32_bf16 v[88:91], a[180:183], a[112:115], v[88:91]
  v_mfma_f32_16x16x32_bf16 v[92:95], a[180:183], a[116:119], v[92:95]
  s_waitcnt vmcnt(43)
  v_mfma_f32_16x16x32_bf16 v[96:99], a[184:187], a[104:107], v[96:99]
  buffer_load_dwordx4 a[172:175], v208, s[8:11], s20 offen offset:3072
  s_add_u32 s20, s20, 4096
  buffer_load_dwordx4 a[176:179], v208, s[8:11], s20 offen
  v_mfma_f32_16x16x32_bf16 v[100:103], a[184:187], a[108:111], v[100:103]
  v_mfma_f32_16x16x32_bf16 v[104:107], a[184:187], a[112:115], v[104:107]
  v_mfma_f32_16x16x32_bf16 v[108:111], a[184:187], a[116:119], v[108:111]
  v_mfma_f32_16x16x32_bf16 v[112:115], a[188:191], a[104:107], v[112:115]
  buffer_load_dwordx4 a[180:183], v208, s[8:11], s20 offen offset:1024
  buffer_load_dwordx4 a[184:187], v208, s[8:11], s20 offen offset:2048
  v_mfma_f32_16x16x32_bf16 v[116:119], a[188:191], a[108:111], v[116:119]
  v_mfma_f32_16x16x32_bf16 v[120:123], a[188:191], a[112:115], v[120:123]
  v_mfma_f32_16x16x32_bf16 v[124:127], a[188:191], a[116:119], v[124:127]
  s_waitcnt vmcnt(45) lgkmcnt(0)
  v_mfma_f32_16x16x32_bf16 v[0:3], a[192:195], a[120:123], v[0:3]
  buffer_load_dwordx4 a[188:191], v208, s[8:11], s20 offen offset:3072
  v_mfma_f32_16x16x32_bf16 v[4:7], a[192:195], a[124:127], v[4:7]
  v_mfma_f32_16x16x32_bf16 v[8:11], a[192:195], a[128:131], v[8:11]
  v_mfma_f32_16x16x32_bf16 v[12:15], a[192:195], a[132:135], v[12:15]
  v_mfma_f32_16x16x32_bf16 v[16:19], a[196:199], a[120:123], v[16:19]
  s_add_u32 s20, s20, 4096
  buffer_load_dwordx4 a[192:195], v208, s[8:11], s20 offen
  v_mfma_f32_16x16x32_bf16 v[20:23], a[196:199], a[124:127], v[20:23]
  ds_read_b128 a[104:107], v211 offset:16384
  v_mfma_f32_16x16x32_bf16 v[24:27], a[196:199], a[128:131], v[24:27]
  v_mfma_f32_16x16x32_bf16 v[28:31], a[196:199], a[132:135], v[28:31]
  s_waitcnt vmcnt(45)
  v_mfma_f32_16x16x32_bf16 v[32:35], a[200:203], a[120:123], v[32:35]
  buffer_load_dwordx4 a[196:199], v208, s[8:11], s20 offen offset:1024
  v_mfma_f32_16x16x32_bf16 v[36:39], a[200:203], a[124:127], v[36:39]
  ds_read_b128 a[108:111], v211 offset:20480
  v_mfma_f32_16x16x32_bf16 v[40:43], a[200:203], a[128:131], v[40:43]
  v_mfma_f32_16x16x32_bf16 v[44:47], a[200:203], a[132:135], v[44:47]
  v_mfma_f32_16x16x32_bf16 v[48:51], a[204:207], a[120:123], v[48:51]
  buffer_load_dwordx4 a[200:203], v208, s[8:11], s20 offen offset:2048
  v_mfma_f32_16x16x32_bf16 v[52:55], a[204:207], a[124:127], v[52:55]
  ds_read_b128 a[112:115], v211 offset:24576
  v_mfma_f32_16x16x32_bf16 v[56:59], a[204:207], a[128:131], v[56:59]
  v_mfma_f32_16x16x32_bf16 v[60:63], a[204:207], a[132:135], v[60:63]
  s_waitcnt vmcnt(45)
  v_mfma_f32_16x16x32_bf16 v[64:67], a[208:211], a[120:123], v[64:67]
  buffer_load_dwordx4 a[204:207], v208, s[8:11], s20 offen offset:3072
  v_mfma_f32_16x16x32_bf16 v[68:71], a[208:211], a[124:127], v[68:71]
  ds_read_b128 a[116:119], v211 offset:28672
  v_mfma_f32_16x16x32_bf16 v[72:75], a[208:211], a[128:131], v[72:75]
  v_mfma_f32_16x16x32_bf16 v[76:79], a[208:211], a[132:135], v[76:79]
  v_mfma_f32_16x16x32_bf16 v[80:83], a[212:215], a[120:123], v[80:83]
  s_add_u32 s20, s20, 4096
  buffer_load_dwordx4 a[208:211], v208, s[8:11], s20 offen
  v_mfma_f32_16x16x32_bf16 v[84:87], a[212:215], a[124:127], v[84:87]
  v_mfma_f32_16x16x32_bf16 v[88:91], a[212:215], a[128:131], v[88:91]
  v_mfma_f32_16x16x32_bf16 v[92:95], a[212:215], a[132:135], v[92:95]
  s_waitcnt vmcnt(45)
  v_mfma_f32_16x16x32_bf16 v[96:99], a[216:219], a[120:123], v[96:99]
  buffer_load_dwordx4 a[212:215], v208, s[8:11], s20 offen offset:1024
  v_mfma_f32_16x16x32_bf16 v[100:103], a[216:219], a[124:127], v[100:103]
  v_mfma_f32_16x16x32_bf16 v[104:107], a[216:219], a[128:131], v[104:107]
  v_mfma_f32_16x16x32_bf16 v[108:111], a[216:219], a[132:135], v[108:111]
  v_mfma_f32_16x16x32_bf16 v[112:115], a[220:223], a[120:123], v[112:115]
  buffer_load_dwordx4 a[216:219], v208, s[8:11], s20 offen offset:2048
  v_mfma_f32_16x16x32_bf16 v[116:119], a[220:223], a[124:127], v[116:119]
  v_mfma_f32_16x16x32_bf16 v[120:123], a[220:223], a[128:131], v[120:123]
  v_mfma_f32_16x16x32_bf16 v[124:127], a[220:223], a[132:135], v[124:127]
  s_waitcnt vmcnt(45) lgkmcnt(0)
  v_mfma_f32_16x16x32_bf16 v[0:3], a[0:3], a[104:107], v[0:3]
  buffer_load_dwordx4 a[220:223], v208, s[8:11], s20 offen offset:3072
  v_mfma_f32_16x16x32_bf16 v[4:7], a[0:3], a[108:111], v[4:7]
  ds_write_b128 v237, v[144:147] offset:32768
  v_mfma_f32_16x16x32_bf16 v[8:11], a[0:3], a[112:115], v[8:11]
  v_mfma_f32_16x16x32_bf16 v[12:15], a[0:3], a[116:119], v[12:15]
  v_mfma_f32_16x16x32_bf16 v[16:19], a[4:7], a[104:107], v[16:19]
  s_add_u32 s20, s20, 4096
  buffer_load_dwordx4 a[0:3], v208, s[8:11], s20 offen
  v_mfma_f32_16x16x32_bf16 v[20:23], a[4:7], a[108:111], v[20:23]
  ds_read_b128 a[120:123], v212 offset:16384
  ds_write_b128 v237, v[148:151] offset:36864
  v_mfma_f32_16x16x32_bf16 v[24:27], a[4:7], a[112:115], v[24:27]
  v_mfma_f32_16x16x32_bf16 v[28:31], a[4:7], a[116:119], v[28:31]
  s_waitcnt vmcnt(45)
  v_mfma_f32_16x16x32_bf16 v[32:35], a[8:11], a[104:107], v[32:35]
  buffer_load_dwordx4 a[4:7], v208, s[8:11], s20 offen offset:1024
  v_mfma_f32_16x16x32_bf16 v[36:39], a[8:11], a[108:111], v[36:39]
  ds_read_b128 a[124:127], v212 offset:20480
  ds_write_b128 v237, v[152:155] offset:40960
  v_mfma_f32_16x16x32_bf16 v[40:43], a[8:11], a[112:115], v[40:43]
  v_mfma_f32_16x16x32_bf16 v[44:47], a[8:11], a[116:119], v[44:47]
  v_mfma_f32_16x16x32_bf16 v[48:51], a[12:15], a[104:107], v[48:51]
  buffer_load_dwordx4 a[8:11], v208, s[8:11], s20 offen offset:2048
  v_mfma_f32_16x16x32_bf16 v[52:55], a[12:15], a[108:111], v[52:55]
  ds_read_b128 a[128:131], v212 offset:24576
  ds_write_b128 v237, v[156:159] offset:45056
  v_mfma_f32_16x16x32_bf16 v[56:59], a[12:15], a[112:115], v[56:59]
  v_mfma_f32_16x16x32_bf16 v[60:63], a[12:15], a[116:119], v[60:63]
  s_waitcnt vmcnt(45)
  v_mfma_f32_16x16x32_bf16 v[64:67], a[16:19], a[104:107], v[64:67]
  buffer_load_dwordx4 a[12:15], v208, s[8:11], s20 offen offset:3072
  v_mfma_f32_16x16x32_bf16 v[68:71], a[16:19], a[108:111], v[68:71]
  ds_read_b128 a[132:135], v212 offset:28672
  v_mfma_f32_16x16x32_bf16 v[72:75], a[16:19], a[112:115], v[72:75]
  v_mfma_f32_16x16x32_bf16 v[76:79], a[16:19], a[116:119], v[76:79]
  v_mfma_f32_16x16x32_bf16 v[80:83], a[20:23], a[104:107], v[80:83]
  s_add_u32 s20, s20, 4096
  buffer_load_dwordx4 a[16:19], v208, s[8:11], s20 offen
  v_mfma_f32_16x16x32_bf16 v[84:87], a[20:23], a[108:111], v[84:87]
  v_mfma_f32_16x16x32_bf16 v[88:91], a[20:23], a[112:115], v[88:91]
  v_mfma_f32_16x16x32_bf16 v[92:95], a[20:23], a[116:119], v[92:95]
  s_waitcnt vmcnt(45)
  v_mfma_f32_16x16x32_bf16 v[96:99], a[24:27], a[104:107], v[96:99]
  buffer_load_dwordx4 a[20:23], v208, s[8:11], s20 offen offset:1024
  v_mfma_f32_16x16x32_bf16 v[100:103], a[24:27], a[108:111], v[100:103]
  v_mfma_f32_16x16x32_bf16 v[104:107], a[24:27], a[112:115], v[104:107]
  v_mfma_f32_16x16x32_bf16 v[108:111], a[24:27], a[116:119], v[108:111]
  v_mfma_f32_16x16x32_bf16 v[112:115], a[28:31], a[104:107], v[112:115]
  buffer_load_dwordx4 a[24:27], v208, s[8:11], s20 offen offset:2048
  v_mfma_f32_16x16x32_bf16 v[116:119], a[28:31], a[108:111], v[116:119]
  v_mfma_f32_16x16x32_bf16 v[120:123], a[28:31], a[112:115], v[120:123]
  v_mfma_f32_16x16x32_bf16 v[124:127], a[28:31], a[116:119], v[124:127]
  s_waitcnt lgkmcnt(0)
  s_barrier
  s_waitcnt vmcnt(45)
  v_mfma_f32_16x16x32_bf16 v[0:3], a[32:35], a[120:123], v[0:3]
  buffer_load_dwordx4 a[28:31], v208, s[8:11], s20 offen offset:3072
  v_mfma_f32_16x16x32_bf16 v[4:7], a[32:35], a[124:127], v[4:7]
  v_mfma_f32_16x16x32_bf16 v[8:11], a[32:35], a[128:131], v[8:11]
  v_mfma_f32_16x16x32_bf16 v[12:15], a[32:35], a[132:135], v[12:15]
  v_mfma_f32_16x16x32_bf16 v[16:19], a[36:39], a[120:123], v[16:19]
  s_add_u32 s20, s20, 4096
  buffer_load_dwordx4 a[32:35], v208, s[8:11], s20 offen
  v_mfma_f32_16x16x32_bf16 v[20:23], a[36:39], a[124:127], v[20:23]
  ds_read_b128 a[104:107], v209 offset:32768
  v_mfma_f32_16x16x32_bf16 v[24:27], a[36:39], a[128:131], v[24:27]
  v_mfma_f32_16x16x32_bf16 v[28:31], a[36:39], a[132:135], v[28:31]
  s_waitcnt vmcnt(45)
  v_mfma_f32_16x16x32_bf16 v[32:35], a[40:43], a[120:123], v[32:35]
  buffer_load_dwordx4 a[36:39], v208, s[8:11], s20 offen offset:1024
  v_mfma_f32_16x16x32_bf16 v[36:39], a[40:43], a[124:127], v[36:39]
  ds_read_b128 a[108:111], v209 offset:36864
  v_mfma_f32_16x16x32_bf16 v[40:43], a[40:43], a[128:131], v[40:43]
  v_mfma_f32_16x16x32_bf16 v[44:47], a[40:43], a[132:135], v[44:47]
  v_mfma_f32_16x16x32_bf16 v[48:51], a[44:47], a[120:123], v[48:51]
  buffer_load_dwordx4 a[40:43], v208, s[8:11], s20 offen offset:2048
  v_mfma_f32_16x16x32_bf16 v[52:55], a[44:47], a[124:127], v[52:55]
  ds_read_b128 a[112:115], v209 offset:40960
  v_mfma_f32_16x16x32_bf16 v[56:59], a[44:47], a[128:131], v[56:59]
  v_mfma_f32_16x16x32_bf16 v[60:63], a[44:47], a[132:135], v[60:63]
  s_waitcnt vmcnt(45)
  v_mfma_f32_16x16x32_bf16 v[64:67], a[48:51], a[120:123], v[64:67]
  buffer_load_dwordx4 a[44:47], v208, s[8:11], s20 offen offset:3072
  v_mfma_f32_16x16x32_bf16 v[68:71], a[48:51], a[124:127], v[68:71]
  ds_read_b128 a[116:119], v209 offset:45056
  v_mfma_f32_16x16x32_bf16 v[72:75], a[48:51], a[128:131], v[72:75]
  v_mfma_f32_16x16x32_bf16 v[76:79], a[48:51], a[132:135], v[76:79]
  v_mfma_f32_16x16x32_bf16 v[80:83], a[52:55], a[120:123], v[80:83]
  s_add_u32 s20, s20, 4096
  buffer_load_dwordx4 a[48:51], v208, s[8:11], s20 offen
  v_mfma_f32_16x16x32_bf16 v[84:87], a[52:55], a[124:127], v[84:87]
  v_mfma_f32_16x16x32_bf16 v[88:91], a[52:55], a[128:131], v[88:91]
  v_mfma_f32_16x16x32_bf16 v[92:95], a[52:55], a[132:135], v[92:95]
  s_waitcnt vmcnt(45)
  v_mfma_f32_16x16x32_bf16 v[96:99], a[56:59], a[120:123], v[96:99]
  buffer_load_dwordx4 a[52:55], v208, s[8:11], s20 offen offset:1024
  v_mfma_f32_16x16x32_bf16 v[100:103], a[56:59], a[124:127], v[100:103]
  v_mfma_f32_16x16x32_bf16 v[104:107], a[56:59], a[128:131], v[104:107]
  v_mfma_f32_16x16x32_bf16 v[108:111], a[56:59], a[132:135], v[108:111]
  v_mfma_f32_16x16x32_bf16 v[112:115], a[60:63], a[120:123], v[112:115]
  buffer_load_dwordx4 a[56:59], v208, s[8:11], s20 offen offset:2048
  v_mfma_f32_16x16x32_bf16 v[116:119], a[60:63], a[124:127], v[116:119]
  v_mfma_f32_16x16x32_bf16 v[120:123], a[60:63], a[128:131], v[120:123]
  v_mfma_f32_16x16x32_bf16 v[124:127], a[60:63], a[132:135], v[124:127]
  s_waitcnt vmcnt(45) lgkmcnt(0)
  v_mfma_f32_16x16x32_bf16 v[0:3], a[64:67], a[104:107], v[0:3]
  buffer_load_dwordx4 a[60:63], v208, s[8:11], s20 offen offset:3072
  v_mfma_f32_16x16x32_bf16 v[4:7], a[64:67], a[108:111], v[4:7]
  v_mfma_f32_16x16x32_bf16 v[8:11], a[64:67], a[112:115], v[8:11]
  v_mfma_f32_16x16x32_bf16 v[12:15], a[64:67], a[116:119], v[12:15]
  v_mfma_f32_16x16x32_bf16 v[16:19], a[68:71], a[104:107], v[16:19]
  s_add_u32 s20, s20, 4096
  buffer_load_dwordx4 a[64:67], v208, s[8:11], s20 offen
  v_mfma_f32_16x16x32_bf16 v[20:23], a[68:71], a[108:111], v[20:23]
  ds_read_b128 a[120:123], v210 offset:32768
  v_mfma_f32_16x16x32_bf16 v[24:27], a[68:71], a[112:115], v[24:27]
  v_mfma_f32_16x16x32_bf16 v[28:31], a[68:71], a[116:119], v[28:31]
  s_waitcnt vmcnt(45)
  v_mfma_f32_16x16x32_bf16 v[32:35], a[72:75], a[104:107], v[32:35]
  buffer_load_dwordx4 a[68:71], v208, s[8:11], s20 offen offset:1024
  v_mfma_f32_16x16x32_bf16 v[36:39], a[72:75], a[108:111], v[36:39]
  ds_read_b128 a[124:127], v210 offset:36864
  v_mfma_f32_16x16x32_bf16 v[40:43], a[72:75], a[112:115], v[40:43]
  v_mfma_f32_16x16x32_bf16 v[44:47], a[72:75], a[116:119], v[44:47]
  v_mfma_f32_16x16x32_bf16 v[48:51], a[76:79], a[104:107], v[48:51]
  buffer_load_dwordx4 a[72:75], v208, s[8:11], s20 offen offset:2048
  v_mfma_f32_16x16x32_bf16 v[52:55], a[76:79], a[108:111], v[52:55]
  ds_read_b128 a[128:131], v210 offset:40960
  v_mfma_f32_16x16x32_bf16 v[56:59], a[76:79], a[112:115], v[56:59]
  v_mfma_f32_16x16x32_bf16 v[60:63], a[76:79], a[116:119], v[60:63]
  s_waitcnt vmcnt(45)
  v_mfma_f32_16x16x32_bf16 v[64:67], a[80:83], a[104:107], v[64:67]
  buffer_load_dwordx4 a[76:79], v208, s[8:11], s20 offen offset:3072
  v_mfma_f32_16x16x32_bf16 v[68:71], a[80:83], a[108:111], v[68:71]
  ds_read_b128 a[132:135], v210 offset:45056
  v_mfma_f32_16x16x32_bf16 v[72:75], a[80:83], a[112:115], v[72:75]
  v_mfma_f32_16x16x32_bf16 v[76:79], a[80:83], a[116:119], v[76:79]
  v_mfma_f32_16x16x32_bf16 v[80:83], a[84:87], a[104:107], v[80:83]
  s_add_u32 s20, s20, 4096
  buffer_load_dwordx4 a[80:83], v208, s[8:11], s20 offen
  v_mfma_f32_16x16x32_bf16 v[84:87], a[84:87], a[108:111], v[84:87]
  v_mfma_f32_16x16x32_bf16 v[88:91], a[84:87], a[112:115], v[88:91]
  v_mfma_f32_16x16x32_bf16 v[92:95], a[84:87], a[116:119], v[92:95]
  s_waitcnt vmcnt(45)
  v_mfma_f32_16x16x32_bf16 v[96:99], a[88:91], a[104:107], v[96:99]
  buffer_load_dwordx4 a[84:87], v208, s[8:11], s20 offen offset:1024
  v_mfma_f32_16x16x32_bf16 v[100:103], a[88:91], a[108:111], v[100:103]
  v_mfma_f32_16x16x32_bf16 v[104:107], a[88:91], a[112:115], v[104:107]
  v_mfma_f32_16x16x32_bf16 v[108:111], a[88:91], a[116:119], v[108:111]
  v_mfma_f32_16x16x32_bf16 v[112:115], a[92:95], a[104:107], v[112:115]
  buffer_load_dwordx4 a[88:91], v208, s[8:11], s20 offen offset:2048
  v_mfma_f32_16x16x32_bf16 v[116:119], a[92:95], a[108:111], v[116:119]
  v_mfma_f32_16x16x32_bf16 v[120:123], a[92:95], a[112:115], v[120:123]
  v_mfma_f32_16x16x32_bf16 v[124:127], a[92:95], a[116:119], v[124:127]
  s_waitcnt vmcnt(45) lgkmcnt(0)
  v_mfma_f32_16x16x32_bf16 v[0:3], a[96:99], a[120:123], v[0:3]
  buffer_load_dwordx4 a[92:95], v208, s[8:11], s20 offen offset:3072
  v_mfma_f32_16x16x32_bf16 v[4:7], a[96:99], a[124:127], v[4:7]
  v_mfma_f32_16x16x32_bf16 v[8:11], a[96:99], a[128:131], v[8:11]
  v_mfma_f32_16x16x32_bf16 v[12:15], a[96:99], a[132:135], v[12:15]
  v_mfma_f32_16x16x32_bf16 v[16:19], a[100:103], a[120:123], v[16:19]
  s_add_u32 s20, s20, 4096
  buffer_load_dwordx4 a[96:99], v208, s[8:11], s20 offen
  v_mfma_f32_16x16x32_bf16 v[20:23], a[100:103], a[124:127], v[20:23]
  ds_read_b128 a[104:107], v211 offset:32768
  v_mfma_f32_16x16x32_bf16 v[24:27], a[100:103], a[128:131], v[24:27]
  v_mfma_f32_16x16x32_bf16 v[28:31], a[100:103], a[132:135], v[28:31]
  s_waitcnt vmcnt(45)
  v_mfma_f32_16x16x32_bf16 v[32:35], a[136:139], a[120:123], v[32:35]
  buffer_load_dwordx4 a[100:103], v208, s[8:11], s20 offen offset:1024
  v_mfma_f32_16x16x32_bf16 v[36:39], a[136:139], a[124:127], v[36:39]
  ds_read_b128 a[108:111], v211 offset:36864
  v_mfma_f32_16x16x32_bf16 v[40:43], a[136:139], a[128:131], v[40:43]
  v_mfma_f32_16x16x32_bf16 v[44:47], a[136:139], a[132:135], v[44:47]
  v_mfma_f32_16x16x32_bf16 v[48:51], a[140:143], a[120:123], v[48:51]
  buffer_load_dwordx4 a[136:139], v208, s[8:11], s20 offen offset:2048
  v_mfma_f32_16x16x32_bf16 v[52:55], a[140:143], a[124:127], v[52:55]
  ds_read_b128 a[112:115], v211 offset:40960
  v_mfma_f32_16x16x32_bf16 v[56:59], a[140:143], a[128:131], v[56:59]
  v_mfma_f32_16x16x32_bf16 v[60:63], a[140:143], a[132:135], v[60:63]
  s_waitcnt vmcnt(45)
  v_mfma_f32_16x16x32_bf16 v[64:67], a[144:147], a[120:123], v[64:67]
  buffer_load_dwordx4 a[140:143], v208, s[8:11], s20 offen offset:3072
  v_mfma_f32_16x16x32_bf16 v[68:71], a[144:147], a[124:127], v[68:71]
  ds_read_b128 a[116:119], v211 offset:45056
  v_mfma_f32_16x16x32_bf16 v[72:75], a[144:147], a[128:131], v[72:75]
  v_mfma_f32_16x16x32_bf16 v[76:79], a[144:147], a[132:135], v[76:79]
  v_mfma_f32_16x16x32_bf16 v[80:83], a[148:151], a[120:123], v[80:83]
  s_add_u32 s20, s20, 4096
  buffer_load_dwordx4 a[144:147], v208, s[8:11], s20 offen
  v_mfma_f32_16x16x32_bf16 v[84:87], a[148:151], a[124:127], v[84:87]
  v_mfma_f32_16x16x32_bf16 v[88:91], a[148:151], a[128:131], v[88:91]
  v_mfma_f32_16x16x32_bf16 v[92:95], a[148:151], a[132:135], v[92:95]
  s_waitcnt vmcnt(45)
  v_mfma_f32_16x16x32_bf16 v[96:99], a[152:155], a[120:123], v[96:99]
  buffer_load_dwordx4 a[148:151], v208, s[8:11], s20 offen offset:1024
  v_mfma_f32_16x16x32_bf16 v[100:103], a[152:155], a[124:127], v[100:103]
  v_mfma_f32_16x16x32_bf16 v[104:107], a[152:155], a[128:131], v[104:107]
  v_mfma_f32_16x16x32_bf16 v[108:111], a[152:155], a[132:135], v[108:111]
  v_mfma_f32_16x16x32_bf16 v[112:115], a[156:159], a[120:123], v[112:115]
  buffer_load_dwordx4 a[152:155], v208, s[8:11], s20 offen offset:2048
  v_mfma_f32_16x16x32_bf16 v[116:119], a[156:159], a[124:127], v[116:119]
  v_mfma_f32_16x16x32_bf16 v[120:123], a[156:159], a[128:131], v[120:123]
  v_mfma_f32_16x16x32_bf16 v[124:127], a[156:159], a[132:135], v[124:127]
  s_waitcnt vmcnt(45) lgkmcnt(0)
  v_mfma_f32_16x16x32_bf16 v[0:3], a[160:163], a[104:107], v[0:3]
  buffer_load_dwordx4 a[156:159], v208, s[8:11], s20 offen offset:3072
  v_mfma_f32_16x16x32_bf16 v[4:7], a[160:163], a[108:111], v[4:7]
  ds_write_b128 v237, v[160:163] offset:49152
  v_mfma_f32_16x16x32_bf16 v[8:11], a[160:163], a[112:115], v[8:11]
  v_mfma_f32_16x16x32_bf16 v[12:15], a[160:163], a[116:119], v[12:15]
  v_mfma_f32_16x16x32_bf16 v[16:19], a[164:167], a[104:107], v[16:19]
  s_add_u32 s20, s20, 4096
  buffer_load_dwordx4 a[160:163], v208, s[8:11], s20 offen
  v_mfma_f32_16x16x32_bf16 v[20:23], a[164:167], a[108:111], v[20:23]
  ds_read_b128 a[120:123], v212 offset:32768
  ds_write_b128 v237, v[164:167] offset:53248
  v_mfma_f32_16x16x32_bf16 v[24:27], a[164:167], a[112:115], v[24:27]
  v_mfma_f32_16x16x32_bf16 v[28:31], a[164:167], a[116:119], v[28:31]
  s_waitcnt vmcnt(45)
  v_mfma_f32_16x16x32_bf16 v[32:35], a[168:171], a[104:107], v[32:35]
  buffer_load_dwordx4 a[164:167], v208, s[8:11], s20 offen offset:1024
  v_mfma_f32_16x16x32_bf16 v[36:39], a[168:171], a[108:111], v[36:39]
  ds_read_b128 a[124:127], v212 offset:36864
  ds_write_b128 v237, v[168:171] offset:57344
  v_mfma_f32_16x16x32_bf16 v[40:43], a[168:171], a[112:115], v[40:43]
  v_mfma_f32_16x16x32_bf16 v[44:47], a[168:171], a[116:119], v[44:47]
  v_mfma_f32_16x16x32_bf16 v[48:51], a[172:175], a[104:107], v[48:51]
  buffer_load_dwordx4 a[168:171], v208, s[8:11], s20 offen offset:2048
  v_mfma_f32_16x16x32_bf16 v[52:55], a[172:175], a[108:111], v[52:55]
  ds_read_b128 a[128:131], v212 offset:40960
  ds_write_b128 v237, v[172:175] offset:61440
  v_mfma_f32_16x16x32_bf16 v[56:59], a[172:175], a[112:115], v[56:59]
  v_mfma_f32_16x16x32_bf16 v[60:63], a[172:175], a[116:119], v[60:63]
  s_waitcnt vmcnt(45)
  v_mfma_f32_16x16x32_bf16 v[64:67], a[176:179], a[104:107], v[64:67]
  buffer_load_dwordx4 a[172:175], v208, s[8:11], s20 offen offset:3072
  v_mfma_f32_16x16x32_bf16 v[68:71], a[176:179], a[108:111], v[68:71]
  ds_read_b128 a[132:135], v212 offset:45056
  v_mfma_f32_16x16x32_bf16 v[72:75], a[176:179], a[112:115], v[72:75]
  v_mfma_f32_16x16x32_bf16 v[76:79], a[176:179], a[116:119], v[76:79]
  v_mfma_f32_16x16x32_bf16 v[80:83], a[180:183], a[104:107], v[80:83]
  s_add_u32 s20, s20, 4096
  buffer_load_dwordx4 a[176:179], v208, s[8:11], s20 offen
  v_mfma_f32_16x16x32_bf16 v[84:87], a[180:183], a[108:111], v[84:87]
  v_mfma_f32_16x16x32_bf16 v[88:91], a[180:183], a[112:115], v[88:91]
  v_mfma_f32_16x16x32_bf16 v[92:95], a[180:183], a[116:119], v[92:95]
  s_waitcnt vmcnt(45)
  v_mfma_f32_16x16x32_bf16 v[96:99], a[184:187], a[104:107], v[96:99]
  buffer_load_dwordx4 a[180:183], v208, s[8:11], s20 offen offset:1024
  v_mfma_f32_16x16x32_bf16 v[100:103], a[184:187], a[108:111], v[100:103]
  v_mfma_f32_16x16x32_bf16 v[104:107], a[184:187], a[112:115], v[104:107]
  v_mfma_f32_16x16x32_bf16 v[108:111], a[184:187], a[116:119], v[108:111]
  v_mfma_f32_16x16x32_bf16 v[112:115], a[188:191], a[104:107], v[112:115]
  buffer_load_dwordx4 a[184:187], v208, s[8:11], s20 offen offset:2048
  v_mfma_f32_16x16x32_bf16 v[116:119], a[188:191], a[108:111], v[116:119]
  v_mfma_f32_16x16x32_bf16 v[120:123], a[188:191], a[112:115], v[120:123]
  v_mfma_f32_16x16x32_bf16 v[124:127], a[188:191], a[116:119], v[124:127]
  s_waitcnt lgkmcnt(0)
  s_barrier
  s_waitcnt vmcnt(45)
  v_mfma_f32_16x16x32_bf16 v[0:3], a[192:195], a[120:123], v[0:3]
  buffer_load_dwordx4 a[188:191], v208, s[8:11], s20 offen offset:3072
  v_mfma_f32_16x16x32_bf16 v[4:7], a[192:195], a[124:127], v[4:7]
  v_mfma_f32_16x16x32_bf16 v[8:11], a[192:195], a[128:131], v[8:11]
  v_mfma_f32_16x16x32_bf16 v[12:15], a[192:195], a[132:135], v[12:15]
  v_mfma_f32_16x16x32_bf16 v[16:19], a[196:199], a[120:123], v[16:19]
  s_add_u32 s20, s20, 4096
  buffer_load_dwordx4 a[192:195], v208, s[8:11], s20 offen
  v_mfma_f32_16x16x32_bf16 v[20:23], a[196:199], a[124:127], v[20:23]
  ds_read_b128 a[104:107], v209 offset:49152
  v_mfma_f32_16x16x32_bf16 v[24:27], a[196:199], a[128:131], v[24:27]
  v_mfma_f32_16x16x32_bf16 v[28:31], a[196:199], a[132:135], v[28:31]
  s_waitcnt vmcnt(45)
  v_mfma_f32_16x16x32_bf16 v[32:35], a[200:203], a[120:123], v[32:35]
  buffer_load_dwordx4 a[196:199], v208, s[8:11], s20 offen offset:1024
  v_mfma_f32_16x16x32_bf16 v[36:39], a[200:203], a[124:127], v[36:39]
  ds_read_b128 a[108:111], v209 offset:53248
  v_mfma_f32_16x16x32_bf16 v[40:43], a[200:203], a[128:131], v[40:43]
  v_mfma_f32_16x16x32_bf16 v[44:47], a[200:203], a[132:135], v[44:47]
  v_mfma_f32_16x16x32_bf16 v[48:51], a[204:207], a[120:123], v[48:51]
  buffer_load_dwordx4 a[200:203], v208, s[8:11], s20 offen offset:2048
  v_mfma_f32_16x16x32_bf16 v[52:55], a[204:207], a[124:127], v[52:55]
  ds_read_b128 a[112:115], v209 offset:57344
  v_mfma_f32_16x16x32_bf16 v[56:59], a[204:207], a[128:131], v[56:59]
  v_mfma_f32_16x16x32_bf16 v[60:63], a[204:207], a[132:135], v[60:63]
  s_waitcnt vmcnt(45)
  v_mfma_f32_16x16x32_bf16 v[64:67], a[208:211], a[120:123], v[64:67]
  buffer_load_dwordx4 a[204:207], v208, s[8:11], s20 offen offset:3072
  v_mfma_f32_16x16x32_bf16 v[68:71], a[208:211], a[124:127], v[68:71]
  ds_read_b128 a[116:119], v209 offset:61440
  v_mfma_f32_16x16x32_bf16 v[72:75], a[208:211], a[128:131], v[72:75]
  v_mfma_f32_16x16x32_bf16 v[76:79], a[208:211], a[132:135], v[76:79]
  v_mfma_f32_16x16x32_bf16 v[80:83], a[212:215], a[120:123], v[80:83]
  s_add_u32 s20, s20, 4096
  buffer_load_dwordx4 a[208:211], v208, s[8:11], s20 offen
  v_mfma_f32_16x16x32_bf16 v[84:87], a[212:215], a[124:127], v[84:87]
  v_mfma_f32_16x16x32_bf16 v[88:91], a[212:215], a[128:131], v[88:91]
  v_mfma_f32_16x16x32_bf16 v[92:95], a[212:215], a[132:135], v[92:95]
  s_waitcnt vmcnt(45)
  v_mfma_f32_16x16x32_bf16 v[96:99], a[216:219], a[120:123], v[96:99]
  buffer_load_dwordx4 a[212:215], v208, s[8:11], s20 offen offset:1024
  v_mfma_f32_16x16x32_bf16 v[100:103], a[216:219], a[124:127], v[100:103]
  v_mfma_f32_16x16x32_bf16 v[104:107], a[216:219], a[128:131], v[104:107]
  v_mfma_f32_16x16x32_bf16 v[108:111], a[216:219], a[132:135], v[108:111]
  v_mfma_f32_16x16x32_bf16 v[112:115], a[220:223], a[120:123], v[112:115]
  buffer_load_dwordx4 a[216:219], v208, s[8:11], s20 offen offset:2048
  v_mfma_f32_16x16x32_bf16 v[116:119], a[220:223], a[124:127], v[116:119]
  v_mfma_f32_16x16x32_bf16 v[120:123], a[220:223], a[128:131], v[120:123]
  v_mfma_f32_16x16x32_bf16 v[124:127], a[220:223], a[132:135], v[124:127]
  s_waitcnt vmcnt(45) lgkmcnt(0)
  v_mfma_f32_16x16x32_bf16 v[0:3], a[0:3], a[104:107], v[0:3]
  buffer_load_dwordx4 a[220:223], v208, s[8:11], s20 offen offset:3072
  v_mfma_f32_16x16x32_bf16 v[4:7], a[0:3], a[108:111], v[4:7]
  v_mfma_f32_16x16x32_bf16 v[8:11], a[0:3], a[112:115], v[8:11]
  v_mfma_f32_16x16x32_bf16 v[12:15], a[0:3], a[116:119], v[12:15]
  v_mfma_f32_16x16x32_bf16 v[16:19], a[4:7], a[104:107], v[16:19]
  s_add_u32 s20, s20, 4096
  buffer_load_dwordx4 a[0:3], v208, s[8:11], s20 offen
  v_mfma_f32_16x16x32_bf16 v[20:23], a[4:7], a[108:111], v[20:23]
  ds_read_b128 a[120:123], v210 offset:49152
  v_mfma_f32_16x16x32_bf16 v[24:27], a[4:7], a[112:115], v[24:27]
  v_mfma_f32_16x16x32_bf16 v[28:31], a[4:7], a[116:119], v[28:31]
  s_waitcnt vmcnt(45)
  v_mfma_f32_16x16x32_bf16 v[32:35], a[8:11], a[104:107], v[32:35]
  buffer_load_dwordx4 a[4:7], v208, s[8:11], s20 offen offset:1024
  v_mfma_f32_16x16x32_bf16 v[36:39], a[8:11], a[108:111], v[36:39]
  ds_read_b128 a[124:127], v210 offset:53248
  v_mfma_f32_16x16x32_bf16 v[40:43], a[8:11], a[112:115], v[40:43]
  v_mfma_f32_16x16x32_bf16 v[44:47], a[8:11], a[116:119], v[44:47]
  v_mfma_f32_16x16x32_bf16 v[48:51], a[12:15], a[104:107], v[48:51]
  buffer_load_dwordx4 a[8:11], v208, s[8:11], s20 offen offset:2048
  v_mfma_f32_16x16x32_bf16 v[52:55], a[12:15], a[108:111], v[52:55]
  ds_read_b128 a[128:131], v210 offset:57344
  v_mfma_f32_16x16x32_bf16 v[56:59], a[12:15], a[112:115], v[56:59]
  v_mfma_f32_16x16x32_bf16 v[60:63], a[12:15], a[116:119], v[60:63]
  s_waitcnt vmcnt(45)
  v_mfma_f32_16x16x32_bf16 v[64:67], a[16:19], a[104:107], v[64:67]
  buffer_load_dwordx4 a[12:15], v208, s[8:11], s20 offen offset:3072
  v_mfma_f32_16x16x32_bf16 v[68:71], a[16:19], a[108:111], v[68:71]
  ds_read_b128 a[132:135], v210 offset:61440
  v_mfma_f32_16x16x32_bf16 v[72:75], a[16:19], a[112:115], v[72:75]
  v_mfma_f32_16x16x32_bf16 v[76:79], a[16:19], a[116:119], v[76:79]
  v_mfma_f32_16x16x32_bf16 v[80:83], a[20:23], a[104:107], v[80:83]
  s_add_u32 s20, s20, 4096
  buffer_load_dwordx4 a[16:19], v208, s[8:11], s20 offen
  v_mfma_f32_16x16x32_bf16 v[84:87], a[20:23], a[108:111], v[84:87]
  v_mfma_f32_16x16x32_bf16 v[88:91], a[20:23], a[112:115], v[88:91]
  v_mfma_f32_16x16x32_bf16 v[92:95], a[20:23], a[116:119], v[92:95]
  s_waitcnt vmcnt(45)
  v_mfma_f32_16x16x32_bf16 v[96:99], a[24:27], a[104:107], v[96:99]
  buffer_load_dwordx4 a[20:23], v208, s[8:11], s20 offen offset:1024
  v_mfma_f32_16x16x32_bf16 v[100:103], a[24:27], a[108:111], v[100:103]
  v_mfma_f32_16x16x32_bf16 v[104:107], a[24:27], a[112:115], v[104:107]
  v_mfma_f32_16x16x32_bf16 v[108:111], a[24:27], a[116:119], v[108:111]
  v_mfma_f32_16x16x32_bf16 v[112:115], a[28:31], a[104:107], v[112:115]
  buffer_load_dwordx4 a[24:27], v208, s[8:11], s20 offen offset:2048
  v_mfma_f32_16x16x32_bf16 v[116:119], a[28:31], a[108:111], v[116:119]
  v_mfma_f32_16x16x32_bf16 v[120:123], a[28:31], a[112:115], v[120:123]
  v_mfma_f32_16x16x32_bf16 v[124:127], a[28:31], a[116:119], v[124:127]
  s_waitcnt vmcnt(45) lgkmcnt(0)
  v_mfma_f32_16x16x32_bf16 v[0:3], a[32:35], a[120:123], v[0:3]
  buffer_load_dwordx4 a[28:31], v208, s[8:11], s20 offen offset:3072
  v_mfma_f32_16x16x32_bf16 v[4:7], a[32:35], a[124:127], v[4:7]
  v_mfma_f32_16x16x32_bf16 v[8:11], a[32:35], a[128:131], v[8:11]
  v_mfma_f32_16x16x32_bf16 v[12:15], a[32:35], a[132:135], v[12:15]
  v_mfma_f32_16x16x32_bf16 v[16:19], a[36:39], a[120:123], v[16:19]
  s_add_u32 s20, s20, 4096
  buffer_load_dwordx4 a[32:35], v208, s[8:11], s20 offen
  v_mfma_f32_16x16x32_bf16 v[20:23], a[36:39], a[124:127], v[20:23]
  ds_read_b128 a[104:107], v211 offset:49152
  v_mfma_f32_16x16x32_bf16 v[24:27], a[36:39], a[128:131], v[24:27]
  v_mfma_f32_16x16x32_bf16 v[28:31], a[36:39], a[132:135], v[28:31]
  s_waitcnt vmcnt(45)
  v_mfma_f32_16x16x32_bf16 v[32:35], a[40:43], a[120:123], v[32:35]
  buffer_load_dwordx4 a[36:39], v208, s[8:11], s20 offen offset:1024
  v_mfma_f32_16x16x32_bf16 v[36:39], a[40:43], a[124:127], v[36:39]
  ds_read_b128 a[108:111], v211 offset:53248
  v_mfma_f32_16x16x32_bf16 v[40:43], a[40:43], a[128:131], v[40:43]
  v_mfma_f32_16x16x32_bf16 v[44:47], a[40:43], a[132:135], v[44:47]
  v_mfma_f32_16x16x32_bf16 v[48:51], a[44:47], a[120:123], v[48:51]
  buffer_load_dwordx4 a[40:43], v208, s[8:11], s20 offen offset:2048
  v_mfma_f32_16x16x32_bf16 v[52:55], a[44:47], a[124:127], v[52:55]
  ds_read_b128 a[112:115], v211 offset:57344
  v_mfma_f32_16x16x32_bf16 v[56:59], a[44:47], a[128:131], v[56:59]
  v_mfma_f32_16x16x32_bf16 v[60:63], a[44:47], a[132:135], v[60:63]
  s_waitcnt vmcnt(45)
  v_mfma_f32_16x16x32_bf16 v[64:67], a[48:51], a[120:123], v[64:67]
  buffer_load_dwordx4 a[44:47], v208, s[8:11], s20 offen offset:3072
  v_mfma_f32_16x16x32_bf16 v[68:71], a[48:51], a[124:127], v[68:71]
  ds_read_b128 a[116:119], v211 offset:61440
  v_mfma_f32_16x16x32_bf16 v[72:75], a[48:51], a[128:131], v[72:75]
  v_mfma_f32_16x16x32_bf16 v[76:79], a[48:51], a[132:135], v[76:79]
  v_mfma_f32_16x16x32_bf16 v[80:83], a[52:55], a[120:123], v[80:83]
  s_add_u32 s20, s20, 4096
  buffer_load_dwordx4 a[48:51], v208, s[8:11], s20 offen
  v_mfma_f32_16x16x32_bf16 v[84:87], a[52:55], a[124:127], v[84:87]
  v_mfma_f32_16x16x32_bf16 v[88:91], a[52:55], a[128:131], v[88:91]
  v_mfma_f32_16x16x32_bf16 v[92:95], a[52:55], a[132:135], v[92:95]
  s_waitcnt vmcnt(45)
  v_mfma_f32_16x16x32_bf16 v[96:99], a[56:59], a[120:123], v[96:99]
  buffer_load_dwordx4 a[52:55], v208, s[8:11], s20 offen offset:1024
  v_mfma_f32_16x16x32_bf16 v[100:103], a[56:59], a[124:127], v[100:103]
  v_mfma_f32_16x16x32_bf16 v[104:107], a[56:59], a[128:131], v[104:107]
  v_mfma_f32_16x16x32_bf16 v[108:111], a[56:59], a[132:135], v[108:111]
  v_mfma_f32_16x16x32_bf16 v[112:115], a[60:63], a[120:123], v[112:115]
  buffer_load_dwordx4 a[56:59], v208, s[8:11], s20 offen offset:2048
  v_mfma_f32_16x16x32_bf16 v[116:119], a[60:63], a[124:127], v[116:119]
  v_mfma_f32_16x16x32_bf16 v[120:123], a[60:63], a[128:131], v[120:123]
  v_mfma_f32_16x16x32_bf16 v[124:127], a[60:63], a[132:135], v[124:127]
  s_waitcnt vmcnt(45) lgkmcnt(0)
  v_mfma_f32_16x16x32_bf16 v[0:3], a[64:67], a[104:107], v[0:3]
  buffer_load_dwordx4 a[60:63], v208, s[8:11], s20 offen offset:3072
  v_mfma_f32_16x16x32_bf16 v[4:7], a[64:67], a[108:111], v[4:7]
  ds_write_b128 v238, v[176:179]
  v_mfma_f32_16x16x32_bf16 v[8:11], a[64:67], a[112:115], v[8:11]
  v_mfma_f32_16x16x32_bf16 v[12:15], a[64:67], a[116:119], v[12:15]
  v_mfma_f32_16x16x32_bf16 v[16:19], a[68:71], a[104:107], v[16:19]
  s_add_u32 s20, s20, 4096
  buffer_load_dwordx4 a[64:67], v208, s[8:11], s20 offen
  v_mfma_f32_16x16x32_bf16 v[20:23], a[68:71], a[108:111], v[20:23]
  ds_read_b128 a[120:123], v212 offset:49152
  ds_write_b128 v238, v[180:183] offset:4096
  v_mfma_f32_16x16x32_bf16 v[24:27], a[68:71], a[112:115], v[24:27]
  v_mfma_f32_16x16x32_bf16 v[28:31], a[68:71], a[116:119], v[28:31]
  s_waitcnt vmcnt(45)
  v_mfma_f32_16x16x32_bf16 v[32:35], a[72:75], a[104:107], v[32:35]
  buffer_load_dwordx4 a[68:71], v208, s[8:11], s20 offen offset:1024
  v_mfma_f32_16x16x32_bf16 v[36:39], a[72:75], a[108:111], v[36:39]
  ds_read_b128 a[124:127], v212 offset:53248
  ds_write_b128 v238, v[184:187] offset:8192
  v_mfma_f32_16x16x32_bf16 v[40:43], a[72:75], a[112:115], v[40:43]
  v_mfma_f32_16x16x32_bf16 v[44:47], a[72:75], a[116:119], v[44:47]
  v_mfma_f32_16x16x32_bf16 v[48:51], a[76:79], a[104:107], v[48:51]
  buffer_load_dwordx4 a[72:75], v208, s[8:11], s20 offen offset:2048
  v_mfma_f32_16x16x32_bf16 v[52:55], a[76:79], a[108:111], v[52:55]
  ds_read_b128 a[128:131], v212 offset:57344
  ds_write_b128 v238, v[188:191] offset:12288
  v_mfma_f32_16x16x32_bf16 v[56:59], a[76:79], a[112:115], v[56:59]
  v_mfma_f32_16x16x32_bf16 v[60:63], a[76:79], a[116:119], v[60:63]
  s_waitcnt vmcnt(45)
  v_mfma_f32_16x16x32_bf16 v[64:67], a[80:83], a[104:107], v[64:67]
  buffer_load_dwordx4 a[76:79], v208, s[8:11], s20 offen offset:3072
  v_mfma_f32_16x16x32_bf16 v[68:71], a[80:83], a[108:111], v[68:71]
  ds_read_b128 a[132:135], v212 offset:61440
  v_mfma_f32_16x16x32_bf16 v[72:75], a[80:83], a[112:115], v[72:75]
  v_mfma_f32_16x16x32_bf16 v[76:79], a[80:83], a[116:119], v[76:79]
  v_mfma_f32_16x16x32_bf16 v[80:83], a[84:87], a[104:107], v[80:83]
  s_add_u32 s20, s20, 4096
  buffer_load_dwordx4 a[80:83], v208, s[8:11], s20 offen
  v_mfma_f32_16x16x32_bf16 v[84:87], a[84:87], a[108:111], v[84:87]
  v_mfma_f32_16x16x32_bf16 v[88:91], a[84:87], a[112:115], v[88:91]
  v_mfma_f32_16x16x32_bf16 v[92:95], a[84:87], a[116:119], v[92:95]
  s_waitcnt vmcnt(45)
  v_mfma_f32_16x16x32_bf16 v[96:99], a[88:91], a[104:107], v[96:99]
  buffer_load_dwordx4 a[84:87], v208, s[8:11], s20 offen offset:1024
  v_mfma_f32_16x16x32_bf16 v[100:103], a[88:91], a[108:111], v[100:103]
  v_mfma_f32_16x16x32_bf16 v[104:107], a[88:91], a[112:115], v[104:107]
  v_mfma_f32_16x16x32_bf16 v[108:111], a[88:91], a[116:119], v[108:111]
  v_mfma_f32_16x16x32_bf16 v[112:115], a[92:95], a[104:107], v[112:115]
  buffer_load_dwordx4 a[88:91], v208, s[8:11], s20 offen offset:2048
  v_mfma_f32_16x16x32_bf16 v[116:119], a[92:95], a[108:111], v[116:119]
  v_mfma_f32_16x16x32_bf16 v[120:123], a[92:95], a[112:115], v[120:123]
  v_mfma_f32_16x16x32_bf16 v[124:127], a[92:95], a[116:119], v[124:127]
  s_waitcnt lgkmcnt(0)
  s_barrier
  s_waitcnt vmcnt(45)
  v_mfma_f32_16x16x32_bf16 v[0:3], a[96:99], a[120:123], v[0:3]
  buffer_load_dwordx4 a[92:95], v208, s[8:11], s20 offen offset:3072
  v_mfma_f32_16x16x32_bf16 v[4:7], a[96:99], a[124:127], v[4:7]
  v_mfma_f32_16x16x32_bf16 v[8:11], a[96:99], a[128:131], v[8:11]
  v_mfma_f32_16x16x32_bf16 v[12:15], a[96:99], a[132:135], v[12:15]
  v_mfma_f32_16x16x32_bf16 v[16:19], a[100:103], a[120:123], v[16:19]
  s_add_u32 s20, s20, 4096
  buffer_load_dwordx4 a[96:99], v208, s[8:11], s20 offen
  v_mfma_f32_16x16x32_bf16 v[20:23], a[100:103], a[124:127], v[20:23]
  ds_read_b128 a[104:107], v213
  v_mfma_f32_16x16x32_bf16 v[24:27], a[100:103], a[128:131], v[24:27]
  v_mfma_f32_16x16x32_bf16 v[28:31], a[100:103], a[132:135], v[28:31]
  s_waitcnt vmcnt(45)
  v_mfma_f32_16x16x32_bf16 v[32:35], a[136:139], a[120:123], v[32:35]
  buffer_load_dwordx4 a[100:103], v208, s[8:11], s20 offen offset:1024
  v_mfma_f32_16x16x32_bf16 v[36:39], a[136:139], a[124:127], v[36:39]
  ds_read_b128 a[108:111], v213 offset:4096
  v_mfma_f32_16x16x32_bf16 v[40:43], a[136:139], a[128:131], v[40:43]
  v_mfma_f32_16x16x32_bf16 v[44:47], a[136:139], a[132:135], v[44:47]
  v_mfma_f32_16x16x32_bf16 v[48:51], a[140:143], a[120:123], v[48:51]
  buffer_load_dwordx4 a[136:139], v208, s[8:11], s20 offen offset:2048
  v_mfma_f32_16x16x32_bf16 v[52:55], a[140:143], a[124:127], v[52:55]
  ds_read_b128 a[112:115], v213 offset:8192
  v_mfma_f32_16x16x32_bf16 v[56:59], a[140:143], a[128:131], v[56:59]
  v_mfma_f32_16x16x32_bf16 v[60:63], a[140:143], a[132:135], v[60:63]
  s_waitcnt vmcnt(45)
  v_mfma_f32_16x16x32_bf16 v[64:67], a[144:147], a[120:123], v[64:67]
  buffer_load_dwordx4 a[140:143], v208, s[8:11], s20 offen offset:3072
  v_mfma_f32_16x16x32_bf16 v[68:71], a[144:147], a[124:127], v[68:71]
  ds_read_b128 a[116:119], v213 offset:12288
  v_mfma_f32_16x16x32_bf16 v[72:75], a[144:147], a[128:131], v[72:75]
  v_mfma_f32_16x16x32_bf16 v[76:79], a[144:147], a[132:135], v[76:79]
  v_mfma_f32_16x16x32_bf16 v[80:83], a[148:151], a[120:123], v[80:83]
  s_add_u32 s20, s20, 4096
  buffer_load_dwordx4 a[144:147], v208, s[8:11], s20 offen
  v_mfma_f32_16x16x32_bf16 v[84:87], a[148:151], a[124:127], v[84:87]
  v_mfma_f32_16x16x32_bf16 v[88:91], a[148:151], a[128:131], v[88:91]
  v_mfma_f32_16x16x32_bf16 v[92:95], a[148:151], a[132:135], v[92:95]
  s_waitcnt vmcnt(45)
  v_mfma_f32_16x16x32_bf16 v[96:99], a[152:155], a[120:123], v[96:99]
  buffer_load_dwordx4 a[148:151], v208, s[8:11], s20 offen offset:1024
  v_mfma_f32_16x16x32_bf16 v[100:103], a[152:155], a[124:127], v[100:103]
  v_mfma_f32_16x16x32_bf16 v[104:107], a[152:155], a[128:131], v[104:107]
  v_mfma_f32_16x16x32_bf16 v[108:111], a[152:155], a[132:135], v[108:111]
  v_mfma_f32_16x16x32_bf16 v[112:115], a[156:159], a[120:123], v[112:115]
  buffer_load_dwordx4 a[152:155], v208, s[8:11], s20 offen offset:2048
  v_mfma_f32_16x16x32_bf16 v[116:119], a[156:159], a[124:127], v[116:119]
  v_mfma_f32_16x16x32_bf16 v[120:123], a[156:159], a[128:131], v[120:123]
  v_mfma_f32_16x16x32_bf16 v[124:127], a[156:159], a[132:135], v[124:127]
  s_waitcnt vmcnt(45) lgkmcnt(0)
  v_mfma_f32_16x16x32_bf16 v[0:3], a[160:163], a[104:107], v[0:3]
  buffer_load_dwordx4 a[156:159], v208, s[8:11], s20 offen offset:3072
  v_mfma_f32_16x16x32_bf16 v[4:7], a[160:163], a[108:111], v[4:7]
  v_mfma_f32_16x16x32_bf16 v[8:11], a[160:163], a[112:115], v[8:11]
  v_mfma_f32_16x16x32_bf16 v[12:15], a[160:163], a[116:119], v[12:15]
  v_mfma_f32_16x16x32_bf16 v[16:19], a[164:167], a[104:107], v[16:19]
  s_add_u32 s20, s20, 4096
  buffer_load_dwordx4 a[160:163], v208, s[8:11], s20 offen
  v_mfma_f32_16x16x32_bf16 v[20:23], a[164:167], a[108:111], v[20:23]
  ds_read_b128 a[120:123], v214
  v_mfma_f32_16x16x32_bf16 v[24:27], a[164:167], a[112:115], v[24:27]
  v_mfma_f32_16x16x32_bf16 v[28:31], a[164:167], a[116:119], v[28:31]
  s_waitcnt vmcnt(45)
  v_mfma_f32_16x16x32_bf16 v[32:35], a[168:171], a[104:107], v[32:35]
  buffer_load_dwordx4 a[164:167], v208, s[8:11], s20 offen offset:1024
  v_mfma_f32_16x16x32_bf16 v[36:39], a[168:171], a[108:111], v[36:39]
  ds_read_b128 a[124:127], v214 offset:4096
  v_mfma_f32_16x16x32_bf16 v[40:43], a[168:171], a[112:115], v[40:43]
  v_mfma_f32_16x16x32_bf16 v[44:47], a[168:171], a[116:119], v[44:47]
  v_mfma_f32_16x16x32_bf16 v[48:51], a[172:175], a[104:107], v[48:51]
  buffer_load_dwordx4 a[168:171], v208, s[8:11], s20 offen offset:2048
  v_mfma_f32_16x16x32_bf16 v[52:55], a[172:175], a[108:111], v[52:55]
  ds_read_b128 a[128:131], v214 offset:8192
  v_mfma_f32_16x16x32_bf16 v[56:59], a[172:175], a[112:115], v[56:59]
  v_mfma_f32_16x16x32_bf16 v[60:63], a[172:175], a[116:119], v[60:63]
  s_waitcnt vmcnt(45)
  v_mfma_f32_16x16x32_bf16 v[64:67], a[176:179], a[104:107], v[64:67]
  buffer_load_dwordx4 a[172:175], v208, s[8:11], s20 offen offset:3072
  v_mfma_f32_16x16x32_bf16 v[68:71], a[176:179], a[108:111], v[68:71]
  ds_read_b128 a[132:135], v214 offset:12288
  v_mfma_f32_16x16x32_bf16 v[72:75], a[176:179], a[112:115], v[72:75]
  v_mfma_f32_16x16x32_bf16 v[76:79], a[176:179], a[116:119], v[76:79]
  v_mfma_f32_16x16x32_bf16 v[80:83], a[180:183], a[104:107], v[80:83]
  s_add_u32 s20, s20, 4096
  buffer_load_dwordx4 a[176:179], v208, s[8:11], s20 offen
  v_mfma_f32_16x16x32_bf16 v[84:87], a[180:183], a[108:111], v[84:87]
  v_mfma_f32_16x16x32_bf16 v[88:91], a[180:183], a[112:115], v[88:91]
  v_mfma_f32_16x16x32_bf16 v[92:95], a[180:183], a[116:119], v[92:95]
  s_waitcnt vmcnt(45)
  v_mfma_f32_16x16x32_bf16 v[96:99], a[184:187], a[104:107], v[96:99]
  buffer_load_dwordx4 a[180:183], v208, s[8:11], s20 offen offset:1024
  v_mfma_f32_16x16x32_bf16 v[100:103], a[184:187], a[108:111], v[100:103]
  v_mfma_f32_16x16x32_bf16 v[104:107], a[184:187], a[112:115], v[104:107]
  v_mfma_f32_16x16x32_bf16 v[108:111], a[184:187], a[116:119], v[108:111]
  v_mfma_f32_16x16x32_bf16 v[112:115], a[188:191], a[104:107], v[112:115]
  buffer_load_dwordx4 a[184:187], v208, s[8:11], s20 offen offset:2048
  v_mfma_f32_16x16x32_bf16 v[116:119], a[188:191], a[108:111], v[116:119]
  v_mfma_f32_16x16x32_bf16 v[120:123], a[188:191], a[112:115], v[120:123]
  v_mfma_f32_16x16x32_bf16 v[124:127], a[188:191], a[116:119], v[124:127]
  s_waitcnt vmcnt(45) lgkmcnt(0)
  v_mfma_f32_16x16x32_bf16 v[0:3], a[192:195], a[120:123], v[0:3]
  buffer_load_dwordx4 a[188:191], v208, s[8:11], s20 offen offset:3072
  v_mfma_f32_16x16x32_bf16 v[4:7], a[192:195], a[124:127], v[4:7]
  v_mfma_f32_16x16x32_bf16 v[8:11], a[192:195], a[128:131], v[8:11]
  v_mfma_f32_16x16x32_bf16 v[12:15], a[192:195], a[132:135], v[12:15]
  v_mfma_f32_16x16x32_bf16 v[16:19], a[196:199], a[120:123], v[16:19]
  s_add_u32 s20, s20, 4096
  buffer_load_dwordx4 a[192:195], v208, s[8:11], s20 offen
  v_mfma_f32_16x16x32_bf16 v[20:23], a[196:199], a[124:127], v[20:23]
  ds_read_b128 a[104:107], v215
  v_mfma_f32_16x16x32_bf16 v[24:27], a[196:199], a[128:131], v[24:27]
  v_mfma_f32_16x16x32_bf16 v[28:31], a[196:199], a[132:135], v[28:31]
  s_waitcnt vmcnt(45)
  v_mfma_f32_16x16x32_bf16 v[32:35], a[200:203], a[120:123], v[32:35]
  buffer_load_dwordx4 a[196:199], v208, s[8:11], s20 offen offset:1024
  v_mfma_f32_16x16x32_bf16 v[36:39], a[200:203], a[124:127], v[36:39]
  ds_read_b128 a[108:111], v215 offset:4096
  v_mfma_f32_16x16x32_bf16 v[40:43], a[200:203], a[128:131], v[40:43]
  v_mfma_f32_16x16x32_bf16 v[44:47], a[200:203], a[132:135], v[44:47]
  v_mfma_f32_16x16x32_bf16 v[48:51], a[204:207], a[120:123], v[48:51]
  buffer_load_dwordx4 a[200:203], v208, s[8:11], s20 offen offset:2048
  v_mfma_f32_16x16x32_bf16 v[52:55], a[204:207], a[124:127], v[52:55]
  ds_read_b128 a[112:115], v215 offset:8192
  v_mfma_f32_16x16x32_bf16 v[56:59], a[204:207], a[128:131], v[56:59]
  v_mfma_f32_16x16x32_bf16 v[60:63], a[204:207], a[132:135], v[60:63]
  s_waitcnt vmcnt(45)
  v_mfma_f32_16x16x32_bf16 v[64:67], a[208:211], a[120:123], v[64:67]
  buffer_load_dwordx4 a[204:207], v208, s[8:11], s20 offen offset:3072
  v_mfma_f32_16x16x32_bf16 v[68:71], a[208:211], a[124:127], v[68:71]
  ds_read_b128 a[116:119], v215 offset:12288
  v_mfma_f32_16x16x32_bf16 v[72:75], a[208:211], a[128:131], v[72:75]
  v_mfma_f32_16x16x32_bf16 v[76:79], a[208:211], a[132:135], v[76:79]
  v_mfma_f32_16x16x32_bf16 v[80:83], a[212:215], a[120:123], v[80:83]
  s_add_u32 s20, s20, 4096
  buffer_load_dwordx4 a[208:211], v208, s[8:11], s20 offen
  v_mfma_f32_16x16x32_bf16 v[84:87], a[212:215], a[124:127], v[84:87]
  v_mfma_f32_16x16x32_bf16 v[88:91], a[212:215], a[128:131], v[88:91]
  v_mfma_f32_16x16x32_bf16 v[92:95], a[212:215], a[132:135], v[92:95]
  s_waitcnt vmcnt(45)
  v_mfma_f32_16x16x32_bf16 v[96:99], a[216:219], a[120:123], v[96:99]
  buffer_load_dwordx4 a[212:215], v208, s[8:11], s20 offen offset:1024
  v_mfma_f32_16x16x32_bf16 v[100:103], a[216:219], a[124:127], v[100:103]
  v_mfma_f32_16x16x32_bf16 v[104:107], a[216:219], a[128:131], v[104:107]
  v_mfma_f32_16x16x32_bf16 v[108:111], a[216:219], a[132:135], v[108:111]
  v_mfma_f32_16x16x32_bf16 v[112:115], a[220:223], a[120:123], v[112:115]
  buffer_load_dwordx4 a[216:219], v208, s[8:11], s20 offen offset:2048
  v_mfma_f32_16x16x32_bf16 v[116:119], a[220:223], a[124:127], v[116:119]
  v_mfma_f32_16x16x32_bf16 v[120:123], a[220:223], a[128:131], v[120:123]
  v_mfma_f32_16x16x32_bf16 v[124:127], a[220:223], a[132:135], v[124:127]
  s_waitcnt vmcnt(45) lgkmcnt(0)
  v_mfma_f32_16x16x32_bf16 v[0:3], a[0:3], a[104:107], v[0:3]
  buffer_load_dwordx4 a[220:223], v208, s[8:11], s20 offen offset:3072
  v_mfma_f32_16x16x32_bf16 v[4:7], a[0:3], a[108:111], v[4:7]
  ds_write_b128 v238, v[192:195] offset:16384
  v_mfma_f32_16x16x32_bf16 v[8:11], a[0:3], a[112:115], v[8:11]
  v_mfma_f32_16x16x32_bf16 v[12:15], a[0:3], a[116:119], v[12:15]
  v_mfma_f32_16x16x32_bf16 v[16:19], a[4:7], a[104:107], v[16:19]
  s_add_u32 s20, s20, 4096
  buffer_load_dwordx4 a[0:3], v208, s[8:11], s20 offen
  v_mfma_f32_16x16x32_bf16 v[20:23], a[4:7], a[108:111], v[20:23]
  ds_read_b128 a[120:123], v216
  ds_write_b128 v238, v[196:199] offset:20480
  v_mfma_f32_16x16x32_bf16 v[24:27], a[4:7], a[112:115], v[24:27]
  v_mfma_f32_16x16x32_bf16 v[28:31], a[4:7], a[116:119], v[28:31]
  s_waitcnt vmcnt(45)
  v_mfma_f32_16x16x32_bf16 v[32:35], a[8:11], a[104:107], v[32:35]
  buffer_load_dwordx4 a[4:7], v208, s[8:11], s20 offen offset:1024
  v_mfma_f32_16x16x32_bf16 v[36:39], a[8:11], a[108:111], v[36:39]
  ds_read_b128 a[124:127], v216 offset:4096
  ds_write_b128 v238, v[200:203] offset:24576
  v_mfma_f32_16x16x32_bf16 v[40:43], a[8:11], a[112:115], v[40:43]
  v_mfma_f32_16x16x32_bf16 v[44:47], a[8:11], a[116:119], v[44:47]
  v_mfma_f32_16x16x32_bf16 v[48:51], a[12:15], a[104:107], v[48:51]
  buffer_load_dwordx4 a[8:11], v208, s[8:11], s20 offen offset:2048
  v_mfma_f32_16x16x32_bf16 v[52:55], a[12:15], a[108:111], v[52:55]
  ds_read_b128 a[128:131], v216 offset:8192
  ds_write_b128 v238, v[204:207] offset:28672
  v_mfma_f32_16x16x32_bf16 v[56:59], a[12:15], a[112:115], v[56:59]
  v_mfma_f32_16x16x32_bf16 v[60:63], a[12:15], a[116:119], v[60:63]
  s_waitcnt vmcnt(45)
  v_mfma_f32_16x16x32_bf16 v[64:67], a[16:19], a[104:107], v[64:67]
  buffer_load_dwordx4 a[12:15], v208, s[8:11], s20 offen offset:3072
  v_mfma_f32_16x16x32_bf16 v[68:71], a[16:19], a[108:111], v[68:71]
  ds_read_b128 a[132:135], v216 offset:12288
  v_mfma_f32_16x16x32_bf16 v[72:75], a[16:19], a[112:115], v[72:75]
  v_mfma_f32_16x16x32_bf16 v[76:79], a[16:19], a[116:119], v[76:79]
  v_mfma_f32_16x16x32_bf16 v[80:83], a[20:23], a[104:107], v[80:83]
  s_add_u32 s20, s20, 4096
  buffer_load_dwordx4 a[16:19], v208, s[8:11], s20 offen
  v_mfma_f32_16x16x32_bf16 v[84:87], a[20:23], a[108:111], v[84:87]
  v_mfma_f32_16x16x32_bf16 v[88:91], a[20:23], a[112:115], v[88:91]
  v_mfma_f32_16x16x32_bf16 v[92:95], a[20:23], a[116:119], v[92:95]
  s_waitcnt vmcnt(45)
  v_mfma_f32_16x16x32_bf16 v[96:99], a[24:27], a[104:107], v[96:99]
  buffer_load_dwordx4 a[20:23], v208, s[8:11], s20 offen offset:1024
  v_mfma_f32_16x16x32_bf16 v[100:103], a[24:27], a[108:111], v[100:103]
  v_mfma_f32_16x16x32_bf16 v[104:107], a[24:27], a[112:115], v[104:107]
  v_mfma_f32_16x16x32_bf16 v[108:111], a[24:27], a[116:119], v[108:111]
  v_mfma_f32_16x16x32_bf16 v[112:115], a[28:31], a[104:107], v[112:115]
  buffer_load_dwordx4 a[24:27], v208, s[8:11], s20 offen offset:2048
  v_mfma_f32_16x16x32_bf16 v[116:119], a[28:31], a[108:111], v[116:119]
  v_mfma_f32_16x16x32_bf16 v[120:123], a[28:31], a[112:115], v[120:123]
  v_mfma_f32_16x16x32_bf16 v[124:127], a[28:31], a[116:119], v[124:127]
  s_waitcnt lgkmcnt(0)
  s_barrier
  s_waitcnt vmcnt(45)
  v_mfma_f32_16x16x32_bf16 v[0:3], a[32:35], a[120:123], v[0:3]
  buffer_load_dwordx4 a[28:31], v208, s[8:11], s20 offen offset:3072
  v_mfma_f32_16x16x32_bf16 v[4:7], a[32:35], a[124:127], v[4:7]
  v_mfma_f32_16x16x32_bf16 v[8:11], a[32:35], a[128:131], v[8:11]
  v_mfma_f32_16x16x32_bf16 v[12:15], a[32:35], a[132:135], v[12:15]
  v_mfma_f32_16x16x32_bf16 v[16:19], a[36:39], a[120:123], v[16:19]
  s_add_u32 s20, s20, 4096
  buffer_load_dwordx4 a[32:35], v208, s[8:11], s20 offen
  v_mfma_f32_16x16x32_bf16 v[20:23], a[36:39], a[124:127], v[20:23]
  ds_read_b128 a[104:107], v213 offset:16384
  v_mfma_f32_16x16x32_bf16 v[24:27], a[36:39], a[128:131], v[24:27]
  v_mfma_f32_16x16x32_bf16 v[28:31], a[36:39], a[132:135], v[28:31]
  s_waitcnt vmcnt(45)
  v_mfma_f32_16x16x32_bf16 v[32:35], a[40:43], a[120:123], v[32:35]
  buffer_load_dwordx4 a[36:39], v208, s[8:11], s20 offen offset:1024
  v_mfma_f32_16x16x32_bf16 v[36:39], a[40:43], a[124:127], v[36:39]
  ds_read_b128 a[108:111], v213 offset:20480
  v_mfma_f32_16x16x32_bf16 v[40:43], a[40:43], a[128:131], v[40:43]
  v_mfma_f32_16x16x32_bf16 v[44:47], a[40:43], a[132:135], v[44:47]
  v_mfma_f32_16x16x32_bf16 v[48:51], a[44:47], a[120:123], v[48:51]
  buffer_load_dwordx4 a[40:43], v208, s[8:11], s20 offen offset:2048
  v_mfma_f32_16x16x32_bf16 v[52:55], a[44:47], a[124:127], v[52:55]
  ds_read_b128 a[112:115], v213 offset:24576
  v_mfma_f32_16x16x32_bf16 v[56:59], a[44:47], a[128:131], v[56:59]
  v_mfma_f32_16x16x32_bf16 v[60:63], a[44:47], a[132:135], v[60:63]
  s_waitcnt vmcnt(45)
  v_mfma_f32_16x16x32_bf16 v[64:67], a[48:51], a[120:123], v[64:67]
  buffer_load_dwordx4 a[44:47], v208, s[8:11], s20 offen offset:3072
  v_mfma_f32_16x16x32_bf16 v[68:71], a[48:51], a[124:127], v[68:71]
  ds_read_b128 a[116:119], v213 offset:28672
  v_mfma_f32_16x16x32_bf16 v[72:75], a[48:51], a[128:131], v[72:75]
  v_mfma_f32_16x16x32_bf16 v[76:79], a[48:51], a[132:135], v[76:79]
  v_mfma_f32_16x16x32_bf16 v[80:83], a[52:55], a[120:123], v[80:83]
  s_add_u32 s20, s20, 4096
  buffer_load_dwordx4 a[48:51], v208, s[8:11], s20 offen
  v_mfma_f32_16x16x32_bf16 v[84:87], a[52:55], a[124:127], v[84:87]
  v_mfma_f32_16x16x32_bf16 v[88:91], a[52:55], a[128:131], v[88:91]
  v_mfma_f32_16x16x32_bf16 v[92:95], a[52:55], a[132:135], v[92:95]
  s_waitcnt vmcnt(45)
  v_mfma_f32_16x16x32_bf16 v[96:99], a[56:59], a[120:123], v[96:99]
  buffer_load_dwordx4 a[52:55], v208, s[8:11], s20 offen offset:1024
  v_mfma_f32_16x16x32_bf16 v[100:103], a[56:59], a[124:127], v[100:103]
  v_mfma_f32_16x16x32_bf16 v[104:107], a[56:59], a[128:131], v[104:107]
  v_mfma_f32_16x16x32_bf16 v[108:111], a[56:59], a[132:135], v[108:111]
  v_mfma_f32_16x16x32_bf16 v[112:115], a[60:63], a[120:123], v[112:115]
  buffer_load_dwordx4 a[56:59], v208, s[8:11], s20 offen offset:2048
  v_mfma_f32_16x16x32_bf16 v[116:119], a[60:63], a[124:127], v[116:119]
  v_mfma_f32_16x16x32_bf16 v[120:123], a[60:63], a[128:131], v[120:123]
  v_mfma_f32_16x16x32_bf16 v[124:127], a[60:63], a[132:135], v[124:127]
  s_waitcnt vmcnt(45) lgkmcnt(0)
  v_mfma_f32_16x16x32_bf16 v[0:3], a[64:67], a[104:107], v[0:3]
  buffer_load_dwordx4 a[60:63], v208, s[8:11], s20 offen offset:3072
  v_mfma_f32_16x16x32_bf16 v[4:7], a[64:67], a[108:111], v[4:7]
  v_mfma_f32_16x16x32_bf16 v[8:11], a[64:67], a[112:115], v[8:11]
  v_mfma_f32_16x16x32_bf16 v[12:15], a[64:67], a[116:119], v[12:15]
  v_mfma_f32_16x16x32_bf16 v[16:19], a[68:71], a[104:107], v[16:19]
  s_add_u32 s20, s20, 4096
  buffer_load_dwordx4 a[64:67], v208, s[8:11], s20 offen
  v_mfma_f32_16x16x32_bf16 v[20:23], a[68:71], a[108:111], v[20:23]
  ds_read_b128 a[120:123], v214 offset:16384
  v_mfma_f32_16x16x32_bf16 v[24:27], a[68:71], a[112:115], v[24:27]
  v_mfma_f32_16x16x32_bf16 v[28:31], a[68:71], a[116:119], v[28:31]
  s_waitcnt vmcnt(45)
  v_mfma_f32_16x16x32_bf16 v[32:35], a[72:75], a[104:107], v[32:35]
  buffer_load_dwordx4 a[68:71], v208, s[8:11], s20 offen offset:1024
  v_mfma_f32_16x16x32_bf16 v[36:39], a[72:75], a[108:111], v[36:39]
  ds_read_b128 a[124:127], v214 offset:20480
  v_mfma_f32_16x16x32_bf16 v[40:43], a[72:75], a[112:115], v[40:43]
  v_mfma_f32_16x16x32_bf16 v[44:47], a[72:75], a[116:119], v[44:47]
  v_mfma_f32_16x16x32_bf16 v[48:51], a[76:79], a[104:107], v[48:51]
  buffer_load_dwordx4 a[72:75], v208, s[8:11], s20 offen offset:2048
  v_mfma_f32_16x16x32_bf16 v[52:55], a[76:79], a[108:111], v[52:55]
  ds_read_b128 a[128:131], v214 offset:24576
  v_mfma_f32_16x16x32_bf16 v[56:59], a[76:79], a[112:115], v[56:59]
  v_mfma_f32_16x16x32_bf16 v[60:63], a[76:79], a[116:119], v[60:63]
  s_waitcnt vmcnt(45)
  v_mfma_f32_16x16x32_bf16 v[64:67], a[80:83], a[104:107], v[64:67]
  buffer_load_dwordx4 a[76:79], v208, s[8:11], s20 offen offset:3072
  v_mfma_f32_16x16x32_bf16 v[68:71], a[80:83], a[108:111], v[68:71]
  ds_read_b128 a[132:135], v214 offset:28672
  v_mfma_f32_16x16x32_bf16 v[72:75], a[80:83], a[112:115], v[72:75]
  v_mfma_f32_16x16x32_bf16 v[76:79], a[80:83], a[116:119], v[76:79]
  v_mfma_f32_16x16x32_bf16 v[80:83], a[84:87], a[104:107], v[80:83]
  s_add_u32 s20, s20, 4096
  buffer_load_dwordx4 a[80:83], v208, s[8:11], s20 offen
  v_mfma_f32_16x16x32_bf16 v[84:87], a[84:87], a[108:111], v[84:87]
  v_mfma_f32_16x16x32_bf16 v[88:91], a[84:87], a[112:115], v[88:91]
  v_mfma_f32_16x16x32_bf16 v[92:95], a[84:87], a[116:119], v[92:95]
  s_waitcnt vmcnt(45)
  v_mfma_f32_16x16x32_bf16 v[96:99], a[88:91], a[104:107], v[96:99]
  buffer_load_dwordx4 a[84:87], v208, s[8:11], s20 offen offset:1024
  v_mfma_f32_16x16x32_bf16 v[100:103], a[88:91], a[108:111], v[100:103]
  v_mfma_f32_16x16x32_bf16 v[104:107], a[88:91], a[112:115], v[104:107]
  v_mfma_f32_16x16x32_bf16 v[108:111], a[88:91], a[116:119], v[108:111]
  v_mfma_f32_16x16x32_bf16 v[112:115], a[92:95], a[104:107], v[112:115]
  buffer_load_dwordx4 a[88:91], v208, s[8:11], s20 offen offset:2048
  v_mfma_f32_16x16x32_bf16 v[116:119], a[92:95], a[108:111], v[116:119]
  v_mfma_f32_16x16x32_bf16 v[120:123], a[92:95], a[112:115], v[120:123]
  v_mfma_f32_16x16x32_bf16 v[124:127], a[92:95], a[116:119], v[124:127]
  s_waitcnt vmcnt(45) lgkmcnt(0)
  v_mfma_f32_16x16x32_bf16 v[0:3], a[96:99], a[120:123], v[0:3]
  buffer_load_dwordx4 a[92:95], v208, s[8:11], s20 offen offset:3072
  v_mfma_f32_16x16x32_bf16 v[4:7], a[96:99], a[124:127], v[4:7]
  v_mfma_f32_16x16x32_bf16 v[8:11], a[96:99], a[128:131], v[8:11]
  v_mfma_f32_16x16x32_bf16 v[12:15], a[96:99], a[132:135], v[12:15]
  v_mfma_f32_16x16x32_bf16 v[16:19], a[100:103], a[120:123], v[16:19]
  s_add_u32 s20, s20, 4096
  buffer_load_dwordx4 a[96:99], v208, s[8:11], s20 offen
  v_mfma_f32_16x16x32_bf16 v[20:23], a[100:103], a[124:127], v[20:23]
  ds_read_b128 a[104:107], v215 offset:16384
  v_mfma_f32_16x16x32_bf16 v[24:27], a[100:103], a[128:131], v[24:27]
  v_mfma_f32_16x16x32_bf16 v[28:31], a[100:103], a[132:135], v[28:31]
  s_waitcnt vmcnt(45)
  v_mfma_f32_16x16x32_bf16 v[32:35], a[136:139], a[120:123], v[32:35]
  buffer_load_dwordx4 a[100:103], v208, s[8:11], s20 offen offset:1024
  v_mfma_f32_16x16x32_bf16 v[36:39], a[136:139], a[124:127], v[36:39]
  ds_read_b128 a[108:111], v215 offset:20480
  v_mfma_f32_16x16x32_bf16 v[40:43], a[136:139], a[128:131], v[40:43]
  v_mfma_f32_16x16x32_bf16 v[44:47], a[136:139], a[132:135], v[44:47]
  v_mfma_f32_16x16x32_bf16 v[48:51], a[140:143], a[120:123], v[48:51]
  v_mfma_f32_16x16x32_bf16 v[52:55], a[140:143], a[124:127], v[52:55]
  ds_read_b128 a[112:115], v215 offset:24576
  v_mfma_f32_16x16x32_bf16 v[56:59], a[140:143], a[128:131], v[56:59]
  v_mfma_f32_16x16x32_bf16 v[60:63], a[140:143], a[132:135], v[60:63]
  s_waitcnt vmcnt(44)
  v_mfma_f32_16x16x32_bf16 v[64:67], a[144:147], a[120:123], v[64:67]
  v_mfma_f32_16x16x32_bf16 v[68:71], a[144:147], a[124:127], v[68:71]
  ds_read_b128 a[116:119], v215 offset:28672
  v_mfma_f32_16x16x32_bf16 v[72:75], a[144:147], a[128:131], v[72:75]
  v_mfma_f32_16x16x32_bf16 v[76:79], a[144:147], a[132:135], v[76:79]
  v_mfma_f32_16x16x32_bf16 v[80:83], a[148:151], a[120:123], v[80:83]
  v_mfma_f32_16x16x32_bf16 v[84:87], a[148:151], a[124:127], v[84:87]
  v_mfma_f32_16x16x32_bf16 v[88:91], a[148:151], a[128:131], v[88:91]
  v_mfma_f32_16x16x32_bf16 v[92:95], a[148:151], a[132:135], v[92:95]
  s_waitcnt vmcnt(42)
  v_mfma_f32_16x16x32_bf16 v[96:99], a[152:155], a[120:123], v[96:99]
  v_mfma_f32_16x16x32_bf16 v[100:103], a[152:155], a[124:127], v[100:103]
  v_mfma_f32_16x16x32_bf16 v[104:107], a[152:155], a[128:131], v[104:107]
  v_mfma_f32_16x16x32_bf16 v[108:111], a[152:155], a[132:135], v[108:111]
  v_mfma_f32_16x16x32_bf16 v[112:115], a[156:159], a[120:123], v[112:115]
  v_mfma_f32_16x16x32_bf16 v[116:119], a[156:159], a[124:127], v[116:119]
  v_mfma_f32_16x16x32_bf16 v[120:123], a[156:159], a[128:131], v[120:123]
  v_mfma_f32_16x16x32_bf16 v[124:127], a[156:159], a[132:135], v[124:127]
  s_waitcnt vmcnt(40) lgkmcnt(0)
  v_mfma_f32_16x16x32_bf16 v[0:3], a[160:163], a[104:107], v[0:3]
  v_mfma_f32_16x16x32_bf16 v[4:7], a[160:163], a[108:111], v[4:7]
  ds_write_b128 v238, a[224:227] offset:32768
  v_mfma_f32_16x16x32_bf16 v[8:11], a[160:163], a[112:115], v[8:11]
  v_mfma_f32_16x16x32_bf16 v[12:15], a[160:163], a[116:119], v[12:15]
  v_mfma_f32_16x16x32_bf16 v[16:19], a[164:167], a[104:107], v[16:19]
  v_mfma_f32_16x16x32_bf16 v[20:23], a[164:167], a[108:111], v[20:23]
  ds_read_b128 a[120:123], v216 offset:16384
  ds_write_b128 v238, a[228:231] offset:36864
  v_mfma_f32_16x16x32_bf16 v[24:27], a[164:167], a[112:115], v[24:27]
  v_mfma_f32_16x16x32_bf16 v[28:31], a[164:167], a[116:119], v[28:31]
  s_waitcnt vmcnt(38)
  v_mfma_f32_16x16x32_bf16 v[32:35], a[168:171], a[104:107], v[32:35]
  v_mfma_f32_16x16x32_bf16 v[36:39], a[168:171], a[108:111], v[36:39]
  ds_read_b128 a[124:127], v216 offset:20480
  ds_write_b128 v238, a[232:235] offset:40960
  v_mfma_f32_16x16x32_bf16 v[40:43], a[168:171], a[112:115], v[40:43]
  v_mfma_f32_16x16x32_bf16 v[44:47], a[168:171], a[116:119], v[44:47]
  v_mfma_f32_16x16x32_bf16 v[48:51], a[172:175], a[104:107], v[48:51]
  v_mfma_f32_16x16x32_bf16 v[52:55], a[172:175], a[108:111], v[52:55]
  ds_read_b128 a[128:131], v216 offset:24576
  ds_write_b128 v238, a[236:239] offset:45056
  v_mfma_f32_16x16x32_bf16 v[56:59], a[172:175], a[112:115], v[56:59]
  v_mfma_f32_16x16x32_bf16 v[60:63], a[172:175], a[116:119], v[60:63]
  s_waitcnt vmcnt(36)
  v_mfma_f32_16x16x32_bf16 v[64:67], a[176:179], a[104:107], v[64:67]
  v_mfma_f32_16x16x32_bf16 v[68:71], a[176:179], a[108:111], v[68:71]
  ds_read_b128 a[132:135], v216 offset:28672
  v_mfma_f32_16x16x32_bf16 v[72:75], a[176:179], a[112:115], v[72:75]
  v_mfma_f32_16x16x32_bf16 v[76:79], a[176:179], a[116:119], v[76:79]
  v_mfma_f32_16x16x32_bf16 v[80:83], a[180:183], a[104:107], v[80:83]
  v_mfma_f32_16x16x32_bf16 v[84:87], a[180:183], a[108:111], v[84:87]
  v_mfma_f32_16x16x32_bf16 v[88:91], a[180:183], a[112:115], v[88:91]
  v_mfma_f32_16x16x32_bf16 v[92:95], a[180:183], a[116:119], v[92:95]
  s_waitcnt vmcnt(34)
  v_mfma_f32_16x16x32_bf16 v[96:99], a[184:187], a[104:107], v[96:99]
  v_mfma_f32_16x16x32_bf16 v[100:103], a[184:187], a[108:111], v[100:103]
  v_mfma_f32_16x16x32_bf16 v[104:107], a[184:187], a[112:115], v[104:107]
  v_mfma_f32_16x16x32_bf16 v[108:111], a[184:187], a[116:119], v[108:111]
  v_mfma_f32_16x16x32_bf16 v[112:115], a[188:191], a[104:107], v[112:115]
  v_mfma_f32_16x16x32_bf16 v[116:119], a[188:191], a[108:111], v[116:119]
  v_mfma_f32_16x16x32_bf16 v[120:123], a[188:191], a[112:115], v[120:123]
  v_mfma_f32_16x16x32_bf16 v[124:127], a[188:191], a[116:119], v[124:127]
  s_waitcnt lgkmcnt(0)
  s_barrier
  s_waitcnt vmcnt(32)
  v_mfma_f32_16x16x32_bf16 v[0:3], a[192:195], a[120:123], v[0:3]
  v_mfma_f32_16x16x32_bf16 v[4:7], a[192:195], a[124:127], v[4:7]
  v_mfma_f32_16x16x32_bf16 v[8:11], a[192:195], a[128:131], v[8:11]
  v_mfma_f32_16x16x32_bf16 v[12:15], a[192:195], a[132:135], v[12:15]
  v_mfma_f32_16x16x32_bf16 v[16:19], a[196:199], a[120:123], v[16:19]
  v_mfma_f32_16x16x32_bf16 v[20:23], a[196:199], a[124:127], v[20:23]
  ds_read_b128 a[104:107], v213 offset:32768
  v_mfma_f32_16x16x32_bf16 v[24:27], a[196:199], a[128:131], v[24:27]
  v_mfma_f32_16x16x32_bf16 v[28:31], a[196:199], a[132:135], v[28:31]
  s_waitcnt vmcnt(30)
  v_mfma_f32_16x16x32_bf16 v[32:35], a[200:203], a[120:123], v[32:35]
  v_mfma_f32_16x16x32_bf16 v[36:39], a[200:203], a[124:127], v[36:39]
  ds_read_b128 a[108:111], v213 offset:36864
  v_mfma_f32_16x16x32_bf16 v[40:43], a[200:203], a[128:131], v[40:43]
  v_mfma_f32_16x16x32_bf16 v[44:47], a[200:203], a[132:135], v[44:47]
  v_mfma_f32_16x16x32_bf16 v[48:51], a[204:207], a[120:123], v[48:51]
  v_mfma_f32_16x16x32_bf16 v[52:55], a[204:207], a[124:127], v[52:55]
  ds_read_b128 a[112:115], v213 offset:40960
  v_mfma_f32_16x16x32_bf16 v[56:59], a[204:207], a[128:131], v[56:59]
  v_mfma_f32_16x16x32_bf16 v[60:63], a[204:207], a[132:135], v[60:63]
  s_waitcnt vmcnt(28)
  v_mfma_f32_16x16x32_bf16 v[64:67], a[208:211], a[120:123], v[64:67]
  v_mfma_f32_16x16x32_bf16 v[68:71], a[208:211], a[124:127], v[68:71]
  ds_read_b128 a[116:119], v213 offset:45056
  v_mfma_f32_16x16x32_bf16 v[72:75], a[208:211], a[128:131], v[72:75]
  v_mfma_f32_16x16x32_bf16 v[76:79], a[208:211], a[132:135], v[76:79]
  v_mfma_f32_16x16x32_bf16 v[80:83], a[212:215], a[120:123], v[80:83]
  v_mfma_f32_16x16x32_bf16 v[84:87], a[212:215], a[124:127], v[84:87]
  v_mfma_f32_16x16x32_bf16 v[88:91], a[212:215], a[128:131], v[88:91]
  v_mfma_f32_16x16x32_bf16 v[92:95], a[212:215], a[132:135], v[92:95]
  s_waitcnt vmcnt(26)
  v_mfma_f32_16x16x32_bf16 v[96:99], a[216:219], a[120:123], v[96:99]
  v_mfma_f32_16x16x32_bf16 v[100:103], a[216:219], a[124:127], v[100:103]
  v_mfma_f32_16x16x32_bf16 v[104:107], a[216:219], a[128:131], v[104:107]
  v_mfma_f32_16x16x32_bf16 v[108:111], a[216:219], a[132:135], v[108:111]
  v_mfma_f32_16x16x32_bf16 v[112:115], a[220:223], a[120:123], v[112:115]
  v_mfma_f32_16x16x32_bf16 v[116:119], a[220:223], a[124:127], v[116:119]
  v_mfma_f32_16x16x32_bf16 v[120:123], a[220:223], a[128:131], v[120:123]
  v_mfma_f32_16x16x32_bf16 v[124:127], a[220:223], a[132:135], v[124:127]
  s_waitcnt vmcnt(24) lgkmcnt(0)
  v_mfma_f32_16x16x32_bf16 v[0:3], a[0:3], a[104:107], v[0:3]
  v_mfma_f32_16x16x32_bf16 v[4:7], a[0:3], a[108:111], v[4:7]
  ds_read_b128 v[128:131], v226 offset:512
  v_mfma_f32_16x16x32_bf16 v[8:11], a[0:3], a[112:115], v[8:11]
  v_mfma_f32_16x16x32_bf16 v[12:15], a[0:3], a[116:119], v[12:15]
  v_mfma_f32_16x16x32_bf16 v[16:19], a[4:7], a[104:107], v[16:19]
  buffer_load_dwordx4 a[0:3], v208, s[8:11], s20 offen offset:2048
  v_mfma_f32_16x16x32_bf16 v[20:23], a[4:7], a[108:111], v[20:23]
  ds_read_b128 a[120:123], v214 offset:32768
  ds_read_b128 v[144:147], v226 offset:528
  v_mfma_f32_16x16x32_bf16 v[24:27], a[4:7], a[112:115], v[24:27]
  v_mfma_f32_16x16x32_bf16 v[28:31], a[4:7], a[116:119], v[28:31]
  s_waitcnt vmcnt(23)
  v_mfma_f32_16x16x32_bf16 v[32:35], a[8:11], a[104:107], v[32:35]
  buffer_load_dwordx4 a[4:7], v208, s[8:11], s20 offen offset:3072
  v_mfma_f32_16x16x32_bf16 v[36:39], a[8:11], a[108:111], v[36:39]
  ds_read_b128 a[124:127], v214 offset:36864
  ds_read_b128 v[160:163], v226 offset:640
  v_mfma_f32_16x16x32_bf16 v[40:43], a[8:11], a[112:115], v[40:43]
  v_mfma_f32_16x16x32_bf16 v[44:47], a[8:11], a[116:119], v[44:47]
  v_mfma_f32_16x16x32_bf16 v[48:51], a[12:15], a[104:107], v[48:51]
  s_add_u32 s20, s20, 4096
  buffer_load_dwordx4 a[8:11], v208, s[8:11], s20 offen
  v_mfma_f32_16x16x32_bf16 v[52:55], a[12:15], a[108:111], v[52:55]
  ds_read_b128 a[128:131], v214 offset:40960
  ds_read_b128 v[176:179], v226 offset:656
  v_mfma_f32_16x16x32_bf16 v[56:59], a[12:15], a[112:115], v[56:59]
  v_mfma_f32_16x16x32_bf16 v[60:63], a[12:15], a[116:119], v[60:63]
  s_waitcnt vmcnt(23)
  v_mfma_f32_16x16x32_bf16 v[64:67], a[16:19], a[104:107], v[64:67]
  buffer_load_dwordx4 a[12:15], v208, s[8:11], s20 offen offset:1024
  v_mfma_f32_16x16x32_bf16 v[68:71], a[16:19], a[108:111], v[68:71]
  ds_read_b128 a[132:135], v214 offset:45056
  ds_read_b128 v[192:195], v227
  v_mfma_f32_16x16x32_bf16 v[72:75], a[16:19], a[112:115], v[72:75]
  v_mfma_f32_16x16x32_bf16 v[76:79], a[16:19], a[116:119], v[76:79]
  v_mfma_f32_16x16x32_bf16 v[80:83], a[20:23], a[104:107], v[80:83]
  buffer_load_dwordx4 a[16:19], v208, s[8:11], s20 offen offset:2048
  v_mfma_f32_16x16x32_bf16 v[84:87], a[20:23], a[108:111], v[84:87]
  v_mfma_f32_16x16x32_bf16 v[88:91], a[20:23], a[112:115], v[88:91]
  v_mfma_f32_16x16x32_bf16 v[92:95], a[20:23], a[116:119], v[92:95]
  s_waitcnt vmcnt(23)
  v_mfma_f32_16x16x32_bf16 v[96:99], a[24:27], a[104:107], v[96:99]
  buffer_load_dwordx4 a[20:23], v208, s[8:11], s20 offen offset:3072
  v_mfma_f32_16x16x32_bf16 v[100:103], a[24:27], a[108:111], v[100:103]
  v_mfma_f32_16x16x32_bf16 v[104:107], a[24:27], a[112:115], v[104:107]
  v_mfma_f32_16x16x32_bf16 v[108:111], a[24:27], a[116:119], v[108:111]
  v_mfma_f32_16x16x32_bf16 v[112:115], a[28:31], a[104:107], v[112:115]
  s_add_u32 s20, s20, 4096
  buffer_load_dwordx4 a[24:27], v208, s[8:11], s20 offen
  v_mfma_f32_16x16x32_bf16 v[116:119], a[28:31], a[108:111], v[116:119]
  v_mfma_f32_16x16x32_bf16 v[120:123], a[28:31], a[112:115], v[120:123]
  v_mfma_f32_16x16x32_bf16 v[124:127], a[28:31], a[116:119], v[124:127]
  s_waitcnt vmcnt(23) lgkmcnt(1)
  v_mfma_f32_16x16x32_bf16 v[0:3], a[32:35], a[120:123], v[0:3]
  buffer_load_dwordx4 a[28:31], v208, s[8:11], s20 offen offset:1024
  v_mfma_f32_16x16x32_bf16 v[4:7], a[32:35], a[124:127], v[4:7]
  v_mfma_f32_16x16x32_bf16 v[8:11], a[32:35], a[128:131], v[8:11]
  v_mfma_f32_16x16x32_bf16 v[12:15], a[32:35], a[132:135], v[12:15]
  v_mfma_f32_16x16x32_bf16 v[16:19], a[36:39], a[120:123], v[16:19]
  buffer_load_dwordx4 a[32:35], v208, s[8:11], s20 offen offset:2048
  v_mfma_f32_16x16x32_bf16 v[20:23], a[36:39], a[124:127], v[20:23]
  ds_read_b128 a[104:107], v209
  v_mfma_f32_16x16x32_bf16 v[24:27], a[36:39], a[128:131], v[24:27]
  v_mfma_f32_16x16x32_bf16 v[28:31], a[36:39], a[132:135], v[28:31]
  s_waitcnt vmcnt(23)
  v_mfma_f32_16x16x32_bf16 v[32:35], a[40:43], a[120:123], v[32:35]
  buffer_load_dwordx4 a[36:39], v208, s[8:11], s20 offen offset:3072
  v_mfma_f32_16x16x32_bf16 v[36:39], a[40:43], a[124:127], v[36:39]
  ds_read_b128 a[108:111], v209 offset:4096
  v_mfma_f32_16x16x32_bf16 v[40:43], a[40:43], a[128:131], v[40:43]
  v_mfma_f32_16x16x32_bf16 v[44:47], a[40:43], a[132:135], v[44:47]
  v_mfma_f32_16x16x32_bf16 v[48:51], a[44:47], a[120:123], v[48:51]
  s_add_u32 s20, s20, 4096
  buffer_load_dwordx4 a[40:43], v208, s[8:11], s20 offen
  v_mfma_f32_16x16x32_bf16 v[52:55], a[44:47], a[124:127], v[52:55]
  ds_read_b128 a[112:115], v209 offset:8192
  v_mfma_f32_16x16x32_bf16 v[56:59], a[44:47], a[128:131], v[56:59]
  v_mfma_f32_16x16x32_bf16 v[60:63], a[44:47], a[132:135], v[60:63]
  s_waitcnt vmcnt(23)
  v_mfma_f32_16x16x32_bf16 v[64:67], a[48:51], a[120:123], v[64:67]
  buffer_load_dwordx4 a[44:47], v208, s[8:11], s20 offen offset:1024
  v_mfma_f32_16x16x32_bf16 v[68:71], a[48:51], a[124:127], v[68:71]
  ds_read_b128 a[116:119], v209 offset:12288
  v_mfma_f32_16x16x32_bf16 v[72:75], a[48:51], a[128:131], v[72:75]
  v_mfma_f32_16x16x32_bf16 v[76:79], a[48:51], a[132:135], v[76:79]
  v_mfma_f32_16x16x32_bf16 v[80:83], a[52:55], a[120:123], v[80:83]
  buffer_load_dwordx4 a[48:51], v208, s[8:11], s20 offen offset:2048
  v_mfma_f32_16x16x32_bf16 v[84:87], a[52:55], a[124:127], v[84:87]
  v_mfma_f32_16x16x32_bf16 v[88:91], a[52:55], a[128:131], v[88:91]
  v_mfma_f32_16x16x32_bf16 v[92:95], a[52:55], a[132:135], v[92:95]
  s_waitcnt vmcnt(23)
  v_mfma_f32_16x16x32_bf16 v[96:99], a[56:59], a[120:123], v[96:99]
  buffer_load_dwordx4 a[52:55], v208, s[8:11], s20 offen offset:3072
  v_mfma_f32_16x16x32_bf16 v[100:103], a[56:59], a[124:127], v[100:103]
  v_mfma_f32_16x16x32_bf16 v[104:107], a[56:59], a[128:131], v[104:107]
  v_mfma_f32_16x16x32_bf16 v[108:111], a[56:59], a[132:135], v[108:111]
  v_mfma_f32_16x16x32_bf16 v[112:115], a[60:63], a[120:123], v[112:115]
  s_add_u32 s20, s20, 4096
  buffer_load_dwordx4 a[56:59], v208, s[8:11], s20 offen
  v_mfma_f32_16x16x32_bf16 v[116:119], a[60:63], a[124:127], v[116:119]
  v_mfma_f32_16x16x32_bf16 v[120:123], a[60:63], a[128:131], v[120:123]
  v_mfma_f32_16x16x32_bf16 v[124:127], a[60:63], a[132:135], v[124:127]
  s_waitcnt vmcnt(23) lgkmcnt(0)
  v_mfma_f32_16x16x32_bf16 v[140:143], a[64:67], a[116:119], v[128:131]
  buffer_load_dwordx4 a[60:63], v208, s[8:11], s20 offen offset:1024
  v_mfma_f32_16x16x32_bf16 v[136:139], a[64:67], a[112:115], v[128:131]
  ds_read_b128 v[228:231], v217
  v_mfma_f32_16x16x32_bf16 v[132:135], a[64:67], a[108:111], v[128:131]
  ds_read_b128 v[232:235], v217 offset:4096
  s_waitcnt lgkmcnt(1)
  v_lshlrev_b32 v236, 16, v228
  v_mfma_f32_16x16x32_bf16 v[128:131], a[64:67], a[104:107], v[128:131]
  v_mfma_f32_16x16x32_bf16 v[156:159], a[68:71], a[116:119], v[144:147]
  buffer_load_dwordx4 a[64:67], v208, s[8:11], s20 offen offset:2048
  v_mfma_f32_16x16x32_bf16 v[152:155], a[68:71], a[112:115], v[144:147]
  ds_read_b128 a[120:123], v210
  v_and_b32 v237, s27, v228
  v_mfma_f32_16x16x32_bf16 v[148:151], a[68:71], a[108:111], v[144:147]
  v_accvgpr_write_b32 a136, v228
  v_fma_f32 v236, v236, v0, v236
  v_mfma_f32_16x16x32_bf16 v[144:147], a[68:71], a[104:107], v[144:147]
  s_waitcnt vmcnt(23)
  v_mfma_f32_16x16x32_bf16 v[172:175], a[72:75], a[116:119], v[160:163]
  buffer_load_dwordx4 a[68:71], v208, s[8:11], s20 offen offset:3072
  v_mfma_f32_16x16x32_bf16 v[168:171], a[72:75], a[112:115], v[160:163]
  ds_read_b128 a[124:127], v210 offset:4096
  v_fma_f32 v237, v237, v1, v237
  v_mfma_f32_16x16x32_bf16 v[164:167], a[72:75], a[108:111], v[160:163]
  v_cvt_pk_bf16_f32 v0, v236, v237
  v_lshlrev_b32 v238, 16, v229
  v_mfma_f32_16x16x32_bf16 v[160:163], a[72:75], a[104:107], v[160:163]
  v_mfma_f32_16x16x32_bf16 v[188:191], a[76:79], a[116:119], v[176:179]
  s_add_u32 s20, s20, 4096
  buffer_load_dwordx4 a[72:75], v208, s[8:11], s20 offen
  v_mfma_f32_16x16x32_bf16 v[184:187], a[76:79], a[112:115], v[176:179]
  ds_read_b128 a[128:131], v210 offset:8192
  v_and_b32 v239, s27, v229
  v_mfma_f32_16x16x32_bf16 v[180:183], a[76:79], a[108:111], v[176:179]
  v_accvgpr_write_b32 a137, v229
  v_fma_f32 v238, v238, v2, v238
  v_mfma_f32_16x16x32_bf16 v[176:179], a[76:79], a[104:107], v[176:179]
  s_waitcnt vmcnt(23)
  v_mfma_f32_16x16x32_bf16 v[204:207], a[80:83], a[116:119], v[192:195]
  buffer_load_dwordx4 a[76:79], v208, s[8:11], s20 offen offset:1024
  v_mfma_f32_16x16x32_bf16 v[200:203], a[80:83], a[112:115], v[192:195]
  ds_read_b128 a[132:135], v210 offset:12288
  v_fma_f32 v239, v239, v3, v239
  v_mfma_f32_16x16x32_bf16 v[196:199], a[80:83], a[108:111], v[192:195]
  v_cvt_pk_bf16_f32 v1, v238, v239
  v_lshlrev_b32 v236, 16, v230
  v_mfma_f32_16x16x32_bf16 v[192:195], a[80:83], a[104:107], v[192:195]
  s_waitcnt lgkmcnt(0)
  v_mfma_f32_16x16x32_bf16 v[128:131], a[84:87], a[120:123], v[128:131]
  buffer_load_dwordx4 a[80:83], v208, s[8:11], s20 offen offset:2048
  v_mfma_f32_16x16x32_bf16 v[132:135], a[84:87], a[124:127], v[132:135]
  v_and_b32 v237, s27, v230
  v_mfma_f32_16x16x32_bf16 v[136:139], a[84:87], a[128:131], v[136:139]
  v_accvgpr_write_b32 a138, v230
  v_fma_f32 v236, v236, v16, v236
  v_mfma_f32_16x16x32_bf16 v[140:143], a[84:87], a[132:135], v[140:143]
  s_waitcnt vmcnt(23)
  v_mfma_f32_16x16x32_bf16 v[144:147], a[88:91], a[120:123], v[144:147]
  buffer_load_dwordx4 a[84:87], v208, s[8:11], s20 offen offset:3072
  v_mfma_f32_16x16x32_bf16 v[148:151], a[88:91], a[124:127], v[148:151]
  ds_read_b128 a[104:107], v211
  v_fma_f32 v237, v237, v17, v237
  v_mfma_f32_16x16x32_bf16 v[152:155], a[88:91], a[128:131], v[152:155]
  v_cvt_pk_bf16_f32 v2, v236, v237
  v_lshlrev_b32 v238, 16, v231
  v_mfma_f32_16x16x32_bf16 v[156:159], a[88:91], a[132:135], v[156:159]
  v_mfma_f32_16x16x32_bf16 v[160:163], a[92:95], a[120:123], v[160:163]
  s_add_u32 s20, s20, 4096
  buffer_load_dwordx4 a[88:91], v208, s[8:11], s20 offen
  v_mfma_f32_16x16x32_bf16 v[164:167], a[92:95], a[124:127], v[164:167]
  ds_read_b128 a[108:111], v211 offset:4096
  v_and_b32 v239, s27, v231
  v_mfma_f32_16x16x32_bf16 v[168:171], a[92:95], a[128:131], v[168:171]
  v_accvgpr_write_b32 a139, v231
  v_fma_f32 v238, v238, v18, v238
  v_mfma_f32_16x16x32_bf16 v[172:175], a[92:95], a[132:135], v[172:175]
  v_fma_f32 v239, v239, v19, v239
  s_waitcnt vmcnt(23)
  v_mfma_f32_16x16x32_bf16 v[176:179], a[96:99], a[120:123], v[176:179]
  buffer_load_dwordx4 a[92:95], v208, s[8:11], s20 offen offset:1024
  v_mfma_f32_16x16x32_bf16 v[180:183], a[96:99], a[124:127], v[180:183]
  ds_read_b128 a[112:115], v211 offset:8192
  v_cvt_pk_bf16_f32 v3, v238, v239
  v_mfma_f32_16x16x32_bf16 v[184:187], a[96:99], a[128:131], v[184:187]
  ds_read_b128 v[228:231], v217 offset:8192
  v_lshlrev_b32 v236, 16, v232
  v_mfma_f32_16x16x32_bf16 v[188:191], a[96:99], a[132:135], v[188:191]
  v_mfma_f32_16x16x32_bf16 v[192:195], a[100:103], a[120:123], v[192:195]
  buffer_load_dwordx4 a[96:99], v208, s[8:11], s20 offen offset:2048
  v_mfma_f32_16x16x32_bf16 v[196:199], a[100:103], a[124:127], v[196:199]
  ds_read_b128 a[116:119], v211 offset:12288
  v_and_b32 v237, s27, v232
  v_mfma_f32_16x16x32_bf16 v[200:203], a[100:103], a[128:131], v[200:203]
  v_accvgpr_write_b32 a140, v232
  v_fma_f32 v236, v236, v4, v236
  v_mfma_f32_16x16x32_bf16 v[204:207], a[100:103], a[132:135], v[204:207]
  s_waitcnt vmcnt(23) lgkmcnt(0)
  v_mfma_f32_16x16x32_bf16 v[128:131], a[0:3], a[104:107], v[128:131]
  buffer_load_dwordx4 a[100:103], v208, s[8:11], s20 offen offset:3072
  v_mfma_f32_16x16x32_bf16 v[132:135], a[0:3], a[108:111], v[132:135]
  v_fma_f32 v237, v237, v5, v237
  v_mfma_f32_16x16x32_bf16 v[136:139], a[0:3], a[112:115], v[136:139]
  v_cvt_pk_bf16_f32 v4, v236, v237
  v_lshlrev_b32 v238, 16, v233
  v_mfma_f32_16x16x32_bf16 v[140:143], a[0:3], a[116:119], v[140:143]
  v_mfma_f32_16x16x32_bf16 v[144:147], a[4:7], a[104:107], v[144:147]
  s_add_u32 s20, s20, 4096
  buffer_load_dwordx4 a[0:3], v208, s[8:11], s20 offen
  v_mfma_f32_16x16x32_bf16 v[148:151], a[4:7], a[108:111], v[148:151]
  ds_read_b128 a[120:123], v212
  v_and_b32 v239, s27, v233
  v_mfma_f32_16x16x32_bf16 v[152:155], a[4:7], a[112:115], v[152:155]
  v_accvgpr_write_b32 a141, v233
  v_fma_f32 v238, v238, v6, v238
  v_mfma_f32_16x16x32_bf16 v[156:159], a[4:7], a[116:119], v[156:159]
  s_waitcnt vmcnt(23)
  v_mfma_f32_16x16x32_bf16 v[160:163], a[8:11], a[104:107], v[160:163]
  buffer_load_dwordx4 a[4:7], v208, s[8:11], s20 offen offset:1024
  v_mfma_f32_16x16x32_bf16 v[164:167], a[8:11], a[108:111], v[164:167]
  ds_read_b128 a[124:127], v212 offset:4096
  v_fma_f32 v239, v239, v7, v239
  v_mfma_f32_16x16x32_bf16 v[168:171], a[8:11], a[112:115], v[168:171]
  v_cvt_pk_bf16_f32 v5, v238, v239
  v_lshlrev_b32 v236, 16, v234
  v_mfma_f32_16x16x32_bf16 v[172:175], a[8:11], a[116:119], v[172:175]
  v_mfma_f32_16x16x32_bf16 v[176:179], a[12:15], a[104:107], v[176:179]
  buffer_load_dwordx4 a[8:11], v208, s[8:11], s20 offen offset:2048
  v_mfma_f32_16x16x32_bf16 v[180:183], a[12:15], a[108:111], v[180:183]
  ds_read_b128 a[128:131], v212 offset:8192
  v_and_b32 v237, s27, v234
  v_mfma_f32_16x16x32_bf16 v[184:187], a[12:15], a[112:115], v[184:187]
  v_accvgpr_write_b32 a142, v234
  v_fma_f32 v236, v236, v20, v236
  v_mfma_f32_16x16x32_bf16 v[188:191], a[12:15], a[116:119], v[188:191]
  s_waitcnt vmcnt(23)
  v_mfma_f32_16x16x32_bf16 v[192:195], a[16:19], a[104:107], v[192:195]
  buffer_load_dwordx4 a[12:15], v208, s[8:11], s20 offen offset:3072
  v_fma_f32 v237, v237, v21, v237
  v_mfma_f32_16x16x32_bf16 v[196:199], a[16:19], a[108:111], v[196:199]
  ds_read_b128 a[132:135], v212 offset:12288
  v_cvt_pk_bf16_f32 v6, v236, v237
  v_mfma_f32_16x16x32_bf16 v[200:203], a[16:19], a[112:115], v[200:203]
  v_lshlrev_b32 v238, 16, v235
  v_and_b32 v239, s27, v235
  v_mfma_f32_16x16x32_bf16 v[204:207], a[16:19], a[116:119], v[204:207]
  s_waitcnt lgkmcnt(0)
  v_mfma_f32_16x16x32_bf16 v[128:131], a[20:23], a[120:123], v[128:131]
  s_add_u32 s20, s20, 4096
  buffer_load_dwordx4 a[16:19], v208, s[8:11], s20 offen
  v_mfma_f32_16x16x32_bf16 v[132:135], a[20:23], a[124:127], v[132:135]
  v_accvgpr_write_b32 a143, v235
  v_mfma_f32_16x16x32_bf16 v[136:139], a[20:23], a[128:131], v[136:139]
  v_fma_f32 v238, v238, v22, v238
  v_fma_f32 v239, v239, v23, v239
  v_mfma_f32_16x16x32_bf16 v[140:143], a[20:23], a[132:135], v[140:143]
  s_waitcnt vmcnt(23)
  v_mfma_f32_16x16x32_bf16 v[144:147], a[24:27], a[120:123], v[144:147]
  buffer_load_dwordx4 a[20:23], v208, s[8:11], s20 offen offset:1024
  v_mfma_f32_16x16x32_bf16 v[148:151], a[24:27], a[124:127], v[148:151]
  ds_read_b128 a[104:107], v209 offset:16384
  v_cvt_pk_bf16_f32 v7, v238, v239
  v_mfma_f32_16x16x32_bf16 v[152:155], a[24:27], a[128:131], v[152:155]
  ds_read_b128 v[232:235], v217 offset:12288
  v_lshlrev_b32 v236, 16, v228
  v_mfma_f32_16x16x32_bf16 v[156:159], a[24:27], a[132:135], v[156:159]
  v_mfma_f32_16x16x32_bf16 v[160:163], a[28:31], a[120:123], v[160:163]
  buffer_load_dwordx4 a[24:27], v208, s[8:11], s20 offen offset:2048
  v_mfma_f32_16x16x32_bf16 v[164:167], a[28:31], a[124:127], v[164:167]
  ds_read_b128 a[108:111], v209 offset:20480
  v_and_b32 v237, s27, v228
  v_mfma_f32_16x16x32_bf16 v[168:171], a[28:31], a[128:131], v[168:171]
  v_accvgpr_write_b32 a144, v228
  v_fma_f32 v236, v236, v8, v236
  v_mfma_f32_16x16x32_bf16 v[172:175], a[28:31], a[132:135], v[172:175]
  s_waitcnt vmcnt(23)
  v_mfma_f32_16x16x32_bf16 v[176:179], a[32:35], a[120:123], v[176:179]
  buffer_load_dwordx4 a[28:31], v208, s[8:11], s20 offen offset:3072
  v_mfma_f32_16x16x32_bf16 v[180:183], a[32:35], a[124:127], v[180:183]
  ds_read_b128 a[112:115], v209 offset:24576
  v_fma_f32 v237, v237, v9, v237
  v_mfma_f32_16x16x32_bf16 v[184:187], a[32:35], a[128:131], v[184:187]
  v_cvt_pk_bf16_f32 v8, v236, v237
  v_lshlrev_b32 v238, 16, v229
  v_mfma_f32_16x16x32_bf16 v[188:191], a[32:35], a[132:135], v[188:191]
  v_mfma_f32_16x16x32_bf16 v[192:195], a[36:39], a[120:123], v[192:195]
  s_add_u32 s20, s20, 4096
  buffer_load_dwordx4 a[32:35], v208, s[8:11], s20 offen
  v_mfma_f32_16x16x32_bf16 v[196:199], a[36:39], a[124:127], v[196:199]
  ds_read_b128 a[116:119], v209 offset:28672
  v_and_b32 v239, s27, v229
  v_mfma_f32_16x16x32_bf16 v[200:203], a[36:39], a[128:131], v[200:203]
  v_accvgpr_write_b32 a145, v229
  v_fma_f32 v238, v238, v10, v238
  v_mfma_f32_16x16x32_bf16 v[204:207], a[36:39], a[132:135], v[204:207]
  s_waitcnt vmcnt(23) lgkmcnt(0)
  v_mfma_f32_16x16x32_bf16 v[128:131], a[40:43], a[104:107], v[128:131]
  buffer_load_dwordx4 a[36:39], v208, s[8:11], s20 offen offset:1024
  v_mfma_f32_16x16x32_bf16 v[132:135], a[40:43], a[108:111], v[132:135]
  v_fma_f32 v239, v239, v11, v239
  v_mfma_f32_16x16x32_bf16 v[136:139], a[40:43], a[112:115], v[136:139]
  v_cvt_pk_bf16_f32 v9, v238, v239
  v_lshlrev_b32 v236, 16, v230
  v_mfma_f32_16x16x32_bf16 v[140:143], a[40:43], a[116:119], v[140:143]
  v_mfma_f32_16x16x32_bf16 v[144:147], a[44:47], a[104:107], v[144:147]
  buffer_load_dwordx4 a[40:43], v208, s[8:11], s20 offen offset:2048
  v_and_b32 v237, s27, v230
  v_mfma_f32_16x16x32_bf16 v[148:151], a[44:47], a[108:111], v[148:151]
  ds_read_b128 a[120:123], v210 offset:16384
  v_accvgpr_write_b32 a146, v230
  v_mfma_f32_16x16x32_bf16 v[152:155], a[44:47], a[112:115], v[152:155]
  v_fma_f32 v236, v236, v24, v236
  v_fma_f32 v237, v237, v25, v237
  v_mfma_f32_16x16x32_bf16 v[156:159], a[44:47], a[116:119], v[156:159]
  s_waitcnt vmcnt(23)
  v_mfma_f32_16x16x32_bf16 v[160:163], a[48:51], a[104:107], v[160:163]
  buffer_load_dwordx4 a[44:47], v208, s[8:11], s20 offen offset:3072
  v_mfma_f32_16x16x32_bf16 v[164:167], a[48:51], a[108:111], v[164:167]
  ds_read_b128 a[124:127], v210 offset:20480
  v_cvt_pk_bf16_f32 v10, v236, v237
  v_mfma_f32_16x16x32_bf16 v[168:171], a[48:51], a[112:115], v[168:171]
  v_lshlrev_b32 v238, 16, v231
  v_and_b32 v239, s27, v231
  v_mfma_f32_16x16x32_bf16 v[172:175], a[48:51], a[116:119], v[172:175]
  v_mfma_f32_16x16x32_bf16 v[176:179], a[52:55], a[104:107], v[176:179]
  s_add_u32 s20, s20, 4096
  buffer_load_dwordx4 a[48:51], v208, s[8:11], s20 offen
  v_mfma_f32_16x16x32_bf16 v[180:183], a[52:55], a[108:111], v[180:183]
  ds_read_b128 a[128:131], v210 offset:24576
  v_accvgpr_write_b32 a147, v231
  v_mfma_f32_16x16x32_bf16 v[184:187], a[52:55], a[112:115], v[184:187]
  v_fma_f32 v238, v238, v26, v238
  v_fma_f32 v239, v239, v27, v239
  v_mfma_f32_16x16x32_bf16 v[188:191], a[52:55], a[116:119], v[188:191]
  s_waitcnt vmcnt(23)
  v_mfma_f32_16x16x32_bf16 v[192:195], a[56:59], a[104:107], v[192:195]
  buffer_load_dwordx4 a[52:55], v208, s[8:11], s20 offen offset:1024
  v_mfma_f32_16x16x32_bf16 v[196:199], a[56:59], a[108:111], v[196:199]
  ds_read_b128 a[132:135], v210 offset:28672
  v_cvt_pk_bf16_f32 v11, v238, v239
  v_mfma_f32_16x16x32_bf16 v[200:203], a[56:59], a[112:115], v[200:203]
  ds_read_b128 v[228:231], v218
  v_lshlrev_b32 v236, 16, v232
  v_mfma_f32_16x16x32_bf16 v[204:207], a[56:59], a[116:119], v[204:207]
  s_waitcnt lgkmcnt(1)
  v_mfma_f32_16x16x32_bf16 v[128:131], a[60:63], a[120:123], v[128:131]
  buffer_load_dwordx4 a[56:59], v208, s[8:11], s20 offen offset:2048
  v_mfma_f32_16x16x32_bf16 v[132:135], a[60:63], a[124:127], v[132:135]
  v_and_b32 v237, s27, v232
  v_mfma_f32_16x16x32_bf16 v[136:139], a[60:63], a[128:131], v[136:139]
  v_accvgpr_write_b32 a148, v232
  v_fma_f32 v236, v236, v12, v236
  v_mfma_f32_16x16x32_bf16 v[140:143], a[60:63], a[132:135], v[140:143]
  s_waitcnt vmcnt(23)
  v_mfma_f32_16x16x32_bf16 v[144:147], a[64:67], a[120:123], v[144:147]
  buffer_load_dwordx4 a[60:63], v208, s[8:11], s20 offen offset:3072
  v_mfma_f32_16x16x32_bf16 v[148:151], a[64:67], a[124:127], v[148:151]
  ds_read_b128 a[104:107], v211 offset:16384
  v_fma_f32 v237, v237, v13, v237
  v_mfma_f32_16x16x32_bf16 v[152:155], a[64:67], a[128:131], v[152:155]
  v_cvt_pk_bf16_f32 v12, v236, v237
  v_lshlrev_b32 v238, 16, v233
  v_mfma_f32_16x16x32_bf16 v[156:159], a[64:67], a[132:135], v[156:159]
  v_mfma_f32_16x16x32_bf16 v[160:163], a[68:71], a[120:123], v[160:163]
  s_add_u32 s20, s20, 4096
  buffer_load_dwordx4 a[64:67], v208, s[8:11], s20 offen
  v_mfma_f32_16x16x32_bf16 v[164:167], a[68:71], a[124:127], v[164:167]
  ds_read_b128 a[108:111], v211 offset:20480
  v_and_b32 v239, s27, v233
  v_mfma_f32_16x16x32_bf16 v[168:171], a[68:71], a[128:131], v[168:171]
  v_accvgpr_write_b32 a149, v233
  v_fma_f32 v238, v238, v14, v238
  v_mfma_f32_16x16x32_bf16 v[172:175], a[68:71], a[132:135], v[172:175]
  s_waitcnt vmcnt(23)
  v_mfma_f32_16x16x32_bf16 v[176:179], a[72:75], a[120:123], v[176:179]
  buffer_load_dwordx4 a[68:71], v208, s[8:11], s20 offen offset:1024
  v_fma_f32 v239, v239, v15, v239
  v_mfma_f32_16x16x32_bf16 v[180:183], a[72:75], a[124:127], v[180:183]
  ds_read_b128 a[112:115], v211 offset:24576
  v_cvt_pk_bf16_f32 v13, v238, v239
  v_mfma_f32_16x16x32_bf16 v[184:187], a[72:75], a[128:131], v[184:187]
  v_lshlrev_b32 v236, 16, v234
  v_and_b32 v237, s27, v234
  v_mfma_f32_16x16x32_bf16 v[188:191], a[72:75], a[132:135], v[188:191]
  v_mfma_f32_16x16x32_bf16 v[192:195], a[76:79], a[120:123], v[192:195]
  buffer_load_dwordx4 a[72:75], v208, s[8:11], s20 offen offset:2048
  v_mfma_f32_16x16x32_bf16 v[196:199], a[76:79], a[124:127], v[196:199]
  ds_read_b128 a[116:119], v211 offset:28672
  v_accvgpr_write_b32 a150, v234
  v_mfma_f32_16x16x32_bf16 v[200:203], a[76:79], a[128:131], v[200:203]
  v_fma_f32 v236, v236, v28, v236
  v_fma_f32 v237, v237, v29, v237
  v_mfma_f32_16x16x32_bf16 v[204:207], a[76:79], a[132:135], v[204:207]
  s_waitcnt vmcnt(23) lgkmcnt(0)
  v_mfma_f32_16x16x32_bf16 v[128:131], a[80:83], a[104:107], v[128:131]
  buffer_load_dwordx4 a[76:79], v208, s[8:11], s20 offen offset:3072
  v_mfma_f32_16x16x32_bf16 v[132:135], a[80:83], a[108:111], v[132:135]
  v_cvt_pk_bf16_f32 v14, v236, v237
  v_mfma_f32_16x16x32_bf16 v[136:139], a[80:83], a[112:115], v[136:139]
  v_lshlrev_b32 v238, 16, v235
  v_and_b32 v239, s27, v235
  v_mfma_f32_16x16x32_bf16 v[140:143], a[80:83], a[116:119], v[140:143]
  v_mfma_f32_16x16x32_bf16 v[144:147], a[84:87], a[104:107], v[144:147]
  s_add_u32 s20, s20, 4096
  buffer_load_dwordx4 a[80:83], v208, s[8:11], s20 offen
  v_mfma_f32_16x16x32_bf16 v[148:151], a[84:87], a[108:111], v[148:151]
  ds_read_b128 a[120:123], v212 offset:16384
  v_accvgpr_write_b32 a151, v235
  v_mfma_f32_16x16x32_bf16 v[152:155], a[84:87], a[112:115], v[152:155]
  v_fma_f32 v238, v238, v30, v238
  v_fma_f32 v239, v239, v31, v239
  v_mfma_f32_16x16x32_bf16 v[156:159], a[84:87], a[116:119], v[156:159]
  s_waitcnt vmcnt(23)
  v_mfma_f32_16x16x32_bf16 v[160:163], a[88:91], a[104:107], v[160:163]
  buffer_load_dwordx4 a[84:87], v208, s[8:11], s20 offen offset:1024
  v_mfma_f32_16x16x32_bf16 v[164:167], a[88:91], a[108:111], v[164:167]
  ds_read_b128 a[124:127], v212 offset:20480
  v_cvt_pk_bf16_f32 v15, v238, v239
  v_mfma_f32_16x16x32_bf16 v[168:171], a[88:91], a[112:115], v[168:171]
  ds_read_b128 v[20:23], v226 offset:3328
  ds_read_b128 v[16:19], v226 offset:3344
  v_mfma_f32_16x16x32_bf16 v[172:175], a[88:91], a[116:119], v[172:175]
  v_mfma_f32_16x16x32_bf16 v[176:179], a[92:95], a[104:107], v[176:179]
  buffer_load_dwordx4 a[88:91], v208, s[8:11], s20 offen offset:2048
  v_mfma_f32_16x16x32_bf16 v[180:183], a[92:95], a[108:111], v[180:183]
  ds_read_b128 a[128:131], v212 offset:24576
  ds_read_b128 v[232:235], v218 offset:4096
  v_mfma_f32_16x16x32_bf16 v[184:187], a[92:95], a[112:115], v[184:187]
  v_lshlrev_b32 v236, 16, v228
  v_and_b32 v237, s27, v228
  v_mfma_f32_16x16x32_bf16 v[188:191], a[92:95], a[116:119], v[188:191]
  s_waitcnt vmcnt(23)
  v_mfma_f32_16x16x32_bf16 v[192:195], a[96:99], a[104:107], v[192:195]
  buffer_load_dwordx4 a[92:95], v208, s[8:11], s20 offen offset:3072
  v_mfma_f32_16x16x32_bf16 v[196:199], a[96:99], a[108:111], v[196:199]
  ds_read_b128 a[132:135], v212 offset:28672
  v_accvgpr_write_b32 a152, v228
  v_mfma_f32_16x16x32_bf16 v[200:203], a[96:99], a[112:115], v[200:203]
  v_fma_f32 v236, v236, v32, v236
  v_fma_f32 v237, v237, v33, v237
  v_mfma_f32_16x16x32_bf16 v[204:207], a[96:99], a[116:119], v[204:207]
  s_waitcnt lgkmcnt(0)
  v_mfma_f32_16x16x32_bf16 v[128:131], a[100:103], a[120:123], v[128:131]
  s_add_u32 s20, s20, 4096
  buffer_load_dwordx4 a[96:99], v208, s[8:11], s20 offen
  v_mfma_f32_16x16x32_bf16 v[132:135], a[100:103], a[124:127], v[132:135]
  v_cvt_pk_bf16_f32 v32, v236, v237
  v_mfma_f32_16x16x32_bf16 v[136:139], a[100:103], a[128:131], v[136:139]
  v_lshlrev_b32 v238, 16, v229
  v_and_b32 v239, s27, v229
  v_mfma_f32_16x16x32_bf16 v[140:143], a[100:103], a[132:135], v[140:143]
  s_waitcnt vmcnt(23)
  v_mfma_f32_16x16x32_bf16 v[144:147], a[0:3], a[120:123], v[144:147]
  buffer_load_dwordx4 a[100:103], v208, s[8:11], s20 offen offset:1024
  v_accvgpr_write_b32 a153, v229
  v_mfma_f32_16x16x32_bf16 v[148:151], a[0:3], a[124:127], v[148:151]
  ds_read_b128 a[104:107], v209 offset:32768
  v_fma_f32 v238, v238, v34, v238
  v_mfma_f32_16x16x32_bf16 v[152:155], a[0:3], a[128:131], v[152:155]
  v_fma_f32 v239, v239, v35, v239
  v_cvt_pk_bf16_f32 v33, v238, v239
  v_mfma_f32_16x16x32_bf16 v[156:159], a[0:3], a[132:135], v[156:159]
  v_mfma_f32_16x16x32_bf16 v[160:163], a[4:7], a[120:123], v[160:163]
  buffer_load_dwordx4 a[0:3], v208, s[8:11], s20 offen offset:2048
  v_mfma_f32_16x16x32_bf16 v[164:167], a[4:7], a[124:127], v[164:167]
  ds_read_b128 a[108:111], v209 offset:36864
  v_lshlrev_b32 v236, 16, v230
  v_mfma_f32_16x16x32_bf16 v[168:171], a[4:7], a[128:131], v[168:171]
  v_and_b32 v237, s27, v230
  v_accvgpr_write_b32 a154, v230
  v_mfma_f32_16x16x32_bf16 v[172:175], a[4:7], a[132:135], v[172:175]
  s_waitcnt vmcnt(23)
  v_mfma_f32_16x16x32_bf16 v[176:179], a[8:11], a[120:123], v[176:179]
  buffer_load_dwordx4 a[4:7], v208, s[8:11], s20 offen offset:3072
  v_mfma_f32_16x16x32_bf16 v[180:183], a[8:11], a[124:127], v[180:183]
  ds_read_b128 a[112:115], v209 offset:40960
  v_fma_f32 v236, v236, v48, v236
  v_mfma_f32_16x16x32_bf16 v[184:187], a[8:11], a[128:131], v[184:187]
  v_fma_f32 v237, v237, v49, v237
  v_cvt_pk_bf16_f32 v34, v236, v237
  v_mfma_f32_16x16x32_bf16 v[188:191], a[8:11], a[132:135], v[188:191]
  v_mfma_f32_16x16x32_bf16 v[192:195], a[12:15], a[120:123], v[192:195]
  s_add_u32 s20, s20, 4096
  buffer_load_dwordx4 a[8:11], v208, s[8:11], s20 offen
  v_mfma_f32_16x16x32_bf16 v[196:199], a[12:15], a[124:127], v[196:199]
  ds_read_b128 a[116:119], v209 offset:45056
  v_lshlrev_b32 v238, 16, v231
  v_mfma_f32_16x16x32_bf16 v[200:203], a[12:15], a[128:131], v[200:203]
  v_and_b32 v239, s27, v231
  v_accvgpr_write_b32 a155, v231
  v_mfma_f32_16x16x32_bf16 v[204:207], a[12:15], a[132:135], v[204:207]
  s_waitcnt vmcnt(23) lgkmcnt(0)
  v_mfma_f32_16x16x32_bf16 v[128:131], a[16:19], a[104:107], v[128:131]
  buffer_load_dwordx4 a[12:15], v208, s[8:11], s20 offen offset:1024
  v_mfma_f32_16x16x32_bf16 v[132:135], a[16:19], a[108:111], v[132:135]
  v_fma_f32 v238, v238, v50, v238
  v_mfma_f32_16x16x32_bf16 v[136:139], a[16:19], a[112:115], v[136:139]
  v_fma_f32 v239, v239, v51, v239
  v_cvt_pk_bf16_f32 v35, v238, v239
  v_mfma_f32_16x16x32_bf16 v[140:143], a[16:19], a[116:119], v[140:143]
  v_mfma_f32_16x16x32_bf16 v[144:147], a[20:23], a[104:107], v[144:147]
  buffer_load_dwordx4 a[16:19], v208, s[8:11], s20 offen offset:2048
  v_mfma_f32_16x16x32_bf16 v[148:151], a[20:23], a[108:111], v[148:151]
  ds_read_b128 a[120:123], v210 offset:32768
  ds_read_b128 v[228:231], v218 offset:8192
  v_mfma_f32_16x16x32_bf16 v[152:155], a[20:23], a[112:115], v[152:155]
  v_lshlrev_b32 v236, 16, v232
  v_and_b32 v237, s27, v232
  v_mfma_f32_16x16x32_bf16 v[156:159], a[20:23], a[116:119], v[156:159]
  s_waitcnt vmcnt(23)
  v_mfma_f32_16x16x32_bf16 v[160:163], a[24:27], a[104:107], v[160:163]
  buffer_load_dwordx4 a[20:23], v208, s[8:11], s20 offen offset:3072
  v_mfma_f32_16x16x32_bf16 v[164:167], a[24:27], a[108:111], v[164:167]
  ds_read_b128 a[124:127], v210 offset:36864
  v_accvgpr_write_b32 a156, v232
  v_mfma_f32_16x16x32_bf16 v[168:171], a[24:27], a[112:115], v[168:171]
  v_fma_f32 v236, v236, v36, v236
  v_fma_f32 v237, v237, v37, v237
  v_mfma_f32_16x16x32_bf16 v[172:175], a[24:27], a[116:119], v[172:175]
  v_mfma_f32_16x16x32_bf16 v[176:179], a[28:31], a[104:107], v[176:179]
  s_add_u32 s20, s20, 4096
  buffer_load_dwordx4 a[24:27], v208, s[8:11], s20 offen
  v_mfma_f32_16x16x32_bf16 v[180:183], a[28:31], a[108:111], v[180:183]
  ds_read_b128 a[128:131], v210 offset:40960
  v_cvt_pk_bf16_f32 v36, v236, v237
  v_mfma_f32_16x16x32_bf16 v[184:187], a[28:31], a[112:115], v[184:187]
  v_lshlrev_b32 v238, 16, v233
  v_and_b32 v239, s27, v233
  v_mfma_f32_16x16x32_bf16 v[188:191], a[28:31], a[116:119], v[188:191]
  v_accvgpr_write_b32 a157, v233
  s_waitcnt vmcnt(23)
  v_mfma_f32_16x16x32_bf16 v[192:195], a[32:35], a[104:107], v[192:195]
  buffer_load_dwordx4 a[28:31], v208, s[8:11], s20 offen offset:1024
  v_mfma_f32_16x16x32_bf16 v[196:199], a[32:35], a[108:111], v[196:199]
  ds_read_b128 a[132:135], v210 offset:45056
  v_fma_f32 v238, v238, v38, v238
  v_mfma_f32_16x16x32_bf16 v[200:203], a[32:35], a[112:115], v[200:203]
  v_fma_f32 v239, v239, v39, v239
  v_cvt_pk_bf16_f32 v37, v238, v239
  v_mfma_f32_16x16x32_bf16 v[204:207], a[32:35], a[116:119], v[204:207]
  s_waitcnt lgkmcnt(0)
  v_mfma_f32_16x16x32_bf16 v[128:131], a[36:39], a[120:123], v[128:131]
  buffer_load_dwordx4 a[32:35], v208, s[8:11], s20 offen offset:2048
  v_mfma_f32_16x16x32_bf16 v[132:135], a[36:39], a[124:127], v[132:135]
  v_lshlrev_b32 v236, 16, v234
  v_mfma_f32_16x16x32_bf16 v[136:139], a[36:39], a[128:131], v[136:139]
  v_and_b32 v237, s27, v234
  v_accvgpr_write_b32 a158, v234
  v_mfma_f32_16x16x32_bf16 v[140:143], a[36:39], a[132:135], v[140:143]
  s_waitcnt vmcnt(23)
  v_mfma_f32_16x16x32_bf16 v[144:147], a[40:43], a[120:123], v[144:147]
  buffer_load_dwordx4 a[36:39], v208, s[8:11], s20 offen offset:3072
  v_mfma_f32_16x16x32_bf16 v[148:151], a[40:43], a[124:127], v[148:151]
  ds_read_b128 a[104:107], v211 offset:32768
  v_fma_f32 v236, v236, v52, v236
  v_mfma_f32_16x16x32_bf16 v[152:155], a[40:43], a[128:131], v[152:155]
  v_fma_f32 v237, v237, v53, v237
  v_cvt_pk_bf16_f32 v38, v236, v237
  v_mfma_f32_16x16x32_bf16 v[156:159], a[40:43], a[132:135], v[156:159]
  v_mfma_f32_16x16x32_bf16 v[160:163], a[44:47], a[120:123], v[160:163]
  s_add_u32 s20, s20, 4096
  buffer_load_dwordx4 a[40:43], v208, s[8:11], s20 offen
  v_mfma_f32_16x16x32_bf16 v[164:167], a[44:47], a[124:127], v[164:167]
  ds_read_b128 a[108:111], v211 offset:36864
  v_lshlrev_b32 v238, 16, v235
  v_mfma_f32_16x16x32_bf16 v[168:171], a[44:47], a[128:131], v[168:171]
  v_and_b32 v239, s27, v235
  v_accvgpr_write_b32 a159, v235
  v_mfma_f32_16x16x32_bf16 v[172:175], a[44:47], a[132:135], v[172:175]
  s_waitcnt vmcnt(23)
  v_mfma_f32_16x16x32_bf16 v[176:179], a[48:51], a[120:123], v[176:179]
  buffer_load_dwordx4 a[44:47], v208, s[8:11], s20 offen offset:1024
  v_mfma_f32_16x16x32_bf16 v[180:183], a[48:51], a[124:127], v[180:183]
  ds_read_b128 a[112:115], v211 offset:40960
  v_fma_f32 v238, v238, v54, v238
  v_mfma_f32_16x16x32_bf16 v[184:187], a[48:51], a[128:131], v[184:187]
  v_fma_f32 v239, v239, v55, v239
  v_cvt_pk_bf16_f32 v39, v238, v239
  v_mfma_f32_16x16x32_bf16 v[188:191], a[48:51], a[132:135], v[188:191]
  v_mfma_f32_16x16x32_bf16 v[192:195], a[52:55], a[120:123], v[192:195]
  buffer_load_dwordx4 a[48:51], v208, s[8:11], s20 offen offset:2048
  v_mfma_f32_16x16x32_bf16 v[196:199], a[52:55], a[124:127], v[196:199]
  ds_read_b128 a[116:119], v211 offset:45056
  ds_read_b128 v[232:235], v218 offset:12288
  v_mfma_f32_16x16x32_bf16 v[200:203], a[52:55], a[128:131], v[200:203]
  v_lshlrev_b32 v236, 16, v228
  v_and_b32 v237, s27, v228
  v_mfma_f32_16x16x32_bf16 v[204:207], a[52:55], a[132:135], v[204:207]
  s_waitcnt vmcnt(23) lgkmcnt(1)
  v_mfma_f32_16x16x32_bf16 v[128:131], a[56:59], a[104:107], v[128:131]
  buffer_load_dwordx4 a[52:55], v208, s[8:11], s20 offen offset:3072
  v_mfma_f32_16x16x32_bf16 v[132:135], a[56:59], a[108:111], v[132:135]
  v_accvgpr_write_b32 a160, v228
  v_fma_f32 v236, v236, v40, v236
  v_mfma_f32_16x16x32_bf16 v[136:139], a[56:59], a[112:115], v[136:139]
  v_fma_f32 v237, v237, v41, v237
  v_cvt_pk_bf16_f32 v40, v236, v237
  v_mfma_f32_16x16x32_bf16 v[140:143], a[56:59], a[116:119], v[140:143]
  v_mfma_f32_16x16x32_bf16 v[144:147], a[60:63], a[104:107], v[144:147]
  s_add_u32 s20, s20, 4096
  buffer_load_dwordx4 a[56:59], v208, s[8:11], s20 offen
  v_mfma_f32_16x16x32_bf16 v[148:151], a[60:63], a[108:111], v[148:151]
  ds_read_b128 a[120:123], v212 offset:32768
  v_lshlrev_b32 v238, 16, v229
  v_mfma_f32_16x16x32_bf16 v[152:155], a[60:63], a[112:115], v[152:155]
  v_and_b32 v239, s27, v229
  v_accvgpr_write_b32 a161, v229
  v_mfma_f32_16x16x32_bf16 v[156:159], a[60:63], a[116:119], v[156:159]
  s_waitcnt vmcnt(23)
  v_mfma_f32_16x16x32_bf16 v[160:163], a[64:67], a[104:107], v[160:163]
  buffer_load_dwordx4 a[60:63], v208, s[8:11], s20 offen offset:1024
  v_mfma_f32_16x16x32_bf16 v[164:167], a[64:67], a[108:111], v[164:167]
  ds_read_b128 a[124:127], v212 offset:36864
  v_fma_f32 v238, v238, v42, v238
  v_mfma_f32_16x16x32_bf16 v[168:171], a[64:67], a[112:115], v[168:171]
  v_fma_f32 v239, v239, v43, v239
  v_cvt_pk_bf16_f32 v41, v238, v239
  v_mfma_f32_16x16x32_bf16 v[172:175], a[64:67], a[116:119], v[172:175]
  v_mfma_f32_16x16x32_bf16 v[176:179], a[68:71], a[104:107], v[176:179]
  buffer_load_dwordx4 a[64:67], v208, s[8:11], s20 offen offset:2048
  v_mfma_f32_16x16x32_bf16 v[180:183], a[68:71], a[108:111], v[180:183]
  ds_read_b128 a[128:131], v212 offset:40960
  v_lshlrev_b32 v236, 16, v230
  v_mfma_f32_16x16x32_bf16 v[184:187], a[68:71], a[112:115], v[184:187]
  v_and_b32 v237, s27, v230
  v_accvgpr_write_b32 a162, v230
  v_mfma_f32_16x16x32_bf16 v[188:191], a[68:71], a[116:119], v[188:191]
  s_waitcnt vmcnt(23)
  v_mfma_f32_16x16x32_bf16 v[192:195], a[72:75], a[104:107], v[192:195]
  buffer_load_dwordx4 a[68:71], v208, s[8:11], s20 offen offset:3072
  v_mfma_f32_16x16x32_bf16 v[196:199], a[72:75], a[108:111], v[196:199]
  ds_read_b128 a[132:135], v212 offset:45056
  v_fma_f32 v236, v236, v56, v236
  v_mfma_f32_16x16x32_bf16 v[200:203], a[72:75], a[112:115], v[200:203]
  v_fma_f32 v237, v237, v57, v237
  v_cvt_pk_bf16_f32 v42, v236, v237
  v_mfma_f32_16x16x32_bf16 v[204:207], a[72:75], a[116:119], v[204:207]
  s_waitcnt lgkmcnt(0)
  v_mfma_f32_16x16x32_bf16 v[128:131], a[76:79], a[120:123], v[128:131]
  s_add_u32 s20, s20, 4096
  buffer_load_dwordx4 a[72:75], v208, s[8:11], s20 offen
  v_mfma_f32_16x16x32_bf16 v[132:135], a[76:79], a[124:127], v[132:135]
  v_lshlrev_b32 v238, 16, v231
  v_mfma_f32_16x16x32_bf16 v[136:139], a[76:79], a[128:131], v[136:139]
  v_and_b32 v239, s27, v231
  v_accvgpr_write_b32 a163, v231
  v_mfma_f32_16x16x32_bf16 v[140:143], a[76:79], a[132:135], v[140:143]
  s_waitcnt vmcnt(23)
  v_mfma_f32_16x16x32_bf16 v[144:147], a[80:83], a[120:123], v[144:147]
  buffer_load_dwordx4 a[76:79], v208, s[8:11], s20 offen offset:1024
  v_mfma_f32_16x16x32_bf16 v[148:151], a[80:83], a[124:127], v[148:151]
  ds_read_b128 a[104:107], v209 offset:49152
  v_fma_f32 v238, v238, v58, v238
  v_mfma_f32_16x16x32_bf16 v[152:155], a[80:83], a[128:131], v[152:155]
  v_fma_f32 v239, v239, v59, v239
  v_cvt_pk_bf16_f32 v43, v238, v239
  v_mfma_f32_16x16x32_bf16 v[156:159], a[80:83], a[132:135], v[156:159]
  v_mfma_f32_16x16x32_bf16 v[160:163], a[84:87], a[120:123], v[160:163]
  buffer_load_dwordx4 a[80:83], v208, s[8:11], s20 offen offset:2048
  ds_read_b128 v[228:231], v219
  v_mfma_f32_16x16x32_bf16 v[164:167], a[84:87], a[124:127], v[164:167]
  ds_read_b128 a[108:111], v209 offset:53248
  v_lshlrev_b32 v236, 16, v232
  v_mfma_f32_16x16x32_bf16 v[168:171], a[84:87], a[128:131], v[168:171]
  v_and_b32 v237, s27, v232
  v_accvgpr_write_b32 a164, v232
  v_mfma_f32_16x16x32_bf16 v[172:175], a[84:87], a[132:135], v[172:175]
  s_waitcnt vmcnt(23)
  v_mfma_f32_16x16x32_bf16 v[176:179], a[88:91], a[120:123], v[176:179]
  buffer_load_dwordx4 a[84:87], v208, s[8:11], s20 offen offset:3072
  v_mfma_f32_16x16x32_bf16 v[180:183], a[88:91], a[124:127], v[180:183]
  ds_read_b128 a[112:115], v209 offset:57344
  v_fma_f32 v236, v236, v44, v236
  v_mfma_f32_16x16x32_bf16 v[184:187], a[88:91], a[128:131], v[184:187]
  v_fma_f32 v237, v237, v45, v237
  v_cvt_pk_bf16_f32 v44, v236, v237
  v_mfma_f32_16x16x32_bf16 v[188:191], a[88:91], a[132:135], v[188:191]
  v_mfma_f32_16x16x32_bf16 v[192:195], a[92:95], a[120:123], v[192:195]
  s_add_u32 s20, s20, 4096
  buffer_load_dwordx4 a[88:91], v208, s[8:11], s20 offen
  v_mfma_f32_16x16x32_bf16 v[196:199], a[92:95], a[124:127], v[196:199]
  ds_read_b128 a[116:119], v209 offset:61440
  v_lshlrev_b32 v238, 16, v233
  v_mfma_f32_16x16x32_bf16 v[200:203], a[92:95], a[128:131], v[200:203]
  v_and_b32 v239, s27, v233
  v_accvgpr_write_b32 a165, v233
  v_mfma_f32_16x16x32_bf16 v[204:207], a[92:95], a[132:135], v[204:207]
  s_waitcnt vmcnt(23) lgkmcnt(0)
  v_mfma_f32_16x16x32_bf16 v[128:131], a[96:99], a[104:107], v[128:131]
  buffer_load_dwordx4 a[92:95], v208, s[8:11], s20 offen offset:1024
  v_mfma_f32_16x16x32_bf16 v[132:135], a[96:99], a[108:111], v[132:135]
  v_fma_f32 v238, v238, v46, v238
  v_mfma_f32_16x16x32_bf16 v[136:139], a[96:99], a[112:115], v[136:139]
  v_fma_f32 v239, v239, v47, v239
  v_cvt_pk_bf16_f32 v45, v238, v239
  v_mfma_f32_16x16x32_bf16 v[140:143], a[96:99], a[116:119], v[140:143]
  v_mfma_f32_16x16x32_bf16 v[144:147], a[100:103], a[104:107], v[144:147]
  buffer_load_dwordx4 a[96:99], v208, s[8:11], s20 offen offset:2048
  v_mfma_f32_16x16x32_bf16 v[148:151], a[100:103], a[108:111], v[148:151]
  ds_read_b128 a[120:123], v210 offset:49152
  v_lshlrev_b32 v236, 16, v234
  v_mfma_f32_16x16x32_bf16 v[152:155], a[100:103], a[112:115], v[152:155]
  v_and_b32 v237, s27, v234
  v_accvgpr_write_b32 a166, v234
  v_mfma_f32_16x16x32_bf16 v[156:159], a[100:103], a[116:119], v[156:159]
  s_waitcnt vmcnt(23)
  v_mfma_f32_16x16x32_bf16 v[160:163], a[0:3], a[104:107], v[160:163]
  buffer_load_dwordx4 a[100:103], v208, s[8:11], s20 offen offset:3072
  v_mfma_f32_16x16x32_bf16 v[164:167], a[0:3], a[108:111], v[164:167]
  ds_read_b128 a[124:127], v210 offset:53248
  v_fma_f32 v236, v236, v60, v236
  v_mfma_f32_16x16x32_bf16 v[168:171], a[0:3], a[112:115], v[168:171]
  v_fma_f32 v237, v237, v61, v237
  v_cvt_pk_bf16_f32 v46, v236, v237
  v_mfma_f32_16x16x32_bf16 v[172:175], a[0:3], a[116:119], v[172:175]
  v_mfma_f32_16x16x32_bf16 v[176:179], a[4:7], a[104:107], v[176:179]
  s_add_u32 s20, s20, 4096
  buffer_load_dwordx4 a[0:3], v208, s[8:11], s20 offen
  v_mfma_f32_16x16x32_bf16 v[180:183], a[4:7], a[108:111], v[180:183]
  ds_read_b128 a[128:131], v210 offset:57344
  v_lshlrev_b32 v238, 16, v235
  v_mfma_f32_16x16x32_bf16 v[184:187], a[4:7], a[112:115], v[184:187]
  v_and_b32 v239, s27, v235
  v_accvgpr_write_b32 a167, v235
  v_mfma_f32_16x16x32_bf16 v[188:191], a[4:7], a[116:119], v[188:191]
  s_waitcnt vmcnt(23)
  v_mfma_f32_16x16x32_bf16 v[192:195], a[8:11], a[104:107], v[192:195]
  buffer_load_dwordx4 a[4:7], v208, s[8:11], s20 offen offset:1024
  v_fma_f32 v238, v238, v62, v238
  v_mfma_f32_16x16x32_bf16 v[196:199], a[8:11], a[108:111], v[196:199]
  ds_read_b128 a[132:135], v210 offset:61440
  v_fma_f32 v239, v239, v63, v239
  v_mfma_f32_16x16x32_bf16 v[200:203], a[8:11], a[112:115], v[200:203]
  v_cvt_pk_bf16_f32 v47, v238, v239
  ds_read_b128 v[52:55], v226 offset:3456
  v_mfma_f32_16x16x32_bf16 v[204:207], a[8:11], a[116:119], v[204:207]
  s_waitcnt lgkmcnt(1)
  v_mfma_f32_16x16x32_bf16 v[128:131], a[12:15], a[120:123], v[128:131]
  buffer_load_dwordx4 a[8:11], v208, s[8:11], s20 offen offset:2048
  v_mfma_f32_16x16x32_bf16 v[132:135], a[12:15], a[124:127], v[132:135]
  ds_read_b128 v[48:51], v226 offset:3472
  v_mfma_f32_16x16x32_bf16 v[136:139], a[12:15], a[128:131], v[136:139]
  ds_read_b128 v[232:235], v219 offset:4096
  v_lshlrev_b32 v236, 16, v228
  v_mfma_f32_16x16x32_bf16 v[140:143], a[12:15], a[132:135], v[140:143]
  s_waitcnt vmcnt(23)
  v_mfma_f32_16x16x32_bf16 v[144:147], a[16:19], a[120:123], v[144:147]
  buffer_load_dwordx4 a[12:15], v208, s[8:11], s20 offen offset:3072
  v_mfma_f32_16x16x32_bf16 v[148:151], a[16:19], a[124:127], v[148:151]
  ds_read_b128 a[104:107], v211 offset:49152
  v_and_b32 v237, s27, v228
  v_mfma_f32_16x16x32_bf16 v[152:155], a[16:19], a[128:131], v[152:155]
  v_accvgpr_write_b32 a168, v228
  v_fma_f32 v236, v236, v64, v236
  v_mfma_f32_16x16x32_bf16 v[156:159], a[16:19], a[132:135], v[156:159]
  v_mfma_f32_16x16x32_bf16 v[160:163], a[20:23], a[120:123], v[160:163]
  s_add_u32 s20, s20, 4096
  buffer_load_dwordx4 a[16:19], v208, s[8:11], s20 offen
  v_mfma_f32_16x16x32_bf16 v[164:167], a[20:23], a[124:127], v[164:167]
  ds_read_b128 a[108:111], v211 offset:53248
  v_fma_f32 v237, v237, v65, v237
  v_mfma_f32_16x16x32_bf16 v[168:171], a[20:23], a[128:131], v[168:171]
  v_cvt_pk_bf16_f32 v64, v236, v237
  v_lshlrev_b32 v238, 16, v229
  v_mfma_f32_16x16x32_bf16 v[172:175], a[20:23], a[132:135], v[172:175]
  s_waitcnt vmcnt(23)
  v_mfma_f32_16x16x32_bf16 v[176:179], a[24:27], a[120:123], v[176:179]
  buffer_load_dwordx4 a[20:23], v208, s[8:11], s20 offen offset:1024
  v_mfma_f32_16x16x32_bf16 v[180:183], a[24:27], a[124:127], v[180:183]
  ds_read_b128 a[112:115], v211 offset:57344
  v_and_b32 v239, s27, v229
  v_mfma_f32_16x16x32_bf16 v[184:187], a[24:27], a[128:131], v[184:187]
  v_accvgpr_write_b32 a169, v229
  v_fma_f32 v238, v238, v66, v238
  v_mfma_f32_16x16x32_bf16 v[188:191], a[24:27], a[132:135], v[188:191]
  v_mfma_f32_16x16x32_bf16 v[192:195], a[28:31], a[120:123], v[192:195]
  buffer_load_dwordx4 a[24:27], v208, s[8:11], s20 offen offset:2048
  v_mfma_f32_16x16x32_bf16 v[196:199], a[28:31], a[124:127], v[196:199]
  ds_read_b128 a[116:119], v211 offset:61440
  v_fma_f32 v239, v239, v67, v239
  v_mfma_f32_16x16x32_bf16 v[200:203], a[28:31], a[128:131], v[200:203]
  v_cvt_pk_bf16_f32 v65, v238, v239
  v_lshlrev_b32 v236, 16, v230
  v_mfma_f32_16x16x32_bf16 v[204:207], a[28:31], a[132:135], v[204:207]
  s_waitcnt vmcnt(23) lgkmcnt(0)
  v_mfma_f32_16x16x32_bf16 v[128:131], a[32:35], a[104:107], v[128:131]
  buffer_load_dwordx4 a[28:31], v208, s[8:11], s20 offen offset:3072
  v_mfma_f32_16x16x32_bf16 v[132:135], a[32:35], a[108:111], v[132:135]
  v_and_b32 v237, s27, v230
  v_mfma_f32_16x16x32_bf16 v[136:139], a[32:35], a[112:115], v[136:139]
  v_accvgpr_write_b32 a170, v230
  v_fma_f32 v236, v236, v80, v236
  v_mfma_f32_16x16x32_bf16 v[140:143], a[32:35], a[116:119], v[140:143]
  v_mfma_f32_16x16x32_bf16 v[144:147], a[36:39], a[104:107], v[144:147]
  s_add_u32 s20, s20, 4096
  buffer_load_dwordx4 a[32:35], v208, s[8:11], s20 offen
  v_mfma_f32_16x16x32_bf16 v[148:151], a[36:39], a[108:111], v[148:151]
  ds_read_b128 a[120:123], v212 offset:49152
  v_fma_f32 v237, v237, v81, v237
  v_mfma_f32_16x16x32_bf16 v[152:155], a[36:39], a[112:115], v[152:155]
  v_cvt_pk_bf16_f32 v66, v236, v237
  v_lshlrev_b32 v238, 16, v231
  v_mfma_f32_16x16x32_bf16 v[156:159], a[36:39], a[116:119], v[156:159]
  s_waitcnt vmcnt(23)
  v_mfma_f32_16x16x32_bf16 v[160:163], a[40:43], a[104:107], v[160:163]
  buffer_load_dwordx4 a[36:39], v208, s[8:11], s20 offen offset:1024
  v_and_b32 v239, s27, v231
  v_mfma_f32_16x16x32_bf16 v[164:167], a[40:43], a[108:111], v[164:167]
  ds_read_b128 a[124:127], v212 offset:53248
  v_accvgpr_write_b32 a171, v231
  v_mfma_f32_16x16x32_bf16 v[168:171], a[40:43], a[112:115], v[168:171]
  v_fma_f32 v238, v238, v82, v238
  v_fma_f32 v239, v239, v83, v239
  v_mfma_f32_16x16x32_bf16 v[172:175], a[40:43], a[116:119], v[172:175]
  v_mfma_f32_16x16x32_bf16 v[176:179], a[44:47], a[104:107], v[176:179]
  buffer_load_dwordx4 a[40:43], v208, s[8:11], s20 offen offset:2048
  v_mfma_f32_16x16x32_bf16 v[180:183], a[44:47], a[108:111], v[180:183]
  ds_read_b128 a[128:131], v212 offset:57344
  v_cvt_pk_bf16_f32 v67, v238, v239
  v_mfma_f32_16x16x32_bf16 v[184:187], a[44:47], a[112:115], v[184:187]
  ds_read_b128 v[228:231], v219 offset:8192
  v_lshlrev_b32 v236, 16, v232
  v_mfma_f32_16x16x32_bf16 v[188:191], a[44:47], a[116:119], v[188:191]
  s_waitcnt vmcnt(23)
  v_mfma_f32_16x16x32_bf16 v[192:195], a[48:51], a[104:107], v[192:195]
  buffer_load_dwordx4 a[44:47], v208, s[8:11], s20 offen offset:3072
  v_mfma_f32_16x16x32_bf16 v[196:199], a[48:51], a[108:111], v[196:199]
  ds_read_b128 a[132:135], v212 offset:61440
  v_and_b32 v237, s27, v232
  v_mfma_f32_16x16x32_bf16 v[200:203], a[48:51], a[112:115], v[200:203]
  v_accvgpr_write_b32 a172, v232
  v_fma_f32 v236, v236, v68, v236
  v_mfma_f32_16x16x32_bf16 v[204:207], a[48:51], a[116:119], v[204:207]
  s_waitcnt lgkmcnt(0)
  v_mfma_f32_16x16x32_bf16 v[128:131], a[52:55], a[120:123], v[128:131]
  s_add_u32 s20, s20, 4096
  buffer_load_dwordx4 a[48:51], v208, s[8:11], s20 offen
  v_mfma_f32_16x16x32_bf16 v[132:135], a[52:55], a[124:127], v[132:135]
  v_fma_f32 v237, v237, v69, v237
  v_mfma_f32_16x16x32_bf16 v[136:139], a[52:55], a[128:131], v[136:139]
  v_cvt_pk_bf16_f32 v68, v236, v237
  v_lshlrev_b32 v238, 16, v233
  v_mfma_f32_16x16x32_bf16 v[140:143], a[52:55], a[132:135], v[140:143]
  s_waitcnt vmcnt(23)
  v_mfma_f32_16x16x32_bf16 v[144:147], a[56:59], a[120:123], v[144:147]
  buffer_load_dwordx4 a[52:55], v208, s[8:11], s20 offen offset:1024
  v_mfma_f32_16x16x32_bf16 v[148:151], a[56:59], a[124:127], v[148:151]
  ds_read_b128 a[104:107], v213
  v_and_b32 v239, s27, v233
  v_mfma_f32_16x16x32_bf16 v[152:155], a[56:59], a[128:131], v[152:155]
  v_accvgpr_write_b32 a173, v233
  v_fma_f32 v238, v238, v70, v238
  v_mfma_f32_16x16x32_bf16 v[156:159], a[56:59], a[132:135], v[156:159]
  v_mfma_f32_16x16x32_bf16 v[160:163], a[60:63], a[120:123], v[160:163]
  buffer_load_dwordx4 a[56:59], v208, s[8:11], s20 offen offset:2048
  v_mfma_f32_16x16x32_bf16 v[164:167], a[60:63], a[124:127], v[164:167]
  ds_read_b128 a[108:111], v213 offset:4096
  v_fma_f32 v239, v239, v71, v239
  v_mfma_f32_16x16x32_bf16 v[168:171], a[60:63], a[128:131], v[168:171]
  v_cvt_pk_bf16_f32 v69, v238, v239
  v_lshlrev_b32 v236, 16, v234
  v_mfma_f32_16x16x32_bf16 v[172:175], a[60:63], a[132:135], v[172:175]
  s_waitcnt vmcnt(23)
  v_mfma_f32_16x16x32_bf16 v[176:179], a[64:67], a[120:123], v[176:179]
  buffer_load_dwordx4 a[60:63], v208, s[8:11], s20 offen offset:3072
  v_mfma_f32_16x16x32_bf16 v[180:183], a[64:67], a[124:127], v[180:183]
  ds_read_b128 a[112:115], v213 offset:8192
  v_and_b32 v237, s27, v234
  v_mfma_f32_16x16x32_bf16 v[184:187], a[64:67], a[128:131], v[184:187]
  v_accvgpr_write_b32 a174, v234
  v_fma_f32 v236, v236, v84, v236
  v_mfma_f32_16x16x32_bf16 v[188:191], a[64:67], a[132:135], v[188:191]
  v_mfma_f32_16x16x32_bf16 v[192:195], a[68:71], a[120:123], v[192:195]
  s_add_u32 s20, s20, 4096
  buffer_load_dwordx4 a[64:67], v208, s[8:11], s20 offen
  v_mfma_f32_16x16x32_bf16 v[196:199], a[68:71], a[124:127], v[196:199]
  ds_read_b128 a[116:119], v213 offset:12288
  v_fma_f32 v237, v237, v85, v237
  v_mfma_f32_16x16x32_bf16 v[200:203], a[68:71], a[128:131], v[200:203]
  v_cvt_pk_bf16_f32 v70, v236, v237
  v_lshlrev_b32 v238, 16, v235
  v_mfma_f32_16x16x32_bf16 v[204:207], a[68:71], a[132:135], v[204:207]
  v_and_b32 v239, s27, v235
  s_waitcnt vmcnt(23) lgkmcnt(0)
  v_mfma_f32_16x16x32_bf16 v[128:131], a[72:75], a[104:107], v[128:131]
  buffer_load_dwordx4 a[68:71], v208, s[8:11], s20 offen offset:1024
  v_mfma_f32_16x16x32_bf16 v[132:135], a[72:75], a[108:111], v[132:135]
  v_accvgpr_write_b32 a175, v235
  v_mfma_f32_16x16x32_bf16 v[136:139], a[72:75], a[112:115], v[136:139]
  v_fma_f32 v238, v238, v86, v238
  v_fma_f32 v239, v239, v87, v239
  v_mfma_f32_16x16x32_bf16 v[140:143], a[72:75], a[116:119], v[140:143]
  v_mfma_f32_16x16x32_bf16 v[144:147], a[76:79], a[104:107], v[144:147]
  buffer_load_dwordx4 a[72:75], v208, s[8:11], s20 offen offset:2048
  v_mfma_f32_16x16x32_bf16 v[148:151], a[76:79], a[108:111], v[148:151]
  ds_read_b128 a[120:123], v214
  v_cvt_pk_bf16_f32 v71, v238, v239
  v_mfma_f32_16x16x32_bf16 v[152:155], a[76:79], a[112:115], v[152:155]
  ds_read_b128 v[232:235], v219 offset:12288
  v_lshlrev_b32 v236, 16, v228
  v_mfma_f32_16x16x32_bf16 v[156:159], a[76:79], a[116:119], v[156:159]
  s_waitcnt vmcnt(23)
  v_mfma_f32_16x16x32_bf16 v[160:163], a[80:83], a[104:107], v[160:163]
  buffer_load_dwordx4 a[76:79], v208, s[8:11], s20 offen offset:3072
  v_mfma_f32_16x16x32_bf16 v[164:167], a[80:83], a[108:111], v[164:167]
  ds_read_b128 a[124:127], v214 offset:4096
  v_and_b32 v237, s27, v228
  v_mfma_f32_16x16x32_bf16 v[168:171], a[80:83], a[112:115], v[168:171]
  v_accvgpr_write_b32 a176, v228
  v_fma_f32 v236, v236, v72, v236
  v_mfma_f32_16x16x32_bf16 v[172:175], a[80:83], a[116:119], v[172:175]
  v_mfma_f32_16x16x32_bf16 v[176:179], a[84:87], a[104:107], v[176:179]
  s_add_u32 s20, s20, 4096
  buffer_load_dwordx4 a[80:83], v208, s[8:11], s20 offen
  v_mfma_f32_16x16x32_bf16 v[180:183], a[84:87], a[108:111], v[180:183]
  ds_read_b128 a[128:131], v214 offset:8192
  v_fma_f32 v237, v237, v73, v237
  v_mfma_f32_16x16x32_bf16 v[184:187], a[84:87], a[112:115], v[184:187]
  v_cvt_pk_bf16_f32 v72, v236, v237
  v_lshlrev_b32 v238, 16, v229
  v_mfma_f32_16x16x32_bf16 v[188:191], a[84:87], a[116:119], v[188:191]
  s_waitcnt vmcnt(23)
  v_mfma_f32_16x16x32_bf16 v[192:195], a[88:91], a[104:107], v[192:195]
  buffer_load_dwordx4 a[84:87], v208, s[8:11], s20 offen offset:1024
  v_mfma_f32_16x16x32_bf16 v[196:199], a[88:91], a[108:111], v[196:199]
  ds_read_b128 a[132:135], v214 offset:12288
  v_and_b32 v239, s27, v229
  v_mfma_f32_16x16x32_bf16 v[200:203], a[88:91], a[112:115], v[200:203]
  v_accvgpr_write_b32 a177, v229
  v_fma_f32 v238, v238, v74, v238
  v_mfma_f32_16x16x32_bf16 v[204:207], a[88:91], a[116:119], v[204:207]
  s_waitcnt lgkmcnt(0)
  v_mfma_f32_16x16x32_bf16 v[128:131], a[92:95], a[120:123], v[128:131]
  buffer_load_dwordx4 a[88:91], v208, s[8:11], s20 offen offset:2048
  v_mfma_f32_16x16x32_bf16 v[132:135], a[92:95], a[124:127], v[132:135]
  v_fma_f32 v239, v239, v75, v239
  v_mfma_f32_16x16x32_bf16 v[136:139], a[92:95], a[128:131], v[136:139]
  v_cvt_pk_bf16_f32 v73, v238, v239
  v_lshlrev_b32 v236, 16, v230
  v_mfma_f32_16x16x32_bf16 v[140:143], a[92:95], a[132:135], v[140:143]
  s_waitcnt vmcnt(23)
  v_mfma_f32_16x16x32_bf16 v[144:147], a[96:99], a[120:123], v[144:147]
  buffer_load_dwordx4 a[92:95], v208, s[8:11], s20 offen offset:3072
  v_and_b32 v237, s27, v230
  v_mfma_f32_16x16x32_bf16 v[148:151], a[96:99], a[124:127], v[148:151]
  ds_read_b128 a[104:107], v215
  v_accvgpr_write_b32 a178, v230
  v_mfma_f32_16x16x32_bf16 v[152:155], a[96:99], a[128:131], v[152:155]
  v_fma_f32 v236, v236, v88, v236
  v_fma_f32 v237, v237, v89, v237
  v_mfma_f32_16x16x32_bf16 v[156:159], a[96:99], a[132:135], v[156:159]
  v_mfma_f32_16x16x32_bf16 v[160:163], a[100:103], a[120:123], v[160:163]
  s_add_u32 s20, s20, 4096
  buffer_load_dwordx4 a[96:99], v208, s[8:11], s20 offen
  v_mfma_f32_16x16x32_bf16 v[164:167], a[100:103], a[124:127], v[164:167]
  ds_read_b128 a[108:111], v215 offset:4096
  v_cvt_pk_bf16_f32 v74, v236, v237
  v_mfma_f32_16x16x32_bf16 v[168:171], a[100:103], a[128:131], v[168:171]
  v_lshlrev_b32 v238, 16, v231
  v_and_b32 v239, s27, v231
  v_mfma_f32_16x16x32_bf16 v[172:175], a[100:103], a[132:135], v[172:175]
  s_waitcnt vmcnt(23)
  v_mfma_f32_16x16x32_bf16 v[176:179], a[0:3], a[120:123], v[176:179]
  buffer_load_dwordx4 a[100:103], v208, s[8:11], s20 offen offset:1024
  v_mfma_f32_16x16x32_bf16 v[180:183], a[0:3], a[124:127], v[180:183]
  ds_read_b128 a[112:115], v215 offset:8192
  v_accvgpr_write_b32 a179, v231
  v_mfma_f32_16x16x32_bf16 v[184:187], a[0:3], a[128:131], v[184:187]
  v_fma_f32 v238, v238, v90, v238
  v_fma_f32 v239, v239, v91, v239
  v_mfma_f32_16x16x32_bf16 v[188:191], a[0:3], a[132:135], v[188:191]
  v_mfma_f32_16x16x32_bf16 v[192:195], a[4:7], a[120:123], v[192:195]
  buffer_load_dwordx4 a[0:3], v208, s[8:11], s20 offen offset:2048
  v_mfma_f32_16x16x32_bf16 v[196:199], a[4:7], a[124:127], v[196:199]
  ds_read_b128 a[116:119], v215 offset:12288
  v_cvt_pk_bf16_f32 v75, v238, v239
  v_mfma_f32_16x16x32_bf16 v[200:203], a[4:7], a[128:131], v[200:203]
  ds_read_b128 v[228:231], v220
  v_lshlrev_b32 v236, 16, v232
  v_mfma_f32_16x16x32_bf16 v[204:207], a[4:7], a[132:135], v[204:207]
  s_waitcnt vmcnt(23) lgkmcnt(1)
  v_mfma_f32_16x16x32_bf16 v[128:131], a[8:11], a[104:107], v[128:131]
  buffer_load_dwordx4 a[4:7], v208, s[8:11], s20 offen offset:3072
  v_mfma_f32_16x16x32_bf16 v[132:135], a[8:11], a[108:111], v[132:135]
  v_and_b32 v237, s27, v232
  v_mfma_f32_16x16x32_bf16 v[136:139], a[8:11], a[112:115], v[136:139]
  v_accvgpr_write_b32 a180, v232
  v_fma_f32 v236, v236, v76, v236
  v_mfma_f32_16x16x32_bf16 v[140:143], a[8:11], a[116:119], v[140:143]
  v_mfma_f32_16x16x32_bf16 v[144:147], a[12:15], a[104:107], v[144:147]
  s_add_u32 s20, s20, 4096
  buffer_load_dwordx4 a[8:11], v208, s[8:11], s20 offen
  v_mfma_f32_16x16x32_bf16 v[148:151], a[12:15], a[108:111], v[148:151]
  ds_read_b128 a[120:123], v216
  v_fma_f32 v237, v237, v77, v237
  v_mfma_f32_16x16x32_bf16 v[152:155], a[12:15], a[112:115], v[152:155]
  v_cvt_pk_bf16_f32 v76, v236, v237
  v_lshlrev_b32 v238, 16, v233
  v_mfma_f32_16x16x32_bf16 v[156:159], a[12:15], a[116:119], v[156:159]
  s_waitcnt vmcnt(23)
  v_mfma_f32_16x16x32_bf16 v[160:163], a[16:19], a[104:107], v[160:163]
  buffer_load_dwordx4 a[12:15], v208, s[8:11], s20 offen offset:1024
  v_mfma_f32_16x16x32_bf16 v[164:167], a[16:19], a[108:111], v[164:167]
  ds_read_b128 a[124:127], v216 offset:4096
  v_and_b32 v239, s27, v233
  v_mfma_f32_16x16x32_bf16 v[168:171], a[16:19], a[112:115], v[168:171]
  v_accvgpr_write_b32 a181, v233
  v_fma_f32 v238, v238, v78, v238
  v_mfma_f32_16x16x32_bf16 v[172:175], a[16:19], a[116:119], v[172:175]
  v_mfma_f32_16x16x32_bf16 v[176:179], a[20:23], a[104:107], v[176:179]
  buffer_load_dwordx4 a[16:19], v208, s[8:11], s20 offen offset:2048
  v_fma_f32 v239, v239, v79, v239
  v_mfma_f32_16x16x32_bf16 v[180:183], a[20:23], a[108:111], v[180:183]
  ds_read_b128 a[128:131], v216 offset:8192
  v_cvt_pk_bf16_f32 v77, v238, v239
  v_mfma_f32_16x16x32_bf16 v[184:187], a[20:23], a[112:115], v[184:187]
  v_lshlrev_b32 v236, 16, v234
  v_and_b32 v237, s27, v234
  v_mfma_f32_16x16x32_bf16 v[188:191], a[20:23], a[116:119], v[188:191]
  s_waitcnt vmcnt(23)
  v_mfma_f32_16x16x32_bf16 v[192:195], a[24:27], a[104:107], v[192:195]
  buffer_load_dwordx4 a[20:23], v208, s[8:11], s20 offen offset:3072
  v_mfma_f32_16x16x32_bf16 v[196:199], a[24:27], a[108:111], v[196:199]
  ds_read_b128 a[132:135], v216 offset:12288
  v_accvgpr_write_b32 a182, v234
  v_mfma_f32_16x16x32_bf16 v[200:203], a[24:27], a[112:115], v[200:203]
  v_fma_f32 v236, v236, v92, v236
  v_fma_f32 v237, v237, v93, v237
  v_mfma_f32_16x16x32_bf16 v[204:207], a[24:27], a[116:119], v[204:207]
  s_waitcnt lgkmcnt(0)
  v_mfma_f32_16x16x32_bf16 v[128:131], a[28:31], a[120:123], v[128:131]
  s_add_u32 s20, s20, 4096
  buffer_load_dwordx4 a[24:27], v208, s[8:11], s20 offen
  v_mfma_f32_16x16x32_bf16 v[132:135], a[28:31], a[124:127], v[132:135]
  v_cvt_pk_bf16_f32 v78, v236, v237
  v_mfma_f32_16x16x32_bf16 v[136:139], a[28:31], a[128:131], v[136:139]
  v_lshlrev_b32 v238, 16, v235
  v_and_b32 v239, s27, v235
  v_mfma_f32_16x16x32_bf16 v[140:143], a[28:31], a[132:135], v[140:143]
  s_waitcnt vmcnt(23)
  v_mfma_f32_16x16x32_bf16 v[144:147], a[32:35], a[120:123], v[144:147]
  buffer_load_dwordx4 a[28:31], v208, s[8:11], s20 offen offset:1024
  v_mfma_f32_16x16x32_bf16 v[148:151], a[32:35], a[124:127], v[148:151]
  ds_read_b128 a[104:107], v213 offset:16384
  v_accvgpr_write_b32 a183, v235
  v_mfma_f32_16x16x32_bf16 v[152:155], a[32:35], a[128:131], v[152:155]
  v_fma_f32 v238, v238, v94, v238
  v_fma_f32 v239, v239, v95, v239
  v_mfma_f32_16x16x32_bf16 v[156:159], a[32:35], a[132:135], v[156:159]
  v_mfma_f32_16x16x32_bf16 v[160:163], a[36:39], a[120:123], v[160:163]
  buffer_load_dwordx4 a[32:35], v208, s[8:11], s20 offen offset:2048
  v_mfma_f32_16x16x32_bf16 v[164:167], a[36:39], a[124:127], v[164:167]
  ds_read_b128 a[108:111], v213 offset:20480
  v_cvt_pk_bf16_f32 v79, v238, v239
  v_mfma_f32_16x16x32_bf16 v[168:171], a[36:39], a[128:131], v[168:171]
  ds_read_b128 v[84:87], v226 offset:3584
  ds_read_b128 v[80:83], v226 offset:3600
  v_mfma_f32_16x16x32_bf16 v[172:175], a[36:39], a[132:135], v[172:175]
  s_waitcnt vmcnt(23)
  v_mfma_f32_16x16x32_bf16 v[176:179], a[40:43], a[120:123], v[176:179]
  buffer_load_dwordx4 a[36:39], v208, s[8:11], s20 offen offset:3072
  v_mfma_f32_16x16x32_bf16 v[180:183], a[40:43], a[124:127], v[180:183]
  ds_read_b128 a[112:115], v213 offset:24576
  ds_read_b128 v[232:235], v220 offset:4096
  v_mfma_f32_16x16x32_bf16 v[184:187], a[40:43], a[128:131], v[184:187]
  v_lshlrev_b32 v236, 16, v228
  v_and_b32 v237, s27, v228
  v_mfma_f32_16x16x32_bf16 v[188:191], a[40:43], a[132:135], v[188:191]
  v_mfma_f32_16x16x32_bf16 v[192:195], a[44:47], a[120:123], v[192:195]
  s_add_u32 s20, s20, 4096
  buffer_load_dwordx4 a[40:43], v208, s[8:11], s20 offen
  v_mfma_f32_16x16x32_bf16 v[196:199], a[44:47], a[124:127], v[196:199]
  ds_read_b128 a[116:119], v213 offset:28672
  v_accvgpr_write_b32 a184, v228
  v_mfma_f32_16x16x32_bf16 v[200:203], a[44:47], a[128:131], v[200:203]
  v_fma_f32 v236, v236, v96, v236
  v_fma_f32 v237, v237, v97, v237
  v_mfma_f32_16x16x32_bf16 v[204:207], a[44:47], a[132:135], v[204:207]
  s_waitcnt vmcnt(23) lgkmcnt(0)
  v_mfma_f32_16x16x32_bf16 v[128:131], a[48:51], a[104:107], v[128:131]
  buffer_load_dwordx4 a[44:47], v208, s[8:11], s20 offen offset:1024
  v_mfma_f32_16x16x32_bf16 v[132:135], a[48:51], a[108:111], v[132:135]
  v_cvt_pk_bf16_f32 v96, v236, v237
  v_mfma_f32_16x16x32_bf16 v[136:139], a[48:51], a[112:115], v[136:139]
  v_lshlrev_b32 v238, 16, v229
  v_and_b32 v239, s27, v229
  v_mfma_f32_16x16x32_bf16 v[140:143], a[48:51], a[116:119], v[140:143]
  v_mfma_f32_16x16x32_bf16 v[144:147], a[52:55], a[104:107], v[144:147]
  buffer_load_dwordx4 a[48:51], v208, s[8:11], s20 offen offset:2048
  v_accvgpr_write_b32 a185, v229
  v_mfma_f32_16x16x32_bf16 v[148:151], a[52:55], a[108:111], v[148:151]
  ds_read_b128 a[120:123], v214 offset:16384
  v_fma_f32 v238, v238, v98, v238
  v_mfma_f32_16x16x32_bf16 v[152:155], a[52:55], a[112:115], v[152:155]
  v_fma_f32 v239, v239, v99, v239
  v_cvt_pk_bf16_f32 v97, v238, v239
  v_mfma_f32_16x16x32_bf16 v[156:159], a[52:55], a[116:119], v[156:159]
  s_waitcnt vmcnt(23)
  v_mfma_f32_16x16x32_bf16 v[160:163], a[56:59], a[104:107], v[160:163]
  buffer_load_dwordx4 a[52:55], v208, s[8:11], s20 offen offset:3072
  v_mfma_f32_16x16x32_bf16 v[164:167], a[56:59], a[108:111], v[164:167]
  ds_read_b128 a[124:127], v214 offset:20480
  v_lshlrev_b32 v236, 16, v230
  v_mfma_f32_16x16x32_bf16 v[168:171], a[56:59], a[112:115], v[168:171]
  v_and_b32 v237, s27, v230
  v_accvgpr_write_b32 a186, v230
  v_mfma_f32_16x16x32_bf16 v[172:175], a[56:59], a[116:119], v[172:175]
  v_mfma_f32_16x16x32_bf16 v[176:179], a[60:63], a[104:107], v[176:179]
  s_add_u32 s20, s20, 4096
  buffer_load_dwordx4 a[56:59], v208, s[8:11], s20 offen
  v_mfma_f32_16x16x32_bf16 v[180:183], a[60:63], a[108:111], v[180:183]
  ds_read_b128 a[128:131], v214 offset:24576
  v_fma_f32 v236, v236, v112, v236
  v_mfma_f32_16x16x32_bf16 v[184:187], a[60:63], a[112:115], v[184:187]
  v_fma_f32 v237, v237, v113, v237
  v_cvt_pk_bf16_f32 v98, v236, v237
  v_mfma_f32_16x16x32_bf16 v[188:191], a[60:63], a[116:119], v[188:191]
  s_waitcnt vmcnt(23)
  v_mfma_f32_16x16x32_bf16 v[192:195], a[64:67], a[104:107], v[192:195]
  buffer_load_dwordx4 a[60:63], v208, s[8:11], s20 offen offset:1024
  v_mfma_f32_16x16x32_bf16 v[196:199], a[64:67], a[108:111], v[196:199]
  ds_read_b128 a[132:135], v214 offset:28672
  v_lshlrev_b32 v238, 16, v231
  v_mfma_f32_16x16x32_bf16 v[200:203], a[64:67], a[112:115], v[200:203]
  v_and_b32 v239, s27, v231
  v_accvgpr_write_b32 a187, v231
  v_mfma_f32_16x16x32_bf16 v[204:207], a[64:67], a[116:119], v[204:207]
  s_waitcnt lgkmcnt(0)
  v_mfma_f32_16x16x32_bf16 v[128:131], a[68:71], a[120:123], v[128:131]
  buffer_load_dwordx4 a[64:67], v208, s[8:11], s20 offen offset:2048
  v_mfma_f32_16x16x32_bf16 v[132:135], a[68:71], a[124:127], v[132:135]
  v_fma_f32 v238, v238, v114, v238
  v_mfma_f32_16x16x32_bf16 v[136:139], a[68:71], a[128:131], v[136:139]
  v_fma_f32 v239, v239, v115, v239
  v_cvt_pk_bf16_f32 v99, v238, v239
  v_mfma_f32_16x16x32_bf16 v[140:143], a[68:71], a[132:135], v[140:143]
  s_waitcnt vmcnt(23)
  v_mfma_f32_16x16x32_bf16 v[144:147], a[72:75], a[120:123], v[144:147]
  buffer_load_dwordx4 a[68:71], v208, s[8:11], s20 offen offset:3072
  v_mfma_f32_16x16x32_bf16 v[148:151], a[72:75], a[124:127], v[148:151]
  ds_read_b128 a[104:107], v215 offset:16384
  ds_read_b128 v[228:231], v220 offset:8192
  v_mfma_f32_16x16x32_bf16 v[152:155], a[72:75], a[128:131], v[152:155]
  v_lshlrev_b32 v236, 16, v232
  v_and_b32 v237, s27, v232
  v_mfma_f32_16x16x32_bf16 v[156:159], a[72:75], a[132:135], v[156:159]
  v_mfma_f32_16x16x32_bf16 v[160:163], a[76:79], a[120:123], v[160:163]
  s_add_u32 s20, s20, 4096
  buffer_load_dwordx4 a[72:75], v208, s[8:11], s20 offen
  v_mfma_f32_16x16x32_bf16 v[164:167], a[76:79], a[124:127], v[164:167]
  ds_read_b128 a[108:111], v215 offset:20480
  v_accvgpr_write_b32 a188, v232
  v_mfma_f32_16x16x32_bf16 v[168:171], a[76:79], a[128:131], v[168:171]
  v_fma_f32 v236, v236, v100, v236
  v_fma_f32 v237, v237, v101, v237
  v_mfma_f32_16x16x32_bf16 v[172:175], a[76:79], a[132:135], v[172:175]
  s_waitcnt vmcnt(23)
  v_mfma_f32_16x16x32_bf16 v[176:179], a[80:83], a[120:123], v[176:179]
  buffer_load_dwordx4 a[76:79], v208, s[8:11], s20 offen offset:1024
  v_cvt_pk_bf16_f32 v100, v236, v237
  v_mfma_f32_16x16x32_bf16 v[180:183], a[80:83], a[124:127], v[180:183]
  ds_read_b128 a[112:115], v215 offset:24576
  v_lshlrev_b32 v238, 16, v233
  v_mfma_f32_16x16x32_bf16 v[184:187], a[80:83], a[128:131], v[184:187]
  v_and_b32 v239, s27, v233
  v_accvgpr_write_b32 a189, v233
  v_mfma_f32_16x16x32_bf16 v[188:191], a[80:83], a[132:135], v[188:191]
  v_mfma_f32_16x16x32_bf16 v[192:195], a[84:87], a[120:123], v[192:195]
  buffer_load_dwordx4 a[80:83], v208, s[8:11], s20 offen offset:2048
  v_mfma_f32_16x16x32_bf16 v[196:199], a[84:87], a[124:127], v[196:199]
  ds_read_b128 a[116:119], v215 offset:28672
  v_fma_f32 v238, v238, v102, v238
  v_mfma_f32_16x16x32_bf16 v[200:203], a[84:87], a[128:131], v[200:203]
  v_fma_f32 v239, v239, v103, v239
  v_cvt_pk_bf16_f32 v101, v238, v239
  v_mfma_f32_16x16x32_bf16 v[204:207], a[84:87], a[132:135], v[204:207]
  s_waitcnt vmcnt(23) lgkmcnt(0)
  v_mfma_f32_16x16x32_bf16 v[128:131], a[88:91], a[104:107], v[128:131]
  buffer_load_dwordx4 a[84:87], v208, s[8:11], s20 offen offset:3072
  v_mfma_f32_16x16x32_bf16 v[132:135], a[88:91], a[108:111], v[132:135]
  v_lshlrev_b32 v236, 16, v234
  v_mfma_f32_16x16x32_bf16 v[136:139], a[88:91], a[112:115], v[136:139]
  v_and_b32 v237, s27, v234
  v_accvgpr_write_b32 a190, v234
  v_mfma_f32_16x16x32_bf16 v[140:143], a[88:91], a[116:119], v[140:143]
  v_mfma_f32_16x16x32_bf16 v[144:147], a[92:95], a[104:107], v[144:147]
  s_add_u32 s20, s20, 4096
  buffer_load_dwordx4 a[88:91], v208, s[8:11], s20 offen
  v_mfma_f32_16x16x32_bf16 v[148:151], a[92:95], a[108:111], v[148:151]
  ds_read_b128 a[120:123], v216 offset:16384
  v_fma_f32 v236, v236, v116, v236
  v_mfma_f32_16x16x32_bf16 v[152:155], a[92:95], a[112:115], v[152:155]
  v_fma_f32 v237, v237, v117, v237
  v_cvt_pk_bf16_f32 v102, v236, v237
  v_mfma_f32_16x16x32_bf16 v[156:159], a[92:95], a[116:119], v[156:159]
  s_waitcnt vmcnt(23)
  v_mfma_f32_16x16x32_bf16 v[160:163], a[96:99], a[104:107], v[160:163]
  buffer_load_dwordx4 a[92:95], v208, s[8:11], s20 offen offset:1024
  v_mfma_f32_16x16x32_bf16 v[164:167], a[96:99], a[108:111], v[164:167]
  ds_read_b128 a[124:127], v216 offset:20480
  v_lshlrev_b32 v238, 16, v235
  v_mfma_f32_16x16x32_bf16 v[168:171], a[96:99], a[112:115], v[168:171]
  v_and_b32 v239, s27, v235
  v_accvgpr_write_b32 a191, v235
  v_mfma_f32_16x16x32_bf16 v[172:175], a[96:99], a[116:119], v[172:175]
  v_mfma_f32_16x16x32_bf16 v[176:179], a[100:103], a[104:107], v[176:179]
  buffer_load_dwordx4 a[96:99], v208, s[8:11], s20 offen offset:2048
  v_mfma_f32_16x16x32_bf16 v[180:183], a[100:103], a[108:111], v[180:183]
  ds_read_b128 a[128:131], v216 offset:24576
  v_fma_f32 v238, v238, v118, v238
  v_mfma_f32_16x16x32_bf16 v[184:187], a[100:103], a[112:115], v[184:187]
  v_fma_f32 v239, v239, v119, v239
  v_cvt_pk_bf16_f32 v103, v238, v239
  v_mfma_f32_16x16x32_bf16 v[188:191], a[100:103], a[116:119], v[188:191]
  s_waitcnt vmcnt(23)
  v_mfma_f32_16x16x32_bf16 v[192:195], a[0:3], a[104:107], v[192:195]
  buffer_load_dwordx4 a[100:103], v208, s[8:11], s20 offen offset:3072
  v_mfma_f32_16x16x32_bf16 v[196:199], a[0:3], a[108:111], v[196:199]
  ds_read_b128 a[132:135], v216 offset:28672
  ds_read_b128 v[232:235], v220 offset:12288
  v_mfma_f32_16x16x32_bf16 v[200:203], a[0:3], a[112:115], v[200:203]
  v_lshlrev_b32 v236, 16, v228
  v_and_b32 v237, s27, v228
  v_mfma_f32_16x16x32_bf16 v[204:207], a[0:3], a[116:119], v[204:207]
  s_waitcnt lgkmcnt(1)
  v_mfma_f32_16x16x32_bf16 v[128:131], a[4:7], a[120:123], v[128:131]
  s_add_u32 s20, s20, 4096
  buffer_load_dwordx4 a[0:3], v208, s[8:11], s20 offen
  v_mfma_f32_16x16x32_bf16 v[132:135], a[4:7], a[124:127], v[132:135]
  v_accvgpr_write_b32 a192, v228
  v_fma_f32 v236, v236, v104, v236
  v_mfma_f32_16x16x32_bf16 v[136:139], a[4:7], a[128:131], v[136:139]
  v_fma_f32 v237, v237, v105, v237
  v_cvt_pk_bf16_f32 v104, v236, v237
  v_mfma_f32_16x16x32_bf16 v[140:143], a[4:7], a[132:135], v[140:143]
  s_waitcnt vmcnt(23)
  v_mfma_f32_16x16x32_bf16 v[144:147], a[8:11], a[120:123], v[144:147]
  buffer_load_dwordx4 a[4:7], v208, s[8:11], s20 offen offset:1024
  v_mfma_f32_16x16x32_bf16 v[148:151], a[8:11], a[124:127], v[148:151]
  ds_read_b128 a[104:107], v213 offset:32768
  v_lshlrev_b32 v238, 16, v229
  v_mfma_f32_16x16x32_bf16 v[152:155], a[8:11], a[128:131], v[152:155]
  v_and_b32 v239, s27, v229
  v_accvgpr_write_b32 a193, v229
  v_mfma_f32_16x16x32_bf16 v[156:159], a[8:11], a[132:135], v[156:159]
  v_mfma_f32_16x16x32_bf16 v[160:163], a[12:15], a[120:123], v[160:163]
  buffer_load_dwordx4 a[8:11], v208, s[8:11], s20 offen offset:2048
  v_mfma_f32_16x16x32_bf16 v[164:167], a[12:15], a[124:127], v[164:167]
  ds_read_b128 a[108:111], v213 offset:36864
  v_fma_f32 v238, v238, v106, v238
  v_mfma_f32_16x16x32_bf16 v[168:171], a[12:15], a[128:131], v[168:171]
  v_fma_f32 v239, v239, v107, v239
  v_cvt_pk_bf16_f32 v105, v238, v239
  v_mfma_f32_16x16x32_bf16 v[172:175], a[12:15], a[132:135], v[172:175]
  s_waitcnt vmcnt(23)
  v_mfma_f32_16x16x32_bf16 v[176:179], a[16:19], a[120:123], v[176:179]
  buffer_load_dwordx4 a[12:15], v208, s[8:11], s20 offen offset:3072
  v_mfma_f32_16x16x32_bf16 v[180:183], a[16:19], a[124:127], v[180:183]
  ds_read_b128 a[112:115], v213 offset:40960
  v_lshlrev_b32 v236, 16, v230
  v_mfma_f32_16x16x32_bf16 v[184:187], a[16:19], a[128:131], v[184:187]
  v_and_b32 v237, s27, v230
  v_accvgpr_write_b32 a194, v230
  v_mfma_f32_16x16x32_bf16 v[188:191], a[16:19], a[132:135], v[188:191]
  v_mfma_f32_16x16x32_bf16 v[192:195], a[20:23], a[120:123], v[192:195]
  s_add_u32 s20, s20, 4096
  buffer_load_dwordx4 a[16:19], v208, s[8:11], s20 offen
  v_mfma_f32_16x16x32_bf16 v[196:199], a[20:23], a[124:127], v[196:199]
  ds_read_b128 a[116:119], v213 offset:45056
  v_fma_f32 v236, v236, v120, v236
  v_mfma_f32_16x16x32_bf16 v[200:203], a[20:23], a[128:131], v[200:203]
  v_fma_f32 v237, v237, v121, v237
  v_cvt_pk_bf16_f32 v106, v236, v237
  v_mfma_f32_16x16x32_bf16 v[204:207], a[20:23], a[132:135], v[204:207]
  s_waitcnt vmcnt(23) lgkmcnt(0)
  v_mfma_f32_16x16x32_bf16 v[128:131], a[24:27], a[104:107], v[128:131]
  buffer_load_dwordx4 a[20:23], v208, s[8:11], s20 offen offset:1024
  v_mfma_f32_16x16x32_bf16 v[132:135], a[24:27], a[108:111], v[132:135]
  v_lshlrev_b32 v238, 16, v231
  v_mfma_f32_16x16x32_bf16 v[136:139], a[24:27], a[112:115], v[136:139]
  v_and_b32 v239, s27, v231
  v_accvgpr_write_b32 a195, v231
  v_mfma_f32_16x16x32_bf16 v[140:143], a[24:27], a[116:119], v[140:143]
  v_mfma_f32_16x16x32_bf16 v[144:147], a[28:31], a[104:107], v[144:147]
  buffer_load_dwordx4 a[24:27], v208, s[8:11], s20 offen offset:2048
  v_mfma_f32_16x16x32_bf16 v[148:151], a[28:31], a[108:111], v[148:151]
  ds_read_b128 a[120:123], v214 offset:32768
  v_fma_f32 v238, v238, v122, v238
  v_mfma_f32_16x16x32_bf16 v[152:155], a[28:31], a[112:115], v[152:155]
  v_fma_f32 v239, v239, v123, v239
  v_cvt_pk_bf16_f32 v107, v238, v239
  v_mfma_f32_16x16x32_bf16 v[156:159], a[28:31], a[116:119], v[156:159]
  s_waitcnt vmcnt(23)
  v_mfma_f32_16x16x32_bf16 v[160:163], a[32:35], a[104:107], v[160:163]
  buffer_load_dwordx4 a[28:31], v208, s[8:11], s20 offen offset:3072
  v_lshlrev_b32 v236, 16, v232
  v_mfma_f32_16x16x32_bf16 v[164:167], a[32:35], a[108:111], v[164:167]
  ds_read_b128 a[124:127], v214 offset:36864
  v_and_b32 v237, s27, v232
  v_mfma_f32_16x16x32_bf16 v[168:171], a[32:35], a[112:115], v[168:171]
  v_accvgpr_write_b32 a196, v232
  v_fma_f32 v236, v236, v108, v236
  v_mfma_f32_16x16x32_bf16 v[172:175], a[32:35], a[116:119], v[172:175]
  v_mfma_f32_16x16x32_bf16 v[176:179], a[36:39], a[104:107], v[176:179]
  s_add_u32 s20, s20, 4096
  buffer_load_dwordx4 a[32:35], v208, s[8:11], s20 offen
  v_mfma_f32_16x16x32_bf16 v[180:183], a[36:39], a[108:111], v[180:183]
  ds_read_b128 a[128:131], v214 offset:40960
  v_fma_f32 v237, v237, v109, v237
  v_mfma_f32_16x16x32_bf16 v[184:187], a[36:39], a[112:115], v[184:187]
  v_cvt_pk_bf16_f32 v108, v236, v237
  v_lshlrev_b32 v238, 16, v233
  v_mfma_f32_16x16x32_bf16 v[188:191], a[36:39], a[116:119], v[188:191]
  s_waitcnt vmcnt(23)
  v_mfma_f32_16x16x32_bf16 v[192:195], a[40:43], a[104:107], v[192:195]
  buffer_load_dwordx4 a[36:39], v208, s[8:11], s20 offen offset:1024
  v_mfma_f32_16x16x32_bf16 v[196:199], a[40:43], a[108:111], v[196:199]
  ds_read_b128 a[132:135], v214 offset:45056
  v_and_b32 v239, s27, v233
  v_mfma_f32_16x16x32_bf16 v[200:203], a[40:43], a[112:115], v[200:203]
  v_accvgpr_write_b32 a197, v233
  v_fma_f32 v238, v238, v110, v238
  v_mfma_f32_16x16x32_bf16 v[204:207], a[40:43], a[116:119], v[204:207]
  s_waitcnt lgkmcnt(0)
  v_mfma_f32_16x16x32_bf16 v[128:131], a[44:47], a[120:123], v[128:131]
  buffer_load_dwordx4 a[40:43], v208, s[8:11], s20 offen offset:2048
  v_mfma_f32_16x16x32_bf16 v[132:135], a[44:47], a[124:127], v[132:135]
  v_fma_f32 v239, v239, v111, v239
  v_mfma_f32_16x16x32_bf16 v[136:139], a[44:47], a[128:131], v[136:139]
  v_cvt_pk_bf16_f32 v109, v238, v239
  v_lshlrev_b32 v236, 16, v234
  v_mfma_f32_16x16x32_bf16 v[140:143], a[44:47], a[132:135], v[140:143]
  s_waitcnt vmcnt(23)
  v_mfma_f32_16x16x32_bf16 v[144:147], a[48:51], a[120:123], v[144:147]
  buffer_load_dwordx4 a[44:47], v208, s[8:11], s20 offen offset:3072
  v_mfma_f32_16x16x32_bf16 v[148:151], a[48:51], a[124:127], v[148:151]
  v_and_b32 v237, s27, v234
  v_mfma_f32_16x16x32_bf16 v[152:155], a[48:51], a[128:131], v[152:155]
  v_accvgpr_write_b32 a198, v234
  v_fma_f32 v236, v236, v124, v236
  v_mfma_f32_16x16x32_bf16 v[156:159], a[48:51], a[132:135], v[156:159]
  v_mfma_f32_16x16x32_bf16 v[160:163], a[52:55], a[120:123], v[160:163]
  s_add_u32 s20, s20, 4096
  buffer_load_dwordx4 a[48:51], v208, s[8:11], s20 offen
  v_mfma_f32_16x16x32_bf16 v[164:167], a[52:55], a[124:127], v[164:167]
  v_fma_f32 v237, v237, v125, v237
  v_mfma_f32_16x16x32_bf16 v[168:171], a[52:55], a[128:131], v[168:171]
  v_cvt_pk_bf16_f32 v110, v236, v237
  v_lshlrev_b32 v238, 16, v235
  v_mfma_f32_16x16x32_bf16 v[172:175], a[52:55], a[132:135], v[172:175]
  s_waitcnt vmcnt(23)
  v_mfma_f32_16x16x32_bf16 v[176:179], a[56:59], a[120:123], v[176:179]
  buffer_load_dwordx4 a[52:55], v208, s[8:11], s20 offen offset:1024
  v_mfma_f32_16x16x32_bf16 v[180:183], a[56:59], a[124:127], v[180:183]
  v_and_b32 v239, s27, v235
  v_mfma_f32_16x16x32_bf16 v[184:187], a[56:59], a[128:131], v[184:187]
  v_accvgpr_write_b32 a199, v235
  v_fma_f32 v238, v238, v126, v238
  v_mfma_f32_16x16x32_bf16 v[188:191], a[56:59], a[132:135], v[188:191]
  v_mfma_f32_16x16x32_bf16 v[192:195], a[60:63], a[120:123], v[192:195]
  buffer_load_dwordx4 a[56:59], v208, s[8:11], s20 offen offset:2048
  v_mfma_f32_16x16x32_bf16 v[196:199], a[60:63], a[124:127], v[196:199]
  v_fma_f32 v239, v239, v127, v239
  v_cvt_pk_bf16_f32 v111, v238, v239
  v_mfma_f32_16x16x32_bf16 v[200:203], a[60:63], a[128:131], v[200:203]
  ds_read_b128 v[116:119], v226 offset:3712
  ds_read_b128 v[112:115], v226 offset:3728
  v_mfma_f32_16x16x32_bf16 v[204:207], a[60:63], a[132:135], v[204:207]
  s_waitcnt lgkmcnt(0)
  s_barrier
  ds_write_b128 v217, v[0:3]
  ds_write_b128 v217, v[4:7] offset:4096
  ds_write_b128 v217, v[8:11] offset:8192
  ds_write_b128 v217, v[12:15] offset:12288
  ds_write_b128 v218, v[32:35]
  ds_write_b128 v218, v[36:39] offset:4096
  ds_write_b128 v218, v[40:43] offset:8192
  ds_write_b128 v218, v[44:47] offset:12288
  ds_write_b128 v219, v[64:67]
  ds_write_b128 v219, v[68:71] offset:4096
  ds_write_b128 v219, v[72:75] offset:8192
  ds_write_b128 v219, v[76:79] offset:12288
  ds_write_b128 v220, v[96:99]
  ds_write_b128 v220, v[100:103] offset:4096
  ds_write_b128 v220, v[104:107] offset:8192
  ds_write_b128 v220, v[108:111] offset:12288
  s_waitcnt lgkmcnt(0)
  s_barrier
  ds_read_b128 a[104:107], v209
  ds_read_b128 a[108:111], v209 offset:4096
  ds_read_b128 a[112:115], v209 offset:8192
  ds_read_b128 a[116:119], v209 offset:12288
  s_waitcnt vmcnt(23) lgkmcnt(0)
  v_mfma_f32_16x16x32_bf16 v[12:15], a[64:67], a[116:119], v[20:23]
  buffer_load_dwordx4 a[60:63], v208, s[8:11], s20 offen offset:3072
  v_mfma_f32_16x16x32_bf16 v[8:11], a[64:67], a[112:115], v[20:23]
  v_mfma_f32_16x16x32_bf16 v[4:7], a[64:67], a[108:111], v[20:23]
  ds_read_b128 v[228:231], v221
  ds_read_b128 v[232:235], v221 offset:4096
  v_mfma_f32_16x16x32_bf16 v[0:3], a[64:67], a[104:107], v[20:23]
  v_mfma_f32_16x16x32_bf16 v[28:31], a[68:71], a[116:119], v[16:19]
  s_add_u32 s20, s20, 4096
  buffer_load_dwordx4 a[64:67], v208, s[8:11], s20 offen
  v_mfma_f32_16x16x32_bf16 v[24:27], a[68:71], a[112:115], v[16:19]
  ds_read_b128 a[120:123], v210
  s_waitcnt lgkmcnt(2)
  v_lshlrev_b32 v236, 16, v228
  v_mfma_f32_16x16x32_bf16 v[20:23], a[68:71], a[108:111], v[16:19]
  v_and_b32 v237, s27, v228
  v_accvgpr_write_b32 a200, v228
  v_mfma_f32_16x16x32_bf16 v[16:19], a[68:71], a[104:107], v[16:19]
  s_waitcnt vmcnt(23)
  v_mfma_f32_16x16x32_bf16 v[44:47], a[72:75], a[116:119], v[52:55]
  buffer_load_dwordx4 a[68:71], v208, s[8:11], s20 offen offset:1024
  v_mfma_f32_16x16x32_bf16 v[40:43], a[72:75], a[112:115], v[52:55]
  ds_read_b128 a[124:127], v210 offset:4096
  v_mfma_f32_16x16x32_bf16 v[36:39], a[72:75], a[108:111], v[52:55]
  v_fma_f32 v236, v236, v128, v236
  v_fma_f32 v237, v237, v129, v237
  v_mfma_f32_16x16x32_bf16 v[32:35], a[72:75], a[104:107], v[52:55]
  v_mfma_f32_16x16x32_bf16 v[60:63], a[76:79], a[116:119], v[48:51]
  buffer_load_dwordx4 a[72:75], v208, s[8:11], s20 offen offset:2048
  v_mfma_f32_16x16x32_bf16 v[56:59], a[76:79], a[112:115], v[48:51]
  ds_read_b128 a[128:131], v210 offset:8192
  v_cvt_pk_bf16_f32 v228, v236, v237
  v_mfma_f32_16x16x32_bf16 v[52:55], a[76:79], a[108:111], v[48:51]
  v_lshlrev_b32 v238, 16, v229
  v_and_b32 v239, s27, v229
  v_mfma_f32_16x16x32_bf16 v[48:51], a[76:79], a[104:107], v[48:51]
  s_waitcnt vmcnt(23)
  v_mfma_f32_16x16x32_bf16 v[76:79], a[80:83], a[116:119], v[84:87]
  buffer_load_dwordx4 a[76:79], v208, s[8:11], s20 offen offset:3072
  v_mfma_f32_16x16x32_bf16 v[72:75], a[80:83], a[112:115], v[84:87]
  ds_read_b128 a[132:135], v210 offset:12288
  v_mfma_f32_16x16x32_bf16 v[68:71], a[80:83], a[108:111], v[84:87]
  v_accvgpr_write_b32 a201, v229
  v_fma_f32 v238, v238, v130, v238
  v_mfma_f32_16x16x32_bf16 v[64:67], a[80:83], a[104:107], v[84:87]
  v_mfma_f32_16x16x32_bf16 v[92:95], a[84:87], a[116:119], v[80:83]
  s_add_u32 s20, s20, 4096
  buffer_load_dwordx4 a[80:83], v208, s[8:11], s20 offen
  v_mfma_f32_16x16x32_bf16 v[88:91], a[84:87], a[112:115], v[80:83]
  v_fma_f32 v239, v239, v131, v239
  v_mfma_f32_16x16x32_bf16 v[84:87], a[84:87], a[108:111], v[80:83]
  v_cvt_pk_bf16_f32 v229, v238, v239
  v_lshlrev_b32 v236, 16, v230
  v_mfma_f32_16x16x32_bf16 v[80:83], a[84:87], a[104:107], v[80:83]
  s_waitcnt vmcnt(23)
  v_mfma_f32_16x16x32_bf16 v[108:111], a[88:91], a[116:119], v[116:119]
  buffer_load_dwordx4 a[84:87], v208, s[8:11], s20 offen offset:1024
  v_mfma_f32_16x16x32_bf16 v[104:107], a[88:91], a[112:115], v[116:119]
  v_and_b32 v237, s27, v230
  v_mfma_f32_16x16x32_bf16 v[100:103], a[88:91], a[108:111], v[116:119]
  v_accvgpr_write_b32 a202, v230
  v_fma_f32 v236, v236, v144, v236
  v_mfma_f32_16x16x32_bf16 v[96:99], a[88:91], a[104:107], v[116:119]
  v_mfma_f32_16x16x32_bf16 v[124:127], a[92:95], a[116:119], v[112:115]
  buffer_load_dwordx4 a[88:91], v208, s[8:11], s20 offen offset:2048
  v_mfma_f32_16x16x32_bf16 v[120:123], a[92:95], a[112:115], v[112:115]
  v_mfma_f32_16x16x32_bf16 v[116:119], a[92:95], a[108:111], v[112:115]
  v_fma_f32 v237, v237, v145, v237
  v_cvt_pk_bf16_f32 v230, v236, v237
  v_mfma_f32_16x16x32_bf16 v[112:115], a[92:95], a[104:107], v[112:115]
  s_waitcnt vmcnt(23) lgkmcnt(0)
  v_mfma_f32_16x16x32_bf16 v[0:3], a[96:99], a[120:123], v[0:3]
  buffer_load_dwordx4 a[92:95], v208, s[8:11], s20 offen offset:3072
  v_mfma_f32_16x16x32_bf16 v[4:7], a[96:99], a[124:127], v[4:7]
  v_lshlrev_b32 v238, 16, v231
  v_mfma_f32_16x16x32_bf16 v[8:11], a[96:99], a[128:131], v[8:11]
  v_and_b32 v239, s27, v231
  v_accvgpr_write_b32 a203, v231
  v_mfma_f32_16x16x32_bf16 v[12:15], a[96:99], a[132:135], v[12:15]
  v_mfma_f32_16x16x32_bf16 v[16:19], a[100:103], a[120:123], v[16:19]
  s_add_u32 s20, s20, 4096
  buffer_load_dwordx4 a[96:99], v208, s[8:11], s20 offen
  v_mfma_f32_16x16x32_bf16 v[20:23], a[100:103], a[124:127], v[20:23]
  ds_read_b128 a[104:107], v211
  v_mfma_f32_16x16x32_bf16 v[24:27], a[100:103], a[128:131], v[24:27]
  v_fma_f32 v238, v238, v146, v238
  v_fma_f32 v239, v239, v147, v239
  v_mfma_f32_16x16x32_bf16 v[28:31], a[100:103], a[132:135], v[28:31]
  s_waitcnt vmcnt(23)
  v_mfma_f32_16x16x32_bf16 v[32:35], a[0:3], a[120:123], v[32:35]
  buffer_load_dwordx4 a[100:103], v208, s[8:11], s20 offen offset:1024
  v_mfma_f32_16x16x32_bf16 v[36:39], a[0:3], a[124:127], v[36:39]
  ds_read_b128 a[108:111], v211 offset:4096
  v_cvt_pk_bf16_f32 v231, v238, v239
  v_mfma_f32_16x16x32_bf16 v[40:43], a[0:3], a[128:131], v[40:43]
  ds_write_b128 v221, v[228:231]
  ds_read_b128 v[228:231], v221 offset:8192
  v_mfma_f32_16x16x32_bf16 v[44:47], a[0:3], a[132:135], v[44:47]
  v_mfma_f32_16x16x32_bf16 v[48:51], a[4:7], a[120:123], v[48:51]
  buffer_load_dwordx4 a[0:3], v208, s[8:11], s20 offen offset:2048
  v_mfma_f32_16x16x32_bf16 v[52:55], a[4:7], a[124:127], v[52:55]
  ds_read_b128 a[112:115], v211 offset:8192
  v_lshlrev_b32 v236, 16, v232
  v_mfma_f32_16x16x32_bf16 v[56:59], a[4:7], a[128:131], v[56:59]
  v_and_b32 v237, s27, v232
  v_accvgpr_write_b32 a204, v232
  v_mfma_f32_16x16x32_bf16 v[60:63], a[4:7], a[132:135], v[60:63]
  s_waitcnt vmcnt(23)
  v_mfma_f32_16x16x32_bf16 v[64:67], a[8:11], a[120:123], v[64:67]
  buffer_load_dwordx4 a[4:7], v208, s[8:11], s20 offen offset:3072
  v_mfma_f32_16x16x32_bf16 v[68:71], a[8:11], a[124:127], v[68:71]
  ds_read_b128 a[116:119], v211 offset:12288
  v_mfma_f32_16x16x32_bf16 v[72:75], a[8:11], a[128:131], v[72:75]
  v_fma_f32 v236, v236, v132, v236
  v_fma_f32 v237, v237, v133, v237
  v_mfma_f32_16x16x32_bf16 v[76:79], a[8:11], a[132:135], v[76:79]
  v_mfma_f32_16x16x32_bf16 v[80:83], a[12:15], a[120:123], v[80:83]
  s_add_u32 s20, s20, 4096
  buffer_load_dwordx4 a[8:11], v208, s[8:11], s20 offen
  v_mfma_f32_16x16x32_bf16 v[84:87], a[12:15], a[124:127], v[84:87]
  v_cvt_pk_bf16_f32 v232, v236, v237
  v_mfma_f32_16x16x32_bf16 v[88:91], a[12:15], a[128:131], v[88:91]
  v_lshlrev_b32 v238, 16, v233
  v_and_b32 v239, s27, v233
  v_mfma_f32_16x16x32_bf16 v[92:95], a[12:15], a[132:135], v[92:95]
  s_waitcnt vmcnt(23)
  v_mfma_f32_16x16x32_bf16 v[96:99], a[16:19], a[120:123], v[96:99]
  buffer_load_dwordx4 a[12:15], v208, s[8:11], s20 offen offset:1024
  v_mfma_f32_16x16x32_bf16 v[100:103], a[16:19], a[124:127], v[100:103]
  v_mfma_f32_16x16x32_bf16 v[104:107], a[16:19], a[128:131], v[104:107]
  v_accvgpr_write_b32 a205, v233
  v_fma_f32 v238, v238, v134, v238
  v_mfma_f32_16x16x32_bf16 v[108:111], a[16:19], a[132:135], v[108:111]
  v_mfma_f32_16x16x32_bf16 v[112:115], a[20:23], a[120:123], v[112:115]
  buffer_load_dwordx4 a[16:19], v208, s[8:11], s20 offen offset:2048
  v_mfma_f32_16x16x32_bf16 v[116:119], a[20:23], a[124:127], v[116:119]
  v_fma_f32 v239, v239, v135, v239
  v_mfma_f32_16x16x32_bf16 v[120:123], a[20:23], a[128:131], v[120:123]
  v_cvt_pk_bf16_f32 v233, v238, v239
  v_lshlrev_b32 v236, 16, v234
  v_mfma_f32_16x16x32_bf16 v[124:127], a[20:23], a[132:135], v[124:127]
  s_waitcnt vmcnt(23) lgkmcnt(0)
  v_mfma_f32_16x16x32_bf16 v[0:3], a[24:27], a[104:107], v[0:3]
  buffer_load_dwordx4 a[20:23], v208, s[8:11], s20 offen offset:3072
  v_mfma_f32_16x16x32_bf16 v[4:7], a[24:27], a[108:111], v[4:7]
  v_mfma_f32_16x16x32_bf16 v[8:11], a[24:27], a[112:115], v[8:11]
  v_and_b32 v237, s27, v234
  v_accvgpr_write_b32 a206, v234
  v_mfma_f32_16x16x32_bf16 v[12:15], a[24:27], a[116:119], v[12:15]
  v_mfma_f32_16x16x32_bf16 v[16:19], a[28:31], a[104:107], v[16:19]
  s_add_u32 s20, s20, 4096
  buffer_load_dwordx4 a[24:27], v208, s[8:11], s20 offen
  v_mfma_f32_16x16x32_bf16 v[20:23], a[28:31], a[108:111], v[20:23]
  ds_read_b128 a[120:123], v212
  v_fma_f32 v236, v236, v148, v236
  v_mfma_f32_16x16x32_bf16 v[24:27], a[28:31], a[112:115], v[24:27]
  v_fma_f32 v237, v237, v149, v237
  v_cvt_pk_bf16_f32 v234, v236, v237
  v_mfma_f32_16x16x32_bf16 v[28:31], a[28:31], a[116:119], v[28:31]
  s_waitcnt vmcnt(23)
  v_mfma_f32_16x16x32_bf16 v[32:35], a[32:35], a[104:107], v[32:35]
  buffer_load_dwordx4 a[28:31], v208, s[8:11], s20 offen offset:1024
  v_mfma_f32_16x16x32_bf16 v[36:39], a[32:35], a[108:111], v[36:39]
  ds_read_b128 a[124:127], v212 offset:4096
  v_lshlrev_b32 v238, 16, v235
  v_mfma_f32_16x16x32_bf16 v[40:43], a[32:35], a[112:115], v[40:43]
  v_and_b32 v239, s27, v235
  v_accvgpr_write_b32 a207, v235
  v_mfma_f32_16x16x32_bf16 v[44:47], a[32:35], a[116:119], v[44:47]
  v_mfma_f32_16x16x32_bf16 v[48:51], a[36:39], a[104:107], v[48:51]
  buffer_load_dwordx4 a[32:35], v208, s[8:11], s20 offen offset:2048
  v_mfma_f32_16x16x32_bf16 v[52:55], a[36:39], a[108:111], v[52:55]
  ds_read_b128 a[128:131], v212 offset:8192
  v_mfma_f32_16x16x32_bf16 v[56:59], a[36:39], a[112:115], v[56:59]
  v_fma_f32 v238, v238, v150, v238
  v_fma_f32 v239, v239, v151, v239
  v_mfma_f32_16x16x32_bf16 v[60:63], a[36:39], a[116:119], v[60:63]
  s_waitcnt vmcnt(23)
  v_mfma_f32_16x16x32_bf16 v[64:67], a[40:43], a[104:107], v[64:67]
  buffer_load_dwordx4 a[36:39], v208, s[8:11], s20 offen offset:3072
  v_mfma_f32_16x16x32_bf16 v[68:71], a[40:43], a[108:111], v[68:71]
  ds_read_b128 a[132:135], v212 offset:12288
  v_cvt_pk_bf16_f32 v235, v238, v239
  v_mfma_f32_16x16x32_bf16 v[72:75], a[40:43], a[112:115], v[72:75]
  ds_write_b128 v221, v[232:235] offset:4096
  ds_read_b128 v[232:235], v221 offset:12288
  v_mfma_f32_16x16x32_bf16 v[76:79], a[40:43], a[116:119], v[76:79]
  v_mfma_f32_16x16x32_bf16 v[80:83], a[44:47], a[104:107], v[80:83]
  s_add_u32 s20, s20, 4096
  buffer_load_dwordx4 a[40:43], v208, s[8:11], s20 offen
  v_mfma_f32_16x16x32_bf16 v[84:87], a[44:47], a[108:111], v[84:87]
  v_mfma_f32_16x16x32_bf16 v[88:91], a[44:47], a[112:115], v[88:91]
  v_lshlrev_b32 v236, 16, v228
  v_and_b32 v237, s27, v228
  v_mfma_f32_16x16x32_bf16 v[92:95], a[44:47], a[116:119], v[92:95]
  s_waitcnt vmcnt(23)
  v_mfma_f32_16x16x32_bf16 v[96:99], a[48:51], a[104:107], v[96:99]
  buffer_load_dwordx4 a[44:47], v208, s[8:11], s20 offen offset:1024
  v_mfma_f32_16x16x32_bf16 v[100:103], a[48:51], a[108:111], v[100:103]
  v_accvgpr_write_b32 a208, v228
  v_mfma_f32_16x16x32_bf16 v[104:107], a[48:51], a[112:115], v[104:107]
  v_fma_f32 v236, v236, v136, v236
  v_fma_f32 v237, v237, v137, v237
  v_mfma_f32_16x16x32_bf16 v[108:111], a[48:51], a[116:119], v[108:111]
  v_mfma_f32_16x16x32_bf16 v[112:115], a[52:55], a[104:107], v[112:115]
  buffer_load_dwordx4 a[48:51], v208, s[8:11], s20 offen offset:2048
  v_mfma_f32_16x16x32_bf16 v[116:119], a[52:55], a[108:111], v[116:119]
  v_cvt_pk_bf16_f32 v228, v236, v237
  v_mfma_f32_16x16x32_bf16 v[120:123], a[52:55], a[112:115], v[120:123]
  v_lshlrev_b32 v238, 16, v229
  v_and_b32 v239, s27, v229
  v_mfma_f32_16x16x32_bf16 v[124:127], a[52:55], a[116:119], v[124:127]
  s_waitcnt vmcnt(23) lgkmcnt(2)
  v_mfma_f32_16x16x32_bf16 v[0:3], a[56:59], a[120:123], v[0:3]
  buffer_load_dwordx4 a[52:55], v208, s[8:11], s20 offen offset:3072
  v_mfma_f32_16x16x32_bf16 v[4:7], a[56:59], a[124:127], v[4:7]
  v_mfma_f32_16x16x32_bf16 v[8:11], a[56:59], a[128:131], v[8:11]
  v_accvgpr_write_b32 a209, v229
  v_fma_f32 v238, v238, v138, v238
  v_mfma_f32_16x16x32_bf16 v[12:15], a[56:59], a[132:135], v[12:15]
  v_mfma_f32_16x16x32_bf16 v[16:19], a[60:63], a[120:123], v[16:19]
  s_add_u32 s20, s20, 4096
  buffer_load_dwordx4 a[56:59], v208, s[8:11], s20 offen
  v_mfma_f32_16x16x32_bf16 v[20:23], a[60:63], a[124:127], v[20:23]
  ds_read_b128 a[104:107], v209 offset:16384
  v_fma_f32 v239, v239, v139, v239
  v_mfma_f32_16x16x32_bf16 v[24:27], a[60:63], a[128:131], v[24:27]
  v_cvt_pk_bf16_f32 v229, v238, v239
  v_lshlrev_b32 v236, 16, v230
  v_mfma_f32_16x16x32_bf16 v[28:31], a[60:63], a[132:135], v[28:31]
  s_waitcnt vmcnt(23)
  v_mfma_f32_16x16x32_bf16 v[32:35], a[64:67], a[120:123], v[32:35]
  buffer_load_dwordx4 a[60:63], v208, s[8:11], s20 offen offset:1024
  v_mfma_f32_16x16x32_bf16 v[36:39], a[64:67], a[124:127], v[36:39]
  ds_read_b128 a[108:111], v209 offset:20480
  v_mfma_f32_16x16x32_bf16 v[40:43], a[64:67], a[128:131], v[40:43]
  v_and_b32 v237, s27, v230
  v_accvgpr_write_b32 a210, v230
  v_mfma_f32_16x16x32_bf16 v[44:47], a[64:67], a[132:135], v[44:47]
  v_mfma_f32_16x16x32_bf16 v[48:51], a[68:71], a[120:123], v[48:51]
  buffer_load_dwordx4 a[64:67], v208, s[8:11], s20 offen offset:2048
  v_mfma_f32_16x16x32_bf16 v[52:55], a[68:71], a[124:127], v[52:55]
  ds_read_b128 a[112:115], v209 offset:24576
  v_fma_f32 v236, v236, v152, v236
  v_mfma_f32_16x16x32_bf16 v[56:59], a[68:71], a[128:131], v[56:59]
  v_fma_f32 v237, v237, v153, v237
  v_cvt_pk_bf16_f32 v230, v236, v237
  v_mfma_f32_16x16x32_bf16 v[60:63], a[68:71], a[132:135], v[60:63]
  s_waitcnt vmcnt(23)
  v_mfma_f32_16x16x32_bf16 v[64:67], a[72:75], a[120:123], v[64:67]
  buffer_load_dwordx4 a[68:71], v208, s[8:11], s20 offen offset:3072
  v_mfma_f32_16x16x32_bf16 v[68:71], a[72:75], a[124:127], v[68:71]
  ds_read_b128 a[116:119], v209 offset:28672
  v_lshlrev_b32 v238, 16, v231
  v_mfma_f32_16x16x32_bf16 v[72:75], a[72:75], a[128:131], v[72:75]
  v_and_b32 v239, s27, v231
  v_accvgpr_write_b32 a211, v231
  v_mfma_f32_16x16x32_bf16 v[76:79], a[72:75], a[132:135], v[76:79]
  v_mfma_f32_16x16x32_bf16 v[80:83], a[76:79], a[120:123], v[80:83]
  s_add_u32 s20, s20, 4096
  buffer_load_dwordx4 a[72:75], v208, s[8:11], s20 offen
  v_mfma_f32_16x16x32_bf16 v[84:87], a[76:79], a[124:127], v[84:87]
  v_mfma_f32_16x16x32_bf16 v[88:91], a[76:79], a[128:131], v[88:91]
  v_fma_f32 v238, v238, v154, v238
  v_fma_f32 v239, v239, v155, v239
  v_mfma_f32_16x16x32_bf16 v[92:95], a[76:79], a[132:135], v[92:95]
  s_waitcnt vmcnt(23)
  v_mfma_f32_16x16x32_bf16 v[96:99], a[80:83], a[120:123], v[96:99]
  buffer_load_dwordx4 a[76:79], v208, s[8:11], s20 offen offset:1024
  v_mfma_f32_16x16x32_bf16 v[100:103], a[80:83], a[124:127], v[100:103]
  v_cvt_pk_bf16_f32 v231, v238, v239
  v_mfma_f32_16x16x32_bf16 v[104:107], a[80:83], a[128:131], v[104:107]
  ds_write_b128 v221, v[228:231] offset:8192
  ds_read_b128 v[228:231], v222
  v_mfma_f32_16x16x32_bf16 v[108:111], a[80:83], a[132:135], v[108:111]
  v_mfma_f32_16x16x32_bf16 v[112:115], a[84:87], a[120:123], v[112:115]
  buffer_load_dwordx4 a[80:83], v208, s[8:11], s20 offen offset:2048
  v_mfma_f32_16x16x32_bf16 v[116:119], a[84:87], a[124:127], v[116:119]
  v_mfma_f32_16x16x32_bf16 v[120:123], a[84:87], a[128:131], v[120:123]
  s_waitcnt lgkmcnt(6)
  v_lshlrev_b32 v236, 16, v232
  v_and_b32 v237, s27, v232
  v_mfma_f32_16x16x32_bf16 v[124:127], a[84:87], a[132:135], v[124:127]
  s_waitcnt vmcnt(23) lgkmcnt(2)
  v_mfma_f32_16x16x32_bf16 v[0:3], a[88:91], a[104:107], v[0:3]
  buffer_load_dwordx4 a[84:87], v208, s[8:11], s20 offen offset:3072
  v_mfma_f32_16x16x32_bf16 v[4:7], a[88:91], a[108:111], v[4:7]
  v_accvgpr_write_b32 a212, v232
  v_mfma_f32_16x16x32_bf16 v[8:11], a[88:91], a[112:115], v[8:11]
  v_fma_f32 v236, v236, v140, v236
  v_fma_f32 v237, v237, v141, v237
  v_mfma_f32_16x16x32_bf16 v[12:15], a[88:91], a[116:119], v[12:15]
  v_mfma_f32_16x16x32_bf16 v[16:19], a[92:95], a[104:107], v[16:19]
  s_add_u32 s20, s20, 4096
  buffer_load_dwordx4 a[88:91], v208, s[8:11], s20 offen
  v_mfma_f32_16x16x32_bf16 v[20:23], a[92:95], a[108:111], v[20:23]
  ds_read_b128 a[120:123], v210 offset:16384
  v_mfma_f32_16x16x32_bf16 v[24:27], a[92:95], a[112:115], v[24:27]
  v_cvt_pk_bf16_f32 v232, v236, v237
  v_lshlrev_b32 v238, 16, v233
  v_mfma_f32_16x16x32_bf16 v[28:31], a[92:95], a[116:119], v[28:31]
  s_waitcnt vmcnt(23)
  v_mfma_f32_16x16x32_bf16 v[32:35], a[96:99], a[104:107], v[32:35]
  buffer_load_dwordx4 a[92:95], v208, s[8:11], s20 offen offset:1024
  v_mfma_f32_16x16x32_bf16 v[36:39], a[96:99], a[108:111], v[36:39]
  ds_read_b128 a[124:127], v210 offset:20480
  v_and_b32 v239, s27, v233
  v_mfma_f32_16x16x32_bf16 v[40:43], a[96:99], a[112:115], v[40:43]
  v_accvgpr_write_b32 a213, v233
  v_fma_f32 v238, v238, v142, v238
  v_mfma_f32_16x16x32_bf16 v[44:47], a[96:99], a[116:119], v[44:47]
  v_mfma_f32_16x16x32_bf16 v[48:51], a[100:103], a[104:107], v[48:51]
  buffer_load_dwordx4 a[96:99], v208, s[8:11], s20 offen offset:2048
  v_mfma_f32_16x16x32_bf16 v[52:55], a[100:103], a[108:111], v[52:55]
  ds_read_b128 a[128:131], v210 offset:24576
  v_fma_f32 v239, v239, v143, v239
  v_mfma_f32_16x16x32_bf16 v[56:59], a[100:103], a[112:115], v[56:59]
  v_cvt_pk_bf16_f32 v233, v238, v239
  v_lshlrev_b32 v236, 16, v234
  v_mfma_f32_16x16x32_bf16 v[60:63], a[100:103], a[116:119], v[60:63]
  s_waitcnt vmcnt(23)
  v_mfma_f32_16x16x32_bf16 v[64:67], a[0:3], a[104:107], v[64:67]
  buffer_load_dwordx4 a[100:103], v208, s[8:11], s20 offen offset:3072
  v_mfma_f32_16x16x32_bf16 v[68:71], a[0:3], a[108:111], v[68:71]
  ds_read_b128 a[132:135], v210 offset:28672
  v_mfma_f32_16x16x32_bf16 v[72:75], a[0:3], a[112:115], v[72:75]
  v_and_b32 v237, s27, v234
  v_accvgpr_write_b32 a214, v234
  v_mfma_f32_16x16x32_bf16 v[76:79], a[0:3], a[116:119], v[76:79]
  v_mfma_f32_16x16x32_bf16 v[80:83], a[4:7], a[104:107], v[80:83]
  s_add_u32 s20, s20, 4096
  buffer_load_dwordx4 a[0:3], v208, s[8:11], s20 offen
  v_mfma_f32_16x16x32_bf16 v[84:87], a[4:7], a[108:111], v[84:87]
  v_fma_f32 v236, v236, v156, v236
  v_mfma_f32_16x16x32_bf16 v[88:91], a[4:7], a[112:115], v[88:91]
  v_fma_f32 v237, v237, v157, v237
  v_cvt_pk_bf16_f32 v234, v236, v237
  v_mfma_f32_16x16x32_bf16 v[92:95], a[4:7], a[116:119], v[92:95]
  s_waitcnt vmcnt(23)
  v_mfma_f32_16x16x32_bf16 v[96:99], a[8:11], a[104:107], v[96:99]
  buffer_load_dwordx4 a[4:7], v208, s[8:11], s20 offen offset:1024
  v_mfma_f32_16x16x32_bf16 v[100:103], a[8:11], a[108:111], v[100:103]
  v_mfma_f32_16x16x32_bf16 v[104:107], a[8:11], a[112:115], v[104:107]
  v_lshlrev_b32 v238, 16, v235
  v_and_b32 v239, s27, v235
  v_mfma_f32_16x16x32_bf16 v[108:111], a[8:11], a[116:119], v[108:111]
  v_mfma_f32_16x16x32_bf16 v[112:115], a[12:15], a[104:107], v[112:115]
  buffer_load_dwordx4 a[8:11], v208, s[8:11], s20 offen offset:2048
  v_mfma_f32_16x16x32_bf16 v[116:119], a[12:15], a[108:111], v[116:119]
  v_accvgpr_write_b32 a215, v235
  v_mfma_f32_16x16x32_bf16 v[120:123], a[12:15], a[112:115], v[120:123]
  v_fma_f32 v238, v238, v158, v238
  v_fma_f32 v239, v239, v159, v239
  v_mfma_f32_16x16x32_bf16 v[124:127], a[12:15], a[116:119], v[124:127]
  s_waitcnt vmcnt(23) lgkmcnt(0)
  v_mfma_f32_16x16x32_bf16 v[0:3], a[16:19], a[120:123], v[0:3]
  buffer_load_dwordx4 a[12:15], v208, s[8:11], s20 offen offset:3072
  v_mfma_f32_16x16x32_bf16 v[4:7], a[16:19], a[124:127], v[4:7]
  v_cvt_pk_bf16_f32 v235, v238, v239
  v_mfma_f32_16x16x32_bf16 v[8:11], a[16:19], a[128:131], v[8:11]
  ds_write_b128 v221, v[232:235] offset:12288
  ds_read_b128 v[232:235], v222 offset:4096
  v_mfma_f32_16x16x32_bf16 v[12:15], a[16:19], a[132:135], v[12:15]
  v_mfma_f32_16x16x32_bf16 v[16:19], a[20:23], a[120:123], v[16:19]
  s_add_u32 s20, s20, 4096
  buffer_load_dwordx4 a[16:19], v208, s[8:11], s20 offen
  v_mfma_f32_16x16x32_bf16 v[20:23], a[20:23], a[124:127], v[20:23]
  ds_read_b128 a[104:107], v211 offset:16384
  v_mfma_f32_16x16x32_bf16 v[24:27], a[20:23], a[128:131], v[24:27]
  v_lshlrev_b32 v236, 16, v228
  v_and_b32 v237, s27, v228
  v_mfma_f32_16x16x32_bf16 v[28:31], a[20:23], a[132:135], v[28:31]
  s_waitcnt vmcnt(23)
  v_mfma_f32_16x16x32_bf16 v[32:35], a[24:27], a[120:123], v[32:35]
  buffer_load_dwordx4 a[20:23], v208, s[8:11], s20 offen offset:1024
  v_mfma_f32_16x16x32_bf16 v[36:39], a[24:27], a[124:127], v[36:39]
  ds_read_b128 a[108:111], v211 offset:20480
  v_accvgpr_write_b32 a216, v228
  v_mfma_f32_16x16x32_bf16 v[40:43], a[24:27], a[128:131], v[40:43]
  v_fma_f32 v236, v236, v160, v236
  v_fma_f32 v237, v237, v161, v237
  v_mfma_f32_16x16x32_bf16 v[44:47], a[24:27], a[132:135], v[44:47]
  v_mfma_f32_16x16x32_bf16 v[48:51], a[28:31], a[120:123], v[48:51]
  buffer_load_dwordx4 a[24:27], v208, s[8:11], s20 offen offset:2048
  v_mfma_f32_16x16x32_bf16 v[52:55], a[28:31], a[124:127], v[52:55]
  ds_read_b128 a[112:115], v211 offset:24576
  v_mfma_f32_16x16x32_bf16 v[56:59], a[28:31], a[128:131], v[56:59]
  v_cvt_pk_bf16_f32 v228, v236, v237
  v_lshlrev_b32 v238, 16, v229
  v_mfma_f32_16x16x32_bf16 v[60:63], a[28:31], a[132:135], v[60:63]
  s_waitcnt vmcnt(23)
  v_mfma_f32_16x16x32_bf16 v[64:67], a[32:35], a[120:123], v[64:67]
  buffer_load_dwordx4 a[28:31], v208, s[8:11], s20 offen offset:3072
  v_mfma_f32_16x16x32_bf16 v[68:71], a[32:35], a[124:127], v[68:71]
  ds_read_b128 a[116:119], v211 offset:28672
  v_and_b32 v239, s27, v229
  v_mfma_f32_16x16x32_bf16 v[72:75], a[32:35], a[128:131], v[72:75]
  v_accvgpr_write_b32 a217, v229
  v_fma_f32 v238, v238, v162, v238
  v_mfma_f32_16x16x32_bf16 v[76:79], a[32:35], a[132:135], v[76:79]
  v_mfma_f32_16x16x32_bf16 v[80:83], a[36:39], a[120:123], v[80:83]
  s_add_u32 s20, s20, 4096
  buffer_load_dwordx4 a[32:35], v208, s[8:11], s20 offen
  v_mfma_f32_16x16x32_bf16 v[84:87], a[36:39], a[124:127], v[84:87]
  v_mfma_f32_16x16x32_bf16 v[88:91], a[36:39], a[128:131], v[88:91]
  v_fma_f32 v239, v239, v163, v239
  v_cvt_pk_bf16_f32 v229, v238, v239
  v_mfma_f32_16x16x32_bf16 v[92:95], a[36:39], a[132:135], v[92:95]
  s_waitcnt vmcnt(23)
  v_mfma_f32_16x16x32_bf16 v[96:99], a[40:43], a[120:123], v[96:99]
  buffer_load_dwordx4 a[36:39], v208, s[8:11], s20 offen offset:1024
  v_mfma_f32_16x16x32_bf16 v[100:103], a[40:43], a[124:127], v[100:103]
  v_lshlrev_b32 v236, 16, v230
  v_mfma_f32_16x16x32_bf16 v[104:107], a[40:43], a[128:131], v[104:107]
  v_and_b32 v237, s27, v230
  v_accvgpr_write_b32 a218, v230
  v_mfma_f32_16x16x32_bf16 v[108:111], a[40:43], a[132:135], v[108:111]
  v_mfma_f32_16x16x32_bf16 v[112:115], a[44:47], a[120:123], v[112:115]
  buffer_load_dwordx4 a[40:43], v208, s[8:11], s20 offen offset:2048
  v_mfma_f32_16x16x32_bf16 v[116:119], a[44:47], a[124:127], v[116:119]
  v_fma_f32 v236, v236, v176, v236
  v_mfma_f32_16x16x32_bf16 v[120:123], a[44:47], a[128:131], v[120:123]
  v_fma_f32 v237, v237, v177, v237
  v_cvt_pk_bf16_f32 v230, v236, v237
  v_mfma_f32_16x16x32_bf16 v[124:127], a[44:47], a[132:135], v[124:127]
  s_waitcnt vmcnt(23) lgkmcnt(0)
  v_mfma_f32_16x16x32_bf16 v[0:3], a[48:51], a[104:107], v[0:3]
  buffer_load_dwordx4 a[44:47], v208, s[8:11], s20 offen offset:3072
  v_mfma_f32_16x16x32_bf16 v[4:7], a[48:51], a[108:111], v[4:7]
  v_mfma_f32_16x16x32_bf16 v[8:11], a[48:51], a[112:115], v[8:11]
  v_lshlrev_b32 v238, 16, v231
  v_and_b32 v239, s27, v231
  v_mfma_f32_16x16x32_bf16 v[12:15], a[48:51], a[116:119], v[12:15]
  v_mfma_f32_16x16x32_bf16 v[16:19], a[52:55], a[104:107], v[16:19]
  s_add_u32 s20, s20, 4096
  buffer_load_dwordx4 a[48:51], v208, s[8:11], s20 offen
  v_mfma_f32_16x16x32_bf16 v[20:23], a[52:55], a[108:111], v[20:23]
  ds_read_b128 a[120:123], v212 offset:16384
  v_accvgpr_write_b32 a219, v231
  v_mfma_f32_16x16x32_bf16 v[24:27], a[52:55], a[112:115], v[24:27]
  v_fma_f32 v238, v238, v178, v238
  v_fma_f32 v239, v239, v179, v239
  v_mfma_f32_16x16x32_bf16 v[28:31], a[52:55], a[116:119], v[28:31]
  s_waitcnt vmcnt(23)
  v_mfma_f32_16x16x32_bf16 v[32:35], a[56:59], a[104:107], v[32:35]
  buffer_load_dwordx4 a[52:55], v208, s[8:11], s20 offen offset:1024
  v_mfma_f32_16x16x32_bf16 v[36:39], a[56:59], a[108:111], v[36:39]
  ds_read_b128 a[124:127], v212 offset:20480
  v_mfma_f32_16x16x32_bf16 v[40:43], a[56:59], a[112:115], v[40:43]
  v_cvt_pk_bf16_f32 v231, v238, v239
  ds_write_b128 v222, v[228:231]
  v_mfma_f32_16x16x32_bf16 v[44:47], a[56:59], a[116:119], v[44:47]
  v_mfma_f32_16x16x32_bf16 v[48:51], a[60:63], a[104:107], v[48:51]
  buffer_load_dwordx4 a[56:59], v208, s[8:11], s20 offen offset:2048
  v_mfma_f32_16x16x32_bf16 v[52:55], a[60:63], a[108:111], v[52:55]
  ds_read_b128 a[128:131], v212 offset:24576
  ds_read_b128 v[228:231], v222 offset:8192
  v_mfma_f32_16x16x32_bf16 v[56:59], a[60:63], a[112:115], v[56:59]
  v_lshlrev_b32 v236, 16, v232
  v_and_b32 v237, s27, v232
  v_mfma_f32_16x16x32_bf16 v[60:63], a[60:63], a[116:119], v[60:63]
  s_waitcnt vmcnt(23)
  v_mfma_f32_16x16x32_bf16 v[64:67], a[64:67], a[104:107], v[64:67]
  buffer_load_dwordx4 a[60:63], v208, s[8:11], s20 offen offset:3072
  v_mfma_f32_16x16x32_bf16 v[68:71], a[64:67], a[108:111], v[68:71]
  ds_read_b128 a[132:135], v212 offset:28672
  v_accvgpr_write_b32 a220, v232
  v_mfma_f32_16x16x32_bf16 v[72:75], a[64:67], a[112:115], v[72:75]
  v_fma_f32 v236, v236, v164, v236
  v_fma_f32 v237, v237, v165, v237
  v_mfma_f32_16x16x32_bf16 v[76:79], a[64:67], a[116:119], v[76:79]
  v_mfma_f32_16x16x32_bf16 v[80:83], a[68:71], a[104:107], v[80:83]
  s_add_u32 s20, s20, 4096
  buffer_load_dwordx4 a[64:67], v208, s[8:11], s20 offen
  v_mfma_f32_16x16x32_bf16 v[84:87], a[68:71], a[108:111], v[84:87]
  v_mfma_f32_16x16x32_bf16 v[88:91], a[68:71], a[112:115], v[88:91]
  v_cvt_pk_bf16_f32 v232, v236, v237
  v_lshlrev_b32 v238, 16, v233
  v_mfma_f32_16x16x32_bf16 v[92:95], a[68:71], a[116:119], v[92:95]
  s_waitcnt vmcnt(23)
  v_mfma_f32_16x16x32_bf16 v[96:99], a[72:75], a[104:107], v[96:99]
  buffer_load_dwordx4 a[68:71], v208, s[8:11], s20 offen offset:1024
  v_mfma_f32_16x16x32_bf16 v[100:103], a[72:75], a[108:111], v[100:103]
  v_and_b32 v239, s27, v233
  v_mfma_f32_16x16x32_bf16 v[104:107], a[72:75], a[112:115], v[104:107]
  v_accvgpr_write_b32 a221, v233
  v_fma_f32 v238, v238, v166, v238
  v_mfma_f32_16x16x32_bf16 v[108:111], a[72:75], a[116:119], v[108:111]
  v_mfma_f32_16x16x32_bf16 v[112:115], a[76:79], a[104:107], v[112:115]
  buffer_load_dwordx4 a[72:75], v208, s[8:11], s20 offen offset:2048
  v_mfma_f32_16x16x32_bf16 v[116:119], a[76:79], a[108:111], v[116:119]
  v_mfma_f32_16x16x32_bf16 v[120:123], a[76:79], a[112:115], v[120:123]
  v_fma_f32 v239, v239, v167, v239
  v_cvt_pk_bf16_f32 v233, v238, v239
  v_mfma_f32_16x16x32_bf16 v[124:127], a[76:79], a[116:119], v[124:127]
  s_waitcnt vmcnt(23) lgkmcnt(0)
  v_mfma_f32_16x16x32_bf16 v[0:3], a[80:83], a[120:123], v[0:3]
  buffer_load_dwordx4 a[76:79], v208, s[8:11], s20 offen offset:3072
  v_mfma_f32_16x16x32_bf16 v[4:7], a[80:83], a[124:127], v[4:7]
  v_lshlrev_b32 v236, 16, v234
  v_mfma_f32_16x16x32_bf16 v[8:11], a[80:83], a[128:131], v[8:11]
  v_and_b32 v237, s27, v234
  v_accvgpr_write_b32 a222, v234
  v_mfma_f32_16x16x32_bf16 v[12:15], a[80:83], a[132:135], v[12:15]
  v_mfma_f32_16x16x32_bf16 v[16:19], a[84:87], a[120:123], v[16:19]
  s_add_u32 s20, s20, 4096
  buffer_load_dwordx4 a[80:83], v208, s[8:11], s20 offen
  v_mfma_f32_16x16x32_bf16 v[20:23], a[84:87], a[124:127], v[20:23]
  ds_read_b128 a[104:107], v209 offset:32768
  v_fma_f32 v236, v236, v180, v236
  v_mfma_f32_16x16x32_bf16 v[24:27], a[84:87], a[128:131], v[24:27]
  v_fma_f32 v237, v237, v181, v237
  v_cvt_pk_bf16_f32 v234, v236, v237
  v_mfma_f32_16x16x32_bf16 v[28:31], a[84:87], a[132:135], v[28:31]
  s_waitcnt vmcnt(23)
  v_mfma_f32_16x16x32_bf16 v[32:35], a[88:91], a[120:123], v[32:35]
  buffer_load_dwordx4 a[84:87], v208, s[8:11], s20 offen offset:1024
  v_mfma_f32_16x16x32_bf16 v[36:39], a[88:91], a[124:127], v[36:39]
  ds_read_b128 a[108:111], v209 offset:36864
  v_mfma_f32_16x16x32_bf16 v[40:43], a[88:91], a[128:131], v[40:43]
  v_lshlrev_b32 v238, 16, v235
  v_and_b32 v239, s27, v235
  v_mfma_f32_16x16x32_bf16 v[44:47], a[88:91], a[132:135], v[44:47]
  v_mfma_f32_16x16x32_bf16 v[48:51], a[92:95], a[120:123], v[48:51]
  buffer_load_dwordx4 a[88:91], v208, s[8:11], s20 offen offset:2048
  v_mfma_f32_16x16x32_bf16 v[52:55], a[92:95], a[124:127], v[52:55]
  ds_read_b128 a[112:115], v209 offset:40960
  v_accvgpr_write_b32 a223, v235
  v_mfma_f32_16x16x32_bf16 v[56:59], a[92:95], a[128:131], v[56:59]
  v_fma_f32 v238, v238, v182, v238
  v_fma_f32 v239, v239, v183, v239
  v_mfma_f32_16x16x32_bf16 v[60:63], a[92:95], a[132:135], v[60:63]
  s_waitcnt vmcnt(23)
  v_mfma_f32_16x16x32_bf16 v[64:67], a[96:99], a[120:123], v[64:67]
  buffer_load_dwordx4 a[92:95], v208, s[8:11], s20 offen offset:3072
  v_mfma_f32_16x16x32_bf16 v[68:71], a[96:99], a[124:127], v[68:71]
  ds_read_b128 a[116:119], v209 offset:45056
  v_mfma_f32_16x16x32_bf16 v[72:75], a[96:99], a[128:131], v[72:75]
  v_cvt_pk_bf16_f32 v235, v238, v239
  ds_write_b128 v222, v[232:235] offset:4096
  v_mfma_f32_16x16x32_bf16 v[76:79], a[96:99], a[132:135], v[76:79]
  v_mfma_f32_16x16x32_bf16 v[80:83], a[100:103], a[120:123], v[80:83]
  s_add_u32 s20, s20, 4096
  buffer_load_dwordx4 a[96:99], v208, s[8:11], s20 offen
  v_mfma_f32_16x16x32_bf16 v[84:87], a[100:103], a[124:127], v[84:87]
  ds_read_b128 v[232:235], v222 offset:12288
  v_mfma_f32_16x16x32_bf16 v[88:91], a[100:103], a[128:131], v[88:91]
  v_lshlrev_b32 v236, 16, v228
  v_and_b32 v237, s27, v228
  v_mfma_f32_16x16x32_bf16 v[92:95], a[100:103], a[132:135], v[92:95]
  s_waitcnt vmcnt(23)
  v_mfma_f32_16x16x32_bf16 v[96:99], a[0:3], a[120:123], v[96:99]
  buffer_load_dwordx4 a[100:103], v208, s[8:11], s20 offen offset:1024
  v_mfma_f32_16x16x32_bf16 v[100:103], a[0:3], a[124:127], v[100:103]
  v_mfma_f32_16x16x32_bf16 v[104:107], a[0:3], a[128:131], v[104:107]
  v_accvgpr_write_b32 a224, v228
  v_fma_f32 v236, v236, v168, v236
  v_mfma_f32_16x16x32_bf16 v[108:111], a[0:3], a[132:135], v[108:111]
  v_mfma_f32_16x16x32_bf16 v[112:115], a[4:7], a[120:123], v[112:115]
  buffer_load_dwordx4 a[0:3], v208, s[8:11], s20 offen offset:2048
  v_mfma_f32_16x16x32_bf16 v[116:119], a[4:7], a[124:127], v[116:119]
  v_fma_f32 v237, v237, v169, v237
  v_mfma_f32_16x16x32_bf16 v[120:123], a[4:7], a[128:131], v[120:123]
  v_cvt_pk_bf16_f32 v228, v236, v237
  v_lshlrev_b32 v238, 16, v229
  v_mfma_f32_16x16x32_bf16 v[124:127], a[4:7], a[132:135], v[124:127]
  s_waitcnt vmcnt(23) lgkmcnt(2)
  v_mfma_f32_16x16x32_bf16 v[0:3], a[8:11], a[104:107], v[0:3]
  buffer_load_dwordx4 a[4:7], v208, s[8:11], s20 offen offset:3072
  v_mfma_f32_16x16x32_bf16 v[4:7], a[8:11], a[108:111], v[4:7]
  v_and_b32 v239, s27, v229
  v_mfma_f32_16x16x32_bf16 v[8:11], a[8:11], a[112:115], v[8:11]
  v_accvgpr_write_b32 a225, v229
  v_fma_f32 v238, v238, v170, v238
  v_mfma_f32_16x16x32_bf16 v[12:15], a[8:11], a[116:119], v[12:15]
  v_mfma_f32_16x16x32_bf16 v[16:19], a[12:15], a[104:107], v[16:19]
  s_add_u32 s20, s20, 4096
  buffer_load_dwordx4 a[8:11], v208, s[8:11], s20 offen
  v_mfma_f32_16x16x32_bf16 v[20:23], a[12:15], a[108:111], v[20:23]
  ds_read_b128 a[120:123], v210 offset:32768
  v_mfma_f32_16x16x32_bf16 v[24:27], a[12:15], a[112:115], v[24:27]
  v_fma_f32 v239, v239, v171, v239
  v_cvt_pk_bf16_f32 v229, v238, v239
  v_mfma_f32_16x16x32_bf16 v[28:31], a[12:15], a[116:119], v[28:31]
  s_waitcnt vmcnt(23)
  v_mfma_f32_16x16x32_bf16 v[32:35], a[16:19], a[104:107], v[32:35]
  buffer_load_dwordx4 a[12:15], v208, s[8:11], s20 offen offset:1024
  v_mfma_f32_16x16x32_bf16 v[36:39], a[16:19], a[108:111], v[36:39]
  ds_read_b128 a[124:127], v210 offset:36864
  v_lshlrev_b32 v236, 16, v230
  v_mfma_f32_16x16x32_bf16 v[40:43], a[16:19], a[112:115], v[40:43]
  v_and_b32 v237, s27, v230
  v_accvgpr_write_b32 a226, v230
  v_mfma_f32_16x16x32_bf16 v[44:47], a[16:19], a[116:119], v[44:47]
  v_mfma_f32_16x16x32_bf16 v[48:51], a[20:23], a[104:107], v[48:51]
  buffer_load_dwordx4 a[16:19], v208, s[8:11], s20 offen offset:2048
  v_mfma_f32_16x16x32_bf16 v[52:55], a[20:23], a[108:111], v[52:55]
  ds_read_b128 a[128:131], v210 offset:40960
  v_mfma_f32_16x16x32_bf16 v[56:59], a[20:23], a[112:115], v[56:59]
  v_fma_f32 v236, v236, v184, v236
  v_fma_f32 v237, v237, v185, v237
  v_mfma_f32_16x16x32_bf16 v[60:63], a[20:23], a[116:119], v[60:63]
  s_waitcnt vmcnt(23)
  v_mfma_f32_16x16x32_bf16 v[64:67], a[24:27], a[104:107], v[64:67]
  buffer_load_dwordx4 a[20:23], v208, s[8:11], s20 offen offset:3072
  v_mfma_f32_16x16x32_bf16 v[68:71], a[24:27], a[108:111], v[68:71]
  ds_read_b128 a[132:135], v210 offset:45056
  v_cvt_pk_bf16_f32 v230, v236, v237
  v_mfma_f32_16x16x32_bf16 v[72:75], a[24:27], a[112:115], v[72:75]
  v_lshlrev_b32 v238, 16, v231
  v_and_b32 v239, s27, v231
  v_mfma_f32_16x16x32_bf16 v[76:79], a[24:27], a[116:119], v[76:79]
  v_mfma_f32_16x16x32_bf16 v[80:83], a[28:31], a[104:107], v[80:83]
  s_add_u32 s20, s20, 4096
  buffer_load_dwordx4 a[24:27], v208, s[8:11], s20 offen
  v_mfma_f32_16x16x32_bf16 v[84:87], a[28:31], a[108:111], v[84:87]
  v_accvgpr_write_b32 a227, v231
  v_mfma_f32_16x16x32_bf16 v[88:91], a[28:31], a[112:115], v[88:91]
  v_fma_f32 v238, v238, v186, v238
  v_fma_f32 v239, v239, v187, v239
  v_mfma_f32_16x16x32_bf16 v[92:95], a[28:31], a[116:119], v[92:95]
  s_waitcnt vmcnt(23)
  v_mfma_f32_16x16x32_bf16 v[96:99], a[32:35], a[104:107], v[96:99]
  buffer_load_dwordx4 a[28:31], v208, s[8:11], s20 offen offset:1024
  v_mfma_f32_16x16x32_bf16 v[100:103], a[32:35], a[108:111], v[100:103]
  v_mfma_f32_16x16x32_bf16 v[104:107], a[32:35], a[112:115], v[104:107]
  v_cvt_pk_bf16_f32 v231, v238, v239
  ds_write_b128 v222, v[228:231] offset:8192
  v_mfma_f32_16x16x32_bf16 v[108:111], a[32:35], a[116:119], v[108:111]
  v_mfma_f32_16x16x32_bf16 v[112:115], a[36:39], a[104:107], v[112:115]
  buffer_load_dwordx4 a[32:35], v208, s[8:11], s20 offen offset:2048
  v_mfma_f32_16x16x32_bf16 v[116:119], a[36:39], a[108:111], v[116:119]
  ds_read_b64 v[228:229], v223
  v_mfma_f32_16x16x32_bf16 v[120:123], a[36:39], a[112:115], v[120:123]
  s_waitcnt lgkmcnt(6)
  v_lshlrev_b32 v236, 16, v232
  v_and_b32 v237, s27, v232
  v_mfma_f32_16x16x32_bf16 v[124:127], a[36:39], a[116:119], v[124:127]
  s_waitcnt vmcnt(23) lgkmcnt(2)
  v_mfma_f32_16x16x32_bf16 v[0:3], a[40:43], a[120:123], v[0:3]
  buffer_load_dwordx4 a[36:39], v208, s[8:11], s20 offen offset:3072
  v_mfma_f32_16x16x32_bf16 v[4:7], a[40:43], a[124:127], v[4:7]
  v_mfma_f32_16x16x32_bf16 v[8:11], a[40:43], a[128:131], v[8:11]
  v_accvgpr_write_b32 a228, v232
  v_fma_f32 v236, v236, v172, v236
  v_mfma_f32_16x16x32_bf16 v[12:15], a[40:43], a[132:135], v[12:15]
  v_mfma_f32_16x16x32_bf16 v[16:19], a[44:47], a[120:123], v[16:19]
  s_add_u32 s20, s20, 4096
  buffer_load_dwordx4 a[40:43], v208, s[8:11], s20 offen
  v_mfma_f32_16x16x32_bf16 v[20:23], a[44:47], a[124:127], v[20:23]
  ds_read_b128 a[104:107], v211 offset:32768
  v_fma_f32 v237, v237, v173, v237
  v_mfma_f32_16x16x32_bf16 v[24:27], a[44:47], a[128:131], v[24:27]
  v_cvt_pk_bf16_f32 v232, v236, v237
  v_lshlrev_b32 v238, 16, v233
  v_mfma_f32_16x16x32_bf16 v[28:31], a[44:47], a[132:135], v[28:31]
  s_waitcnt vmcnt(23)
  v_mfma_f32_16x16x32_bf16 v[32:35], a[48:51], a[120:123], v[32:35]
  buffer_load_dwordx4 a[44:47], v208, s[8:11], s20 offen offset:1024
  v_mfma_f32_16x16x32_bf16 v[36:39], a[48:51], a[124:127], v[36:39]
  ds_read_b128 a[108:111], v211 offset:36864
  v_mfma_f32_16x16x32_bf16 v[40:43], a[48:51], a[128:131], v[40:43]
  v_and_b32 v239, s27, v233
  v_accvgpr_write_b32 a229, v233
  v_mfma_f32_16x16x32_bf16 v[44:47], a[48:51], a[132:135], v[44:47]
  v_mfma_f32_16x16x32_bf16 v[48:51], a[52:55], a[120:123], v[48:51]
  buffer_load_dwordx4 a[48:51], v208, s[8:11], s20 offen offset:2048
  v_mfma_f32_16x16x32_bf16 v[52:55], a[52:55], a[124:127], v[52:55]
  ds_read_b128 a[112:115], v211 offset:40960
  v_fma_f32 v238, v238, v174, v238
  v_mfma_f32_16x16x32_bf16 v[56:59], a[52:55], a[128:131], v[56:59]
  v_fma_f32 v239, v239, v175, v239
  v_cvt_pk_bf16_f32 v233, v238, v239
  v_mfma_f32_16x16x32_bf16 v[60:63], a[52:55], a[132:135], v[60:63]
  s_waitcnt vmcnt(23)
  v_mfma_f32_16x16x32_bf16 v[64:67], a[56:59], a[120:123], v[64:67]
  buffer_load_dwordx4 a[52:55], v208, s[8:11], s20 offen offset:3072
  v_mfma_f32_16x16x32_bf16 v[68:71], a[56:59], a[124:127], v[68:71]
  ds_read_b128 a[116:119], v211 offset:45056
  v_lshlrev_b32 v236, 16, v234
  v_mfma_f32_16x16x32_bf16 v[72:75], a[56:59], a[128:131], v[72:75]
  v_and_b32 v237, s27, v234
  v_accvgpr_write_b32 a230, v234
  v_mfma_f32_16x16x32_bf16 v[76:79], a[56:59], a[132:135], v[76:79]
  v_mfma_f32_16x16x32_bf16 v[80:83], a[60:63], a[120:123], v[80:83]
  s_add_u32 s20, s20, 4096
  buffer_load_dwordx4 a[56:59], v208, s[8:11], s20 offen
  v_mfma_f32_16x16x32_bf16 v[84:87], a[60:63], a[124:127], v[84:87]
  v_mfma_f32_16x16x32_bf16 v[88:91], a[60:63], a[128:131], v[88:91]
  v_fma_f32 v236, v236, v188, v236
  v_fma_f32 v237, v237, v189, v237
  v_mfma_f32_16x16x32_bf16 v[92:95], a[60:63], a[132:135], v[92:95]
  s_waitcnt vmcnt(23)
  v_mfma_f32_16x16x32_bf16 v[96:99], a[64:67], a[120:123], v[96:99]
  buffer_load_dwordx4 a[60:63], v208, s[8:11], s20 offen offset:1024
  v_mfma_f32_16x16x32_bf16 v[100:103], a[64:67], a[124:127], v[100:103]
  v_cvt_pk_bf16_f32 v234, v236, v237
  v_mfma_f32_16x16x32_bf16 v[104:107], a[64:67], a[128:131], v[104:107]
  v_lshlrev_b32 v238, 16, v235
  v_and_b32 v239, s27, v235
  v_mfma_f32_16x16x32_bf16 v[108:111], a[64:67], a[132:135], v[108:111]
  v_mfma_f32_16x16x32_bf16 v[112:115], a[68:71], a[120:123], v[112:115]
  buffer_load_dwordx4 a[64:67], v208, s[8:11], s20 offen offset:2048
  v_mfma_f32_16x16x32_bf16 v[116:119], a[68:71], a[124:127], v[116:119]
  v_mfma_f32_16x16x32_bf16 v[120:123], a[68:71], a[128:131], v[120:123]
  v_accvgpr_write_b32 a231, v235
  v_fma_f32 v238, v238, v190, v238
  v_mfma_f32_16x16x32_bf16 v[124:127], a[68:71], a[132:135], v[124:127]
  s_waitcnt vmcnt(23) lgkmcnt(0)
  v_mfma_f32_16x16x32_bf16 v[0:3], a[72:75], a[104:107], v[0:3]
  buffer_load_dwordx4 a[68:71], v208, s[8:11], s20 offen offset:3072
  v_mfma_f32_16x16x32_bf16 v[4:7], a[72:75], a[108:111], v[4:7]
  v_fma_f32 v239, v239, v191, v239
  v_mfma_f32_16x16x32_bf16 v[8:11], a[72:75], a[112:115], v[8:11]
  v_cvt_pk_bf16_f32 v235, v238, v239
  ds_write_b128 v222, v[232:235] offset:12288
  v_mfma_f32_16x16x32_bf16 v[12:15], a[72:75], a[116:119], v[12:15]
  v_mfma_f32_16x16x32_bf16 v[16:19], a[76:79], a[104:107], v[16:19]
  s_add_u32 s20, s20, 4096
  buffer_load_dwordx4 a[72:75], v208, s[8:11], s20 offen
  v_mfma_f32_16x16x32_bf16 v[20:23], a[76:79], a[108:111], v[20:23]
  ds_read_b128 a[120:123], v212 offset:32768
  ds_read_b64 v[232:233], v223 offset:4096
  v_mfma_f32_16x16x32_bf16 v[24:27], a[76:79], a[112:115], v[24:27]
  v_lshlrev_b32 v236, 16, v228
  v_and_b32 v237, s27, v228
  v_mfma_f32_16x16x32_bf16 v[28:31], a[76:79], a[116:119], v[28:31]
  s_waitcnt vmcnt(23)
  v_mfma_f32_16x16x32_bf16 v[32:35], a[80:83], a[104:107], v[32:35]
  buffer_load_dwordx4 a[76:79], v208, s[8:11], s20 offen offset:1024
  v_mfma_f32_16x16x32_bf16 v[36:39], a[80:83], a[108:111], v[36:39]
  ds_read_b128 a[124:127], v212 offset:36864
  v_mfma_f32_16x16x32_bf16 v[40:43], a[80:83], a[112:115], v[40:43]
  v_accvgpr_write_b32 a232, v228
  v_fma_f32 v236, v236, v192, v236
  v_mfma_f32_16x16x32_bf16 v[44:47], a[80:83], a[116:119], v[44:47]
  v_mfma_f32_16x16x32_bf16 v[48:51], a[84:87], a[104:107], v[48:51]
  buffer_load_dwordx4 a[80:83], v208, s[8:11], s20 offen offset:2048
  v_mfma_f32_16x16x32_bf16 v[52:55], a[84:87], a[108:111], v[52:55]
  ds_read_b128 a[128:131], v212 offset:40960
  v_fma_f32 v237, v237, v193, v237
  v_mfma_f32_16x16x32_bf16 v[56:59], a[84:87], a[112:115], v[56:59]
  v_cvt_pk_bf16_f32 v228, v236, v237
  v_lshlrev_b32 v238, 16, v229
  v_mfma_f32_16x16x32_bf16 v[60:63], a[84:87], a[116:119], v[60:63]
  s_waitcnt vmcnt(23)
  v_mfma_f32_16x16x32_bf16 v[64:67], a[88:91], a[104:107], v[64:67]
  buffer_load_dwordx4 a[84:87], v208, s[8:11], s20 offen offset:3072
  v_mfma_f32_16x16x32_bf16 v[68:71], a[88:91], a[108:111], v[68:71]
  ds_read_b128 a[132:135], v212 offset:45056
  v_mfma_f32_16x16x32_bf16 v[72:75], a[88:91], a[112:115], v[72:75]
  v_and_b32 v239, s27, v229
  v_accvgpr_write_b32 a233, v229
  v_mfma_f32_16x16x32_bf16 v[76:79], a[88:91], a[116:119], v[76:79]
  v_mfma_f32_16x16x32_bf16 v[80:83], a[92:95], a[104:107], v[80:83]
  s_add_u32 s20, s20, 4096
  buffer_load_dwordx4 a[88:91], v208, s[8:11], s20 offen
  v_mfma_f32_16x16x32_bf16 v[84:87], a[92:95], a[108:111], v[84:87]
  v_fma_f32 v238, v238, v194, v238
  v_mfma_f32_16x16x32_bf16 v[88:91], a[92:95], a[112:115], v[88:91]
  v_fma_f32 v239, v239, v195, v239
  v_cvt_pk_bf16_f32 v229, v238, v239
  v_mfma_f32_16x16x32_bf16 v[92:95], a[92:95], a[116:119], v[92:95]
  s_waitcnt vmcnt(23)
  v_mfma_f32_16x16x32_bf16 v[96:99], a[96:99], a[104:107], v[96:99]
  buffer_load_dwordx4 a[92:95], v208, s[8:11], s20 offen offset:1024
  v_mfma_f32_16x16x32_bf16 v[100:103], a[96:99], a[108:111], v[100:103]
  ds_write_b64 v223, v[228:229]
  v_mfma_f32_16x16x32_bf16 v[104:107], a[96:99], a[112:115], v[104:107]
  ds_read_b64 v[228:229], v223 offset:8192
  s_waitcnt lgkmcnt(5)
  v_lshlrev_b32 v236, 16, v232
  v_mfma_f32_16x16x32_bf16 v[108:111], a[96:99], a[116:119], v[108:111]
  v_mfma_f32_16x16x32_bf16 v[112:115], a[100:103], a[104:107], v[112:115]
  buffer_load_dwordx4 a[96:99], v208, s[8:11], s20 offen offset:2048
  v_mfma_f32_16x16x32_bf16 v[116:119], a[100:103], a[108:111], v[116:119]
  v_mfma_f32_16x16x32_bf16 v[120:123], a[100:103], a[112:115], v[120:123]
  v_and_b32 v237, s27, v232
  v_accvgpr_write_b32 a234, v232
  v_mfma_f32_16x16x32_bf16 v[124:127], a[100:103], a[116:119], v[124:127]
  s_waitcnt vmcnt(23) lgkmcnt(2)
  v_mfma_f32_16x16x32_bf16 v[0:3], a[0:3], a[120:123], v[0:3]
  buffer_load_dwordx4 a[100:103], v208, s[8:11], s20 offen offset:3072
  v_mfma_f32_16x16x32_bf16 v[4:7], a[0:3], a[124:127], v[4:7]
  v_fma_f32 v236, v236, v196, v236
  v_mfma_f32_16x16x32_bf16 v[8:11], a[0:3], a[128:131], v[8:11]
  v_fma_f32 v237, v237, v197, v237
  v_cvt_pk_bf16_f32 v232, v236, v237
  v_mfma_f32_16x16x32_bf16 v[12:15], a[0:3], a[132:135], v[12:15]
  v_mfma_f32_16x16x32_bf16 v[16:19], a[4:7], a[120:123], v[16:19]
  s_add_u32 s20, s20, 4096
  buffer_load_dwordx4 a[0:3], v208, s[8:11], s20 offen
  v_mfma_f32_16x16x32_bf16 v[20:23], a[4:7], a[124:127], v[20:23]
  ds_read_b128 a[104:107], v209 offset:49152
  v_mfma_f32_16x16x32_bf16 v[24:27], a[4:7], a[128:131], v[24:27]
  v_lshlrev_b32 v238, 16, v233
  v_and_b32 v239, s27, v233
  v_mfma_f32_16x16x32_bf16 v[28:31], a[4:7], a[132:135], v[28:31]
  s_waitcnt vmcnt(23)
  v_mfma_f32_16x16x32_bf16 v[32:35], a[8:11], a[120:123], v[32:35]
  buffer_load_dwordx4 a[4:7], v208, s[8:11], s20 offen offset:1024
  v_mfma_f32_16x16x32_bf16 v[36:39], a[8:11], a[124:127], v[36:39]
  ds_read_b128 a[108:111], v209 offset:53248
  v_accvgpr_write_b32 a235, v233
  v_mfma_f32_16x16x32_bf16 v[40:43], a[8:11], a[128:131], v[40:43]
  v_fma_f32 v238, v238, v198, v238
  v_fma_f32 v239, v239, v199, v239
  v_mfma_f32_16x16x32_bf16 v[44:47], a[8:11], a[132:135], v[44:47]
  v_mfma_f32_16x16x32_bf16 v[48:51], a[12:15], a[120:123], v[48:51]
  buffer_load_dwordx4 a[8:11], v208, s[8:11], s20 offen offset:2048
  v_mfma_f32_16x16x32_bf16 v[52:55], a[12:15], a[124:127], v[52:55]
  ds_read_b128 a[112:115], v209 offset:57344
  v_mfma_f32_16x16x32_bf16 v[56:59], a[12:15], a[128:131], v[56:59]
  v_cvt_pk_bf16_f32 v233, v238, v239
  ds_write_b64 v223, v[232:233] offset:4096
  v_mfma_f32_16x16x32_bf16 v[60:63], a[12:15], a[132:135], v[60:63]
  s_waitcnt vmcnt(23)
  v_mfma_f32_16x16x32_bf16 v[64:67], a[16:19], a[120:123], v[64:67]
  buffer_load_dwordx4 a[12:15], v208, s[8:11], s20 offen offset:3072
  v_mfma_f32_16x16x32_bf16 v[68:71], a[16:19], a[124:127], v[68:71]
  ds_read_b128 a[116:119], v209 offset:61440
  ds_read_b64 v[232:233], v223 offset:12288
  v_mfma_f32_16x16x32_bf16 v[72:75], a[16:19], a[128:131], v[72:75]
  s_waitcnt lgkmcnt(6)
  v_lshlrev_b32 v236, 16, v228
  v_and_b32 v237, s27, v228
  v_mfma_f32_16x16x32_bf16 v[76:79], a[16:19], a[132:135], v[76:79]
  v_mfma_f32_16x16x32_bf16 v[80:83], a[20:23], a[120:123], v[80:83]
  s_add_u32 s20, s20, 4096
  buffer_load_dwordx4 a[16:19], v208, s[8:11], s20 offen
  v_mfma_f32_16x16x32_bf16 v[84:87], a[20:23], a[124:127], v[84:87]
  v_accvgpr_write_b32 a236, v228
  v_mfma_f32_16x16x32_bf16 v[88:91], a[20:23], a[128:131], v[88:91]
  v_fma_f32 v236, v236, v200, v236
  v_fma_f32 v237, v237, v201, v237
  v_mfma_f32_16x16x32_bf16 v[92:95], a[20:23], a[132:135], v[92:95]
  s_waitcnt vmcnt(23)
  v_mfma_f32_16x16x32_bf16 v[96:99], a[24:27], a[120:123], v[96:99]
  buffer_load_dwordx4 a[20:23], v208, s[8:11], s20 offen offset:1024
  v_mfma_f32_16x16x32_bf16 v[100:103], a[24:27], a[124:127], v[100:103]
  v_mfma_f32_16x16x32_bf16 v[104:107], a[24:27], a[128:131], v[104:107]
  v_cvt_pk_bf16_f32 v228, v236, v237
  v_lshlrev_b32 v238, 16, v229
  v_mfma_f32_16x16x32_bf16 v[108:111], a[24:27], a[132:135], v[108:111]
  v_mfma_f32_16x16x32_bf16 v[112:115], a[28:31], a[120:123], v[112:115]
  buffer_load_dwordx4 a[24:27], v208, s[8:11], s20 offen offset:2048
  v_mfma_f32_16x16x32_bf16 v[116:119], a[28:31], a[124:127], v[116:119]
  v_and_b32 v239, s27, v229
  v_mfma_f32_16x16x32_bf16 v[120:123], a[28:31], a[128:131], v[120:123]
  v_accvgpr_write_b32 a237, v229
  v_fma_f32 v238, v238, v202, v238
  v_mfma_f32_16x16x32_bf16 v[124:127], a[28:31], a[132:135], v[124:127]
  s_waitcnt vmcnt(23) lgkmcnt(1)
  v_mfma_f32_16x16x32_bf16 v[0:3], a[32:35], a[104:107], v[0:3]
  buffer_load_dwordx4 a[28:31], v208, s[8:11], s20 offen offset:3072
  v_mfma_f32_16x16x32_bf16 v[4:7], a[32:35], a[108:111], v[4:7]
  v_mfma_f32_16x16x32_bf16 v[8:11], a[32:35], a[112:115], v[8:11]
  v_fma_f32 v239, v239, v203, v239
  v_cvt_pk_bf16_f32 v229, v238, v239
  v_mfma_f32_16x16x32_bf16 v[12:15], a[32:35], a[116:119], v[12:15]
  v_mfma_f32_16x16x32_bf16 v[16:19], a[36:39], a[104:107], v[16:19]
  s_add_u32 s20, s20, 4096
  buffer_load_dwordx4 a[32:35], v208, s[8:11], s20 offen
  v_mfma_f32_16x16x32_bf16 v[20:23], a[36:39], a[108:111], v[20:23]
  ds_read_b128 a[120:123], v210 offset:49152
  ds_write_b64 v223, v[228:229] offset:8192
  v_mfma_f32_16x16x32_bf16 v[24:27], a[36:39], a[112:115], v[24:27]
  s_waitcnt lgkmcnt(2)
  v_lshlrev_b32 v236, 16, v232
  v_and_b32 v237, s27, v232
  v_mfma_f32_16x16x32_bf16 v[28:31], a[36:39], a[116:119], v[28:31]
  s_waitcnt vmcnt(23)
  v_mfma_f32_16x16x32_bf16 v[32:35], a[40:43], a[104:107], v[32:35]
  buffer_load_dwordx4 a[36:39], v208, s[8:11], s20 offen offset:1024
  v_mfma_f32_16x16x32_bf16 v[36:39], a[40:43], a[108:111], v[36:39]
  ds_read_b128 a[124:127], v210 offset:53248
  v_accvgpr_write_b32 a238, v232
  v_mfma_f32_16x16x32_bf16 v[40:43], a[40:43], a[112:115], v[40:43]
  v_fma_f32 v236, v236, v204, v236
  v_fma_f32 v237, v237, v205, v237
  v_mfma_f32_16x16x32_bf16 v[44:47], a[40:43], a[116:119], v[44:47]
  v_mfma_f32_16x16x32_bf16 v[48:51], a[44:47], a[104:107], v[48:51]
  buffer_load_dwordx4 a[40:43], v208, s[8:11], s20 offen offset:2048
  v_mfma_f32_16x16x32_bf16 v[52:55], a[44:47], a[108:111], v[52:55]
  ds_read_b128 a[128:131], v210 offset:57344
  v_mfma_f32_16x16x32_bf16 v[56:59], a[44:47], a[112:115], v[56:59]
  v_cvt_pk_bf16_f32 v232, v236, v237
  v_lshlrev_b32 v238, 16, v233
  v_mfma_f32_16x16x32_bf16 v[60:63], a[44:47], a[116:119], v[60:63]
  s_waitcnt vmcnt(23)
  v_mfma_f32_16x16x32_bf16 v[64:67], a[48:51], a[104:107], v[64:67]
  buffer_load_dwordx4 a[44:47], v208, s[8:11], s20 offen offset:3072
  v_mfma_f32_16x16x32_bf16 v[68:71], a[48:51], a[108:111], v[68:71]
  ds_read_b128 a[132:135], v210 offset:61440
  v_and_b32 v239, s27, v233
  v_mfma_f32_16x16x32_bf16 v[72:75], a[48:51], a[112:115], v[72:75]
  v_accvgpr_write_b32 a239, v233
  v_fma_f32 v238, v238, v206, v238
  v_mfma_f32_16x16x32_bf16 v[76:79], a[48:51], a[116:119], v[76:79]
  v_mfma_f32_16x16x32_bf16 v[80:83], a[52:55], a[104:107], v[80:83]
  s_add_u32 s20, s20, 4096
  buffer_load_dwordx4 a[48:51], v208, s[8:11], s20 offen
  v_mfma_f32_16x16x32_bf16 v[84:87], a[52:55], a[108:111], v[84:87]
  v_mfma_f32_16x16x32_bf16 v[88:91], a[52:55], a[112:115], v[88:91]
  v_fma_f32 v239, v239, v207, v239
  v_cvt_pk_bf16_f32 v233, v238, v239
  v_mfma_f32_16x16x32_bf16 v[92:95], a[52:55], a[116:119], v[92:95]
  s_waitcnt vmcnt(23)
  v_mfma_f32_16x16x32_bf16 v[96:99], a[56:59], a[104:107], v[96:99]
  buffer_load_dwordx4 a[52:55], v208, s[8:11], s20 offen offset:1024
  v_mfma_f32_16x16x32_bf16 v[100:103], a[56:59], a[108:111], v[100:103]
  ds_write_b64 v223, v[232:233] offset:12288
  v_mfma_f32_16x16x32_bf16 v[104:107], a[56:59], a[112:115], v[104:107]
  ds_read_b128 v[128:131], v226 offset:3840
  ds_read_b128 v[144:147], v226 offset:3856
  v_mfma_f32_16x16x32_bf16 v[108:111], a[56:59], a[116:119], v[108:111]
  v_mfma_f32_16x16x32_bf16 v[112:115], a[60:63], a[104:107], v[112:115]
  buffer_load_dwordx4 a[56:59], v208, s[8:11], s20 offen offset:2048
  v_mfma_f32_16x16x32_bf16 v[116:119], a[60:63], a[108:111], v[116:119]
  ds_read_b128 v[160:163], v226 offset:3968
  v_mfma_f32_16x16x32_bf16 v[120:123], a[60:63], a[112:115], v[120:123]
  ds_read_b128 v[176:179], v226 offset:3984
  ds_read_b128 v[192:195], v227 offset:3328
  v_mfma_f32_16x16x32_bf16 v[124:127], a[60:63], a[116:119], v[124:127]
  s_waitcnt vmcnt(23) lgkmcnt(6)
  v_mfma_f32_16x16x32_bf16 v[0:3], a[64:67], a[120:123], v[0:3]
  buffer_load_dwordx4 a[60:63], v208, s[8:11], s20 offen offset:3072
  v_mfma_f32_16x16x32_bf16 v[4:7], a[64:67], a[124:127], v[4:7]
  v_mfma_f32_16x16x32_bf16 v[8:11], a[64:67], a[128:131], v[8:11]
  v_mfma_f32_16x16x32_bf16 v[12:15], a[64:67], a[132:135], v[12:15]
  v_mfma_f32_16x16x32_bf16 v[16:19], a[68:71], a[120:123], v[16:19]
  s_add_u32 s20, s20, 4096
  buffer_load_dwordx4 a[64:67], v208, s[8:11], s20 offen
  v_mfma_f32_16x16x32_bf16 v[20:23], a[68:71], a[124:127], v[20:23]
  ds_read_b128 a[104:107], v211 offset:49152
  v_mfma_f32_16x16x32_bf16 v[24:27], a[68:71], a[128:131], v[24:27]
  v_mfma_f32_16x16x32_bf16 v[28:31], a[68:71], a[132:135], v[28:31]
  s_waitcnt vmcnt(23)
  v_mfma_f32_16x16x32_bf16 v[32:35], a[72:75], a[120:123], v[32:35]
  buffer_load_dwordx4 a[68:71], v208, s[8:11], s20 offen offset:1024
  v_mfma_f32_16x16x32_bf16 v[36:39], a[72:75], a[124:127], v[36:39]
  ds_read_b128 a[108:111], v211 offset:53248
  v_mfma_f32_16x16x32_bf16 v[40:43], a[72:75], a[128:131], v[40:43]
  v_mfma_f32_16x16x32_bf16 v[44:47], a[72:75], a[132:135], v[44:47]
  v_mfma_f32_16x16x32_bf16 v[48:51], a[76:79], a[120:123], v[48:51]
  buffer_load_dwordx4 a[72:75], v208, s[8:11], s20 offen offset:2048
  v_mfma_f32_16x16x32_bf16 v[52:55], a[76:79], a[124:127], v[52:55]
  ds_read_b128 a[112:115], v211 offset:57344
  v_mfma_f32_16x16x32_bf16 v[56:59], a[76:79], a[128:131], v[56:59]
  v_mfma_f32_16x16x32_bf16 v[60:63], a[76:79], a[132:135], v[60:63]
  s_waitcnt vmcnt(23)
  v_mfma_f32_16x16x32_bf16 v[64:67], a[80:83], a[120:123], v[64:67]
  buffer_load_dwordx4 a[76:79], v208, s[8:11], s20 offen offset:3072
  v_mfma_f32_16x16x32_bf16 v[68:71], a[80:83], a[124:127], v[68:71]
  ds_read_b128 a[116:119], v211 offset:61440
  v_mfma_f32_16x16x32_bf16 v[72:75], a[80:83], a[128:131], v[72:75]
  v_mfma_f32_16x16x32_bf16 v[76:79], a[80:83], a[132:135], v[76:79]
  v_mfma_f32_16x16x32_bf16 v[80:83], a[84:87], a[120:123], v[80:83]
  s_add_u32 s20, s20, 4096
  buffer_load_dwordx4 a[80:83], v208, s[8:11], s20 offen
  v_mfma_f32_16x16x32_bf16 v[84:87], a[84:87], a[124:127], v[84:87]
  v_mfma_f32_16x16x32_bf16 v[88:91], a[84:87], a[128:131], v[88:91]
  v_mfma_f32_16x16x32_bf16 v[92:95], a[84:87], a[132:135], v[92:95]
  s_waitcnt vmcnt(23)
  v_mfma_f32_16x16x32_bf16 v[96:99], a[88:91], a[120:123], v[96:99]
  buffer_load_dwordx4 a[84:87], v208, s[8:11], s20 offen offset:1024
  v_mfma_f32_16x16x32_bf16 v[100:103], a[88:91], a[124:127], v[100:103]
  v_mfma_f32_16x16x32_bf16 v[104:107], a[88:91], a[128:131], v[104:107]
  v_mfma_f32_16x16x32_bf16 v[108:111], a[88:91], a[132:135], v[108:111]
  v_mfma_f32_16x16x32_bf16 v[112:115], a[92:95], a[120:123], v[112:115]
  buffer_load_dwordx4 a[88:91], v208, s[8:11], s20 offen offset:2048
  v_mfma_f32_16x16x32_bf16 v[116:119], a[92:95], a[124:127], v[116:119]
  v_mfma_f32_16x16x32_bf16 v[120:123], a[92:95], a[128:131], v[120:123]
  v_mfma_f32_16x16x32_bf16 v[124:127], a[92:95], a[132:135], v[124:127]
  s_waitcnt lgkmcnt(0)
  s_barrier
  s_waitcnt vmcnt(23)
  v_mfma_f32_16x16x32_bf16 v[0:3], a[96:99], a[104:107], v[0:3]
  buffer_load_dwordx4 a[92:95], v208, s[8:11], s20 offen offset:3072
  v_mfma_f32_16x16x32_bf16 v[4:7], a[96:99], a[108:111], v[4:7]
  v_mfma_f32_16x16x32_bf16 v[8:11], a[96:99], a[112:115], v[8:11]
  v_mfma_f32_16x16x32_bf16 v[12:15], a[96:99], a[116:119], v[12:15]
  v_mfma_f32_16x16x32_bf16 v[16:19], a[100:103], a[104:107], v[16:19]
  s_add_u32 s20, s20, 4096
  buffer_load_dwordx4 a[96:99], v208, s[8:11], s20 offen
  v_mfma_f32_16x16x32_bf16 v[20:23], a[100:103], a[108:111], v[20:23]
  ds_read_b128 a[120:123], v212 offset:49152
  v_mfma_f32_16x16x32_bf16 v[24:27], a[100:103], a[112:115], v[24:27]
  v_mfma_f32_16x16x32_bf16 v[28:31], a[100:103], a[116:119], v[28:31]
  s_waitcnt vmcnt(23)
  v_mfma_f32_16x16x32_bf16 v[32:35], a[0:3], a[104:107], v[32:35]
  buffer_load_dwordx4 a[100:103], v208, s[8:11], s20 offen offset:1024
  v_mfma_f32_16x16x32_bf16 v[36:39], a[0:3], a[108:111], v[36:39]
  ds_read_b128 a[124:127], v212 offset:53248
  v_mfma_f32_16x16x32_bf16 v[40:43], a[0:3], a[112:115], v[40:43]
  v_mfma_f32_16x16x32_bf16 v[44:47], a[0:3], a[116:119], v[44:47]
  v_mfma_f32_16x16x32_bf16 v[48:51], a[4:7], a[104:107], v[48:51]
  buffer_load_dwordx4 a[0:3], v208, s[8:11], s20 offen offset:2048
  v_mfma_f32_16x16x32_bf16 v[52:55], a[4:7], a[108:111], v[52:55]
  ds_read_b128 a[128:131], v212 offset:57344
  v_mfma_f32_16x16x32_bf16 v[56:59], a[4:7], a[112:115], v[56:59]
  v_mfma_f32_16x16x32_bf16 v[60:63], a[4:7], a[116:119], v[60:63]
  s_waitcnt vmcnt(23)
  v_mfma_f32_16x16x32_bf16 v[64:67], a[8:11], a[104:107], v[64:67]
  buffer_load_dwordx4 a[4:7], v208, s[8:11], s20 offen offset:3072
  v_mfma_f32_16x16x32_bf16 v[68:71], a[8:11], a[108:111], v[68:71]
  ds_read_b128 a[132:135], v212 offset:61440
  v_mfma_f32_16x16x32_bf16 v[72:75], a[8:11], a[112:115], v[72:75]
  v_mfma_f32_16x16x32_bf16 v[76:79], a[8:11], a[116:119], v[76:79]
  v_mfma_f32_16x16x32_bf16 v[80:83], a[12:15], a[104:107], v[80:83]
  s_add_u32 s20, s20, 4096
  buffer_load_dwordx4 a[8:11], v208, s[8:11], s20 offen
  v_mfma_f32_16x16x32_bf16 v[84:87], a[12:15], a[108:111], v[84:87]
  v_mfma_f32_16x16x32_bf16 v[88:91], a[12:15], a[112:115], v[88:91]
  v_mfma_f32_16x16x32_bf16 v[92:95], a[12:15], a[116:119], v[92:95]
  s_waitcnt vmcnt(23)
  v_mfma_f32_16x16x32_bf16 v[96:99], a[16:19], a[104:107], v[96:99]
  buffer_load_dwordx4 a[12:15], v208, s[8:11], s20 offen offset:1024
  v_mfma_f32_16x16x32_bf16 v[100:103], a[16:19], a[108:111], v[100:103]
  v_mfma_f32_16x16x32_bf16 v[104:107], a[16:19], a[112:115], v[104:107]
  v_mfma_f32_16x16x32_bf16 v[108:111], a[16:19], a[116:119], v[108:111]
  v_mfma_f32_16x16x32_bf16 v[112:115], a[20:23], a[104:107], v[112:115]
  buffer_load_dwordx4 a[16:19], v208, s[8:11], s20 offen offset:2048
  v_mfma_f32_16x16x32_bf16 v[116:119], a[20:23], a[108:111], v[116:119]
  v_mfma_f32_16x16x32_bf16 v[120:123], a[20:23], a[112:115], v[120:123]
  v_mfma_f32_16x16x32_bf16 v[124:127], a[20:23], a[116:119], v[124:127]
  s_waitcnt vmcnt(23) lgkmcnt(0)
  v_mfma_f32_16x16x32_bf16 v[0:3], a[24:27], a[120:123], v[0:3]
  buffer_load_dwordx4 a[20:23], v208, s[8:11], s20 offen offset:3072
  v_mfma_f32_16x16x32_bf16 v[4:7], a[24:27], a[124:127], v[4:7]
  v_mfma_f32_16x16x32_bf16 v[8:11], a[24:27], a[128:131], v[8:11]
  v_mfma_f32_16x16x32_bf16 v[12:15], a[24:27], a[132:135], v[12:15]
  v_mfma_f32_16x16x32_bf16 v[16:19], a[28:31], a[120:123], v[16:19]
  s_add_u32 s20, s20, 4096
  buffer_load_dwordx4 a[24:27], v208, s[8:11], s20 offen
  v_mfma_f32_16x16x32_bf16 v[20:23], a[28:31], a[124:127], v[20:23]
  ds_read_b128 a[104:107], v213
  v_mfma_f32_16x16x32_bf16 v[24:27], a[28:31], a[128:131], v[24:27]
  v_mfma_f32_16x16x32_bf16 v[28:31], a[28:31], a[132:135], v[28:31]
  s_waitcnt vmcnt(23)
  v_mfma_f32_16x16x32_bf16 v[32:35], a[32:35], a[120:123], v[32:35]
  buffer_load_dwordx4 a[28:31], v208, s[8:11], s20 offen offset:1024
  v_mfma_f32_16x16x32_bf16 v[36:39], a[32:35], a[124:127], v[36:39]
  ds_read_b128 a[108:111], v213 offset:4096
  v_mfma_f32_16x16x32_bf16 v[40:43], a[32:35], a[128:131], v[40:43]
  v_mfma_f32_16x16x32_bf16 v[44:47], a[32:35], a[132:135], v[44:47]
  v_mfma_f32_16x16x32_bf16 v[48:51], a[36:39], a[120:123], v[48:51]
  buffer_load_dwordx4 a[32:35], v208, s[8:11], s20 offen offset:2048
  v_mfma_f32_16x16x32_bf16 v[52:55], a[36:39], a[124:127], v[52:55]
  ds_read_b128 a[112:115], v213 offset:8192
  v_mfma_f32_16x16x32_bf16 v[56:59], a[36:39], a[128:131], v[56:59]
  v_mfma_f32_16x16x32_bf16 v[60:63], a[36:39], a[132:135], v[60:63]
  s_waitcnt vmcnt(23)
  v_mfma_f32_16x16x32_bf16 v[64:67], a[40:43], a[120:123], v[64:67]
  buffer_load_dwordx4 a[36:39], v208, s[8:11], s20 offen offset:3072
  v_mfma_f32_16x16x32_bf16 v[68:71], a[40:43], a[124:127], v[68:71]
  ds_read_b128 a[116:119], v213 offset:12288
  v_mfma_f32_16x16x32_bf16 v[72:75], a[40:43], a[128:131], v[72:75]
  v_mfma_f32_16x16x32_bf16 v[76:79], a[40:43], a[132:135], v[76:79]
  v_mfma_f32_16x16x32_bf16 v[80:83], a[44:47], a[120:123], v[80:83]
  s_add_u32 s20, s20, 4096
  buffer_load_dwordx4 a[40:43], v208, s[8:11], s20 offen
  v_mfma_f32_16x16x32_bf16 v[84:87], a[44:47], a[124:127], v[84:87]
  v_mfma_f32_16x16x32_bf16 v[88:91], a[44:47], a[128:131], v[88:91]
  v_mfma_f32_16x16x32_bf16 v[92:95], a[44:47], a[132:135], v[92:95]
  s_waitcnt vmcnt(23)
  v_mfma_f32_16x16x32_bf16 v[96:99], a[48:51], a[120:123], v[96:99]
  buffer_load_dwordx4 a[44:47], v208, s[8:11], s20 offen offset:1024
  v_mfma_f32_16x16x32_bf16 v[100:103], a[48:51], a[124:127], v[100:103]
  v_mfma_f32_16x16x32_bf16 v[104:107], a[48:51], a[128:131], v[104:107]
  v_mfma_f32_16x16x32_bf16 v[108:111], a[48:51], a[132:135], v[108:111]
  v_mfma_f32_16x16x32_bf16 v[112:115], a[52:55], a[120:123], v[112:115]
  buffer_load_dwordx4 a[48:51], v208, s[8:11], s20 offen offset:2048
  v_mfma_f32_16x16x32_bf16 v[116:119], a[52:55], a[124:127], v[116:119]
  v_mfma_f32_16x16x32_bf16 v[120:123], a[52:55], a[128:131], v[120:123]
  v_mfma_f32_16x16x32_bf16 v[124:127], a[52:55], a[132:135], v[124:127]
  s_waitcnt vmcnt(23) lgkmcnt(0)
  v_mfma_f32_16x16x32_bf16 v[0:3], a[56:59], a[104:107], v[0:3]
  buffer_load_dwordx4 a[52:55], v208, s[8:11], s20 offen offset:3072
  v_mfma_f32_16x16x32_bf16 v[4:7], a[56:59], a[108:111], v[4:7]
  v_mfma_f32_16x16x32_bf16 v[8:11], a[56:59], a[112:115], v[8:11]
  v_mfma_f32_16x16x32_bf16 v[12:15], a[56:59], a[116:119], v[12:15]
  v_mfma_f32_16x16x32_bf16 v[16:19], a[60:63], a[104:107], v[16:19]
  s_add_u32 s20, s20, 4096
  buffer_load_dwordx4 a[56:59], v208, s[8:11], s20 offen
  v_mfma_f32_16x16x32_bf16 v[20:23], a[60:63], a[108:111], v[20:23]
  ds_read_b128 a[120:123], v214
  v_mfma_f32_16x16x32_bf16 v[24:27], a[60:63], a[112:115], v[24:27]
  v_mfma_f32_16x16x32_bf16 v[28:31], a[60:63], a[116:119], v[28:31]
  s_waitcnt vmcnt(23)
  v_mfma_f32_16x16x32_bf16 v[32:35], a[64:67], a[104:107], v[32:35]
  buffer_load_dwordx4 a[60:63], v208, s[8:11], s20 offen offset:1024
  v_mfma_f32_16x16x32_bf16 v[36:39], a[64:67], a[108:111], v[36:39]
  ds_read_b128 a[124:127], v214 offset:4096
  v_mfma_f32_16x16x32_bf16 v[40:43], a[64:67], a[112:115], v[40:43]
  v_mfma_f32_16x16x32_bf16 v[44:47], a[64:67], a[116:119], v[44:47]
  v_mfma_f32_16x16x32_bf16 v[48:51], a[68:71], a[104:107], v[48:51]
  buffer_load_dwordx4 a[64:67], v208, s[8:11], s20 offen offset:2048
  v_mfma_f32_16x16x32_bf16 v[52:55], a[68:71], a[108:111], v[52:55]
  ds_read_b128 a[128:131], v214 offset:8192
  v_mfma_f32_16x16x32_bf16 v[56:59], a[68:71], a[112:115], v[56:59]
  v_mfma_f32_16x16x32_bf16 v[60:63], a[68:71], a[116:119], v[60:63]
  s_waitcnt vmcnt(23)
  v_mfma_f32_16x16x32_bf16 v[64:67], a[72:75], a[104:107], v[64:67]
  buffer_load_dwordx4 a[68:71], v208, s[8:11], s20 offen offset:3072
  v_mfma_f32_16x16x32_bf16 v[68:71], a[72:75], a[108:111], v[68:71]
  ds_read_b128 a[132:135], v214 offset:12288
  v_mfma_f32_16x16x32_bf16 v[72:75], a[72:75], a[112:115], v[72:75]
  v_mfma_f32_16x16x32_bf16 v[76:79], a[72:75], a[116:119], v[76:79]
  v_mfma_f32_16x16x32_bf16 v[80:83], a[76:79], a[104:107], v[80:83]
  s_add_u32 s20, s20, 4096
  buffer_load_dwordx4 a[72:75], v208, s[8:11], s20 offen
  v_mfma_f32_16x16x32_bf16 v[84:87], a[76:79], a[108:111], v[84:87]
  v_mfma_f32_16x16x32_bf16 v[88:91], a[76:79], a[112:115], v[88:91]
  v_mfma_f32_16x16x32_bf16 v[92:95], a[76:79], a[116:119], v[92:95]
  s_waitcnt vmcnt(23)
  v_mfma_f32_16x16x32_bf16 v[96:99], a[80:83], a[104:107], v[96:99]
  buffer_load_dwordx4 a[76:79], v208, s[8:11], s20 offen offset:1024
  v_mfma_f32_16x16x32_bf16 v[100:103], a[80:83], a[108:111], v[100:103]
  v_mfma_f32_16x16x32_bf16 v[104:107], a[80:83], a[112:115], v[104:107]
  v_mfma_f32_16x16x32_bf16 v[108:111], a[80:83], a[116:119], v[108:111]
  v_mfma_f32_16x16x32_bf16 v[112:115], a[84:87], a[104:107], v[112:115]
  buffer_load_dwordx4 a[80:83], v208, s[8:11], s20 offen offset:2048
  v_mfma_f32_16x16x32_bf16 v[116:119], a[84:87], a[108:111], v[116:119]
  v_mfma_f32_16x16x32_bf16 v[120:123], a[84:87], a[112:115], v[120:123]
  v_mfma_f32_16x16x32_bf16 v[124:127], a[84:87], a[116:119], v[124:127]
  s_waitcnt vmcnt(23) lgkmcnt(0)
  v_mfma_f32_16x16x32_bf16 v[0:3], a[88:91], a[120:123], v[0:3]
  buffer_load_dwordx4 a[84:87], v208, s[8:11], s20 offen offset:3072
  v_mfma_f32_16x16x32_bf16 v[4:7], a[88:91], a[124:127], v[4:7]
  v_mfma_f32_16x16x32_bf16 v[8:11], a[88:91], a[128:131], v[8:11]
  v_mfma_f32_16x16x32_bf16 v[12:15], a[88:91], a[132:135], v[12:15]
  v_mfma_f32_16x16x32_bf16 v[16:19], a[92:95], a[120:123], v[16:19]
  s_add_u32 s20, s20, 4096
  buffer_load_dwordx4 a[88:91], v208, s[8:11], s20 offen
  v_mfma_f32_16x16x32_bf16 v[20:23], a[92:95], a[124:127], v[20:23]
  ds_read_b128 a[104:107], v215
  v_mfma_f32_16x16x32_bf16 v[24:27], a[92:95], a[128:131], v[24:27]
  v_mfma_f32_16x16x32_bf16 v[28:31], a[92:95], a[132:135], v[28:31]
  s_waitcnt vmcnt(23)
  v_mfma_f32_16x16x32_bf16 v[32:35], a[96:99], a[120:123], v[32:35]
  buffer_load_dwordx4 a[92:95], v208, s[8:11], s20 offen offset:1024
  v_mfma_f32_16x16x32_bf16 v[36:39], a[96:99], a[124:127], v[36:39]
  ds_read_b128 a[108:111], v215 offset:4096
  v_mfma_f32_16x16x32_bf16 v[40:43], a[96:99], a[128:131], v[40:43]
  v_mfma_f32_16x16x32_bf16 v[44:47], a[96:99], a[132:135], v[44:47]
  v_mfma_f32_16x16x32_bf16 v[48:51], a[100:103], a[120:123], v[48:51]
  buffer_load_dwordx4 a[96:99], v208, s[8:11], s20 offen offset:2048
  v_mfma_f32_16x16x32_bf16 v[52:55], a[100:103], a[124:127], v[52:55]
  ds_read_b128 a[112:115], v215 offset:8192
  v_mfma_f32_16x16x32_bf16 v[56:59], a[100:103], a[128:131], v[56:59]
  v_mfma_f32_16x16x32_bf16 v[60:63], a[100:103], a[132:135], v[60:63]
  s_waitcnt vmcnt(23)
  v_mfma_f32_16x16x32_bf16 v[64:67], a[0:3], a[120:123], v[64:67]
  buffer_load_dwordx4 a[100:103], v208, s[8:11], s20 offen offset:3072
  v_mfma_f32_16x16x32_bf16 v[68:71], a[0:3], a[124:127], v[68:71]
  ds_read_b128 a[116:119], v215 offset:12288
  v_mfma_f32_16x16x32_bf16 v[72:75], a[0:3], a[128:131], v[72:75]
  v_mfma_f32_16x16x32_bf16 v[76:79], a[0:3], a[132:135], v[76:79]
  v_mfma_f32_16x16x32_bf16 v[80:83], a[4:7], a[120:123], v[80:83]
  s_add_u32 s20, s20, 4096
  buffer_load_dwordx4 a[0:3], v208, s[8:11], s20 offen
  v_mfma_f32_16x16x32_bf16 v[84:87], a[4:7], a[124:127], v[84:87]
  v_mfma_f32_16x16x32_bf16 v[88:91], a[4:7], a[128:131], v[88:91]
  v_mfma_f32_16x16x32_bf16 v[92:95], a[4:7], a[132:135], v[92:95]
  s_waitcnt vmcnt(23)
  v_mfma_f32_16x16x32_bf16 v[96:99], a[8:11], a[120:123], v[96:99]
  buffer_load_dwordx4 a[4:7], v208, s[8:11], s20 offen offset:1024
  v_mfma_f32_16x16x32_bf16 v[100:103], a[8:11], a[124:127], v[100:103]
  v_mfma_f32_16x16x32_bf16 v[104:107], a[8:11], a[128:131], v[104:107]
  v_mfma_f32_16x16x32_bf16 v[108:111], a[8:11], a[132:135], v[108:111]
  v_mfma_f32_16x16x32_bf16 v[112:115], a[12:15], a[120:123], v[112:115]
  buffer_load_dwordx4 a[8:11], v208, s[8:11], s20 offen offset:2048
  v_mfma_f32_16x16x32_bf16 v[116:119], a[12:15], a[124:127], v[116:119]
  v_mfma_f32_16x16x32_bf16 v[120:123], a[12:15], a[128:131], v[120:123]
  v_mfma_f32_16x16x32_bf16 v[124:127], a[12:15], a[132:135], v[124:127]
  s_waitcnt vmcnt(23) lgkmcnt(0)
  v_mfma_f32_16x16x32_bf16 v[0:3], a[16:19], a[104:107], v[0:3]
  buffer_load_dwordx4 a[12:15], v208, s[8:11], s20 offen offset:3072
  v_mfma_f32_16x16x32_bf16 v[4:7], a[16:19], a[108:111], v[4:7]
  v_mfma_f32_16x16x32_bf16 v[8:11], a[16:19], a[112:115], v[8:11]
  v_mfma_f32_16x16x32_bf16 v[12:15], a[16:19], a[116:119], v[12:15]
  v_mfma_f32_16x16x32_bf16 v[16:19], a[20:23], a[104:107], v[16:19]
  s_add_u32 s20, s20, 4096
  buffer_load_dwordx4 a[16:19], v208, s[8:11], s20 offen
  v_mfma_f32_16x16x32_bf16 v[20:23], a[20:23], a[108:111], v[20:23]
  ds_read_b128 a[120:123], v216
  v_mfma_f32_16x16x32_bf16 v[24:27], a[20:23], a[112:115], v[24:27]
  v_mfma_f32_16x16x32_bf16 v[28:31], a[20:23], a[116:119], v[28:31]
  s_waitcnt vmcnt(23)
  v_mfma_f32_16x16x32_bf16 v[32:35], a[24:27], a[104:107], v[32:35]
  buffer_load_dwordx4 a[20:23], v208, s[8:11], s20 offen offset:1024
  v_mfma_f32_16x16x32_bf16 v[36:39], a[24:27], a[108:111], v[36:39]
  ds_read_b128 a[124:127], v216 offset:4096
  v_mfma_f32_16x16x32_bf16 v[40:43], a[24:27], a[112:115], v[40:43]
  v_mfma_f32_16x16x32_bf16 v[44:47], a[24:27], a[116:119], v[44:47]
  v_mfma_f32_16x16x32_bf16 v[48:51], a[28:31], a[104:107], v[48:51]
  buffer_load_dwordx4 a[24:27], v208, s[8:11], s20 offen offset:2048
  v_mfma_f32_16x16x32_bf16 v[52:55], a[28:31], a[108:111], v[52:55]
  ds_read_b128 a[128:131], v216 offset:8192
  v_mfma_f32_16x16x32_bf16 v[56:59], a[28:31], a[112:115], v[56:59]
  v_mfma_f32_16x16x32_bf16 v[60:63], a[28:31], a[116:119], v[60:63]
  s_waitcnt vmcnt(23)
  v_mfma_f32_16x16x32_bf16 v[64:67], a[32:35], a[104:107], v[64:67]
  buffer_load_dwordx4 a[28:31], v208, s[8:11], s20 offen offset:3072
  v_mfma_f32_16x16x32_bf16 v[68:71], a[32:35], a[108:111], v[68:71]
  ds_read_b128 a[132:135], v216 offset:12288
  v_mfma_f32_16x16x32_bf16 v[72:75], a[32:35], a[112:115], v[72:75]
  v_mfma_f32_16x16x32_bf16 v[76:79], a[32:35], a[116:119], v[76:79]
  v_mfma_f32_16x16x32_bf16 v[80:83], a[36:39], a[104:107], v[80:83]
  s_add_u32 s20, s20, 4096
  buffer_load_dwordx4 a[32:35], v208, s[8:11], s20 offen
  v_mfma_f32_16x16x32_bf16 v[84:87], a[36:39], a[108:111], v[84:87]
  v_mfma_f32_16x16x32_bf16 v[88:91], a[36:39], a[112:115], v[88:91]
  v_mfma_f32_16x16x32_bf16 v[92:95], a[36:39], a[116:119], v[92:95]
  s_waitcnt vmcnt(23)
  v_mfma_f32_16x16x32_bf16 v[96:99], a[40:43], a[104:107], v[96:99]
  buffer_load_dwordx4 a[36:39], v208, s[8:11], s20 offen offset:1024
  v_mfma_f32_16x16x32_bf16 v[100:103], a[40:43], a[108:111], v[100:103]
  v_mfma_f32_16x16x32_bf16 v[104:107], a[40:43], a[112:115], v[104:107]
  v_mfma_f32_16x16x32_bf16 v[108:111], a[40:43], a[116:119], v[108:111]
  v_mfma_f32_16x16x32_bf16 v[112:115], a[44:47], a[104:107], v[112:115]
  buffer_load_dwordx4 a[40:43], v208, s[8:11], s20 offen offset:2048
  v_mfma_f32_16x16x32_bf16 v[116:119], a[44:47], a[108:111], v[116:119]
  v_mfma_f32_16x16x32_bf16 v[120:123], a[44:47], a[112:115], v[120:123]
  v_mfma_f32_16x16x32_bf16 v[124:127], a[44:47], a[116:119], v[124:127]
  s_waitcnt vmcnt(23) lgkmcnt(0)
  v_mfma_f32_16x16x32_bf16 v[0:3], a[48:51], a[120:123], v[0:3]
  buffer_load_dwordx4 a[44:47], v208, s[8:11], s20 offen offset:3072
  v_mfma_f32_16x16x32_bf16 v[4:7], a[48:51], a[124:127], v[4:7]
  v_mfma_f32_16x16x32_bf16 v[8:11], a[48:51], a[128:131], v[8:11]
  v_mfma_f32_16x16x32_bf16 v[12:15], a[48:51], a[132:135], v[12:15]
  v_mfma_f32_16x16x32_bf16 v[16:19], a[52:55], a[120:123], v[16:19]
  s_add_u32 s20, s20, 4096
  buffer_load_dwordx4 a[48:51], v208, s[8:11], s20 offen
  v_mfma_f32_16x16x32_bf16 v[20:23], a[52:55], a[124:127], v[20:23]
  ds_read_b128 a[104:107], v213 offset:16384
  v_mfma_f32_16x16x32_bf16 v[24:27], a[52:55], a[128:131], v[24:27]
  v_mfma_f32_16x16x32_bf16 v[28:31], a[52:55], a[132:135], v[28:31]
  s_waitcnt vmcnt(23)
  v_mfma_f32_16x16x32_bf16 v[32:35], a[56:59], a[120:123], v[32:35]
  buffer_load_dwordx4 a[52:55], v208, s[8:11], s20 offen offset:1024
  v_mfma_f32_16x16x32_bf16 v[36:39], a[56:59], a[124:127], v[36:39]
  ds_read_b128 a[108:111], v213 offset:20480
  v_mfma_f32_16x16x32_bf16 v[40:43], a[56:59], a[128:131], v[40:43]
  v_mfma_f32_16x16x32_bf16 v[44:47], a[56:59], a[132:135], v[44:47]
  v_mfma_f32_16x16x32_bf16 v[48:51], a[60:63], a[120:123], v[48:51]
  buffer_load_dwordx4 a[56:59], v208, s[8:11], s20 offen offset:2048
  v_mfma_f32_16x16x32_bf16 v[52:55], a[60:63], a[124:127], v[52:55]
  ds_read_b128 a[112:115], v213 offset:24576
  v_mfma_f32_16x16x32_bf16 v[56:59], a[60:63], a[128:131], v[56:59]
  v_mfma_f32_16x16x32_bf16 v[60:63], a[60:63], a[132:135], v[60:63]
  s_waitcnt vmcnt(23)
  v_mfma_f32_16x16x32_bf16 v[64:67], a[64:67], a[120:123], v[64:67]
  buffer_load_dwordx4 a[60:63], v208, s[8:11], s20 offen offset:3072
  v_mfma_f32_16x16x32_bf16 v[68:71], a[64:67], a[124:127], v[68:71]
  ds_read_b128 a[116:119], v213 offset:28672
  v_mfma_f32_16x16x32_bf16 v[72:75], a[64:67], a[128:131], v[72:75]
  v_mfma_f32_16x16x32_bf16 v[76:79], a[64:67], a[132:135], v[76:79]
  v_mfma_f32_16x16x32_bf16 v[80:83], a[68:71], a[120:123], v[80:83]
  s_add_u32 s20, s20, 4096
  buffer_load_dwordx4 a[64:67], v208, s[8:11], s20 offen
  v_mfma_f32_16x16x32_bf16 v[84:87], a[68:71], a[124:127], v[84:87]
  v_mfma_f32_16x16x32_bf16 v[88:91], a[68:71], a[128:131], v[88:91]
  v_mfma_f32_16x16x32_bf16 v[92:95], a[68:71], a[132:135], v[92:95]
  s_waitcnt vmcnt(23)
  v_mfma_f32_16x16x32_bf16 v[96:99], a[72:75], a[120:123], v[96:99]
  buffer_load_dwordx4 a[68:71], v208, s[8:11], s20 offen offset:1024
  v_mfma_f32_16x16x32_bf16 v[100:103], a[72:75], a[124:127], v[100:103]
  v_mfma_f32_16x16x32_bf16 v[104:107], a[72:75], a[128:131], v[104:107]
  v_mfma_f32_16x16x32_bf16 v[108:111], a[72:75], a[132:135], v[108:111]
  v_mfma_f32_16x16x32_bf16 v[112:115], a[76:79], a[120:123], v[112:115]
  buffer_load_dwordx4 a[72:75], v208, s[8:11], s20 offen offset:2048
  v_mfma_f32_16x16x32_bf16 v[116:119], a[76:79], a[124:127], v[116:119]
  v_mfma_f32_16x16x32_bf16 v[120:123], a[76:79], a[128:131], v[120:123]
  v_mfma_f32_16x16x32_bf16 v[124:127], a[76:79], a[132:135], v[124:127]
  s_waitcnt vmcnt(23) lgkmcnt(0)
  v_mfma_f32_16x16x32_bf16 v[0:3], a[80:83], a[104:107], v[0:3]
  buffer_load_dwordx4 a[76:79], v208, s[8:11], s20 offen offset:3072
  v_mfma_f32_16x16x32_bf16 v[4:7], a[80:83], a[108:111], v[4:7]
  v_mfma_f32_16x16x32_bf16 v[8:11], a[80:83], a[112:115], v[8:11]
  v_mfma_f32_16x16x32_bf16 v[12:15], a[80:83], a[116:119], v[12:15]
  v_mfma_f32_16x16x32_bf16 v[16:19], a[84:87], a[104:107], v[16:19]
  s_add_u32 s20, s20, 4096
  buffer_load_dwordx4 a[80:83], v208, s[8:11], s20 offen
  v_mfma_f32_16x16x32_bf16 v[20:23], a[84:87], a[108:111], v[20:23]
  ds_read_b128 a[120:123], v214 offset:16384
  v_mfma_f32_16x16x32_bf16 v[24:27], a[84:87], a[112:115], v[24:27]
  v_mfma_f32_16x16x32_bf16 v[28:31], a[84:87], a[116:119], v[28:31]
  s_waitcnt vmcnt(23)
  v_mfma_f32_16x16x32_bf16 v[32:35], a[88:91], a[104:107], v[32:35]
  buffer_load_dwordx4 a[84:87], v208, s[8:11], s20 offen offset:1024
  v_mfma_f32_16x16x32_bf16 v[36:39], a[88:91], a[108:111], v[36:39]
  ds_read_b128 a[124:127], v214 offset:20480
  v_mfma_f32_16x16x32_bf16 v[40:43], a[88:91], a[112:115], v[40:43]
  v_mfma_f32_16x16x32_bf16 v[44:47], a[88:91], a[116:119], v[44:47]
  v_mfma_f32_16x16x32_bf16 v[48:51], a[92:95], a[104:107], v[48:51]
  buffer_load_dwordx4 a[88:91], v208, s[8:11], s20 offen offset:2048
  v_mfma_f32_16x16x32_bf16 v[52:55], a[92:95], a[108:111], v[52:55]
  ds_read_b128 a[128:131], v214 offset:24576
  v_mfma_f32_16x16x32_bf16 v[56:59], a[92:95], a[112:115], v[56:59]
  v_mfma_f32_16x16x32_bf16 v[60:63], a[92:95], a[116:119], v[60:63]
  s_waitcnt vmcnt(23)
  v_mfma_f32_16x16x32_bf16 v[64:67], a[96:99], a[104:107], v[64:67]
  buffer_load_dwordx4 a[92:95], v208, s[8:11], s20 offen offset:3072
  v_mfma_f32_16x16x32_bf16 v[68:71], a[96:99], a[108:111], v[68:71]
  ds_read_b128 a[132:135], v214 offset:28672
  v_mfma_f32_16x16x32_bf16 v[72:75], a[96:99], a[112:115], v[72:75]
  v_mfma_f32_16x16x32_bf16 v[76:79], a[96:99], a[116:119], v[76:79]
  v_mfma_f32_16x16x32_bf16 v[80:83], a[100:103], a[104:107], v[80:83]
  s_add_u32 s20, s20, 4096
  buffer_load_dwordx4 a[96:99], v208, s[8:11], s20 offen
  v_mfma_f32_16x16x32_bf16 v[84:87], a[100:103], a[108:111], v[84:87]
  v_mfma_f32_16x16x32_bf16 v[88:91], a[100:103], a[112:115], v[88:91]
  v_mfma_f32_16x16x32_bf16 v[92:95], a[100:103], a[116:119], v[92:95]
  s_waitcnt vmcnt(23)
  v_mfma_f32_16x16x32_bf16 v[96:99], a[0:3], a[104:107], v[96:99]
  buffer_load_dwordx4 a[100:103], v208, s[8:11], s20 offen offset:1024
  v_mfma_f32_16x16x32_bf16 v[100:103], a[0:3], a[108:111], v[100:103]
  v_mfma_f32_16x16x32_bf16 v[104:107], a[0:3], a[112:115], v[104:107]
  v_mfma_f32_16x16x32_bf16 v[108:111], a[0:3], a[116:119], v[108:111]
  v_mfma_f32_16x16x32_bf16 v[112:115], a[4:7], a[104:107], v[112:115]
  buffer_load_dwordx4 a[0:3], v208, s[8:11], s20 offen offset:2048
  v_mfma_f32_16x16x32_bf16 v[116:119], a[4:7], a[108:111], v[116:119]
  v_mfma_f32_16x16x32_bf16 v[120:123], a[4:7], a[112:115], v[120:123]
  v_mfma_f32_16x16x32_bf16 v[124:127], a[4:7], a[116:119], v[124:127]
  s_waitcnt vmcnt(23) lgkmcnt(0)
  v_mfma_f32_16x16x32_bf16 v[0:3], a[8:11], a[120:123], v[0:3]
  buffer_load_dwordx4 a[4:7], v208, s[8:11], s20 offen offset:3072
  v_mfma_f32_16x16x32_bf16 v[4:7], a[8:11], a[124:127], v[4:7]
  v_mfma_f32_16x16x32_bf16 v[8:11], a[8:11], a[128:131], v[8:11]
  v_mfma_f32_16x16x32_bf16 v[12:15], a[8:11], a[132:135], v[12:15]
  v_mfma_f32_16x16x32_bf16 v[16:19], a[12:15], a[120:123], v[16:19]
  s_add_u32 s20, s20, 4096
  buffer_load_dwordx4 a[8:11], v208, s[8:11], s20 offen
  v_mfma_f32_16x16x32_bf16 v[20:23], a[12:15], a[124:127], v[20:23]
  ds_read_b128 a[104:107], v215 offset:16384
  v_mfma_f32_16x16x32_bf16 v[24:27], a[12:15], a[128:131], v[24:27]
  v_mfma_f32_16x16x32_bf16 v[28:31], a[12:15], a[132:135], v[28:31]
  s_waitcnt vmcnt(23)
  v_mfma_f32_16x16x32_bf16 v[32:35], a[16:19], a[120:123], v[32:35]
  buffer_load_dwordx4 a[12:15], v208, s[8:11], s20 offen offset:1024
  v_mfma_f32_16x16x32_bf16 v[36:39], a[16:19], a[124:127], v[36:39]
  ds_read_b128 a[108:111], v215 offset:20480
  v_mfma_f32_16x16x32_bf16 v[40:43], a[16:19], a[128:131], v[40:43]
  v_mfma_f32_16x16x32_bf16 v[44:47], a[16:19], a[132:135], v[44:47]
  v_mfma_f32_16x16x32_bf16 v[48:51], a[20:23], a[120:123], v[48:51]
  buffer_load_dwordx4 a[16:19], v208, s[8:11], s20 offen offset:2048
  v_mfma_f32_16x16x32_bf16 v[52:55], a[20:23], a[124:127], v[52:55]
  ds_read_b128 a[112:115], v215 offset:24576
  v_mfma_f32_16x16x32_bf16 v[56:59], a[20:23], a[128:131], v[56:59]
  v_mfma_f32_16x16x32_bf16 v[60:63], a[20:23], a[132:135], v[60:63]
  s_waitcnt vmcnt(23)
  v_mfma_f32_16x16x32_bf16 v[64:67], a[24:27], a[120:123], v[64:67]
  buffer_load_dwordx4 a[20:23], v208, s[8:11], s20 offen offset:3072
  v_mfma_f32_16x16x32_bf16 v[68:71], a[24:27], a[124:127], v[68:71]
  ds_read_b128 a[116:119], v215 offset:28672
  v_mfma_f32_16x16x32_bf16 v[72:75], a[24:27], a[128:131], v[72:75]
  v_mfma_f32_16x16x32_bf16 v[76:79], a[24:27], a[132:135], v[76:79]
  v_mfma_f32_16x16x32_bf16 v[80:83], a[28:31], a[120:123], v[80:83]
  s_add_u32 s20, s20, 4096
  buffer_load_dwordx4 a[24:27], v208, s[8:11], s20 offen
  v_mfma_f32_16x16x32_bf16 v[84:87], a[28:31], a[124:127], v[84:87]
  v_mfma_f32_16x16x32_bf16 v[88:91], a[28:31], a[128:131], v[88:91]
  v_mfma_f32_16x16x32_bf16 v[92:95], a[28:31], a[132:135], v[92:95]
  s_waitcnt vmcnt(23)
  v_mfma_f32_16x16x32_bf16 v[96:99], a[32:35], a[120:123], v[96:99]
  buffer_load_dwordx4 a[28:31], v208, s[8:11], s20 offen offset:1024
  v_mfma_f32_16x16x32_bf16 v[100:103], a[32:35], a[124:127], v[100:103]
  v_mfma_f32_16x16x32_bf16 v[104:107], a[32:35], a[128:131], v[104:107]
  v_mfma_f32_16x16x32_bf16 v[108:111], a[32:35], a[132:135], v[108:111]
  v_mfma_f32_16x16x32_bf16 v[112:115], a[36:39], a[120:123], v[112:115]
  buffer_load_dwordx4 a[32:35], v208, s[8:11], s20 offen offset:2048
  v_mfma_f32_16x16x32_bf16 v[116:119], a[36:39], a[124:127], v[116:119]
  v_mfma_f32_16x16x32_bf16 v[120:123], a[36:39], a[128:131], v[120:123]
  v_mfma_f32_16x16x32_bf16 v[124:127], a[36:39], a[132:135], v[124:127]
  s_waitcnt vmcnt(23) lgkmcnt(0)
  v_mfma_f32_16x16x32_bf16 v[0:3], a[40:43], a[104:107], v[0:3]
  buffer_load_dwordx4 a[36:39], v208, s[8:11], s20 offen offset:3072
  v_mfma_f32_16x16x32_bf16 v[4:7], a[40:43], a[108:111], v[4:7]
  v_mfma_f32_16x16x32_bf16 v[8:11], a[40:43], a[112:115], v[8:11]
  v_mfma_f32_16x16x32_bf16 v[12:15], a[40:43], a[116:119], v[12:15]
  v_mfma_f32_16x16x32_bf16 v[16:19], a[44:47], a[104:107], v[16:19]
  s_add_u32 s20, s20, 4096
  buffer_load_dwordx4 a[40:43], v208, s[8:11], s20 offen
  v_mfma_f32_16x16x32_bf16 v[20:23], a[44:47], a[108:111], v[20:23]
  ds_read_b128 a[120:123], v216 offset:16384
  v_mfma_f32_16x16x32_bf16 v[24:27], a[44:47], a[112:115], v[24:27]
  v_mfma_f32_16x16x32_bf16 v[28:31], a[44:47], a[116:119], v[28:31]
  s_waitcnt vmcnt(23)
  v_mfma_f32_16x16x32_bf16 v[32:35], a[48:51], a[104:107], v[32:35]
  buffer_load_dwordx4 a[44:47], v208, s[8:11], s20 offen offset:1024
  v_mfma_f32_16x16x32_bf16 v[36:39], a[48:51], a[108:111], v[36:39]
  ds_read_b128 a[124:127], v216 offset:20480
  v_mfma_f32_16x16x32_bf16 v[40:43], a[48:51], a[112:115], v[40:43]
  v_mfma_f32_16x16x32_bf16 v[44:47], a[48:51], a[116:119], v[44:47]
  v_mfma_f32_16x16x32_bf16 v[48:51], a[52:55], a[104:107], v[48:51]
  buffer_load_dwordx4 a[48:51], v208, s[8:11], s20 offen offset:2048
  v_mfma_f32_16x16x32_bf16 v[52:55], a[52:55], a[108:111], v[52:55]
  ds_read_b128 a[128:131], v216 offset:24576
  v_mfma_f32_16x16x32_bf16 v[56:59], a[52:55], a[112:115], v[56:59]
  v_mfma_f32_16x16x32_bf16 v[60:63], a[52:55], a[116:119], v[60:63]
  s_waitcnt vmcnt(23)
  v_mfma_f32_16x16x32_bf16 v[64:67], a[56:59], a[104:107], v[64:67]
  buffer_load_dwordx4 a[52:55], v208, s[8:11], s20 offen offset:3072
  v_mfma_f32_16x16x32_bf16 v[68:71], a[56:59], a[108:111], v[68:71]
  ds_read_b128 a[132:135], v216 offset:28672
  v_mfma_f32_16x16x32_bf16 v[72:75], a[56:59], a[112:115], v[72:75]
  v_mfma_f32_16x16x32_bf16 v[76:79], a[56:59], a[116:119], v[76:79]
  v_mfma_f32_16x16x32_bf16 v[80:83], a[60:63], a[104:107], v[80:83]
  s_add_u32 s20, s20, 4096
  buffer_load_dwordx4 a[56:59], v208, s[8:11], s20 offen
  v_mfma_f32_16x16x32_bf16 v[84:87], a[60:63], a[108:111], v[84:87]
  v_mfma_f32_16x16x32_bf16 v[88:91], a[60:63], a[112:115], v[88:91]
  v_mfma_f32_16x16x32_bf16 v[92:95], a[60:63], a[116:119], v[92:95]
  s_waitcnt vmcnt(23)
  v_mfma_f32_16x16x32_bf16 v[96:99], a[64:67], a[104:107], v[96:99]
  buffer_load_dwordx4 a[60:63], v208, s[8:11], s20 offen offset:1024
  v_mfma_f32_16x16x32_bf16 v[100:103], a[64:67], a[108:111], v[100:103]
  v_mfma_f32_16x16x32_bf16 v[104:107], a[64:67], a[112:115], v[104:107]
  v_mfma_f32_16x16x32_bf16 v[108:111], a[64:67], a[116:119], v[108:111]
  v_mfma_f32_16x16x32_bf16 v[112:115], a[68:71], a[104:107], v[112:115]
  buffer_load_dwordx4 a[64:67], v208, s[8:11], s20 offen offset:2048
  v_mfma_f32_16x16x32_bf16 v[116:119], a[68:71], a[108:111], v[116:119]
  v_mfma_f32_16x16x32_bf16 v[120:123], a[68:71], a[112:115], v[120:123]
  v_mfma_f32_16x16x32_bf16 v[124:127], a[68:71], a[116:119], v[124:127]
  s_waitcnt vmcnt(23) lgkmcnt(0)
  v_mfma_f32_16x16x32_bf16 v[0:3], a[72:75], a[120:123], v[0:3]
  buffer_load_dwordx4 a[68:71], v208, s[8:11], s20 offen offset:3072
  v_mfma_f32_16x16x32_bf16 v[4:7], a[72:75], a[124:127], v[4:7]
  v_mfma_f32_16x16x32_bf16 v[8:11], a[72:75], a[128:131], v[8:11]
  v_mfma_f32_16x16x32_bf16 v[12:15], a[72:75], a[132:135], v[12:15]
  v_mfma_f32_16x16x32_bf16 v[16:19], a[76:79], a[120:123], v[16:19]
  s_add_u32 s20, s20, 4096
  buffer_load_dwordx4 a[72:75], v208, s[8:11], s20 offen
  v_mfma_f32_16x16x32_bf16 v[20:23], a[76:79], a[124:127], v[20:23]
  ds_read_b128 a[104:107], v213 offset:32768
  v_mfma_f32_16x16x32_bf16 v[24:27], a[76:79], a[128:131], v[24:27]
  v_mfma_f32_16x16x32_bf16 v[28:31], a[76:79], a[132:135], v[28:31]
  s_waitcnt vmcnt(23)
  v_mfma_f32_16x16x32_bf16 v[32:35], a[80:83], a[120:123], v[32:35]
  buffer_load_dwordx4 a[76:79], v208, s[8:11], s20 offen offset:1024
  v_mfma_f32_16x16x32_bf16 v[36:39], a[80:83], a[124:127], v[36:39]
  ds_read_b128 a[108:111], v213 offset:36864
  v_mfma_f32_16x16x32_bf16 v[40:43], a[80:83], a[128:131], v[40:43]
  v_mfma_f32_16x16x32_bf16 v[44:47], a[80:83], a[132:135], v[44:47]
  v_mfma_f32_16x16x32_bf16 v[48:51], a[84:87], a[120:123], v[48:51]
  buffer_load_dwordx4 a[80:83], v208, s[8:11], s20 offen offset:2048
  v_mfma_f32_16x16x32_bf16 v[52:55], a[84:87], a[124:127], v[52:55]
  ds_read_b128 a[112:115], v213 offset:40960
  v_mfma_f32_16x16x32_bf16 v[56:59], a[84:87], a[128:131], v[56:59]
  v_mfma_f32_16x16x32_bf16 v[60:63], a[84:87], a[132:135], v[60:63]
  s_waitcnt vmcnt(23)
  v_mfma_f32_16x16x32_bf16 v[64:67], a[88:91], a[120:123], v[64:67]
  buffer_load_dwordx4 a[84:87], v208, s[8:11], s20 offen offset:3072
  v_mfma_f32_16x16x32_bf16 v[68:71], a[88:91], a[124:127], v[68:71]
  ds_read_b128 a[116:119], v213 offset:45056
  v_mfma_f32_16x16x32_bf16 v[72:75], a[88:91], a[128:131], v[72:75]
  v_mfma_f32_16x16x32_bf16 v[76:79], a[88:91], a[132:135], v[76:79]
  v_mfma_f32_16x16x32_bf16 v[80:83], a[92:95], a[120:123], v[80:83]
  s_add_u32 s20, s20, 4096
  buffer_load_dwordx4 a[88:91], v208, s[8:11], s20 offen
  v_mfma_f32_16x16x32_bf16 v[84:87], a[92:95], a[124:127], v[84:87]
  v_mfma_f32_16x16x32_bf16 v[88:91], a[92:95], a[128:131], v[88:91]
  v_mfma_f32_16x16x32_bf16 v[92:95], a[92:95], a[132:135], v[92:95]
  s_waitcnt vmcnt(23)
  v_mfma_f32_16x16x32_bf16 v[96:99], a[96:99], a[120:123], v[96:99]
  buffer_load_dwordx4 a[92:95], v208, s[8:11], s20 offen offset:1024
  v_mfma_f32_16x16x32_bf16 v[100:103], a[96:99], a[124:127], v[100:103]
  v_mfma_f32_16x16x32_bf16 v[104:107], a[96:99], a[128:131], v[104:107]
  v_mfma_f32_16x16x32_bf16 v[108:111], a[96:99], a[132:135], v[108:111]
  v_mfma_f32_16x16x32_bf16 v[112:115], a[100:103], a[120:123], v[112:115]
  buffer_load_dwordx4 a[96:99], v208, s[8:11], s20 offen offset:2048
  v_mfma_f32_16x16x32_bf16 v[116:119], a[100:103], a[124:127], v[116:119]
  v_mfma_f32_16x16x32_bf16 v[120:123], a[100:103], a[128:131], v[120:123]
  v_mfma_f32_16x16x32_bf16 v[124:127], a[100:103], a[132:135], v[124:127]
  s_waitcnt vmcnt(23) lgkmcnt(0)
  v_mfma_f32_16x16x32_bf16 v[0:3], a[0:3], a[104:107], v[0:3]
  buffer_load_dwordx4 a[100:103], v208, s[8:11], s20 offen offset:3072
  v_mfma_f32_16x16x32_bf16 v[4:7], a[0:3], a[108:111], v[4:7]
  v_mfma_f32_16x16x32_bf16 v[8:11], a[0:3], a[112:115], v[8:11]
  v_mfma_f32_16x16x32_bf16 v[12:15], a[0:3], a[116:119], v[12:15]
  v_mfma_f32_16x16x32_bf16 v[16:19], a[4:7], a[104:107], v[16:19]
  s_add_u32 s20, s20, 4096
  buffer_load_dwordx4 a[0:3], v208, s[8:11], s20 offen
  v_mfma_f32_16x16x32_bf16 v[20:23], a[4:7], a[108:111], v[20:23]
  ds_read_b128 a[120:123], v214 offset:32768
  v_mfma_f32_16x16x32_bf16 v[24:27], a[4:7], a[112:115], v[24:27]
  v_mfma_f32_16x16x32_bf16 v[28:31], a[4:7], a[116:119], v[28:31]
  s_waitcnt vmcnt(23)
  v_mfma_f32_16x16x32_bf16 v[32:35], a[8:11], a[104:107], v[32:35]
  buffer_load_dwordx4 a[4:7], v208, s[8:11], s20 offen offset:1024
  v_mfma_f32_16x16x32_bf16 v[36:39], a[8:11], a[108:111], v[36:39]
  ds_read_b128 a[124:127], v214 offset:36864
  v_mfma_f32_16x16x32_bf16 v[40:43], a[8:11], a[112:115], v[40:43]
  v_mfma_f32_16x16x32_bf16 v[44:47], a[8:11], a[116:119], v[44:47]
  v_mfma_f32_16x16x32_bf16 v[48:51], a[12:15], a[104:107], v[48:51]
  buffer_load_dwordx4 a[8:11], v208, s[8:11], s20 offen offset:2048
  v_mfma_f32_16x16x32_bf16 v[52:55], a[12:15], a[108:111], v[52:55]
  ds_read_b128 a[128:131], v214 offset:40960
  v_mfma_f32_16x16x32_bf16 v[56:59], a[12:15], a[112:115], v[56:59]
  v_mfma_f32_16x16x32_bf16 v[60:63], a[12:15], a[116:119], v[60:63]
  s_waitcnt vmcnt(23)
  v_mfma_f32_16x16x32_bf16 v[64:67], a[16:19], a[104:107], v[64:67]
  buffer_load_dwordx4 a[12:15], v208, s[8:11], s20 offen offset:3072
  v_mfma_f32_16x16x32_bf16 v[68:71], a[16:19], a[108:111], v[68:71]
  ds_read_b128 a[132:135], v214 offset:45056
  v_mfma_f32_16x16x32_bf16 v[72:75], a[16:19], a[112:115], v[72:75]
  v_mfma_f32_16x16x32_bf16 v[76:79], a[16:19], a[116:119], v[76:79]
  v_mfma_f32_16x16x32_bf16 v[80:83], a[20:23], a[104:107], v[80:83]
  s_add_u32 s20, s20, 4096
  buffer_load_dwordx4 a[16:19], v208, s[8:11], s20 offen
  v_mfma_f32_16x16x32_bf16 v[84:87], a[20:23], a[108:111], v[84:87]
  v_mfma_f32_16x16x32_bf16 v[88:91], a[20:23], a[112:115], v[88:91]
  v_mfma_f32_16x16x32_bf16 v[92:95], a[20:23], a[116:119], v[92:95]
  s_waitcnt vmcnt(23)
  v_mfma_f32_16x16x32_bf16 v[96:99], a[24:27], a[104:107], v[96:99]
  buffer_load_dwordx4 a[20:23], v208, s[8:11], s20 offen offset:1024
  v_mfma_f32_16x16x32_bf16 v[100:103], a[24:27], a[108:111], v[100:103]
  v_mfma_f32_16x16x32_bf16 v[104:107], a[24:27], a[112:115], v[104:107]
  v_mfma_f32_16x16x32_bf16 v[108:111], a[24:27], a[116:119], v[108:111]
  v_mfma_f32_16x16x32_bf16 v[112:115], a[28:31], a[104:107], v[112:115]
  buffer_load_dwordx4 a[24:27], v208, s[8:11], s20 offen offset:2048
  v_mfma_f32_16x16x32_bf16 v[116:119], a[28:31], a[108:111], v[116:119]
  v_mfma_f32_16x16x32_bf16 v[120:123], a[28:31], a[112:115], v[120:123]
  v_mfma_f32_16x16x32_bf16 v[124:127], a[28:31], a[116:119], v[124:127]
  s_waitcnt vmcnt(23) lgkmcnt(0)
  v_mfma_f32_16x16x32_bf16 v[0:3], a[32:35], a[120:123], v[0:3]
  buffer_load_dwordx4 a[28:31], v208, s[8:11], s20 offen offset:3072
  v_mfma_f32_16x16x32_bf16 v[4:7], a[32:35], a[124:127], v[4:7]
  v_mfma_f32_16x16x32_bf16 v[8:11], a[32:35], a[128:131], v[8:11]
  v_mfma_f32_16x16x32_bf16 v[12:15], a[32:35], a[132:135], v[12:15]
  v_mfma_f32_16x16x32_bf16 v[16:19], a[36:39], a[120:123], v[16:19]
  s_add_u32 s20, s20, 4096
  buffer_load_dwordx4 a[32:35], v208, s[8:11], s20 offen
  v_mfma_f32_16x16x32_bf16 v[20:23], a[36:39], a[124:127], v[20:23]
  ds_read_b128 a[104:107], v209
  v_mfma_f32_16x16x32_bf16 v[24:27], a[36:39], a[128:131], v[24:27]
  v_mfma_f32_16x16x32_bf16 v[28:31], a[36:39], a[132:135], v[28:31]
  s_waitcnt vmcnt(23)
  v_mfma_f32_16x16x32_bf16 v[32:35], a[40:43], a[120:123], v[32:35]
  buffer_load_dwordx4 a[36:39], v208, s[8:11], s20 offen offset:1024
  v_mfma_f32_16x16x32_bf16 v[36:39], a[40:43], a[124:127], v[36:39]
  ds_read_b128 a[108:111], v209 offset:4096
  v_mfma_f32_16x16x32_bf16 v[40:43], a[40:43], a[128:131], v[40:43]
  v_mfma_f32_16x16x32_bf16 v[44:47], a[40:43], a[132:135], v[44:47]
  v_mfma_f32_16x16x32_bf16 v[48:51], a[44:47], a[120:123], v[48:51]
  buffer_load_dwordx4 a[40:43], v208, s[8:11], s20 offen offset:2048
  v_mfma_f32_16x16x32_bf16 v[52:55], a[44:47], a[124:127], v[52:55]
  ds_read_b128 a[112:115], v209 offset:8192
  v_mfma_f32_16x16x32_bf16 v[56:59], a[44:47], a[128:131], v[56:59]
  v_mfma_f32_16x16x32_bf16 v[60:63], a[44:47], a[132:135], v[60:63]
  s_waitcnt vmcnt(23)
  v_mfma_f32_16x16x32_bf16 v[64:67], a[48:51], a[120:123], v[64:67]
  buffer_load_dwordx4 a[44:47], v208, s[8:11], s20 offen offset:3072
  v_mfma_f32_16x16x32_bf16 v[68:71], a[48:51], a[124:127], v[68:71]
  ds_read_b128 a[116:119], v209 offset:12288
  v_mfma_f32_16x16x32_bf16 v[72:75], a[48:51], a[128:131], v[72:75]
  v_mfma_f32_16x16x32_bf16 v[76:79], a[48:51], a[132:135], v[76:79]
  v_mfma_f32_16x16x32_bf16 v[80:83], a[52:55], a[120:123], v[80:83]
  s_add_u32 s20, s20, 4096
  buffer_load_dwordx4 a[48:51], v208, s[8:11], s20 offen
  v_mfma_f32_16x16x32_bf16 v[84:87], a[52:55], a[124:127], v[84:87]
  v_mfma_f32_16x16x32_bf16 v[88:91], a[52:55], a[128:131], v[88:91]
  v_mfma_f32_16x16x32_bf16 v[92:95], a[52:55], a[132:135], v[92:95]
  s_waitcnt vmcnt(23)
  v_mfma_f32_16x16x32_bf16 v[96:99], a[56:59], a[120:123], v[96:99]
  buffer_load_dwordx4 a[52:55], v208, s[8:11], s20 offen offset:1024
  v_mfma_f32_16x16x32_bf16 v[100:103], a[56:59], a[124:127], v[100:103]
  v_mfma_f32_16x16x32_bf16 v[104:107], a[56:59], a[128:131], v[104:107]
  v_mfma_f32_16x16x32_bf16 v[108:111], a[56:59], a[132:135], v[108:111]
  v_mfma_f32_16x16x32_bf16 v[112:115], a[60:63], a[120:123], v[112:115]
  buffer_load_dwordx4 a[56:59], v208, s[8:11], s20 offen offset:2048
  v_mfma_f32_16x16x32_bf16 v[116:119], a[60:63], a[124:127], v[116:119]
  v_mfma_f32_16x16x32_bf16 v[120:123], a[60:63], a[128:131], v[120:123]
  v_mfma_f32_16x16x32_bf16 v[124:127], a[60:63], a[132:135], v[124:127]
  s_waitcnt vmcnt(23) lgkmcnt(0)
  v_mfma_f32_16x16x32_bf16 v[140:143], a[64:67], a[116:119], v[128:131]
  buffer_load_dwordx4 a[60:63], v208, s[8:11], s20 offen offset:3072
  v_mfma_f32_16x16x32_bf16 v[136:139], a[64:67], a[112:115], v[128:131]
  ds_read_b128 v[228:231], v217
  ds_read_b128 v[232:235], v217 offset:4096
  v_mfma_f32_16x16x32_bf16 v[132:135], a[64:67], a[108:111], v[128:131]
  s_waitcnt lgkmcnt(1)
  v_lshlrev_b32 v236, 16, v228
  v_and_b32 v237, s27, v228
  v_mfma_f32_16x16x32_bf16 v[128:131], a[64:67], a[104:107], v[128:131]
  v_mfma_f32_16x16x32_bf16 v[156:159], a[68:71], a[116:119], v[144:147]
  s_add_u32 s20, s20, 4096
  buffer_load_dwordx4 a[64:67], v208, s[8:11], s20 offen
  v_mfma_f32_16x16x32_bf16 v[152:155], a[68:71], a[112:115], v[144:147]
  ds_read_b128 a[120:123], v210
  v_accvgpr_read_b32 v244, a136
  v_mfma_f32_16x16x32_bf16 v[148:151], a[68:71], a[108:111], v[144:147]
  v_lshlrev_b32 v240, 16, v244
  v_and_b32 v241, s27, v244
  v_mfma_f32_16x16x32_bf16 v[144:147], a[68:71], a[104:107], v[144:147]
  v_fma_f32 v236, v240, v0, v236
  s_waitcnt vmcnt(23)
  v_mfma_f32_16x16x32_bf16 v[172:175], a[72:75], a[116:119], v[160:163]
  buffer_load_dwordx4 a[68:71], v208, s[8:11], s20 offen offset:1024
  v_fma_f32 v237, v241, v1, v237
  v_mfma_f32_16x16x32_bf16 v[168:171], a[72:75], a[112:115], v[160:163]
  ds_read_b128 a[124:127], v210 offset:4096
  v_cvt_pk_bf16_f32 v0, v236, v237
  v_mfma_f32_16x16x32_bf16 v[164:167], a[72:75], a[108:111], v[160:163]
  v_lshlrev_b32 v238, 16, v229
  v_and_b32 v239, s27, v229
  v_mfma_f32_16x16x32_bf16 v[160:163], a[72:75], a[104:107], v[160:163]
  v_mfma_f32_16x16x32_bf16 v[188:191], a[76:79], a[116:119], v[176:179]
  buffer_load_dwordx4 a[72:75], v208, s[8:11], s20 offen offset:2048
  v_accvgpr_read_b32 v244, a137
  v_mfma_f32_16x16x32_bf16 v[184:187], a[76:79], a[112:115], v[176:179]
  ds_read_b128 a[128:131], v210 offset:8192
  v_lshlrev_b32 v242, 16, v244
  v_mfma_f32_16x16x32_bf16 v[180:183], a[76:79], a[108:111], v[176:179]
  v_and_b32 v243, s27, v244
  v_fma_f32 v238, v242, v2, v238
  v_mfma_f32_16x16x32_bf16 v[176:179], a[76:79], a[104:107], v[176:179]
  s_waitcnt vmcnt(23)
  v_mfma_f32_16x16x32_bf16 v[204:207], a[80:83], a[116:119], v[192:195]
  buffer_load_dwordx4 a[76:79], v208, s[8:11], s20 offen offset:3072
  v_fma_f32 v239, v243, v3, v239
  v_mfma_f32_16x16x32_bf16 v[200:203], a[80:83], a[112:115], v[192:195]
  ds_read_b128 a[132:135], v210 offset:12288
  v_cvt_pk_bf16_f32 v1, v238, v239
  v_mfma_f32_16x16x32_bf16 v[196:199], a[80:83], a[108:111], v[192:195]
  v_lshlrev_b32 v236, 16, v230
  v_and_b32 v237, s27, v230
  v_mfma_f32_16x16x32_bf16 v[192:195], a[80:83], a[104:107], v[192:195]
  s_waitcnt lgkmcnt(0)
  v_mfma_f32_16x16x32_bf16 v[128:131], a[84:87], a[120:123], v[128:131]
  s_add_u32 s20, s20, 4096
  buffer_load_dwordx4 a[80:83], v208, s[8:11], s20 offen
  v_mfma_f32_16x16x32_bf16 v[132:135], a[84:87], a[124:127], v[132:135]
  v_accvgpr_read_b32 v244, a138
  v_lshlrev_b32 v240, 16, v244
  v_mfma_f32_16x16x32_bf16 v[136:139], a[84:87], a[128:131], v[136:139]
  v_and_b32 v241, s27, v244
  v_fma_f32 v236, v240, v16, v236
  v_mfma_f32_16x16x32_bf16 v[140:143], a[84:87], a[132:135], v[140:143]
  s_waitcnt vmcnt(23)
  v_mfma_f32_16x16x32_bf16 v[144:147], a[88:91], a[120:123], v[144:147]
  buffer_load_dwordx4 a[84:87], v208, s[8:11], s20 offen offset:1024
  v_fma_f32 v237, v241, v17, v237
  v_mfma_f32_16x16x32_bf16 v[148:151], a[88:91], a[124:127], v[148:151]
  ds_read_b128 a[104:107], v211
  v_cvt_pk_bf16_f32 v2, v236, v237
  v_mfma_f32_16x16x32_bf16 v[152:155], a[88:91], a[128:131], v[152:155]
  v_lshlrev_b32 v238, 16, v231
  v_and_b32 v239, s27, v231
  v_mfma_f32_16x16x32_bf16 v[156:159], a[88:91], a[132:135], v[156:159]
  v_mfma_f32_16x16x32_bf16 v[160:163], a[92:95], a[120:123], v[160:163]
  buffer_load_dwordx4 a[88:91], v208, s[8:11], s20 offen offset:2048
  v_accvgpr_read_b32 v244, a139
  v_mfma_f32_16x16x32_bf16 v[164:167], a[92:95], a[124:127], v[164:167]
  ds_read_b128 a[108:111], v211 offset:4096
  v_lshlrev_b32 v242, 16, v244
  v_mfma_f32_16x16x32_bf16 v[168:171], a[92:95], a[128:131], v[168:171]
  v_and_b32 v243, s27, v244
  v_fma_f32 v238, v242, v18, v238
  v_mfma_f32_16x16x32_bf16 v[172:175], a[92:95], a[132:135], v[172:175]
  s_waitcnt vmcnt(23)
  v_mfma_f32_16x16x32_bf16 v[176:179], a[96:99], a[120:123], v[176:179]
  buffer_load_dwordx4 a[92:95], v208, s[8:11], s20 offen offset:3072
  v_fma_f32 v239, v243, v19, v239
  v_mfma_f32_16x16x32_bf16 v[180:183], a[96:99], a[124:127], v[180:183]
  ds_read_b128 a[112:115], v211 offset:8192
  v_cvt_pk_bf16_f32 v3, v238, v239
  v_mfma_f32_16x16x32_bf16 v[184:187], a[96:99], a[128:131], v[184:187]
  ds_read_b128 v[228:231], v217 offset:8192
  v_lshlrev_b32 v236, 16, v232
  v_mfma_f32_16x16x32_bf16 v[188:191], a[96:99], a[132:135], v[188:191]
  v_and_b32 v237, s27, v232
  v_mfma_f32_16x16x32_bf16 v[192:195], a[100:103], a[120:123], v[192:195]
  s_add_u32 s20, s20, 4096
  buffer_load_dwordx4 a[96:99], v208, s[8:11], s20 offen
  v_mfma_f32_16x16x32_bf16 v[196:199], a[100:103], a[124:127], v[196:199]
  ds_read_b128 a[116:119], v211 offset:12288
  v_accvgpr_read_b32 v244, a140
  v_mfma_f32_16x16x32_bf16 v[200:203], a[100:103], a[128:131], v[200:203]
  v_lshlrev_b32 v240, 16, v244
  v_and_b32 v241, s27, v244
  v_mfma_f32_16x16x32_bf16 v[204:207], a[100:103], a[132:135], v[204:207]
  v_fma_f32 v236, v240, v4, v236
  s_waitcnt vmcnt(23) lgkmcnt(0)
  v_mfma_f32_16x16x32_bf16 v[128:131], a[0:3], a[104:107], v[128:131]
  buffer_load_dwordx4 a[100:103], v208, s[8:11], s20 offen offset:1024
  v_mfma_f32_16x16x32_bf16 v[132:135], a[0:3], a[108:111], v[132:135]
  v_fma_f32 v237, v241, v5, v237
  v_cvt_pk_bf16_f32 v4, v236, v237
  v_mfma_f32_16x16x32_bf16 v[136:139], a[0:3], a[112:115], v[136:139]
  v_lshlrev_b32 v238, 16, v233
  v_and_b32 v239, s27, v233
  v_mfma_f32_16x16x32_bf16 v[140:143], a[0:3], a[116:119], v[140:143]
  v_mfma_f32_16x16x32_bf16 v[144:147], a[4:7], a[104:107], v[144:147]
  buffer_load_dwordx4 a[0:3], v208, s[8:11], s20 offen offset:2048
  v_accvgpr_read_b32 v244, a141
  v_mfma_f32_16x16x32_bf16 v[148:151], a[4:7], a[108:111], v[148:151]
  ds_read_b128 a[120:123], v212
  v_lshlrev_b32 v242, 16, v244
  v_mfma_f32_16x16x32_bf16 v[152:155], a[4:7], a[112:115], v[152:155]
  v_and_b32 v243, s27, v244
  v_fma_f32 v238, v242, v6, v238
  v_mfma_f32_16x16x32_bf16 v[156:159], a[4:7], a[116:119], v[156:159]
  s_waitcnt vmcnt(23)
  v_mfma_f32_16x16x32_bf16 v[160:163], a[8:11], a[104:107], v[160:163]
  buffer_load_dwordx4 a[4:7], v208, s[8:11], s20 offen offset:3072
  v_fma_f32 v239, v243, v7, v239
  v_mfma_f32_16x16x32_bf16 v[164:167], a[8:11], a[108:111], v[164:167]
  ds_read_b128 a[124:127], v212 offset:4096
  v_cvt_pk_bf16_f32 v5, v238, v239
  v_mfma_f32_16x16x32_bf16 v[168:171], a[8:11], a[112:115], v[168:171]
  v_lshlrev_b32 v236, 16, v234
  v_and_b32 v237, s27, v234
  v_mfma_f32_16x16x32_bf16 v[172:175], a[8:11], a[116:119], v[172:175]
  v_mfma_f32_16x16x32_bf16 v[176:179], a[12:15], a[104:107], v[176:179]
  s_add_u32 s20, s20, 4096
  buffer_load_dwordx4 a[8:11], v208, s[8:11], s20 offen
  v_mfma_f32_16x16x32_bf16 v[180:183], a[12:15], a[108:111], v[180:183]
  ds_read_b128 a[128:131], v212 offset:8192
  v_accvgpr_read_b32 v244, a142
  v_mfma_f32_16x16x32_bf16 v[184:187], a[12:15], a[112:115], v[184:187]
  v_lshlrev_b32 v240, 16, v244
  v_and_b32 v241, s27, v244
  v_mfma_f32_16x16x32_bf16 v[188:191], a[12:15], a[116:119], v[188:191]
  v_fma_f32 v236, v240, v20, v236
  s_waitcnt vmcnt(23)
  v_mfma_f32_16x16x32_bf16 v[192:195], a[16:19], a[104:107], v[192:195]
  buffer_load_dwordx4 a[12:15], v208, s[8:11], s20 offen offset:1024
  v_fma_f32 v237, v241, v21, v237
  v_mfma_f32_16x16x32_bf16 v[196:199], a[16:19], a[108:111], v[196:199]
  ds_read_b128 a[132:135], v212 offset:12288
  v_cvt_pk_bf16_f32 v6, v236, v237
  v_mfma_f32_16x16x32_bf16 v[200:203], a[16:19], a[112:115], v[200:203]
  v_lshlrev_b32 v238, 16, v235
  v_and_b32 v239, s27, v235
  v_mfma_f32_16x16x32_bf16 v[204:207], a[16:19], a[116:119], v[204:207]
  s_waitcnt lgkmcnt(0)
  v_mfma_f32_16x16x32_bf16 v[128:131], a[20:23], a[120:123], v[128:131]
  buffer_load_dwordx4 a[16:19], v208, s[8:11], s20 offen offset:2048
  v_mfma_f32_16x16x32_bf16 v[132:135], a[20:23], a[124:127], v[132:135]
  v_accvgpr_read_b32 v244, a143
  v_lshlrev_b32 v242, 16, v244
  v_mfma_f32_16x16x32_bf16 v[136:139], a[20:23], a[128:131], v[136:139]
  v_and_b32 v243, s27, v244
  v_fma_f32 v238, v242, v22, v238
  v_mfma_f32_16x16x32_bf16 v[140:143], a[20:23], a[132:135], v[140:143]
  s_waitcnt vmcnt(23)
  v_mfma_f32_16x16x32_bf16 v[144:147], a[24:27], a[120:123], v[144:147]
  buffer_load_dwordx4 a[20:23], v208, s[8:11], s20 offen offset:3072
  v_fma_f32 v239, v243, v23, v239
  v_mfma_f32_16x16x32_bf16 v[148:151], a[24:27], a[124:127], v[148:151]
  ds_read_b128 a[104:107], v209 offset:16384
  v_cvt_pk_bf16_f32 v7, v238, v239
  v_mfma_f32_16x16x32_bf16 v[152:155], a[24:27], a[128:131], v[152:155]
  ds_read_b128 v[232:235], v217 offset:12288
  v_lshlrev_b32 v236, 16, v228
  v_mfma_f32_16x16x32_bf16 v[156:159], a[24:27], a[132:135], v[156:159]
  v_and_b32 v237, s27, v228
  v_mfma_f32_16x16x32_bf16 v[160:163], a[28:31], a[120:123], v[160:163]
  s_add_u32 s20, s20, 4096
  buffer_load_dwordx4 a[24:27], v208, s[8:11], s20 offen
  v_mfma_f32_16x16x32_bf16 v[164:167], a[28:31], a[124:127], v[164:167]
  ds_read_b128 a[108:111], v209 offset:20480
  v_accvgpr_read_b32 v244, a144
  v_mfma_f32_16x16x32_bf16 v[168:171], a[28:31], a[128:131], v[168:171]
  v_lshlrev_b32 v240, 16, v244
  v_and_b32 v241, s27, v244
  v_mfma_f32_16x16x32_bf16 v[172:175], a[28:31], a[132:135], v[172:175]
  v_fma_f32 v236, v240, v8, v236
  s_waitcnt vmcnt(23)
  v_mfma_f32_16x16x32_bf16 v[176:179], a[32:35], a[120:123], v[176:179]
  buffer_load_dwordx4 a[28:31], v208, s[8:11], s20 offen offset:1024
  v_fma_f32 v237, v241, v9, v237
  v_mfma_f32_16x16x32_bf16 v[180:183], a[32:35], a[124:127], v[180:183]
  ds_read_b128 a[112:115], v209 offset:24576
  v_cvt_pk_bf16_f32 v8, v236, v237
  v_mfma_f32_16x16x32_bf16 v[184:187], a[32:35], a[128:131], v[184:187]
  v_lshlrev_b32 v238, 16, v229
  v_and_b32 v239, s27, v229
  v_mfma_f32_16x16x32_bf16 v[188:191], a[32:35], a[132:135], v[188:191]
  v_mfma_f32_16x16x32_bf16 v[192:195], a[36:39], a[120:123], v[192:195]
  buffer_load_dwordx4 a[32:35], v208, s[8:11], s20 offen offset:2048
  v_accvgpr_read_b32 v244, a145
  v_mfma_f32_16x16x32_bf16 v[196:199], a[36:39], a[124:127], v[196:199]
  ds_read_b128 a[116:119], v209 offset:28672
  v_lshlrev_b32 v242, 16, v244
  v_mfma_f32_16x16x32_bf16 v[200:203], a[36:39], a[128:131], v[200:203]
  v_and_b32 v243, s27, v244
  v_fma_f32 v238, v242, v10, v238
  v_mfma_f32_16x16x32_bf16 v[204:207], a[36:39], a[132:135], v[204:207]
  s_waitcnt vmcnt(23) lgkmcnt(0)
  v_mfma_f32_16x16x32_bf16 v[128:131], a[40:43], a[104:107], v[128:131]
  buffer_load_dwordx4 a[36:39], v208, s[8:11], s20 offen offset:3072
  v_mfma_f32_16x16x32_bf16 v[132:135], a[40:43], a[108:111], v[132:135]
  v_fma_f32 v239, v243, v11, v239
  v_cvt_pk_bf16_f32 v9, v238, v239
  v_mfma_f32_16x16x32_bf16 v[136:139], a[40:43], a[112:115], v[136:139]
  v_lshlrev_b32 v236, 16, v230
  v_and_b32 v237, s27, v230
  v_mfma_f32_16x16x32_bf16 v[140:143], a[40:43], a[116:119], v[140:143]
  v_mfma_f32_16x16x32_bf16 v[144:147], a[44:47], a[104:107], v[144:147]
  s_add_u32 s20, s20, 4096
  buffer_load_dwordx4 a[40:43], v208, s[8:11], s20 offen
  v_mfma_f32_16x16x32_bf16 v[148:151], a[44:47], a[108:111], v[148:151]
  ds_read_b128 a[120:123], v210 offset:16384
  v_accvgpr_read_b32 v244, a146
  v_mfma_f32_16x16x32_bf16 v[152:155], a[44:47], a[112:115], v[152:155]
  v_lshlrev_b32 v240, 16, v244
  v_and_b32 v241, s27, v244
  v_mfma_f32_16x16x32_bf16 v[156:159], a[44:47], a[116:119], v[156:159]
  v_fma_f32 v236, v240, v24, v236
  s_waitcnt vmcnt(23)
  v_mfma_f32_16x16x32_bf16 v[160:163], a[48:51], a[104:107], v[160:163]
  buffer_load_dwordx4 a[44:47], v208, s[8:11], s20 offen offset:1024
  v_fma_f32 v237, v241, v25, v237
  v_mfma_f32_16x16x32_bf16 v[164:167], a[48:51], a[108:111], v[164:167]
  ds_read_b128 a[124:127], v210 offset:20480
  v_cvt_pk_bf16_f32 v10, v236, v237
  v_mfma_f32_16x16x32_bf16 v[168:171], a[48:51], a[112:115], v[168:171]
  v_lshlrev_b32 v238, 16, v231
  v_and_b32 v239, s27, v231
  v_mfma_f32_16x16x32_bf16 v[172:175], a[48:51], a[116:119], v[172:175]
  v_mfma_f32_16x16x32_bf16 v[176:179], a[52:55], a[104:107], v[176:179]
  buffer_load_dwordx4 a[48:51], v208, s[8:11], s20 offen offset:2048
  v_accvgpr_read_b32 v244, a147
  v_mfma_f32_16x16x32_bf16 v[180:183], a[52:55], a[108:111], v[180:183]
  ds_read_b128 a[128:131], v210 offset:24576
  v_lshlrev_b32 v242, 16, v244
  v_mfma_f32_16x16x32_bf16 v[184:187], a[52:55], a[112:115], v[184:187]
  v_and_b32 v243, s27, v244
  v_fma_f32 v238, v242, v26, v238
  v_mfma_f32_16x16x32_bf16 v[188:191], a[52:55], a[116:119], v[188:191]
  s_waitcnt vmcnt(23)
  v_mfma_f32_16x16x32_bf16 v[192:195], a[56:59], a[104:107], v[192:195]
  buffer_load_dwordx4 a[52:55], v208, s[8:11], s20 offen offset:3072
  v_fma_f32 v239, v243, v27, v239
  v_mfma_f32_16x16x32_bf16 v[196:199], a[56:59], a[108:111], v[196:199]
  ds_read_b128 a[132:135], v210 offset:28672
  v_cvt_pk_bf16_f32 v11, v238, v239
  v_mfma_f32_16x16x32_bf16 v[200:203], a[56:59], a[112:115], v[200:203]
  ds_read_b128 v[228:231], v218
  v_lshlrev_b32 v236, 16, v232
  v_mfma_f32_16x16x32_bf16 v[204:207], a[56:59], a[116:119], v[204:207]
  v_and_b32 v237, s27, v232
  s_waitcnt lgkmcnt(1)
  v_mfma_f32_16x16x32_bf16 v[128:131], a[60:63], a[120:123], v[128:131]
  s_add_u32 s20, s20, 4096
  buffer_load_dwordx4 a[56:59], v208, s[8:11], s20 offen
  v_mfma_f32_16x16x32_bf16 v[132:135], a[60:63], a[124:127], v[132:135]
  v_accvgpr_read_b32 v244, a148
  v_lshlrev_b32 v240, 16, v244
  v_mfma_f32_16x16x32_bf16 v[136:139], a[60:63], a[128:131], v[136:139]
  v_and_b32 v241, s27, v244
  v_fma_f32 v236, v240, v12, v236
  v_mfma_f32_16x16x32_bf16 v[140:143], a[60:63], a[132:135], v[140:143]
  s_waitcnt vmcnt(23)
  v_mfma_f32_16x16x32_bf16 v[144:147], a[64:67], a[120:123], v[144:147]
  buffer_load_dwordx4 a[60:63], v208, s[8:11], s20 offen offset:1024
  v_fma_f32 v237, v241, v13, v237
  v_mfma_f32_16x16x32_bf16 v[148:151], a[64:67], a[124:127], v[148:151]
  ds_read_b128 a[104:107], v211 offset:16384
  v_cvt_pk_bf16_f32 v12, v236, v237
  v_mfma_f32_16x16x32_bf16 v[152:155], a[64:67], a[128:131], v[152:155]
  v_lshlrev_b32 v238, 16, v233
  v_and_b32 v239, s27, v233
  v_mfma_f32_16x16x32_bf16 v[156:159], a[64:67], a[132:135], v[156:159]
  v_mfma_f32_16x16x32_bf16 v[160:163], a[68:71], a[120:123], v[160:163]
  buffer_load_dwordx4 a[64:67], v208, s[8:11], s20 offen offset:2048
  v_accvgpr_read_b32 v244, a149
  v_mfma_f32_16x16x32_bf16 v[164:167], a[68:71], a[124:127], v[164:167]
  ds_read_b128 a[108:111], v211 offset:20480
  v_lshlrev_b32 v242, 16, v244
  v_mfma_f32_16x16x32_bf16 v[168:171], a[68:71], a[128:131], v[168:171]
  v_and_b32 v243, s27, v244
  v_fma_f32 v238, v242, v14, v238
  v_mfma_f32_16x16x32_bf16 v[172:175], a[68:71], a[132:135], v[172:175]
  s_waitcnt vmcnt(23)
  v_mfma_f32_16x16x32_bf16 v[176:179], a[72:75], a[120:123], v[176:179]
  buffer_load_dwordx4 a[68:71], v208, s[8:11], s20 offen offset:3072
  v_fma_f32 v239, v243, v15, v239
  v_mfma_f32_16x16x32_bf16 v[180:183], a[72:75], a[124:127], v[180:183]
  ds_read_b128 a[112:115], v211 offset:24576
  v_cvt_pk_bf16_f32 v13, v238, v239
  v_mfma_f32_16x16x32_bf16 v[184:187], a[72:75], a[128:131], v[184:187]
  v_lshlrev_b32 v236, 16, v234
  v_and_b32 v237, s27, v234
  v_mfma_f32_16x16x32_bf16 v[188:191], a[72:75], a[132:135], v[188:191]
  v_mfma_f32_16x16x32_bf16 v[192:195], a[76:79], a[120:123], v[192:195]
  s_add_u32 s20, s20, 4096
  buffer_load_dwordx4 a[72:75], v208, s[8:11], s20 offen
  v_mfma_f32_16x16x32_bf16 v[196:199], a[76:79], a[124:127], v[196:199]
  ds_read_b128 a[116:119], v211 offset:28672
  v_accvgpr_read_b32 v244, a150
  v_mfma_f32_16x16x32_bf16 v[200:203], a[76:79], a[128:131], v[200:203]
  v_lshlrev_b32 v240, 16, v244
  v_and_b32 v241, s27, v244
  v_mfma_f32_16x16x32_bf16 v[204:207], a[76:79], a[132:135], v[204:207]
  v_fma_f32 v236, v240, v28, v236
  s_waitcnt vmcnt(23) lgkmcnt(0)
  v_mfma_f32_16x16x32_bf16 v[128:131], a[80:83], a[104:107], v[128:131]
  buffer_load_dwordx4 a[76:79], v208, s[8:11], s20 offen offset:1024
  v_mfma_f32_16x16x32_bf16 v[132:135], a[80:83], a[108:111], v[132:135]
  v_fma_f32 v237, v241, v29, v237
  v_cvt_pk_bf16_f32 v14, v236, v237
  v_mfma_f32_16x16x32_bf16 v[136:139], a[80:83], a[112:115], v[136:139]
  v_lshlrev_b32 v238, 16, v235
  v_and_b32 v239, s27, v235
  v_mfma_f32_16x16x32_bf16 v[140:143], a[80:83], a[116:119], v[140:143]
  v_mfma_f32_16x16x32_bf16 v[144:147], a[84:87], a[104:107], v[144:147]
  buffer_load_dwordx4 a[80:83], v208, s[8:11], s20 offen offset:2048
  v_accvgpr_read_b32 v244, a151
  v_mfma_f32_16x16x32_bf16 v[148:151], a[84:87], a[108:111], v[148:151]
  ds_read_b128 a[120:123], v212 offset:16384
  v_lshlrev_b32 v242, 16, v244
  v_mfma_f32_16x16x32_bf16 v[152:155], a[84:87], a[112:115], v[152:155]
  v_and_b32 v243, s27, v244
  v_fma_f32 v238, v242, v30, v238
  v_mfma_f32_16x16x32_bf16 v[156:159], a[84:87], a[116:119], v[156:159]
  s_waitcnt vmcnt(23)
  v_mfma_f32_16x16x32_bf16 v[160:163], a[88:91], a[104:107], v[160:163]
  buffer_load_dwordx4 a[84:87], v208, s[8:11], s20 offen offset:3072
  v_fma_f32 v239, v243, v31, v239
  v_mfma_f32_16x16x32_bf16 v[164:167], a[88:91], a[108:111], v[164:167]
  ds_read_b128 a[124:127], v212 offset:20480
  v_cvt_pk_bf16_f32 v15, v238, v239
  v_mfma_f32_16x16x32_bf16 v[168:171], a[88:91], a[112:115], v[168:171]
  ds_read_b128 v[20:23], v226 offset:6656
  ds_read_b128 v[16:19], v226 offset:6672
  v_mfma_f32_16x16x32_bf16 v[172:175], a[88:91], a[116:119], v[172:175]
  ds_read_b128 v[232:235], v218 offset:4096
  v_mfma_f32_16x16x32_bf16 v[176:179], a[92:95], a[104:107], v[176:179]
  s_add_u32 s20, s20, 4096
  buffer_load_dwordx4 a[88:91], v208, s[8:11], s20 offen
  v_mfma_f32_16x16x32_bf16 v[180:183], a[92:95], a[108:111], v[180:183]
  ds_read_b128 a[128:131], v212 offset:24576
  v_lshlrev_b32 v236, 16, v228
  v_mfma_f32_16x16x32_bf16 v[184:187], a[92:95], a[112:115], v[184:187]
  v_and_b32 v237, s27, v228
  v_accvgpr_read_b32 v244, a152
  v_mfma_f32_16x16x32_bf16 v[188:191], a[92:95], a[116:119], v[188:191]
  v_lshlrev_b32 v240, 16, v244
  s_waitcnt vmcnt(23)
  v_mfma_f32_16x16x32_bf16 v[192:195], a[96:99], a[104:107], v[192:195]
  buffer_load_dwordx4 a[92:95], v208, s[8:11], s20 offen offset:1024
  v_and_b32 v241, s27, v244
  v_mfma_f32_16x16x32_bf16 v[196:199], a[96:99], a[108:111], v[196:199]
  ds_read_b128 a[132:135], v212 offset:28672
  v_fma_f32 v236, v240, v32, v236
  v_mfma_f32_16x16x32_bf16 v[200:203], a[96:99], a[112:115], v[200:203]
  v_fma_f32 v237, v241, v33, v237
  v_cvt_pk_bf16_f32 v32, v236, v237
  v_mfma_f32_16x16x32_bf16 v[204:207], a[96:99], a[116:119], v[204:207]
  s_waitcnt lgkmcnt(0)
  v_mfma_f32_16x16x32_bf16 v[128:131], a[100:103], a[120:123], v[128:131]
  buffer_load_dwordx4 a[96:99], v208, s[8:11], s20 offen offset:2048
  v_mfma_f32_16x16x32_bf16 v[132:135], a[100:103], a[124:127], v[132:135]
  v_lshlrev_b32 v238, 16, v229
  v_and_b32 v239, s27, v229
  v_mfma_f32_16x16x32_bf16 v[136:139], a[100:103], a[128:131], v[136:139]
  v_accvgpr_read_b32 v244, a153
  v_lshlrev_b32 v242, 16, v244
  v_mfma_f32_16x16x32_bf16 v[140:143], a[100:103], a[132:135], v[140:143]
  s_waitcnt vmcnt(23)
  v_mfma_f32_16x16x32_bf16 v[144:147], a[0:3], a[120:123], v[144:147]
  buffer_load_dwordx4 a[100:103], v208, s[8:11], s20 offen offset:3072
  v_and_b32 v243, s27, v244
  v_mfma_f32_16x16x32_bf16 v[148:151], a[0:3], a[124:127], v[148:151]
  ds_read_b128 a[104:107], v209 offset:32768
  v_fma_f32 v238, v242, v34, v238
  v_mfma_f32_16x16x32_bf16 v[152:155], a[0:3], a[128:131], v[152:155]
  v_fma_f32 v239, v243, v35, v239
  v_cvt_pk_bf16_f32 v33, v238, v239
  v_mfma_f32_16x16x32_bf16 v[156:159], a[0:3], a[132:135], v[156:159]
  v_mfma_f32_16x16x32_bf16 v[160:163], a[4:7], a[120:123], v[160:163]
  s_add_u32 s20, s20, 4096
  buffer_load_dwordx4 a[0:3], v208, s[8:11], s20 offen
  v_mfma_f32_16x16x32_bf16 v[164:167], a[4:7], a[124:127], v[164:167]
  ds_read_b128 a[108:111], v209 offset:36864
  v_lshlrev_b32 v236, 16, v230
  v_mfma_f32_16x16x32_bf16 v[168:171], a[4:7], a[128:131], v[168:171]
  v_and_b32 v237, s27, v230
  v_accvgpr_read_b32 v244, a154
  v_mfma_f32_16x16x32_bf16 v[172:175], a[4:7], a[132:135], v[172:175]
  v_lshlrev_b32 v240, 16, v244
  s_waitcnt vmcnt(23)
  v_mfma_f32_16x16x32_bf16 v[176:179], a[8:11], a[120:123], v[176:179]
  buffer_load_dwordx4 a[4:7], v208, s[8:11], s20 offen offset:1024
  v_and_b32 v241, s27, v244
  v_mfma_f32_16x16x32_bf16 v[180:183], a[8:11], a[124:127], v[180:183]
  ds_read_b128 a[112:115], v209 offset:40960
  v_fma_f32 v236, v240, v48, v236
  v_mfma_f32_16x16x32_bf16 v[184:187], a[8:11], a[128:131], v[184:187]
  v_fma_f32 v237, v241, v49, v237
  v_cvt_pk_bf16_f32 v34, v236, v237
  v_mfma_f32_16x16x32_bf16 v[188:191], a[8:11], a[132:135], v[188:191]
  v_mfma_f32_16x16x32_bf16 v[192:195], a[12:15], a[120:123], v[192:195]
  buffer_load_dwordx4 a[8:11], v208, s[8:11], s20 offen offset:2048
  v_lshlrev_b32 v238, 16, v231
  v_mfma_f32_16x16x32_bf16 v[196:199], a[12:15], a[124:127], v[196:199]
  ds_read_b128 a[116:119], v209 offset:45056
  v_and_b32 v239, s27, v231
  v_mfma_f32_16x16x32_bf16 v[200:203], a[12:15], a[128:131], v[200:203]
  v_accvgpr_read_b32 v244, a155
  v_lshlrev_b32 v242, 16, v244
  v_mfma_f32_16x16x32_bf16 v[204:207], a[12:15], a[132:135], v[204:207]
  s_waitcnt vmcnt(23) lgkmcnt(0)
  v_mfma_f32_16x16x32_bf16 v[128:131], a[16:19], a[104:107], v[128:131]
  buffer_load_dwordx4 a[12:15], v208, s[8:11], s20 offen offset:3072
  v_and_b32 v243, s27, v244
  v_mfma_f32_16x16x32_bf16 v[132:135], a[16:19], a[108:111], v[132:135]
  v_fma_f32 v238, v242, v50, v238
  v_fma_f32 v239, v243, v51, v239
  v_mfma_f32_16x16x32_bf16 v[136:139], a[16:19], a[112:115], v[136:139]
  v_cvt_pk_bf16_f32 v35, v238, v239
  ds_read_b128 v[228:231], v218 offset:8192
  v_mfma_f32_16x16x32_bf16 v[140:143], a[16:19], a[116:119], v[140:143]
  v_mfma_f32_16x16x32_bf16 v[144:147], a[20:23], a[104:107], v[144:147]
  s_add_u32 s20, s20, 4096
  buffer_load_dwordx4 a[16:19], v208, s[8:11], s20 offen
  v_mfma_f32_16x16x32_bf16 v[148:151], a[20:23], a[108:111], v[148:151]
  ds_read_b128 a[120:123], v210 offset:32768
  v_lshlrev_b32 v236, 16, v232
  v_mfma_f32_16x16x32_bf16 v[152:155], a[20:23], a[112:115], v[152:155]
  v_and_b32 v237, s27, v232
  v_accvgpr_read_b32 v244, a156
  v_mfma_f32_16x16x32_bf16 v[156:159], a[20:23], a[116:119], v[156:159]
  v_lshlrev_b32 v240, 16, v244
  s_waitcnt vmcnt(23)
  v_mfma_f32_16x16x32_bf16 v[160:163], a[24:27], a[104:107], v[160:163]
  buffer_load_dwordx4 a[20:23], v208, s[8:11], s20 offen offset:1024
  v_and_b32 v241, s27, v244
  v_mfma_f32_16x16x32_bf16 v[164:167], a[24:27], a[108:111], v[164:167]
  ds_read_b128 a[124:127], v210 offset:36864
  v_fma_f32 v236, v240, v36, v236
  v_mfma_f32_16x16x32_bf16 v[168:171], a[24:27], a[112:115], v[168:171]
  v_fma_f32 v237, v241, v37, v237
  v_cvt_pk_bf16_f32 v36, v236, v237
  v_mfma_f32_16x16x32_bf16 v[172:175], a[24:27], a[116:119], v[172:175]
  v_mfma_f32_16x16x32_bf16 v[176:179], a[28:31], a[104:107], v[176:179]
  buffer_load_dwordx4 a[24:27], v208, s[8:11], s20 offen offset:2048
  v_lshlrev_b32 v238, 16, v233
  v_mfma_f32_16x16x32_bf16 v[180:183], a[28:31], a[108:111], v[180:183]
  ds_read_b128 a[128:131], v210 offset:40960
  v_and_b32 v239, s27, v233
  v_mfma_f32_16x16x32_bf16 v[184:187], a[28:31], a[112:115], v[184:187]
  v_accvgpr_read_b32 v244, a157
  v_lshlrev_b32 v242, 16, v244
  v_mfma_f32_16x16x32_bf16 v[188:191], a[28:31], a[116:119], v[188:191]
  s_waitcnt vmcnt(23)
  v_mfma_f32_16x16x32_bf16 v[192:195], a[32:35], a[104:107], v[192:195]
  buffer_load_dwordx4 a[28:31], v208, s[8:11], s20 offen offset:3072
  v_and_b32 v243, s27, v244
  v_mfma_f32_16x16x32_bf16 v[196:199], a[32:35], a[108:111], v[196:199]
  ds_read_b128 a[132:135], v210 offset:45056
  v_fma_f32 v238, v242, v38, v238
  v_mfma_f32_16x16x32_bf16 v[200:203], a[32:35], a[112:115], v[200:203]
  v_fma_f32 v239, v243, v39, v239
  v_cvt_pk_bf16_f32 v37, v238, v239
  v_mfma_f32_16x16x32_bf16 v[204:207], a[32:35], a[116:119], v[204:207]
  s_waitcnt lgkmcnt(0)
  v_mfma_f32_16x16x32_bf16 v[128:131], a[36:39], a[120:123], v[128:131]
  s_add_u32 s20, s20, 4096
  buffer_load_dwordx4 a[32:35], v208, s[8:11], s20 offen
  v_mfma_f32_16x16x32_bf16 v[132:135], a[36:39], a[124:127], v[132:135]
  v_lshlrev_b32 v236, 16, v234
  v_and_b32 v237, s27, v234
  v_mfma_f32_16x16x32_bf16 v[136:139], a[36:39], a[128:131], v[136:139]
  v_accvgpr_read_b32 v244, a158
  v_lshlrev_b32 v240, 16, v244
  v_mfma_f32_16x16x32_bf16 v[140:143], a[36:39], a[132:135], v[140:143]
  s_waitcnt vmcnt(23)
  v_mfma_f32_16x16x32_bf16 v[144:147], a[40:43], a[120:123], v[144:147]
  buffer_load_dwordx4 a[36:39], v208, s[8:11], s20 offen offset:1024
  v_and_b32 v241, s27, v244
  v_mfma_f32_16x16x32_bf16 v[148:151], a[40:43], a[124:127], v[148:151]
  ds_read_b128 a[104:107], v211 offset:32768
  v_fma_f32 v236, v240, v52, v236
  v_mfma_f32_16x16x32_bf16 v[152:155], a[40:43], a[128:131], v[152:155]
  v_fma_f32 v237, v241, v53, v237
  v_cvt_pk_bf16_f32 v38, v236, v237
  v_mfma_f32_16x16x32_bf16 v[156:159], a[40:43], a[132:135], v[156:159]
  v_mfma_f32_16x16x32_bf16 v[160:163], a[44:47], a[120:123], v[160:163]
  buffer_load_dwordx4 a[40:43], v208, s[8:11], s20 offen offset:2048
  v_lshlrev_b32 v238, 16, v235
  v_mfma_f32_16x16x32_bf16 v[164:167], a[44:47], a[124:127], v[164:167]
  ds_read_b128 a[108:111], v211 offset:36864
  v_and_b32 v239, s27, v235
  v_mfma_f32_16x16x32_bf16 v[168:171], a[44:47], a[128:131], v[168:171]
  v_accvgpr_read_b32 v244, a159
  v_lshlrev_b32 v242, 16, v244
  v_mfma_f32_16x16x32_bf16 v[172:175], a[44:47], a[132:135], v[172:175]
  s_waitcnt vmcnt(23)
  v_mfma_f32_16x16x32_bf16 v[176:179], a[48:51], a[120:123], v[176:179]
  buffer_load_dwordx4 a[44:47], v208, s[8:11], s20 offen offset:3072
  v_and_b32 v243, s27, v244
  v_mfma_f32_16x16x32_bf16 v[180:183], a[48:51], a[124:127], v[180:183]
  ds_read_b128 a[112:115], v211 offset:40960
  v_fma_f32 v238, v242, v54, v238
  v_mfma_f32_16x16x32_bf16 v[184:187], a[48:51], a[128:131], v[184:187]
  v_fma_f32 v239, v243, v55, v239
  v_cvt_pk_bf16_f32 v39, v238, v239
  v_mfma_f32_16x16x32_bf16 v[188:191], a[48:51], a[132:135], v[188:191]
  ds_read_b128 v[232:235], v218 offset:12288
  v_mfma_f32_16x16x32_bf16 v[192:195], a[52:55], a[120:123], v[192:195]
  s_add_u32 s20, s20, 4096
  buffer_load_dwordx4 a[48:51], v208, s[8:11], s20 offen
  v_mfma_f32_16x16x32_bf16 v[196:199], a[52:55], a[124:127], v[196:199]
  ds_read_b128 a[116:119], v211 offset:45056
  v_lshlrev_b32 v236, 16, v228
  v_mfma_f32_16x16x32_bf16 v[200:203], a[52:55], a[128:131], v[200:203]
  v_and_b32 v237, s27, v228
  v_accvgpr_read_b32 v244, a160
  v_mfma_f32_16x16x32_bf16 v[204:207], a[52:55], a[132:135], v[204:207]
  v_lshlrev_b32 v240, 16, v244
  s_waitcnt vmcnt(23) lgkmcnt(0)
  v_mfma_f32_16x16x32_bf16 v[128:131], a[56:59], a[104:107], v[128:131]
  buffer_load_dwordx4 a[52:55], v208, s[8:11], s20 offen offset:1024
  v_mfma_f32_16x16x32_bf16 v[132:135], a[56:59], a[108:111], v[132:135]
  v_and_b32 v241, s27, v244
  v_fma_f32 v236, v240, v40, v236
  v_mfma_f32_16x16x32_bf16 v[136:139], a[56:59], a[112:115], v[136:139]
  v_fma_f32 v237, v241, v41, v237
  v_cvt_pk_bf16_f32 v40, v236, v237
  v_mfma_f32_16x16x32_bf16 v[140:143], a[56:59], a[116:119], v[140:143]
  v_mfma_f32_16x16x32_bf16 v[144:147], a[60:63], a[104:107], v[144:147]
  buffer_load_dwordx4 a[56:59], v208, s[8:11], s20 offen offset:2048
  v_lshlrev_b32 v238, 16, v229
  v_mfma_f32_16x16x32_bf16 v[148:151], a[60:63], a[108:111], v[148:151]
  ds_read_b128 a[120:123], v212 offset:32768
  v_and_b32 v239, s27, v229
  v_mfma_f32_16x16x32_bf16 v[152:155], a[60:63], a[112:115], v[152:155]
  v_accvgpr_read_b32 v244, a161
  v_lshlrev_b32 v242, 16, v244
  v_mfma_f32_16x16x32_bf16 v[156:159], a[60:63], a[116:119], v[156:159]
  s_waitcnt vmcnt(23)
  v_mfma_f32_16x16x32_bf16 v[160:163], a[64:67], a[104:107], v[160:163]
  buffer_load_dwordx4 a[60:63], v208, s[8:11], s20 offen offset:3072
  v_and_b32 v243, s27, v244
  v_mfma_f32_16x16x32_bf16 v[164:167], a[64:67], a[108:111], v[164:167]
  ds_read_b128 a[124:127], v212 offset:36864
  v_fma_f32 v238, v242, v42, v238
  v_mfma_f32_16x16x32_bf16 v[168:171], a[64:67], a[112:115], v[168:171]
  v_fma_f32 v239, v243, v43, v239
  v_cvt_pk_bf16_f32 v41, v238, v239
  v_mfma_f32_16x16x32_bf16 v[172:175], a[64:67], a[116:119], v[172:175]
  v_mfma_f32_16x16x32_bf16 v[176:179], a[68:71], a[104:107], v[176:179]
  s_add_u32 s20, s20, 4096
  buffer_load_dwordx4 a[64:67], v208, s[8:11], s20 offen
  v_mfma_f32_16x16x32_bf16 v[180:183], a[68:71], a[108:111], v[180:183]
  ds_read_b128 a[128:131], v212 offset:40960
  v_lshlrev_b32 v236, 16, v230
  v_mfma_f32_16x16x32_bf16 v[184:187], a[68:71], a[112:115], v[184:187]
  v_and_b32 v237, s27, v230
  v_accvgpr_read_b32 v244, a162
  v_mfma_f32_16x16x32_bf16 v[188:191], a[68:71], a[116:119], v[188:191]
  v_lshlrev_b32 v240, 16, v244
  s_waitcnt vmcnt(23)
  v_mfma_f32_16x16x32_bf16 v[192:195], a[72:75], a[104:107], v[192:195]
  buffer_load_dwordx4 a[68:71], v208, s[8:11], s20 offen offset:1024
  v_and_b32 v241, s27, v244
  v_mfma_f32_16x16x32_bf16 v[196:199], a[72:75], a[108:111], v[196:199]
  ds_read_b128 a[132:135], v212 offset:45056
  v_fma_f32 v236, v240, v56, v236
  v_mfma_f32_16x16x32_bf16 v[200:203], a[72:75], a[112:115], v[200:203]
  v_fma_f32 v237, v241, v57, v237
  v_cvt_pk_bf16_f32 v42, v236, v237
  v_mfma_f32_16x16x32_bf16 v[204:207], a[72:75], a[116:119], v[204:207]
  s_waitcnt lgkmcnt(0)
  v_mfma_f32_16x16x32_bf16 v[128:131], a[76:79], a[120:123], v[128:131]
  buffer_load_dwordx4 a[72:75], v208, s[8:11], s20 offen offset:2048
  v_mfma_f32_16x16x32_bf16 v[132:135], a[76:79], a[124:127], v[132:135]
  v_lshlrev_b32 v238, 16, v231
  v_and_b32 v239, s27, v231
  v_mfma_f32_16x16x32_bf16 v[136:139], a[76:79], a[128:131], v[136:139]
  v_accvgpr_read_b32 v244, a163
  v_lshlrev_b32 v242, 16, v244
  v_mfma_f32_16x16x32_bf16 v[140:143], a[76:79], a[132:135], v[140:143]
  s_waitcnt vmcnt(23)
  v_mfma_f32_16x16x32_bf16 v[144:147], a[80:83], a[120:123], v[144:147]
  buffer_load_dwordx4 a[76:79], v208, s[8:11], s20 offen offset:3072
  v_and_b32 v243, s27, v244
  v_mfma_f32_16x16x32_bf16 v[148:151], a[80:83], a[124:127], v[148:151]
  ds_read_b128 a[104:107], v209 offset:49152
  v_fma_f32 v238, v242, v58, v238
  v_mfma_f32_16x16x32_bf16 v[152:155], a[80:83], a[128:131], v[152:155]
  v_fma_f32 v239, v243, v59, v239
  v_cvt_pk_bf16_f32 v43, v238, v239
  v_mfma_f32_16x16x32_bf16 v[156:159], a[80:83], a[132:135], v[156:159]
  ds_read_b128 v[228:231], v219
  v_mfma_f32_16x16x32_bf16 v[160:163], a[84:87], a[120:123], v[160:163]
  s_add_u32 s20, s20, 4096
  buffer_load_dwordx4 a[80:83], v208, s[8:11], s20 offen
  v_mfma_f32_16x16x32_bf16 v[164:167], a[84:87], a[124:127], v[164:167]
  ds_read_b128 a[108:111], v209 offset:53248
  v_lshlrev_b32 v236, 16, v232
  v_mfma_f32_16x16x32_bf16 v[168:171], a[84:87], a[128:131], v[168:171]
  v_and_b32 v237, s27, v232
  v_accvgpr_read_b32 v244, a164
  v_mfma_f32_16x16x32_bf16 v[172:175], a[84:87], a[132:135], v[172:175]
  v_lshlrev_b32 v240, 16, v244
  s_waitcnt vmcnt(23)
  v_mfma_f32_16x16x32_bf16 v[176:179], a[88:91], a[120:123], v[176:179]
  buffer_load_dwordx4 a[84:87], v208, s[8:11], s20 offen offset:1024
  v_and_b32 v241, s27, v244
  v_mfma_f32_16x16x32_bf16 v[180:183], a[88:91], a[124:127], v[180:183]
  ds_read_b128 a[112:115], v209 offset:57344
  v_fma_f32 v236, v240, v44, v236
  v_mfma_f32_16x16x32_bf16 v[184:187], a[88:91], a[128:131], v[184:187]
  v_fma_f32 v237, v241, v45, v237
  v_cvt_pk_bf16_f32 v44, v236, v237
  v_mfma_f32_16x16x32_bf16 v[188:191], a[88:91], a[132:135], v[188:191]
  v_mfma_f32_16x16x32_bf16 v[192:195], a[92:95], a[120:123], v[192:195]
  buffer_load_dwordx4 a[88:91], v208, s[8:11], s20 offen offset:2048
  v_lshlrev_b32 v238, 16, v233
  v_mfma_f32_16x16x32_bf16 v[196:199], a[92:95], a[124:127], v[196:199]
  ds_read_b128 a[116:119], v209 offset:61440
  v_and_b32 v239, s27, v233
  v_mfma_f32_16x16x32_bf16 v[200:203], a[92:95], a[128:131], v[200:203]
  v_accvgpr_read_b32 v244, a165
  v_lshlrev_b32 v242, 16, v244
  v_mfma_f32_16x16x32_bf16 v[204:207], a[92:95], a[132:135], v[204:207]
  s_waitcnt vmcnt(23) lgkmcnt(0)
  v_mfma_f32_16x16x32_bf16 v[128:131], a[96:99], a[104:107], v[128:131]
  buffer_load_dwordx4 a[92:95], v208, s[8:11], s20 offen offset:3072
  v_mfma_f32_16x16x32_bf16 v[132:135], a[96:99], a[108:111], v[132:135]
  v_and_b32 v243, s27, v244
  v_fma_f32 v238, v242, v46, v238
  v_mfma_f32_16x16x32_bf16 v[136:139], a[96:99], a[112:115], v[136:139]
  v_fma_f32 v239, v243, v47, v239
  v_cvt_pk_bf16_f32 v45, v238, v239
  v_mfma_f32_16x16x32_bf16 v[140:143], a[96:99], a[116:119], v[140:143]
  v_mfma_f32_16x16x32_bf16 v[144:147], a[100:103], a[104:107], v[144:147]
  s_add_u32 s20, s20, 4096
  buffer_load_dwordx4 a[96:99], v208, s[8:11], s20 offen
  v_mfma_f32_16x16x32_bf16 v[148:151], a[100:103], a[108:111], v[148:151]
  ds_read_b128 a[120:123], v210 offset:49152
  v_lshlrev_b32 v236, 16, v234
  v_mfma_f32_16x16x32_bf16 v[152:155], a[100:103], a[112:115], v[152:155]
  v_and_b32 v237, s27, v234
  v_accvgpr_read_b32 v244, a166
  v_mfma_f32_16x16x32_bf16 v[156:159], a[100:103], a[116:119], v[156:159]
  v_lshlrev_b32 v240, 16, v244
  s_waitcnt vmcnt(23)
  v_mfma_f32_16x16x32_bf16 v[160:163], a[0:3], a[104:107], v[160:163]
  buffer_load_dwordx4 a[100:103], v208, s[8:11], s20 offen offset:1024
  v_and_b32 v241, s27, v244
  v_mfma_f32_16x16x32_bf16 v[164:167], a[0:3], a[108:111], v[164:167]
  ds_read_b128 a[124:127], v210 offset:53248
  v_fma_f32 v236, v240, v60, v236
  v_mfma_f32_16x16x32_bf16 v[168:171], a[0:3], a[112:115], v[168:171]
  v_fma_f32 v237, v241, v61, v237
  v_cvt_pk_bf16_f32 v46, v236, v237
  v_mfma_f32_16x16x32_bf16 v[172:175], a[0:3], a[116:119], v[172:175]
  v_mfma_f32_16x16x32_bf16 v[176:179], a[4:7], a[104:107], v[176:179]
  buffer_load_dwordx4 a[0:3], v208, s[8:11], s20 offen offset:2048
  v_lshlrev_b32 v238, 16, v235
  v_mfma_f32_16x16x32_bf16 v[180:183], a[4:7], a[108:111], v[180:183]
  ds_read_b128 a[128:131], v210 offset:57344
  v_and_b32 v239, s27, v235
  v_mfma_f32_16x16x32_bf16 v[184:187], a[4:7], a[112:115], v[184:187]
  v_accvgpr_read_b32 v244, a167
  v_lshlrev_b32 v242, 16, v244
  v_mfma_f32_16x16x32_bf16 v[188:191], a[4:7], a[116:119], v[188:191]
  s_waitcnt vmcnt(23)
  v_mfma_f32_16x16x32_bf16 v[192:195], a[8:11], a[104:107], v[192:195]
  buffer_load_dwordx4 a[4:7], v208, s[8:11], s20 offen offset:3072
  v_and_b32 v243, s27, v244
  v_mfma_f32_16x16x32_bf16 v[196:199], a[8:11], a[108:111], v[196:199]
  ds_read_b128 a[132:135], v210 offset:61440
  v_fma_f32 v238, v242, v62, v238
  v_mfma_f32_16x16x32_bf16 v[200:203], a[8:11], a[112:115], v[200:203]
  v_fma_f32 v239, v243, v63, v239
  v_cvt_pk_bf16_f32 v47, v238, v239
  v_mfma_f32_16x16x32_bf16 v[204:207], a[8:11], a[116:119], v[204:207]
  ds_read_b128 v[52:55], v226 offset:6784
  s_waitcnt lgkmcnt(1)
  v_mfma_f32_16x16x32_bf16 v[128:131], a[12:15], a[120:123], v[128:131]
  s_add_u32 s20, s20, 4096
  buffer_load_dwordx4 a[8:11], v208, s[8:11], s20 offen
  v_mfma_f32_16x16x32_bf16 v[132:135], a[12:15], a[124:127], v[132:135]
  ds_read_b128 v[48:51], v226 offset:6800
  ds_read_b128 v[232:235], v219 offset:4096
  v_mfma_f32_16x16x32_bf16 v[136:139], a[12:15], a[128:131], v[136:139]
  v_lshlrev_b32 v236, 16, v228
  v_and_b32 v237, s27, v228
  v_mfma_f32_16x16x32_bf16 v[140:143], a[12:15], a[132:135], v[140:143]
  s_waitcnt vmcnt(23)
  v_mfma_f32_16x16x32_bf16 v[144:147], a[16:19], a[120:123], v[144:147]
  buffer_load_dwordx4 a[12:15], v208, s[8:11], s20 offen offset:1024
  v_accvgpr_read_b32 v244, a168
  v_mfma_f32_16x16x32_bf16 v[148:151], a[16:19], a[124:127], v[148:151]
  ds_read_b128 a[104:107], v211 offset:49152
  v_lshlrev_b32 v240, 16, v244
  v_mfma_f32_16x16x32_bf16 v[152:155], a[16:19], a[128:131], v[152:155]
  v_and_b32 v241, s27, v244
  v_fma_f32 v236, v240, v64, v236
  v_mfma_f32_16x16x32_bf16 v[156:159], a[16:19], a[132:135], v[156:159]
  v_mfma_f32_16x16x32_bf16 v[160:163], a[20:23], a[120:123], v[160:163]
  buffer_load_dwordx4 a[16:19], v208, s[8:11], s20 offen offset:2048
  v_fma_f32 v237, v241, v65, v237
  v_mfma_f32_16x16x32_bf16 v[164:167], a[20:23], a[124:127], v[164:167]
  ds_read_b128 a[108:111], v211 offset:53248
  v_cvt_pk_bf16_f32 v64, v236, v237
  v_mfma_f32_16x16x32_bf16 v[168:171], a[20:23], a[128:131], v[168:171]
  v_lshlrev_b32 v238, 16, v229
  v_and_b32 v239, s27, v229
  v_mfma_f32_16x16x32_bf16 v[172:175], a[20:23], a[132:135], v[172:175]
  s_waitcnt vmcnt(23)
  v_mfma_f32_16x16x32_bf16 v[176:179], a[24:27], a[120:123], v[176:179]
  buffer_load_dwordx4 a[20:23], v208, s[8:11], s20 offen offset:3072
  v_accvgpr_read_b32 v244, a169
  v_mfma_f32_16x16x32_bf16 v[180:183], a[24:27], a[124:127], v[180:183]
  ds_read_b128 a[112:115], v211 offset:57344
  v_lshlrev_b32 v242, 16, v244
  v_mfma_f32_16x16x32_bf16 v[184:187], a[24:27], a[128:131], v[184:187]
  v_and_b32 v243, s27, v244
  v_fma_f32 v238, v242, v66, v238
  v_mfma_f32_16x16x32_bf16 v[188:191], a[24:27], a[132:135], v[188:191]
  v_mfma_f32_16x16x32_bf16 v[192:195], a[28:31], a[120:123], v[192:195]
  s_add_u32 s20, s20, 4096
  buffer_load_dwordx4 a[24:27], v208, s[8:11], s20 offen
  v_mfma_f32_16x16x32_bf16 v[196:199], a[28:31], a[124:127], v[196:199]
  ds_read_b128 a[116:119], v211 offset:61440
  v_fma_f32 v239, v243, v67, v239
  v_mfma_f32_16x16x32_bf16 v[200:203], a[28:31], a[128:131], v[200:203]
  v_cvt_pk_bf16_f32 v65, v238, v239
  v_lshlrev_b32 v236, 16, v230
  v_mfma_f32_16x16x32_bf16 v[204:207], a[28:31], a[132:135], v[204:207]
  v_and_b32 v237, s27, v230
  s_waitcnt vmcnt(23) lgkmcnt(0)
  v_mfma_f32_16x16x32_bf16 v[128:131], a[32:35], a[104:107], v[128:131]
  buffer_load_dwordx4 a[28:31], v208, s[8:11], s20 offen offset:1024
  v_mfma_f32_16x16x32_bf16 v[132:135], a[32:35], a[108:111], v[132:135]
  v_accvgpr_read_b32 v244, a170
  v_lshlrev_b32 v240, 16, v244
  v_mfma_f32_16x16x32_bf16 v[136:139], a[32:35], a[112:115], v[136:139]
  v_and_b32 v241, s27, v244
  v_fma_f32 v236, v240, v80, v236
  v_mfma_f32_16x16x32_bf16 v[140:143], a[32:35], a[116:119], v[140:143]
  v_mfma_f32_16x16x32_bf16 v[144:147], a[36:39], a[104:107], v[144:147]
  buffer_load_dwordx4 a[32:35], v208, s[8:11], s20 offen offset:2048
  v_fma_f32 v237, v241, v81, v237
  v_mfma_f32_16x16x32_bf16 v[148:151], a[36:39], a[108:111], v[148:151]
  ds_read_b128 a[120:123], v212 offset:49152
  v_cvt_pk_bf16_f32 v66, v236, v237
  v_mfma_f32_16x16x32_bf16 v[152:155], a[36:39], a[112:115], v[152:155]
  v_lshlrev_b32 v238, 16, v231
  v_and_b32 v239, s27, v231
  v_mfma_f32_16x16x32_bf16 v[156:159], a[36:39], a[116:119], v[156:159]
  s_waitcnt vmcnt(23)
  v_mfma_f32_16x16x32_bf16 v[160:163], a[40:43], a[104:107], v[160:163]
  buffer_load_dwordx4 a[36:39], v208, s[8:11], s20 offen offset:3072
  v_accvgpr_read_b32 v244, a171
  v_mfma_f32_16x16x32_bf16 v[164:167], a[40:43], a[108:111], v[164:167]
  ds_read_b128 a[124:127], v212 offset:53248
  v_lshlrev_b32 v242, 16, v244
  v_mfma_f32_16x16x32_bf16 v[168:171], a[40:43], a[112:115], v[168:171]
  v_and_b32 v243, s27, v244
  v_fma_f32 v238, v242, v82, v238
  v_mfma_f32_16x16x32_bf16 v[172:175], a[40:43], a[116:119], v[172:175]
  v_mfma_f32_16x16x32_bf16 v[176:179], a[44:47], a[104:107], v[176:179]
  s_add_u32 s20, s20, 4096
  buffer_load_dwordx4 a[40:43], v208, s[8:11], s20 offen
  v_fma_f32 v239, v243, v83, v239
  v_mfma_f32_16x16x32_bf16 v[180:183], a[44:47], a[108:111], v[180:183]
  ds_read_b128 a[128:131], v212 offset:57344
  v_cvt_pk_bf16_f32 v67, v238, v239
  v_mfma_f32_16x16x32_bf16 v[184:187], a[44:47], a[112:115], v[184:187]
  ds_read_b128 v[228:231], v219 offset:8192
  v_lshlrev_b32 v236, 16, v232
  v_mfma_f32_16x16x32_bf16 v[188:191], a[44:47], a[116:119], v[188:191]
  v_and_b32 v237, s27, v232
  s_waitcnt vmcnt(23)
  v_mfma_f32_16x16x32_bf16 v[192:195], a[48:51], a[104:107], v[192:195]
  buffer_load_dwordx4 a[44:47], v208, s[8:11], s20 offen offset:1024
  v_accvgpr_read_b32 v244, a172
  v_mfma_f32_16x16x32_bf16 v[196:199], a[48:51], a[108:111], v[196:199]
  ds_read_b128 a[132:135], v212 offset:61440
  v_lshlrev_b32 v240, 16, v244
  v_mfma_f32_16x16x32_bf16 v[200:203], a[48:51], a[112:115], v[200:203]
  v_and_b32 v241, s27, v244
  v_fma_f32 v236, v240, v68, v236
  v_mfma_f32_16x16x32_bf16 v[204:207], a[48:51], a[116:119], v[204:207]
  s_waitcnt lgkmcnt(0)
  v_mfma_f32_16x16x32_bf16 v[128:131], a[52:55], a[120:123], v[128:131]
  buffer_load_dwordx4 a[48:51], v208, s[8:11], s20 offen offset:2048
  v_mfma_f32_16x16x32_bf16 v[132:135], a[52:55], a[124:127], v[132:135]
  v_fma_f32 v237, v241, v69, v237
  v_cvt_pk_bf16_f32 v68, v236, v237
  v_mfma_f32_16x16x32_bf16 v[136:139], a[52:55], a[128:131], v[136:139]
  v_lshlrev_b32 v238, 16, v233
  v_and_b32 v239, s27, v233
  v_mfma_f32_16x16x32_bf16 v[140:143], a[52:55], a[132:135], v[140:143]
  s_waitcnt vmcnt(23)
  v_mfma_f32_16x16x32_bf16 v[144:147], a[56:59], a[120:123], v[144:147]
  buffer_load_dwordx4 a[52:55], v208, s[8:11], s20 offen offset:3072
  v_accvgpr_read_b32 v244, a173
  v_mfma_f32_16x16x32_bf16 v[148:151], a[56:59], a[124:127], v[148:151]
  ds_read_b128 a[104:107], v213
  v_lshlrev_b32 v242, 16, v244
  v_mfma_f32_16x16x32_bf16 v[152:155], a[56:59], a[128:131], v[152:155]
  v_and_b32 v243, s27, v244
  v_fma_f32 v238, v242, v70, v238
  v_mfma_f32_16x16x32_bf16 v[156:159], a[56:59], a[132:135], v[156:159]
  v_mfma_f32_16x16x32_bf16 v[160:163], a[60:63], a[120:123], v[160:163]
  s_add_u32 s20, s20, 4096
  buffer_load_dwordx4 a[56:59], v208, s[8:11], s20 offen
  v_mfma_f32_16x16x32_bf16 v[164:167], a[60:63], a[124:127], v[164:167]
  ds_read_b128 a[108:111], v213 offset:4096
  v_fma_f32 v239, v243, v71, v239
  v_mfma_f32_16x16x32_bf16 v[168:171], a[60:63], a[128:131], v[168:171]
  v_cvt_pk_bf16_f32 v69, v238, v239
  v_lshlrev_b32 v236, 16, v234
  v_mfma_f32_16x16x32_bf16 v[172:175], a[60:63], a[132:135], v[172:175]
  v_and_b32 v237, s27, v234
  s_waitcnt vmcnt(23)
  v_mfma_f32_16x16x32_bf16 v[176:179], a[64:67], a[120:123], v[176:179]
  buffer_load_dwordx4 a[60:63], v208, s[8:11], s20 offen offset:1024
  v_accvgpr_read_b32 v244, a174
  v_mfma_f32_16x16x32_bf16 v[180:183], a[64:67], a[124:127], v[180:183]
  ds_read_b128 a[112:115], v213 offset:8192
  v_lshlrev_b32 v240, 16, v244
  v_mfma_f32_16x16x32_bf16 v[184:187], a[64:67], a[128:131], v[184:187]
  v_and_b32 v241, s27, v244
  v_fma_f32 v236, v240, v84, v236
  v_mfma_f32_16x16x32_bf16 v[188:191], a[64:67], a[132:135], v[188:191]
  v_mfma_f32_16x16x32_bf16 v[192:195], a[68:71], a[120:123], v[192:195]
  buffer_load_dwordx4 a[64:67], v208, s[8:11], s20 offen offset:2048
  v_fma_f32 v237, v241, v85, v237
  v_mfma_f32_16x16x32_bf16 v[196:199], a[68:71], a[124:127], v[196:199]
  ds_read_b128 a[116:119], v213 offset:12288
  v_cvt_pk_bf16_f32 v70, v236, v237
  v_mfma_f32_16x16x32_bf16 v[200:203], a[68:71], a[128:131], v[200:203]
  v_lshlrev_b32 v238, 16, v235
  v_and_b32 v239, s27, v235
  v_mfma_f32_16x16x32_bf16 v[204:207], a[68:71], a[132:135], v[204:207]
  s_waitcnt vmcnt(23) lgkmcnt(0)
  v_mfma_f32_16x16x32_bf16 v[128:131], a[72:75], a[104:107], v[128:131]
  buffer_load_dwordx4 a[68:71], v208, s[8:11], s20 offen offset:3072
  v_mfma_f32_16x16x32_bf16 v[132:135], a[72:75], a[108:111], v[132:135]
  v_accvgpr_read_b32 v244, a175
  v_lshlrev_b32 v242, 16, v244
  v_mfma_f32_16x16x32_bf16 v[136:139], a[72:75], a[112:115], v[136:139]
  v_and_b32 v243, s27, v244
  v_fma_f32 v238, v242, v86, v238
  v_mfma_f32_16x16x32_bf16 v[140:143], a[72:75], a[116:119], v[140:143]
  v_mfma_f32_16x16x32_bf16 v[144:147], a[76:79], a[104:107], v[144:147]
  s_add_u32 s20, s20, 4096
  buffer_load_dwordx4 a[72:75], v208, s[8:11], s20 offen
  v_fma_f32 v239, v243, v87, v239
  v_mfma_f32_16x16x32_bf16 v[148:151], a[76:79], a[108:111], v[148:151]
  ds_read_b128 a[120:123], v214
  v_cvt_pk_bf16_f32 v71, v238, v239
  v_mfma_f32_16x16x32_bf16 v[152:155], a[76:79], a[112:115], v[152:155]
  ds_read_b128 v[232:235], v219 offset:12288
  v_lshlrev_b32 v236, 16, v228
  v_mfma_f32_16x16x32_bf16 v[156:159], a[76:79], a[116:119], v[156:159]
  v_and_b32 v237, s27, v228
  s_waitcnt vmcnt(23)
  v_mfma_f32_16x16x32_bf16 v[160:163], a[80:83], a[104:107], v[160:163]
  buffer_load_dwordx4 a[76:79], v208, s[8:11], s20 offen offset:1024
  v_accvgpr_read_b32 v244, a176
  v_mfma_f32_16x16x32_bf16 v[164:167], a[80:83], a[108:111], v[164:167]
  ds_read_b128 a[124:127], v214 offset:4096
  v_lshlrev_b32 v240, 16, v244
  v_mfma_f32_16x16x32_bf16 v[168:171], a[80:83], a[112:115], v[168:171]
  v_and_b32 v241, s27, v244
  v_fma_f32 v236, v240, v72, v236
  v_mfma_f32_16x16x32_bf16 v[172:175], a[80:83], a[116:119], v[172:175]
  v_mfma_f32_16x16x32_bf16 v[176:179], a[84:87], a[104:107], v[176:179]
  buffer_load_dwordx4 a[80:83], v208, s[8:11], s20 offen offset:2048
  v_fma_f32 v237, v241, v73, v237
  v_mfma_f32_16x16x32_bf16 v[180:183], a[84:87], a[108:111], v[180:183]
  ds_read_b128 a[128:131], v214 offset:8192
  v_cvt_pk_bf16_f32 v72, v236, v237
  v_mfma_f32_16x16x32_bf16 v[184:187], a[84:87], a[112:115], v[184:187]
  v_lshlrev_b32 v238, 16, v229
  v_and_b32 v239, s27, v229
  v_mfma_f32_16x16x32_bf16 v[188:191], a[84:87], a[116:119], v[188:191]
  s_waitcnt vmcnt(23)
  v_mfma_f32_16x16x32_bf16 v[192:195], a[88:91], a[104:107], v[192:195]
  buffer_load_dwordx4 a[84:87], v208, s[8:11], s20 offen offset:3072
  v_accvgpr_read_b32 v244, a177
  v_mfma_f32_16x16x32_bf16 v[196:199], a[88:91], a[108:111], v[196:199]
  ds_read_b128 a[132:135], v214 offset:12288
  v_lshlrev_b32 v242, 16, v244
  v_mfma_f32_16x16x32_bf16 v[200:203], a[88:91], a[112:115], v[200:203]
  v_and_b32 v243, s27, v244
  v_fma_f32 v238, v242, v74, v238
  v_mfma_f32_16x16x32_bf16 v[204:207], a[88:91], a[116:119], v[204:207]
  s_waitcnt lgkmcnt(0)
  v_mfma_f32_16x16x32_bf16 v[128:131], a[92:95], a[120:123], v[128:131]
  s_add_u32 s20, s20, 4096
  buffer_load_dwordx4 a[88:91], v208, s[8:11], s20 offen
  v_mfma_f32_16x16x32_bf16 v[132:135], a[92:95], a[124:127], v[132:135]
  v_fma_f32 v239, v243, v75, v239
  v_cvt_pk_bf16_f32 v73, v238, v239
  v_mfma_f32_16x16x32_bf16 v[136:139], a[92:95], a[128:131], v[136:139]
  v_lshlrev_b32 v236, 16, v230
  v_and_b32 v237, s27, v230
  v_mfma_f32_16x16x32_bf16 v[140:143], a[92:95], a[132:135], v[140:143]
  s_waitcnt vmcnt(23)
  v_mfma_f32_16x16x32_bf16 v[144:147], a[96:99], a[120:123], v[144:147]
  buffer_load_dwordx4 a[92:95], v208, s[8:11], s20 offen offset:1024
  v_accvgpr_read_b32 v244, a178
  v_mfma_f32_16x16x32_bf16 v[148:151], a[96:99], a[124:127], v[148:151]
  ds_read_b128 a[104:107], v215
  v_lshlrev_b32 v240, 16, v244
  v_mfma_f32_16x16x32_bf16 v[152:155], a[96:99], a[128:131], v[152:155]
  v_and_b32 v241, s27, v244
  v_fma_f32 v236, v240, v88, v236
  v_mfma_f32_16x16x32_bf16 v[156:159], a[96:99], a[132:135], v[156:159]
  v_mfma_f32_16x16x32_bf16 v[160:163], a[100:103], a[120:123], v[160:163]
  buffer_load_dwordx4 a[96:99], v208, s[8:11], s20 offen offset:2048
  v_fma_f32 v237, v241, v89, v237
  v_mfma_f32_16x16x32_bf16 v[164:167], a[100:103], a[124:127], v[164:167]
  ds_read_b128 a[108:111], v215 offset:4096
  v_cvt_pk_bf16_f32 v74, v236, v237
  v_mfma_f32_16x16x32_bf16 v[168:171], a[100:103], a[128:131], v[168:171]
  v_lshlrev_b32 v238, 16, v231
  v_and_b32 v239, s27, v231
  v_mfma_f32_16x16x32_bf16 v[172:175], a[100:103], a[132:135], v[172:175]
  s_waitcnt vmcnt(23)
  v_mfma_f32_16x16x32_bf16 v[176:179], a[0:3], a[120:123], v[176:179]
  buffer_load_dwordx4 a[100:103], v208, s[8:11], s20 offen offset:3072
  v_accvgpr_read_b32 v244, a179
  v_mfma_f32_16x16x32_bf16 v[180:183], a[0:3], a[124:127], v[180:183]
  ds_read_b128 a[112:115], v215 offset:8192
  v_lshlrev_b32 v242, 16, v244
  v_mfma_f32_16x16x32_bf16 v[184:187], a[0:3], a[128:131], v[184:187]
  v_and_b32 v243, s27, v244
  v_fma_f32 v238, v242, v90, v238
  v_mfma_f32_16x16x32_bf16 v[188:191], a[0:3], a[132:135], v[188:191]
  v_mfma_f32_16x16x32_bf16 v[192:195], a[4:7], a[120:123], v[192:195]
  s_add_u32 s20, s20, 4096
  buffer_load_dwordx4 a[0:3], v208, s[8:11], s20 offen
  v_fma_f32 v239, v243, v91, v239
  v_mfma_f32_16x16x32_bf16 v[196:199], a[4:7], a[124:127], v[196:199]
  ds_read_b128 a[116:119], v215 offset:12288
  v_cvt_pk_bf16_f32 v75, v238, v239
  v_mfma_f32_16x16x32_bf16 v[200:203], a[4:7], a[128:131], v[200:203]
  ds_read_b128 v[228:231], v220
  v_lshlrev_b32 v236, 16, v232
  v_mfma_f32_16x16x32_bf16 v[204:207], a[4:7], a[132:135], v[204:207]
  v_and_b32 v237, s27, v232
  s_waitcnt vmcnt(23) lgkmcnt(1)
  v_mfma_f32_16x16x32_bf16 v[128:131], a[8:11], a[104:107], v[128:131]
  buffer_load_dwordx4 a[4:7], v208, s[8:11], s20 offen offset:1024
  v_mfma_f32_16x16x32_bf16 v[132:135], a[8:11], a[108:111], v[132:135]
  v_accvgpr_read_b32 v244, a180
  v_lshlrev_b32 v240, 16, v244
  v_mfma_f32_16x16x32_bf16 v[136:139], a[8:11], a[112:115], v[136:139]
  v_and_b32 v241, s27, v244
  v_fma_f32 v236, v240, v76, v236
  v_mfma_f32_16x16x32_bf16 v[140:143], a[8:11], a[116:119], v[140:143]
  v_mfma_f32_16x16x32_bf16 v[144:147], a[12:15], a[104:107], v[144:147]
  buffer_load_dwordx4 a[8:11], v208, s[8:11], s20 offen offset:2048
  v_fma_f32 v237, v241, v77, v237
  v_mfma_f32_16x16x32_bf16 v[148:151], a[12:15], a[108:111], v[148:151]
  ds_read_b128 a[120:123], v216
  v_cvt_pk_bf16_f32 v76, v236, v237
  v_mfma_f32_16x16x32_bf16 v[152:155], a[12:15], a[112:115], v[152:155]
  v_lshlrev_b32 v238, 16, v233
  v_and_b32 v239, s27, v233
  v_mfma_f32_16x16x32_bf16 v[156:159], a[12:15], a[116:119], v[156:159]
  s_waitcnt vmcnt(23)
  v_mfma_f32_16x16x32_bf16 v[160:163], a[16:19], a[104:107], v[160:163]
  buffer_load_dwordx4 a[12:15], v208, s[8:11], s20 offen offset:3072
  v_accvgpr_read_b32 v244, a181
  v_mfma_f32_16x16x32_bf16 v[164:167], a[16:19], a[108:111], v[164:167]
  ds_read_b128 a[124:127], v216 offset:4096
  v_lshlrev_b32 v242, 16, v244
  v_mfma_f32_16x16x32_bf16 v[168:171], a[16:19], a[112:115], v[168:171]
  v_and_b32 v243, s27, v244
  v_fma_f32 v238, v242, v78, v238
  v_mfma_f32_16x16x32_bf16 v[172:175], a[16:19], a[116:119], v[172:175]
  v_mfma_f32_16x16x32_bf16 v[176:179], a[20:23], a[104:107], v[176:179]
  s_add_u32 s20, s20, 4096
  buffer_load_dwordx4 a[16:19], v208, s[8:11], s20 offen
  v_mfma_f32_16x16x32_bf16 v[180:183], a[20:23], a[108:111], v[180:183]
  ds_read_b128 a[128:131], v216 offset:8192
  v_fma_f32 v239, v243, v79, v239
  v_mfma_f32_16x16x32_bf16 v[184:187], a[20:23], a[112:115], v[184:187]
  v_cvt_pk_bf16_f32 v77, v238, v239
  v_lshlrev_b32 v236, 16, v234
  v_mfma_f32_16x16x32_bf16 v[188:191], a[20:23], a[116:119], v[188:191]
  v_and_b32 v237, s27, v234
  s_waitcnt vmcnt(23)
  v_mfma_f32_16x16x32_bf16 v[192:195], a[24:27], a[104:107], v[192:195]
  buffer_load_dwordx4 a[20:23], v208, s[8:11], s20 offen offset:1024
  v_accvgpr_read_b32 v244, a182
  v_mfma_f32_16x16x32_bf16 v[196:199], a[24:27], a[108:111], v[196:199]
  ds_read_b128 a[132:135], v216 offset:12288
  v_lshlrev_b32 v240, 16, v244
  v_mfma_f32_16x16x32_bf16 v[200:203], a[24:27], a[112:115], v[200:203]
  v_and_b32 v241, s27, v244
  v_fma_f32 v236, v240, v92, v236
  v_mfma_f32_16x16x32_bf16 v[204:207], a[24:27], a[116:119], v[204:207]
  s_waitcnt lgkmcnt(0)
  v_mfma_f32_16x16x32_bf16 v[128:131], a[28:31], a[120:123], v[128:131]
  buffer_load_dwordx4 a[24:27], v208, s[8:11], s20 offen offset:2048
  v_mfma_f32_16x16x32_bf16 v[132:135], a[28:31], a[124:127], v[132:135]
  v_fma_f32 v237, v241, v93, v237
  v_cvt_pk_bf16_f32 v78, v236, v237
  v_mfma_f32_16x16x32_bf16 v[136:139], a[28:31], a[128:131], v[136:139]
  v_lshlrev_b32 v238, 16, v235
  v_and_b32 v239, s27, v235
  v_mfma_f32_16x16x32_bf16 v[140:143], a[28:31], a[132:135], v[140:143]
  s_waitcnt vmcnt(23)
  v_mfma_f32_16x16x32_bf16 v[144:147], a[32:35], a[120:123], v[144:147]
  buffer_load_dwordx4 a[28:31], v208, s[8:11], s20 offen offset:3072
  v_accvgpr_read_b32 v244, a183
  v_mfma_f32_16x16x32_bf16 v[148:151], a[32:35], a[124:127], v[148:151]
  ds_read_b128 a[104:107], v213 offset:16384
  v_lshlrev_b32 v242, 16, v244
  v_mfma_f32_16x16x32_bf16 v[152:155], a[32:35], a[128:131], v[152:155]
  v_and_b32 v243, s27, v244
  v_fma_f32 v238, v242, v94, v238
  v_mfma_f32_16x16x32_bf16 v[156:159], a[32:35], a[132:135], v[156:159]
  v_mfma_f32_16x16x32_bf16 v[160:163], a[36:39], a[120:123], v[160:163]
  s_add_u32 s20, s20, 4096
  buffer_load_dwordx4 a[32:35], v208, s[8:11], s20 offen
  v_fma_f32 v239, v243, v95, v239
  v_mfma_f32_16x16x32_bf16 v[164:167], a[36:39], a[124:127], v[164:167]
  ds_read_b128 a[108:111], v213 offset:20480
  v_cvt_pk_bf16_f32 v79, v238, v239
  v_mfma_f32_16x16x32_bf16 v[168:171], a[36:39], a[128:131], v[168:171]
  ds_read_b128 v[84:87], v226 offset:6912
  ds_read_b128 v[80:83], v226 offset:6928
  v_mfma_f32_16x16x32_bf16 v[172:175], a[36:39], a[132:135], v[172:175]
  ds_read_b128 v[232:235], v220 offset:4096
  s_waitcnt vmcnt(23)
  v_mfma_f32_16x16x32_bf16 v[176:179], a[40:43], a[120:123], v[176:179]
  buffer_load_dwordx4 a[36:39], v208, s[8:11], s20 offen offset:1024
  v_lshlrev_b32 v236, 16, v228
  v_mfma_f32_16x16x32_bf16 v[180:183], a[40:43], a[124:127], v[180:183]
  ds_read_b128 a[112:115], v213 offset:24576
  v_and_b32 v237, s27, v228
  v_mfma_f32_16x16x32_bf16 v[184:187], a[40:43], a[128:131], v[184:187]
  v_accvgpr_read_b32 v244, a184
  v_lshlrev_b32 v240, 16, v244
  v_mfma_f32_16x16x32_bf16 v[188:191], a[40:43], a[132:135], v[188:191]
  v_mfma_f32_16x16x32_bf16 v[192:195], a[44:47], a[120:123], v[192:195]
  buffer_load_dwordx4 a[40:43], v208, s[8:11], s20 offen offset:2048
  v_and_b32 v241, s27, v244
  v_mfma_f32_16x16x32_bf16 v[196:199], a[44:47], a[124:127], v[196:199]
  ds_read_b128 a[116:119], v213 offset:28672
  v_fma_f32 v236, v240, v96, v236
  v_mfma_f32_16x16x32_bf16 v[200:203], a[44:47], a[128:131], v[200:203]
  v_fma_f32 v237, v241, v97, v237
  v_cvt_pk_bf16_f32 v96, v236, v237
  v_mfma_f32_16x16x32_bf16 v[204:207], a[44:47], a[132:135], v[204:207]
  s_waitcnt vmcnt(23) lgkmcnt(0)
  v_mfma_f32_16x16x32_bf16 v[128:131], a[48:51], a[104:107], v[128:131]
  buffer_load_dwordx4 a[44:47], v208, s[8:11], s20 offen offset:3072
  v_mfma_f32_16x16x32_bf16 v[132:135], a[48:51], a[108:111], v[132:135]
  v_lshlrev_b32 v238, 16, v229
  v_and_b32 v239, s27, v229
  v_mfma_f32_16x16x32_bf16 v[136:139], a[48:51], a[112:115], v[136:139]
  v_accvgpr_read_b32 v244, a185
  v_lshlrev_b32 v242, 16, v244
  v_mfma_f32_16x16x32_bf16 v[140:143], a[48:51], a[116:119], v[140:143]
  v_mfma_f32_16x16x32_bf16 v[144:147], a[52:55], a[104:107], v[144:147]
  s_add_u32 s20, s20, 4096
  buffer_load_dwordx4 a[48:51], v208, s[8:11], s20 offen
  v_mfma_f32_16x16x32_bf16 v[148:151], a[52:55], a[108:111], v[148:151]
  ds_read_b128 a[120:123], v214 offset:16384
  v_and_b32 v243, s27, v244
  v_mfma_f32_16x16x32_bf16 v[152:155], a[52:55], a[112:115], v[152:155]
  v_fma_f32 v238, v242, v98, v238
  v_fma_f32 v239, v243, v99, v239
  v_mfma_f32_16x16x32_bf16 v[156:159], a[52:55], a[116:119], v[156:159]
  v_cvt_pk_bf16_f32 v97, v238, v239
  s_waitcnt vmcnt(23)
  v_mfma_f32_16x16x32_bf16 v[160:163], a[56:59], a[104:107], v[160:163]
  buffer_load_dwordx4 a[52:55], v208, s[8:11], s20 offen offset:1024
  v_lshlrev_b32 v236, 16, v230
  v_mfma_f32_16x16x32_bf16 v[164:167], a[56:59], a[108:111], v[164:167]
  ds_read_b128 a[124:127], v214 offset:20480
  v_and_b32 v237, s27, v230
  v_mfma_f32_16x16x32_bf16 v[168:171], a[56:59], a[112:115], v[168:171]
  v_accvgpr_read_b32 v244, a186
  v_lshlrev_b32 v240, 16, v244
  v_mfma_f32_16x16x32_bf16 v[172:175], a[56:59], a[116:119], v[172:175]
  v_mfma_f32_16x16x32_bf16 v[176:179], a[60:63], a[104:107], v[176:179]
  buffer_load_dwordx4 a[56:59], v208, s[8:11], s20 offen offset:2048
  v_and_b32 v241, s27, v244
  v_mfma_f32_16x16x32_bf16 v[180:183], a[60:63], a[108:111], v[180:183]
  ds_read_b128 a[128:131], v214 offset:24576
  v_fma_f32 v236, v240, v112, v236
  v_mfma_f32_16x16x32_bf16 v[184:187], a[60:63], a[112:115], v[184:187]
  v_fma_f32 v237, v241, v113, v237
  v_cvt_pk_bf16_f32 v98, v236, v237
  v_mfma_f32_16x16x32_bf16 v[188:191], a[60:63], a[116:119], v[188:191]
  s_waitcnt vmcnt(23)
  v_mfma_f32_16x16x32_bf16 v[192:195], a[64:67], a[104:107], v[192:195]
  buffer_load_dwordx4 a[60:63], v208, s[8:11], s20 offen offset:3072
  v_lshlrev_b32 v238, 16, v231
  v_mfma_f32_16x16x32_bf16 v[196:199], a[64:67], a[108:111], v[196:199]
  ds_read_b128 a[132:135], v214 offset:28672
  v_and_b32 v239, s27, v231
  v_mfma_f32_16x16x32_bf16 v[200:203], a[64:67], a[112:115], v[200:203]
  v_accvgpr_read_b32 v244, a187
  v_lshlrev_b32 v242, 16, v244
  v_mfma_f32_16x16x32_bf16 v[204:207], a[64:67], a[116:119], v[204:207]
  s_waitcnt lgkmcnt(0)
  v_mfma_f32_16x16x32_bf16 v[128:131], a[68:71], a[120:123], v[128:131]
  s_add_u32 s20, s20, 4096
  buffer_load_dwordx4 a[64:67], v208, s[8:11], s20 offen
  v_mfma_f32_16x16x32_bf16 v[132:135], a[68:71], a[124:127], v[132:135]
  v_and_b32 v243, s27, v244
  v_fma_f32 v238, v242, v114, v238
  v_mfma_f32_16x16x32_bf16 v[136:139], a[68:71], a[128:131], v[136:139]
  v_fma_f32 v239, v243, v115, v239
  v_cvt_pk_bf16_f32 v99, v238, v239
  v_mfma_f32_16x16x32_bf16 v[140:143], a[68:71], a[132:135], v[140:143]
  ds_read_b128 v[228:231], v220 offset:8192
  s_waitcnt vmcnt(23)
  v_mfma_f32_16x16x32_bf16 v[144:147], a[72:75], a[120:123], v[144:147]
  buffer_load_dwordx4 a[68:71], v208, s[8:11], s20 offen offset:1024
  v_lshlrev_b32 v236, 16, v232
  v_mfma_f32_16x16x32_bf16 v[148:151], a[72:75], a[124:127], v[148:151]
  ds_read_b128 a[104:107], v215 offset:16384
  v_and_b32 v237, s27, v232
  v_mfma_f32_16x16x32_bf16 v[152:155], a[72:75], a[128:131], v[152:155]
  v_accvgpr_read_b32 v244, a188
  v_lshlrev_b32 v240, 16, v244
  v_mfma_f32_16x16x32_bf16 v[156:159], a[72:75], a[132:135], v[156:159]
  v_mfma_f32_16x16x32_bf16 v[160:163], a[76:79], a[120:123], v[160:163]
  buffer_load_dwordx4 a[72:75], v208, s[8:11], s20 offen offset:2048
  v_and_b32 v241, s27, v244
  v_mfma_f32_16x16x32_bf16 v[164:167], a[76:79], a[124:127], v[164:167]
  ds_read_b128 a[108:111], v215 offset:20480
  v_fma_f32 v236, v240, v100, v236
  v_mfma_f32_16x16x32_bf16 v[168:171], a[76:79], a[128:131], v[168:171]
  v_fma_f32 v237, v241, v101, v237
  v_cvt_pk_bf16_f32 v100, v236, v237
  v_mfma_f32_16x16x32_bf16 v[172:175], a[76:79], a[132:135], v[172:175]
  s_waitcnt vmcnt(23)
  v_mfma_f32_16x16x32_bf16 v[176:179], a[80:83], a[120:123], v[176:179]
  buffer_load_dwordx4 a[76:79], v208, s[8:11], s20 offen offset:3072
  v_lshlrev_b32 v238, 16, v233
  v_mfma_f32_16x16x32_bf16 v[180:183], a[80:83], a[124:127], v[180:183]
  ds_read_b128 a[112:115], v215 offset:24576
  v_and_b32 v239, s27, v233
  v_mfma_f32_16x16x32_bf16 v[184:187], a[80:83], a[128:131], v[184:187]
  v_accvgpr_read_b32 v244, a189
  v_lshlrev_b32 v242, 16, v244
  v_mfma_f32_16x16x32_bf16 v[188:191], a[80:83], a[132:135], v[188:191]
  v_mfma_f32_16x16x32_bf16 v[192:195], a[84:87], a[120:123], v[192:195]
  s_add_u32 s20, s20, 4096
  buffer_load_dwordx4 a[80:83], v208, s[8:11], s20 offen
  v_mfma_f32_16x16x32_bf16 v[196:199], a[84:87], a[124:127], v[196:199]
  ds_read_b128 a[116:119], v215 offset:28672
  v_and_b32 v243, s27, v244
  v_mfma_f32_16x16x32_bf16 v[200:203], a[84:87], a[128:131], v[200:203]
  v_fma_f32 v238, v242, v102, v238
  v_fma_f32 v239, v243, v103, v239
  v_mfma_f32_16x16x32_bf16 v[204:207], a[84:87], a[132:135], v[204:207]
  v_cvt_pk_bf16_f32 v101, v238, v239
  s_waitcnt vmcnt(23) lgkmcnt(0)
  v_mfma_f32_16x16x32_bf16 v[128:131], a[88:91], a[104:107], v[128:131]
  buffer_load_dwordx4 a[84:87], v208, s[8:11], s20 offen offset:1024
  v_mfma_f32_16x16x32_bf16 v[132:135], a[88:91], a[108:111], v[132:135]
  v_lshlrev_b32 v236, 16, v234
  v_and_b32 v237, s27, v234
  v_mfma_f32_16x16x32_bf16 v[136:139], a[88:91], a[112:115], v[136:139]
  v_accvgpr_read_b32 v244, a190
  v_lshlrev_b32 v240, 16, v244
  v_mfma_f32_16x16x32_bf16 v[140:143], a[88:91], a[116:119], v[140:143]
  v_mfma_f32_16x16x32_bf16 v[144:147], a[92:95], a[104:107], v[144:147]
  buffer_load_dwordx4 a[88:91], v208, s[8:11], s20 offen offset:2048
  v_and_b32 v241, s27, v244
  v_mfma_f32_16x16x32_bf16 v[148:151], a[92:95], a[108:111], v[148:151]
  ds_read_b128 a[120:123], v216 offset:16384
  v_fma_f32 v236, v240, v116, v236
  v_mfma_f32_16x16x32_bf16 v[152:155], a[92:95], a[112:115], v[152:155]
  v_fma_f32 v237, v241, v117, v237
  v_cvt_pk_bf16_f32 v102, v236, v237
  v_mfma_f32_16x16x32_bf16 v[156:159], a[92:95], a[116:119], v[156:159]
  s_waitcnt vmcnt(23)
  v_mfma_f32_16x16x32_bf16 v[160:163], a[96:99], a[104:107], v[160:163]
  buffer_load_dwordx4 a[92:95], v208, s[8:11], s20 offen offset:3072
  v_lshlrev_b32 v238, 16, v235
  v_mfma_f32_16x16x32_bf16 v[164:167], a[96:99], a[108:111], v[164:167]
  ds_read_b128 a[124:127], v216 offset:20480
  v_and_b32 v239, s27, v235
  v_mfma_f32_16x16x32_bf16 v[168:171], a[96:99], a[112:115], v[168:171]
  v_accvgpr_read_b32 v244, a191
  v_lshlrev_b32 v242, 16, v244
  v_mfma_f32_16x16x32_bf16 v[172:175], a[96:99], a[116:119], v[172:175]
  v_mfma_f32_16x16x32_bf16 v[176:179], a[100:103], a[104:107], v[176:179]
  s_add_u32 s20, s20, 4096
  buffer_load_dwordx4 a[96:99], v208, s[8:11], s20 offen
  v_and_b32 v243, s27, v244
  v_mfma_f32_16x16x32_bf16 v[180:183], a[100:103], a[108:111], v[180:183]
  ds_read_b128 a[128:131], v216 offset:24576
  v_fma_f32 v238, v242, v118, v238
  v_mfma_f32_16x16x32_bf16 v[184:187], a[100:103], a[112:115], v[184:187]
  v_fma_f32 v239, v243, v119, v239
  v_cvt_pk_bf16_f32 v103, v238, v239
  v_mfma_f32_16x16x32_bf16 v[188:191], a[100:103], a[116:119], v[188:191]
  ds_read_b128 v[232:235], v220 offset:12288
  s_waitcnt vmcnt(23)
  v_mfma_f32_16x16x32_bf16 v[192:195], a[0:3], a[104:107], v[192:195]
  buffer_load_dwordx4 a[100:103], v208, s[8:11], s20 offen offset:1024
  v_lshlrev_b32 v236, 16, v228
  v_mfma_f32_16x16x32_bf16 v[196:199], a[0:3], a[108:111], v[196:199]
  ds_read_b128 a[132:135], v216 offset:28672
  v_and_b32 v237, s27, v228
  v_mfma_f32_16x16x32_bf16 v[200:203], a[0:3], a[112:115], v[200:203]
  v_accvgpr_read_b32 v244, a192
  v_lshlrev_b32 v240, 16, v244
  v_mfma_f32_16x16x32_bf16 v[204:207], a[0:3], a[116:119], v[204:207]
  s_waitcnt lgkmcnt(0)
  v_mfma_f32_16x16x32_bf16 v[128:131], a[4:7], a[120:123], v[128:131]
  buffer_load_dwordx4 a[0:3], v208, s[8:11], s20 offen offset:2048
  v_mfma_f32_16x16x32_bf16 v[132:135], a[4:7], a[124:127], v[132:135]
  v_and_b32 v241, s27, v244
  v_fma_f32 v236, v240, v104, v236
  v_mfma_f32_16x16x32_bf16 v[136:139], a[4:7], a[128:131], v[136:139]
  v_fma_f32 v237, v241, v105, v237
  v_cvt_pk_bf16_f32 v104, v236, v237
  v_mfma_f32_16x16x32_bf16 v[140:143], a[4:7], a[132:135], v[140:143]
  s_waitcnt vmcnt(23)
  v_mfma_f32_16x16x32_bf16 v[144:147], a[8:11], a[120:123], v[144:147]
  buffer_load_dwordx4 a[4:7], v208, s[8:11], s20 offen offset:3072
  v_lshlrev_b32 v238, 16, v229
  v_mfma_f32_16x16x32_bf16 v[148:151], a[8:11], a[124:127], v[148:151]
  ds_read_b128 a[104:107], v213 offset:32768
  v_and_b32 v239, s27, v229
  v_mfma_f32_16x16x32_bf16 v[152:155], a[8:11], a[128:131], v[152:155]
  v_accvgpr_read_b32 v244, a193
  v_lshlrev_b32 v242, 16, v244
  v_mfma_f32_16x16x32_bf16 v[156:159], a[8:11], a[132:135], v[156:159]
  v_mfma_f32_16x16x32_bf16 v[160:163], a[12:15], a[120:123], v[160:163]
  s_add_u32 s20, s20, 4096
  buffer_load_dwordx4 a[8:11], v208, s[8:11], s20 offen
  v_mfma_f32_16x16x32_bf16 v[164:167], a[12:15], a[124:127], v[164:167]
  ds_read_b128 a[108:111], v213 offset:36864
  v_and_b32 v243, s27, v244
  v_mfma_f32_16x16x32_bf16 v[168:171], a[12:15], a[128:131], v[168:171]
  v_fma_f32 v238, v242, v106, v238
  v_fma_f32 v239, v243, v107, v239
  v_mfma_f32_16x16x32_bf16 v[172:175], a[12:15], a[132:135], v[172:175]
  v_cvt_pk_bf16_f32 v105, v238, v239
  s_waitcnt vmcnt(23)
  v_mfma_f32_16x16x32_bf16 v[176:179], a[16:19], a[120:123], v[176:179]
  buffer_load_dwordx4 a[12:15], v208, s[8:11], s20 offen offset:1024
  v_lshlrev_b32 v236, 16, v230
  v_mfma_f32_16x16x32_bf16 v[180:183], a[16:19], a[124:127], v[180:183]
  ds_read_b128 a[112:115], v213 offset:40960
  v_and_b32 v237, s27, v230
  v_mfma_f32_16x16x32_bf16 v[184:187], a[16:19], a[128:131], v[184:187]
  v_accvgpr_read_b32 v244, a194
  v_lshlrev_b32 v240, 16, v244
  v_mfma_f32_16x16x32_bf16 v[188:191], a[16:19], a[132:135], v[188:191]
  v_mfma_f32_16x16x32_bf16 v[192:195], a[20:23], a[120:123], v[192:195]
  buffer_load_dwordx4 a[16:19], v208, s[8:11], s20 offen offset:2048
  v_and_b32 v241, s27, v244
  v_mfma_f32_16x16x32_bf16 v[196:199], a[20:23], a[124:127], v[196:199]
  ds_read_b128 a[116:119], v213 offset:45056
  v_fma_f32 v236, v240, v120, v236
  v_mfma_f32_16x16x32_bf16 v[200:203], a[20:23], a[128:131], v[200:203]
  v_fma_f32 v237, v241, v121, v237
  v_cvt_pk_bf16_f32 v106, v236, v237
  v_mfma_f32_16x16x32_bf16 v[204:207], a[20:23], a[132:135], v[204:207]
  s_waitcnt vmcnt(23) lgkmcnt(0)
  v_mfma_f32_16x16x32_bf16 v[128:131], a[24:27], a[104:107], v[128:131]
  buffer_load_dwordx4 a[20:23], v208, s[8:11], s20 offen offset:3072
  v_mfma_f32_16x16x32_bf16 v[132:135], a[24:27], a[108:111], v[132:135]
  v_lshlrev_b32 v238, 16, v231
  v_and_b32 v239, s27, v231
  v_mfma_f32_16x16x32_bf16 v[136:139], a[24:27], a[112:115], v[136:139]
  v_accvgpr_read_b32 v244, a195
  v_lshlrev_b32 v242, 16, v244
  v_mfma_f32_16x16x32_bf16 v[140:143], a[24:27], a[116:119], v[140:143]
  v_mfma_f32_16x16x32_bf16 v[144:147], a[28:31], a[104:107], v[144:147]
  s_add_u32 s20, s20, 4096
  buffer_load_dwordx4 a[24:27], v208, s[8:11], s20 offen
  v_and_b32 v243, s27, v244
  v_mfma_f32_16x16x32_bf16 v[148:151], a[28:31], a[108:111], v[148:151]
  ds_read_b128 a[120:123], v214 offset:32768
  v_fma_f32 v238, v242, v122, v238
  v_mfma_f32_16x16x32_bf16 v[152:155], a[28:31], a[112:115], v[152:155]
  v_fma_f32 v239, v243, v123, v239
  v_cvt_pk_bf16_f32 v107, v238, v239
  v_mfma_f32_16x16x32_bf16 v[156:159], a[28:31], a[116:119], v[156:159]
  v_lshlrev_b32 v236, 16, v232
  s_waitcnt vmcnt(23)
  v_mfma_f32_16x16x32_bf16 v[160:163], a[32:35], a[104:107], v[160:163]
  buffer_load_dwordx4 a[28:31], v208, s[8:11], s20 offen offset:1024
  v_and_b32 v237, s27, v232
  v_mfma_f32_16x16x32_bf16 v[164:167], a[32:35], a[108:111], v[164:167]
  ds_read_b128 a[124:127], v214 offset:36864
  v_accvgpr_read_b32 v244, a196
  v_mfma_f32_16x16x32_bf16 v[168:171], a[32:35], a[112:115], v[168:171]
  v_lshlrev_b32 v240, 16, v244
  v_and_b32 v241, s27, v244
  v_mfma_f32_16x16x32_bf16 v[172:175], a[32:35], a[116:119], v[172:175]
  v_mfma_f32_16x16x32_bf16 v[176:179], a[36:39], a[104:107], v[176:179]
  buffer_load_dwordx4 a[32:35], v208, s[8:11], s20 offen offset:2048
  v_fma_f32 v236, v240, v108, v236
  v_mfma_f32_16x16x32_bf16 v[180:183], a[36:39], a[108:111], v[180:183]
  ds_read_b128 a[128:131], v214 offset:40960
  v_fma_f32 v237, v241, v109, v237
  v_mfma_f32_16x16x32_bf16 v[184:187], a[36:39], a[112:115], v[184:187]
  v_cvt_pk_bf16_f32 v108, v236, v237
  v_lshlrev_b32 v238, 16, v233
  v_mfma_f32_16x16x32_bf16 v[188:191], a[36:39], a[116:119], v[188:191]
  s_waitcnt vmcnt(23)
  v_mfma_f32_16x16x32_bf16 v[192:195], a[40:43], a[104:107], v[192:195]
  buffer_load_dwordx4 a[36:39], v208, s[8:11], s20 offen offset:3072
  v_and_b32 v239, s27, v233
  v_mfma_f32_16x16x32_bf16 v[196:199], a[40:43], a[108:111], v[196:199]
  ds_read_b128 a[132:135], v214 offset:45056
  v_accvgpr_read_b32 v244, a197
  v_mfma_f32_16x16x32_bf16 v[200:203], a[40:43], a[112:115], v[200:203]
  v_lshlrev_b32 v242, 16, v244
  v_and_b32 v243, s27, v244
  v_mfma_f32_16x16x32_bf16 v[204:207], a[40:43], a[116:119], v[204:207]
  s_waitcnt lgkmcnt(0)
  v_mfma_f32_16x16x32_bf16 v[128:131], a[44:47], a[120:123], v[128:131]
  s_add_u32 s20, s20, 4096
  buffer_load_dwordx4 a[40:43], v208, s[8:11], s20 offen
  v_mfma_f32_16x16x32_bf16 v[132:135], a[44:47], a[124:127], v[132:135]
  v_fma_f32 v238, v242, v110, v238
  v_fma_f32 v239, v243, v111, v239
  v_mfma_f32_16x16x32_bf16 v[136:139], a[44:47], a[128:131], v[136:139]
  v_cvt_pk_bf16_f32 v109, v238, v239
  v_lshlrev_b32 v236, 16, v234
  v_mfma_f32_16x16x32_bf16 v[140:143], a[44:47], a[132:135], v[140:143]
  s_waitcnt vmcnt(23)
  v_mfma_f32_16x16x32_bf16 v[144:147], a[48:51], a[120:123], v[144:147]
  buffer_load_dwordx4 a[44:47], v208, s[8:11], s20 offen offset:1024
  v_mfma_f32_16x16x32_bf16 v[148:151], a[48:51], a[124:127], v[148:151]
  v_and_b32 v237, s27, v234
  v_accvgpr_read_b32 v244, a198
  v_mfma_f32_16x16x32_bf16 v[152:155], a[48:51], a[128:131], v[152:155]
  v_lshlrev_b32 v240, 16, v244
  v_and_b32 v241, s27, v244
  v_mfma_f32_16x16x32_bf16 v[156:159], a[48:51], a[132:135], v[156:159]
  v_mfma_f32_16x16x32_bf16 v[160:163], a[52:55], a[120:123], v[160:163]
  buffer_load_dwordx4 a[48:51], v208, s[8:11], s20 offen offset:2048
  v_mfma_f32_16x16x32_bf16 v[164:167], a[52:55], a[124:127], v[164:167]
  v_fma_f32 v236, v240, v124, v236
  v_fma_f32 v237, v241, v125, v237
  v_mfma_f32_16x16x32_bf16 v[168:171], a[52:55], a[128:131], v[168:171]
  v_cvt_pk_bf16_f32 v110, v236, v237
  v_lshlrev_b32 v238, 16, v235
  v_mfma_f32_16x16x32_bf16 v[172:175], a[52:55], a[132:135], v[172:175]
  s_waitcnt vmcnt(23)
  v_mfma_f32_16x16x32_bf16 v[176:179], a[56:59], a[120:123], v[176:179]
  buffer_load_dwordx4 a[52:55], v208, s[8:11], s20 offen offset:3072
  v_mfma_f32_16x16x32_bf16 v[180:183], a[56:59], a[124:127], v[180:183]
  v_and_b32 v239, s27, v235
  v_accvgpr_read_b32 v244, a199
  v_mfma_f32_16x16x32_bf16 v[184:187], a[56:59], a[128:131], v[184:187]
  v_lshlrev_b32 v242, 16, v244
  v_and_b32 v243, s27, v244
  v_mfma_f32_16x16x32_bf16 v[188:191], a[56:59], a[132:135], v[188:191]
  v_mfma_f32_16x16x32_bf16 v[192:195], a[60:63], a[120:123], v[192:195]
  s_add_u32 s20, s20, 4096
  buffer_load_dwordx4 a[56:59], v208, s[8:11], s20 offen
  v_mfma_f32_16x16x32_bf16 v[196:199], a[60:63], a[124:127], v[196:199]
  v_fma_f32 v238, v242, v126, v238
  v_fma_f32 v239, v243, v127, v239
  v_mfma_f32_16x16x32_bf16 v[200:203], a[60:63], a[128:131], v[200:203]
  v_cvt_pk_bf16_f32 v111, v238, v239
  ds_read_b128 v[116:119], v226 offset:7040
  v_mfma_f32_16x16x32_bf16 v[204:207], a[60:63], a[132:135], v[204:207]
  ds_read_b128 v[112:115], v226 offset:7056
  s_waitcnt lgkmcnt(0)
  s_barrier
  ds_write_b128 v217, v[0:3]
  ds_write_b128 v217, v[4:7] offset:4096
  ds_write_b128 v217, v[8:11] offset:8192
  ds_write_b128 v217, v[12:15] offset:12288
  ds_write_b128 v218, v[32:35]
  ds_write_b128 v218, v[36:39] offset:4096
  ds_write_b128 v218, v[40:43] offset:8192
  ds_write_b128 v218, v[44:47] offset:12288
  ds_write_b128 v219, v[64:67]
  ds_write_b128 v219, v[68:71] offset:4096
  ds_write_b128 v219, v[72:75] offset:8192
  ds_write_b128 v219, v[76:79] offset:12288
  ds_write_b128 v220, v[96:99]
  ds_write_b128 v220, v[100:103] offset:4096
  ds_write_b128 v220, v[104:107] offset:8192
  ds_write_b128 v220, v[108:111] offset:12288
  s_waitcnt lgkmcnt(0)
  s_barrier
  ds_read_b128 a[104:107], v209
  ds_read_b128 a[108:111], v209 offset:4096
  ds_read_b128 a[112:115], v209 offset:8192
  ds_read_b128 a[116:119], v209 offset:12288
  s_waitcnt vmcnt(23) lgkmcnt(0)
  v_mfma_f32_16x16x32_bf16 v[12:15], a[64:67], a[116:119], v[20:23]
  buffer_load_dwordx4 a[60:63], v208, s[8:11], s20 offen offset:1024
  v_mfma_f32_16x16x32_bf16 v[8:11], a[64:67], a[112:115], v[20:23]
  ds_read_b128 v[228:231], v221
  v_mfma_f32_16x16x32_bf16 v[4:7], a[64:67], a[108:111], v[20:23]
  ds_read_b128 v[232:235], v221 offset:4096
  s_waitcnt lgkmcnt(1)
  v_lshlrev_b32 v236, 16, v228
  v_mfma_f32_16x16x32_bf16 v[0:3], a[64:67], a[104:107], v[20:23]
  v_mfma_f32_16x16x32_bf16 v[28:31], a[68:71], a[116:119], v[16:19]
  buffer_load_dwordx4 a[64:67], v208, s[8:11], s20 offen offset:2048
  v_mfma_f32_16x16x32_bf16 v[24:27], a[68:71], a[112:115], v[16:19]
  ds_read_b128 a[120:123], v210
  v_and_b32 v237, s27, v228
  v_mfma_f32_16x16x32_bf16 v[20:23], a[68:71], a[108:111], v[16:19]
  v_accvgpr_read_b32 v244, a200
  v_lshlrev_b32 v240, 16, v244
  v_mfma_f32_16x16x32_bf16 v[16:19], a[68:71], a[104:107], v[16:19]
  s_waitcnt vmcnt(23)
  v_mfma_f32_16x16x32_bf16 v[44:47], a[72:75], a[116:119], v[52:55]
  buffer_load_dwordx4 a[68:71], v208, s[8:11], s20 offen offset:3072
  v_and_b32 v241, s27, v244
  v_mfma_f32_16x16x32_bf16 v[40:43], a[72:75], a[112:115], v[52:55]
  ds_read_b128 a[124:127], v210 offset:4096
  v_fma_f32 v236, v240, v128, v236
  v_mfma_f32_16x16x32_bf16 v[36:39], a[72:75], a[108:111], v[52:55]
  v_fma_f32 v237, v241, v129, v237
  v_cvt_pk_bf16_f32 v228, v236, v237
  v_mfma_f32_16x16x32_bf16 v[32:35], a[72:75], a[104:107], v[52:55]
  v_mfma_f32_16x16x32_bf16 v[60:63], a[76:79], a[116:119], v[48:51]
  s_add_u32 s20, s20, 4096
  buffer_load_dwordx4 a[72:75], v208, s[8:11], s20 offen
  v_mfma_f32_16x16x32_bf16 v[56:59], a[76:79], a[112:115], v[48:51]
  ds_read_b128 a[128:131], v210 offset:8192
  v_lshlrev_b32 v238, 16, v229
  v_mfma_f32_16x16x32_bf16 v[52:55], a[76:79], a[108:111], v[48:51]
  v_and_b32 v239, s27, v229
  v_accvgpr_read_b32 v244, a201
  v_mfma_f32_16x16x32_bf16 v[48:51], a[76:79], a[104:107], v[48:51]
  s_waitcnt vmcnt(23)
  v_mfma_f32_16x16x32_bf16 v[76:79], a[80:83], a[116:119], v[84:87]
  buffer_load_dwordx4 a[76:79], v208, s[8:11], s20 offen offset:1024
  v_mfma_f32_16x16x32_bf16 v[72:75], a[80:83], a[112:115], v[84:87]
  ds_read_b128 a[132:135], v210 offset:12288
  v_lshlrev_b32 v242, 16, v244
  v_mfma_f32_16x16x32_bf16 v[68:71], a[80:83], a[108:111], v[84:87]
  v_and_b32 v243, s27, v244
  v_fma_f32 v238, v242, v130, v238
  v_mfma_f32_16x16x32_bf16 v[64:67], a[80:83], a[104:107], v[84:87]
  v_mfma_f32_16x16x32_bf16 v[92:95], a[84:87], a[116:119], v[80:83]
  buffer_load_dwordx4 a[80:83], v208, s[8:11], s20 offen offset:2048
  v_mfma_f32_16x16x32_bf16 v[88:91], a[84:87], a[112:115], v[80:83]
  v_fma_f32 v239, v243, v131, v239
  v_cvt_pk_bf16_f32 v229, v238, v239
  v_mfma_f32_16x16x32_bf16 v[84:87], a[84:87], a[108:111], v[80:83]
  v_lshlrev_b32 v236, 16, v230
  v_and_b32 v237, s27, v230
  v_mfma_f32_16x16x32_bf16 v[80:83], a[84:87], a[104:107], v[80:83]
  s_waitcnt vmcnt(23)
  v_mfma_f32_16x16x32_bf16 v[108:111], a[88:91], a[116:119], v[116:119]
  buffer_load_dwordx4 a[84:87], v208, s[8:11], s20 offen offset:3072
  v_mfma_f32_16x16x32_bf16 v[104:107], a[88:91], a[112:115], v[116:119]
  v_accvgpr_read_b32 v244, a202
  v_mfma_f32_16x16x32_bf16 v[100:103], a[88:91], a[108:111], v[116:119]
  v_lshlrev_b32 v240, 16, v244
  v_and_b32 v241, s27, v244
  v_mfma_f32_16x16x32_bf16 v[96:99], a[88:91], a[104:107], v[116:119]
  v_mfma_f32_16x16x32_bf16 v[124:127], a[92:95], a[116:119], v[112:115]
  s_add_u32 s20, s20, 4096
  buffer_load_dwordx4 a[88:91], v208, s[8:11], s20 offen
  v_mfma_f32_16x16x32_bf16 v[120:123], a[92:95], a[112:115], v[112:115]
  v_fma_f32 v236, v240, v144, v236
  v_mfma_f32_16x16x32_bf16 v[116:119], a[92:95], a[108:111], v[112:115]
  v_fma_f32 v237, v241, v145, v237
  v_cvt_pk_bf16_f32 v230, v236, v237
  v_mfma_f32_16x16x32_bf16 v[112:115], a[92:95], a[104:107], v[112:115]
  s_waitcnt vmcnt(23) lgkmcnt(0)
  v_mfma_f32_16x16x32_bf16 v[0:3], a[96:99], a[120:123], v[0:3]
  buffer_load_dwordx4 a[92:95], v208, s[8:11], s20 offen offset:1024
  v_mfma_f32_16x16x32_bf16 v[4:7], a[96:99], a[124:127], v[4:7]
  v_lshlrev_b32 v238, 16, v231
  v_and_b32 v239, s27, v231
  v_mfma_f32_16x16x32_bf16 v[8:11], a[96:99], a[128:131], v[8:11]
  v_accvgpr_read_b32 v244, a203
  v_lshlrev_b32 v242, 16, v244
  v_mfma_f32_16x16x32_bf16 v[12:15], a[96:99], a[132:135], v[12:15]
  v_mfma_f32_16x16x32_bf16 v[16:19], a[100:103], a[120:123], v[16:19]
  buffer_load_dwordx4 a[96:99], v208, s[8:11], s20 offen offset:2048
  v_mfma_f32_16x16x32_bf16 v[20:23], a[100:103], a[124:127], v[20:23]
  ds_read_b128 a[104:107], v211
  v_and_b32 v243, s27, v244
  v_mfma_f32_16x16x32_bf16 v[24:27], a[100:103], a[128:131], v[24:27]
  v_fma_f32 v238, v242, v146, v238
  v_fma_f32 v239, v243, v147, v239
  v_mfma_f32_16x16x32_bf16 v[28:31], a[100:103], a[132:135], v[28:31]
  s_waitcnt vmcnt(23)
  v_mfma_f32_16x16x32_bf16 v[32:35], a[0:3], a[120:123], v[32:35]
  buffer_load_dwordx4 a[100:103], v208, s[8:11], s20 offen offset:3072
  v_mfma_f32_16x16x32_bf16 v[36:39], a[0:3], a[124:127], v[36:39]
  ds_read_b128 a[108:111], v211 offset:4096
  v_cvt_pk_bf16_f32 v231, v238, v239
  v_mfma_f32_16x16x32_bf16 v[40:43], a[0:3], a[128:131], v[40:43]
  ds_write_b128 v221, v[228:231]
  ds_read_b128 v[228:231], v221 offset:8192
  v_mfma_f32_16x16x32_bf16 v[44:47], a[0:3], a[132:135], v[44:47]
  v_mfma_f32_16x16x32_bf16 v[48:51], a[4:7], a[120:123], v[48:51]
  s_add_u32 s20, s20, 4096
  buffer_load_dwordx4 a[0:3], v208, s[8:11], s20 offen
  v_mfma_f32_16x16x32_bf16 v[52:55], a[4:7], a[124:127], v[52:55]
  ds_read_b128 a[112:115], v211 offset:8192
  v_lshlrev_b32 v236, 16, v232
  v_mfma_f32_16x16x32_bf16 v[56:59], a[4:7], a[128:131], v[56:59]
  v_and_b32 v237, s27, v232
  v_accvgpr_read_b32 v244, a204
  v_mfma_f32_16x16x32_bf16 v[60:63], a[4:7], a[132:135], v[60:63]
  v_lshlrev_b32 v240, 16, v244
  s_waitcnt vmcnt(23)
  v_mfma_f32_16x16x32_bf16 v[64:67], a[8:11], a[120:123], v[64:67]
  buffer_load_dwordx4 a[4:7], v208, s[8:11], s20 offen offset:1024
  v_mfma_f32_16x16x32_bf16 v[68:71], a[8:11], a[124:127], v[68:71]
  ds_read_b128 a[116:119], v211 offset:12288
  v_and_b32 v241, s27, v244
  v_mfma_f32_16x16x32_bf16 v[72:75], a[8:11], a[128:131], v[72:75]
  v_fma_f32 v236, v240, v132, v236
  v_fma_f32 v237, v241, v133, v237
  v_mfma_f32_16x16x32_bf16 v[76:79], a[8:11], a[132:135], v[76:79]
  v_mfma_f32_16x16x32_bf16 v[80:83], a[12:15], a[120:123], v[80:83]
  buffer_load_dwordx4 a[8:11], v208, s[8:11], s20 offen offset:2048
  v_mfma_f32_16x16x32_bf16 v[84:87], a[12:15], a[124:127], v[84:87]
  v_cvt_pk_bf16_f32 v232, v236, v237
  v_mfma_f32_16x16x32_bf16 v[88:91], a[12:15], a[128:131], v[88:91]
  v_lshlrev_b32 v238, 16, v233
  v_and_b32 v239, s27, v233
  v_mfma_f32_16x16x32_bf16 v[92:95], a[12:15], a[132:135], v[92:95]
  s_waitcnt vmcnt(23)
  v_mfma_f32_16x16x32_bf16 v[96:99], a[16:19], a[120:123], v[96:99]
  buffer_load_dwordx4 a[12:15], v208, s[8:11], s20 offen offset:3072
  v_mfma_f32_16x16x32_bf16 v[100:103], a[16:19], a[124:127], v[100:103]
  v_accvgpr_read_b32 v244, a205
  v_lshlrev_b32 v242, 16, v244
  v_mfma_f32_16x16x32_bf16 v[104:107], a[16:19], a[128:131], v[104:107]
  v_and_b32 v243, s27, v244
  v_fma_f32 v238, v242, v134, v238
  v_mfma_f32_16x16x32_bf16 v[108:111], a[16:19], a[132:135], v[108:111]
  v_mfma_f32_16x16x32_bf16 v[112:115], a[20:23], a[120:123], v[112:115]
  s_add_u32 s20, s20, 4096
  buffer_load_dwordx4 a[16:19], v208, s[8:11], s20 offen
  v_mfma_f32_16x16x32_bf16 v[116:119], a[20:23], a[124:127], v[116:119]
  v_fma_f32 v239, v243, v135, v239
  v_mfma_f32_16x16x32_bf16 v[120:123], a[20:23], a[128:131], v[120:123]
  v_cvt_pk_bf16_f32 v233, v238, v239
  v_lshlrev_b32 v236, 16, v234
  v_mfma_f32_16x16x32_bf16 v[124:127], a[20:23], a[132:135], v[124:127]
  s_waitcnt vmcnt(23) lgkmcnt(0)
  v_mfma_f32_16x16x32_bf16 v[0:3], a[24:27], a[104:107], v[0:3]
  buffer_load_dwordx4 a[20:23], v208, s[8:11], s20 offen offset:1024
  v_mfma_f32_16x16x32_bf16 v[4:7], a[24:27], a[108:111], v[4:7]
  v_and_b32 v237, s27, v234
  v_accvgpr_read_b32 v244, a206
  v_mfma_f32_16x16x32_bf16 v[8:11], a[24:27], a[112:115], v[8:11]
  v_lshlrev_b32 v240, 16, v244
  v_and_b32 v241, s27, v244
  v_mfma_f32_16x16x32_bf16 v[12:15], a[24:27], a[116:119], v[12:15]
  v_mfma_f32_16x16x32_bf16 v[16:19], a[28:31], a[104:107], v[16:19]
  buffer_load_dwordx4 a[24:27], v208, s[8:11], s20 offen offset:2048
  v_mfma_f32_16x16x32_bf16 v[20:23], a[28:31], a[108:111], v[20:23]
  ds_read_b128 a[120:123], v212
  v_fma_f32 v236, v240, v148, v236
  v_mfma_f32_16x16x32_bf16 v[24:27], a[28:31], a[112:115], v[24:27]
  v_fma_f32 v237, v241, v149, v237
  v_cvt_pk_bf16_f32 v234, v236, v237
  v_mfma_f32_16x16x32_bf16 v[28:31], a[28:31], a[116:119], v[28:31]
  s_waitcnt vmcnt(23)
  v_mfma_f32_16x16x32_bf16 v[32:35], a[32:35], a[104:107], v[32:35]
  buffer_load_dwordx4 a[28:31], v208, s[8:11], s20 offen offset:3072
  v_mfma_f32_16x16x32_bf16 v[36:39], a[32:35], a[108:111], v[36:39]
  ds_read_b128 a[124:127], v212 offset:4096
  v_lshlrev_b32 v238, 16, v235
  v_mfma_f32_16x16x32_bf16 v[40:43], a[32:35], a[112:115], v[40:43]
  v_and_b32 v239, s27, v235
  v_accvgpr_read_b32 v244, a207
  v_mfma_f32_16x16x32_bf16 v[44:47], a[32:35], a[116:119], v[44:47]
  v_mfma_f32_16x16x32_bf16 v[48:51], a[36:39], a[104:107], v[48:51]
  s_add_u32 s20, s20, 4096
  buffer_load_dwordx4 a[32:35], v208, s[8:11], s20 offen
  v_mfma_f32_16x16x32_bf16 v[52:55], a[36:39], a[108:111], v[52:55]
  ds_read_b128 a[128:131], v212 offset:8192
  v_lshlrev_b32 v242, 16, v244
  v_mfma_f32_16x16x32_bf16 v[56:59], a[36:39], a[112:115], v[56:59]
  v_and_b32 v243, s27, v244
  v_fma_f32 v238, v242, v150, v238
  v_mfma_f32_16x16x32_bf16 v[60:63], a[36:39], a[116:119], v[60:63]
  v_fma_f32 v239, v243, v151, v239
  s_waitcnt vmcnt(23)
  v_mfma_f32_16x16x32_bf16 v[64:67], a[40:43], a[104:107], v[64:67]
  buffer_load_dwordx4 a[36:39], v208, s[8:11], s20 offen offset:1024
  v_mfma_f32_16x16x32_bf16 v[68:71], a[40:43], a[108:111], v[68:71]
  ds_read_b128 a[132:135], v212 offset:12288
  v_cvt_pk_bf16_f32 v235, v238, v239
  v_mfma_f32_16x16x32_bf16 v[72:75], a[40:43], a[112:115], v[72:75]
  ds_write_b128 v221, v[232:235] offset:4096
  ds_read_b128 v[232:235], v221 offset:12288
  v_mfma_f32_16x16x32_bf16 v[76:79], a[40:43], a[116:119], v[76:79]
  v_mfma_f32_16x16x32_bf16 v[80:83], a[44:47], a[104:107], v[80:83]
  buffer_load_dwordx4 a[40:43], v208, s[8:11], s20 offen offset:2048
  v_mfma_f32_16x16x32_bf16 v[84:87], a[44:47], a[108:111], v[84:87]
  v_lshlrev_b32 v236, 16, v228
  v_mfma_f32_16x16x32_bf16 v[88:91], a[44:47], a[112:115], v[88:91]
  v_and_b32 v237, s27, v228
  v_accvgpr_read_b32 v244, a208
  v_mfma_f32_16x16x32_bf16 v[92:95], a[44:47], a[116:119], v[92:95]
  s_waitcnt vmcnt(23)
  v_mfma_f32_16x16x32_bf16 v[96:99], a[48:51], a[104:107], v[96:99]
  buffer_load_dwordx4 a[44:47], v208, s[8:11], s20 offen offset:3072
  v_mfma_f32_16x16x32_bf16 v[100:103], a[48:51], a[108:111], v[100:103]
  v_lshlrev_b32 v240, 16, v244
  v_and_b32 v241, s27, v244
  v_mfma_f32_16x16x32_bf16 v[104:107], a[48:51], a[112:115], v[104:107]
  v_fma_f32 v236, v240, v136, v236
  v_fma_f32 v237, v241, v137, v237
  v_mfma_f32_16x16x32_bf16 v[108:111], a[48:51], a[116:119], v[108:111]
  v_mfma_f32_16x16x32_bf16 v[112:115], a[52:55], a[104:107], v[112:115]
  s_add_u32 s20, s20, 4096
  buffer_load_dwordx4 a[48:51], v208, s[8:11], s20 offen
  v_mfma_f32_16x16x32_bf16 v[116:119], a[52:55], a[108:111], v[116:119]
  v_cvt_pk_bf16_f32 v228, v236, v237
  v_mfma_f32_16x16x32_bf16 v[120:123], a[52:55], a[112:115], v[120:123]
  v_lshlrev_b32 v238, 16, v229
  v_and_b32 v239, s27, v229
  v_mfma_f32_16x16x32_bf16 v[124:127], a[52:55], a[116:119], v[124:127]
  s_waitcnt vmcnt(23) lgkmcnt(2)
  v_mfma_f32_16x16x32_bf16 v[0:3], a[56:59], a[120:123], v[0:3]
  buffer_load_dwordx4 a[52:55], v208, s[8:11], s20 offen offset:1024
  v_mfma_f32_16x16x32_bf16 v[4:7], a[56:59], a[124:127], v[4:7]
  v_accvgpr_read_b32 v244, a209
  v_mfma_f32_16x16x32_bf16 v[8:11], a[56:59], a[128:131], v[8:11]
  v_lshlrev_b32 v242, 16, v244
  v_and_b32 v243, s27, v244
  v_mfma_f32_16x16x32_bf16 v[12:15], a[56:59], a[132:135], v[12:15]
  v_mfma_f32_16x16x32_bf16 v[16:19], a[60:63], a[120:123], v[16:19]
  buffer_load_dwordx4 a[56:59], v208, s[8:11], s20 offen offset:2048
  v_fma_f32 v238, v242, v138, v238
  v_mfma_f32_16x16x32_bf16 v[20:23], a[60:63], a[124:127], v[20:23]
  ds_read_b128 a[104:107], v209 offset:16384
  v_fma_f32 v239, v243, v139, v239
  v_mfma_f32_16x16x32_bf16 v[24:27], a[60:63], a[128:131], v[24:27]
  v_cvt_pk_bf16_f32 v229, v238, v239
  v_lshlrev_b32 v236, 16, v230
  v_mfma_f32_16x16x32_bf16 v[28:31], a[60:63], a[132:135], v[28:31]
  s_waitcnt vmcnt(23)
  v_mfma_f32_16x16x32_bf16 v[32:35], a[64:67], a[120:123], v[32:35]
  buffer_load_dwordx4 a[60:63], v208, s[8:11], s20 offen offset:3072
  v_mfma_f32_16x16x32_bf16 v[36:39], a[64:67], a[124:127], v[36:39]
  ds_read_b128 a[108:111], v209 offset:20480
  v_and_b32 v237, s27, v230
  v_mfma_f32_16x16x32_bf16 v[40:43], a[64:67], a[128:131], v[40:43]
  v_accvgpr_read_b32 v244, a210
  v_lshlrev_b32 v240, 16, v244
  v_mfma_f32_16x16x32_bf16 v[44:47], a[64:67], a[132:135], v[44:47]
  v_mfma_f32_16x16x32_bf16 v[48:51], a[68:71], a[120:123], v[48:51]
  s_add_u32 s20, s20, 4096
  buffer_load_dwordx4 a[64:67], v208, s[8:11], s20 offen
  v_mfma_f32_16x16x32_bf16 v[52:55], a[68:71], a[124:127], v[52:55]
  ds_read_b128 a[112:115], v209 offset:24576
  v_and_b32 v241, s27, v244
  v_mfma_f32_16x16x32_bf16 v[56:59], a[68:71], a[128:131], v[56:59]
  v_fma_f32 v236, v240, v152, v236
  v_fma_f32 v237, v241, v153, v237
  v_mfma_f32_16x16x32_bf16 v[60:63], a[68:71], a[132:135], v[60:63]
  s_waitcnt vmcnt(23)
  v_mfma_f32_16x16x32_bf16 v[64:67], a[72:75], a[120:123], v[64:67]
  buffer_load_dwordx4 a[68:71], v208, s[8:11], s20 offen offset:1024
  v_cvt_pk_bf16_f32 v230, v236, v237
  v_mfma_f32_16x16x32_bf16 v[68:71], a[72:75], a[124:127], v[68:71]
  ds_read_b128 a[116:119], v209 offset:28672
  v_lshlrev_b32 v238, 16, v231
  v_mfma_f32_16x16x32_bf16 v[72:75], a[72:75], a[128:131], v[72:75]
  v_and_b32 v239, s27, v231
  v_accvgpr_read_b32 v244, a211
  v_mfma_f32_16x16x32_bf16 v[76:79], a[72:75], a[132:135], v[76:79]
  v_mfma_f32_16x16x32_bf16 v[80:83], a[76:79], a[120:123], v[80:83]
  buffer_load_dwordx4 a[72:75], v208, s[8:11], s20 offen offset:2048
  v_mfma_f32_16x16x32_bf16 v[84:87], a[76:79], a[124:127], v[84:87]
  v_lshlrev_b32 v242, 16, v244
  v_mfma_f32_16x16x32_bf16 v[88:91], a[76:79], a[128:131], v[88:91]
  v_and_b32 v243, s27, v244
  v_fma_f32 v238, v242, v154, v238
  v_mfma_f32_16x16x32_bf16 v[92:95], a[76:79], a[132:135], v[92:95]
  s_waitcnt vmcnt(23)
  v_mfma_f32_16x16x32_bf16 v[96:99], a[80:83], a[120:123], v[96:99]
  buffer_load_dwordx4 a[76:79], v208, s[8:11], s20 offen offset:3072
  v_mfma_f32_16x16x32_bf16 v[100:103], a[80:83], a[124:127], v[100:103]
  v_fma_f32 v239, v243, v155, v239
  v_cvt_pk_bf16_f32 v231, v238, v239
  v_mfma_f32_16x16x32_bf16 v[104:107], a[80:83], a[128:131], v[104:107]
  ds_write_b128 v221, v[228:231] offset:8192
  ds_read_b128 v[228:231], v222
  v_mfma_f32_16x16x32_bf16 v[108:111], a[80:83], a[132:135], v[108:111]
  v_mfma_f32_16x16x32_bf16 v[112:115], a[84:87], a[120:123], v[112:115]
  s_add_u32 s20, s20, 4096
  buffer_load_dwordx4 a[80:83], v208, s[8:11], s20 offen
  v_mfma_f32_16x16x32_bf16 v[116:119], a[84:87], a[124:127], v[116:119]
  s_waitcnt lgkmcnt(6)
  v_lshlrev_b32 v236, 16, v232
  v_mfma_f32_16x16x32_bf16 v[120:123], a[84:87], a[128:131], v[120:123]
  v_and_b32 v237, s27, v232
  v_accvgpr_read_b32 v244, a212
  v_mfma_f32_16x16x32_bf16 v[124:127], a[84:87], a[132:135], v[124:127]
  s_waitcnt vmcnt(23) lgkmcnt(2)
  v_mfma_f32_16x16x32_bf16 v[0:3], a[88:91], a[104:107], v[0:3]
  buffer_load_dwordx4 a[84:87], v208, s[8:11], s20 offen offset:1024
  v_mfma_f32_16x16x32_bf16 v[4:7], a[88:91], a[108:111], v[4:7]
  v_lshlrev_b32 v240, 16, v244
  v_mfma_f32_16x16x32_bf16 v[8:11], a[88:91], a[112:115], v[8:11]
  v_and_b32 v241, s27, v244
  v_fma_f32 v236, v240, v140, v236
  v_mfma_f32_16x16x32_bf16 v[12:15], a[88:91], a[116:119], v[12:15]
  v_mfma_f32_16x16x32_bf16 v[16:19], a[92:95], a[104:107], v[16:19]
  buffer_load_dwordx4 a[88:91], v208, s[8:11], s20 offen offset:2048
  v_fma_f32 v237, v241, v141, v237
  v_mfma_f32_16x16x32_bf16 v[20:23], a[92:95], a[108:111], v[20:23]
  ds_read_b128 a[120:123], v210 offset:16384
  v_cvt_pk_bf16_f32 v232, v236, v237
  v_mfma_f32_16x16x32_bf16 v[24:27], a[92:95], a[112:115], v[24:27]
  v_lshlrev_b32 v238, 16, v233
  v_and_b32 v239, s27, v233
  v_mfma_f32_16x16x32_bf16 v[28:31], a[92:95], a[116:119], v[28:31]
  s_waitcnt vmcnt(23)
  v_mfma_f32_16x16x32_bf16 v[32:35], a[96:99], a[104:107], v[32:35]
  buffer_load_dwordx4 a[92:95], v208, s[8:11], s20 offen offset:3072
  v_mfma_f32_16x16x32_bf16 v[36:39], a[96:99], a[108:111], v[36:39]
  ds_read_b128 a[124:127], v210 offset:20480
  v_accvgpr_read_b32 v244, a213
  v_mfma_f32_16x16x32_bf16 v[40:43], a[96:99], a[112:115], v[40:43]
  v_lshlrev_b32 v242, 16, v244
  v_and_b32 v243, s27, v244
  v_mfma_f32_16x16x32_bf16 v[44:47], a[96:99], a[116:119], v[44:47]
  v_mfma_f32_16x16x32_bf16 v[48:51], a[100:103], a[104:107], v[48:51]
  s_add_u32 s20, s20, 4096
  buffer_load_dwordx4 a[96:99], v208, s[8:11], s20 offen
  v_mfma_f32_16x16x32_bf16 v[52:55], a[100:103], a[108:111], v[52:55]
  ds_read_b128 a[128:131], v210 offset:24576
  v_fma_f32 v238, v242, v142, v238
  v_mfma_f32_16x16x32_bf16 v[56:59], a[100:103], a[112:115], v[56:59]
  v_fma_f32 v239, v243, v143, v239
  v_cvt_pk_bf16_f32 v233, v238, v239
  v_mfma_f32_16x16x32_bf16 v[60:63], a[100:103], a[116:119], v[60:63]
  s_waitcnt vmcnt(23)
  v_mfma_f32_16x16x32_bf16 v[64:67], a[0:3], a[104:107], v[64:67]
  buffer_load_dwordx4 a[100:103], v208, s[8:11], s20 offen offset:1024
  v_lshlrev_b32 v236, 16, v234
  v_mfma_f32_16x16x32_bf16 v[68:71], a[0:3], a[108:111], v[68:71]
  ds_read_b128 a[132:135], v210 offset:28672
  v_and_b32 v237, s27, v234
  v_mfma_f32_16x16x32_bf16 v[72:75], a[0:3], a[112:115], v[72:75]
  v_accvgpr_read_b32 v244, a214
  v_lshlrev_b32 v240, 16, v244
  v_mfma_f32_16x16x32_bf16 v[76:79], a[0:3], a[116:119], v[76:79]
  v_mfma_f32_16x16x32_bf16 v[80:83], a[4:7], a[104:107], v[80:83]
  buffer_load_dwordx4 a[0:3], v208, s[8:11], s20 offen offset:2048
  v_mfma_f32_16x16x32_bf16 v[84:87], a[4:7], a[108:111], v[84:87]
  v_and_b32 v241, s27, v244
  v_mfma_f32_16x16x32_bf16 v[88:91], a[4:7], a[112:115], v[88:91]
  v_fma_f32 v236, v240, v156, v236
  v_fma_f32 v237, v241, v157, v237
  v_mfma_f32_16x16x32_bf16 v[92:95], a[4:7], a[116:119], v[92:95]
  s_waitcnt vmcnt(23)
  v_mfma_f32_16x16x32_bf16 v[96:99], a[8:11], a[104:107], v[96:99]
  buffer_load_dwordx4 a[4:7], v208, s[8:11], s20 offen offset:3072
  v_mfma_f32_16x16x32_bf16 v[100:103], a[8:11], a[108:111], v[100:103]
  v_cvt_pk_bf16_f32 v234, v236, v237
  v_mfma_f32_16x16x32_bf16 v[104:107], a[8:11], a[112:115], v[104:107]
  v_lshlrev_b32 v238, 16, v235
  v_and_b32 v239, s27, v235
  v_mfma_f32_16x16x32_bf16 v[108:111], a[8:11], a[116:119], v[108:111]
  v_mfma_f32_16x16x32_bf16 v[112:115], a[12:15], a[104:107], v[112:115]
  s_add_u32 s20, s20, 4096
  buffer_load_dwordx4 a[8:11], v208, s[8:11], s20 offen
  v_mfma_f32_16x16x32_bf16 v[116:119], a[12:15], a[108:111], v[116:119]
  v_accvgpr_read_b32 v244, a215
  v_lshlrev_b32 v242, 16, v244
  v_mfma_f32_16x16x32_bf16 v[120:123], a[12:15], a[112:115], v[120:123]
  v_and_b32 v243, s27, v244
  v_fma_f32 v238, v242, v158, v238
  v_mfma_f32_16x16x32_bf16 v[124:127], a[12:15], a[116:119], v[124:127]
  s_waitcnt vmcnt(23) lgkmcnt(0)
  v_mfma_f32_16x16x32_bf16 v[0:3], a[16:19], a[120:123], v[0:3]
  buffer_load_dwordx4 a[12:15], v208, s[8:11], s20 offen offset:1024
  v_mfma_f32_16x16x32_bf16 v[4:7], a[16:19], a[124:127], v[4:7]
  v_fma_f32 v239, v243, v159, v239
  v_mfma_f32_16x16x32_bf16 v[8:11], a[16:19], a[128:131], v[8:11]
  v_cvt_pk_bf16_f32 v235, v238, v239
  ds_write_b128 v221, v[232:235] offset:12288
  v_mfma_f32_16x16x32_bf16 v[12:15], a[16:19], a[132:135], v[12:15]
  v_mfma_f32_16x16x32_bf16 v[16:19], a[20:23], a[120:123], v[16:19]
  buffer_load_dwordx4 a[16:19], v208, s[8:11], s20 offen offset:2048
  v_mfma_f32_16x16x32_bf16 v[20:23], a[20:23], a[124:127], v[20:23]
  ds_read_b128 a[104:107], v211 offset:16384
  ds_read_b128 v[232:235], v222 offset:4096
  v_mfma_f32_16x16x32_bf16 v[24:27], a[20:23], a[128:131], v[24:27]
  v_lshlrev_b32 v236, 16, v228
  v_and_b32 v237, s27, v228
  v_mfma_f32_16x16x32_bf16 v[28:31], a[20:23], a[132:135], v[28:31]
  s_waitcnt vmcnt(23)
  v_mfma_f32_16x16x32_bf16 v[32:35], a[24:27], a[120:123], v[32:35]
  buffer_load_dwordx4 a[20:23], v208, s[8:11], s20 offen offset:3072
  v_accvgpr_read_b32 v244, a216
  v_mfma_f32_16x16x32_bf16 v[36:39], a[24:27], a[124:127], v[36:39]
  ds_read_b128 a[108:111], v211 offset:20480
  v_lshlrev_b32 v240, 16, v244
  v_mfma_f32_16x16x32_bf16 v[40:43], a[24:27], a[128:131], v[40:43]
  v_and_b32 v241, s27, v244
  v_fma_f32 v236, v240, v160, v236
  v_mfma_f32_16x16x32_bf16 v[44:47], a[24:27], a[132:135], v[44:47]
  v_mfma_f32_16x16x32_bf16 v[48:51], a[28:31], a[120:123], v[48:51]
  s_add_u32 s20, s20, 4096
  buffer_load_dwordx4 a[24:27], v208, s[8:11], s20 offen
  v_mfma_f32_16x16x32_bf16 v[52:55], a[28:31], a[124:127], v[52:55]
  ds_read_b128 a[112:115], v211 offset:24576
  v_fma_f32 v237, v241, v161, v237
  v_mfma_f32_16x16x32_bf16 v[56:59], a[28:31], a[128:131], v[56:59]
  v_cvt_pk_bf16_f32 v228, v236, v237
  v_lshlrev_b32 v238, 16, v229
  v_mfma_f32_16x16x32_bf16 v[60:63], a[28:31], a[132:135], v[60:63]
  s_waitcnt vmcnt(23)
  v_mfma_f32_16x16x32_bf16 v[64:67], a[32:35], a[120:123], v[64:67]
  buffer_load_dwordx4 a[28:31], v208, s[8:11], s20 offen offset:1024
  v_and_b32 v239, s27, v229
  v_mfma_f32_16x16x32_bf16 v[68:71], a[32:35], a[124:127], v[68:71]
  ds_read_b128 a[116:119], v211 offset:28672
  v_accvgpr_read_b32 v244, a217
  v_mfma_f32_16x16x32_bf16 v[72:75], a[32:35], a[128:131], v[72:75]
  v_lshlrev_b32 v242, 16, v244
  v_and_b32 v243, s27, v244
  v_mfma_f32_16x16x32_bf16 v[76:79], a[32:35], a[132:135], v[76:79]
  v_mfma_f32_16x16x32_bf16 v[80:83], a[36:39], a[120:123], v[80:83]
  buffer_load_dwordx4 a[32:35], v208, s[8:11], s20 offen offset:2048
  v_mfma_f32_16x16x32_bf16 v[84:87], a[36:39], a[124:127], v[84:87]
  v_fma_f32 v238, v242, v162, v238
  v_mfma_f32_16x16x32_bf16 v[88:91], a[36:39], a[128:131], v[88:91]
  v_fma_f32 v239, v243, v163, v239
  v_cvt_pk_bf16_f32 v229, v238, v239
  v_mfma_f32_16x16x32_bf16 v[92:95], a[36:39], a[132:135], v[92:95]
  s_waitcnt vmcnt(23)
  v_mfma_f32_16x16x32_bf16 v[96:99], a[40:43], a[120:123], v[96:99]
  buffer_load_dwordx4 a[36:39], v208, s[8:11], s20 offen offset:3072
  v_mfma_f32_16x16x32_bf16 v[100:103], a[40:43], a[124:127], v[100:103]
  v_lshlrev_b32 v236, 16, v230
  v_mfma_f32_16x16x32_bf16 v[104:107], a[40:43], a[128:131], v[104:107]
  v_and_b32 v237, s27, v230
  v_accvgpr_read_b32 v244, a218
  v_mfma_f32_16x16x32_bf16 v[108:111], a[40:43], a[132:135], v[108:111]
  v_mfma_f32_16x16x32_bf16 v[112:115], a[44:47], a[120:123], v[112:115]
  s_add_u32 s20, s20, 4096
  buffer_load_dwordx4 a[40:43], v208, s[8:11], s20 offen
  v_mfma_f32_16x16x32_bf16 v[116:119], a[44:47], a[124:127], v[116:119]
  v_lshlrev_b32 v240, 16, v244
  v_and_b32 v241, s27, v244
  v_mfma_f32_16x16x32_bf16 v[120:123], a[44:47], a[128:131], v[120:123]
  v_fma_f32 v236, v240, v176, v236
  v_fma_f32 v237, v241, v177, v237
  v_mfma_f32_16x16x32_bf16 v[124:127], a[44:47], a[132:135], v[124:127]
  s_waitcnt vmcnt(23) lgkmcnt(0)
  v_mfma_f32_16x16x32_bf16 v[0:3], a[48:51], a[104:107], v[0:3]
  buffer_load_dwordx4 a[44:47], v208, s[8:11], s20 offen offset:1024
  v_mfma_f32_16x16x32_bf16 v[4:7], a[48:51], a[108:111], v[4:7]
  v_cvt_pk_bf16_f32 v230, v236, v237
  v_mfma_f32_16x16x32_bf16 v[8:11], a[48:51], a[112:115], v[8:11]
  v_lshlrev_b32 v238, 16, v231
  v_and_b32 v239, s27, v231
  v_mfma_f32_16x16x32_bf16 v[12:15], a[48:51], a[116:119], v[12:15]
  v_mfma_f32_16x16x32_bf16 v[16:19], a[52:55], a[104:107], v[16:19]
  buffer_load_dwordx4 a[48:51], v208, s[8:11], s20 offen offset:2048
  v_mfma_f32_16x16x32_bf16 v[20:23], a[52:55], a[108:111], v[20:23]
  ds_read_b128 a[120:123], v212 offset:16384
  v_accvgpr_read_b32 v244, a219
  v_mfma_f32_16x16x32_bf16 v[24:27], a[52:55], a[112:115], v[24:27]
  v_lshlrev_b32 v242, 16, v244
  v_and_b32 v243, s27, v244
  v_mfma_f32_16x16x32_bf16 v[28:31], a[52:55], a[116:119], v[28:31]
  s_waitcnt vmcnt(23)
  v_mfma_f32_16x16x32_bf16 v[32:35], a[56:59], a[104:107], v[32:35]
  buffer_load_dwordx4 a[52:55], v208, s[8:11], s20 offen offset:3072
  v_fma_f32 v238, v242, v178, v238
  v_mfma_f32_16x16x32_bf16 v[36:39], a[56:59], a[108:111], v[36:39]
  ds_read_b128 a[124:127], v212 offset:20480
  v_fma_f32 v239, v243, v179, v239
  v_mfma_f32_16x16x32_bf16 v[40:43], a[56:59], a[112:115], v[40:43]
  v_cvt_pk_bf16_f32 v231, v238, v239
  ds_write_b128 v222, v[228:231]
  v_mfma_f32_16x16x32_bf16 v[44:47], a[56:59], a[116:119], v[44:47]
  v_mfma_f32_16x16x32_bf16 v[48:51], a[60:63], a[104:107], v[48:51]
  s_add_u32 s20, s20, 4096
  buffer_load_dwordx4 a[56:59], v208, s[8:11], s20 offen
  v_mfma_f32_16x16x32_bf16 v[52:55], a[60:63], a[108:111], v[52:55]
  ds_read_b128 a[128:131], v212 offset:24576
  ds_read_b128 v[228:231], v222 offset:8192
  v_mfma_f32_16x16x32_bf16 v[56:59], a[60:63], a[112:115], v[56:59]
  v_lshlrev_b32 v236, 16, v232
  v_and_b32 v237, s27, v232
  v_mfma_f32_16x16x32_bf16 v[60:63], a[60:63], a[116:119], v[60:63]
  s_waitcnt vmcnt(23)
  v_mfma_f32_16x16x32_bf16 v[64:67], a[64:67], a[104:107], v[64:67]
  buffer_load_dwordx4 a[60:63], v208, s[8:11], s20 offen offset:1024
  v_mfma_f32_16x16x32_bf16 v[68:71], a[64:67], a[108:111], v[68:71]
  ds_read_b128 a[132:135], v212 offset:28672
  v_accvgpr_read_b32 v244, a220
  v_mfma_f32_16x16x32_bf16 v[72:75], a[64:67], a[112:115], v[72:75]
  v_lshlrev_b32 v240, 16, v244
  v_and_b32 v241, s27, v244
  v_mfma_f32_16x16x32_bf16 v[76:79], a[64:67], a[116:119], v[76:79]
  v_mfma_f32_16x16x32_bf16 v[80:83], a[68:71], a[104:107], v[80:83]
  buffer_load_dwordx4 a[64:67], v208, s[8:11], s20 offen offset:2048
  v_mfma_f32_16x16x32_bf16 v[84:87], a[68:71], a[108:111], v[84:87]
  v_fma_f32 v236, v240, v164, v236
  v_fma_f32 v237, v241, v165, v237
  v_mfma_f32_16x16x32_bf16 v[88:91], a[68:71], a[112:115], v[88:91]
  v_cvt_pk_bf16_f32 v232, v236, v237
  v_lshlrev_b32 v238, 16, v233
  v_mfma_f32_16x16x32_bf16 v[92:95], a[68:71], a[116:119], v[92:95]
  s_waitcnt vmcnt(23)
  v_mfma_f32_16x16x32_bf16 v[96:99], a[72:75], a[104:107], v[96:99]
  buffer_load_dwordx4 a[68:71], v208, s[8:11], s20 offen offset:3072
  v_mfma_f32_16x16x32_bf16 v[100:103], a[72:75], a[108:111], v[100:103]
  v_and_b32 v239, s27, v233
  v_mfma_f32_16x16x32_bf16 v[104:107], a[72:75], a[112:115], v[104:107]
  v_accvgpr_read_b32 v244, a221
  v_lshlrev_b32 v242, 16, v244
  v_mfma_f32_16x16x32_bf16 v[108:111], a[72:75], a[116:119], v[108:111]
  v_mfma_f32_16x16x32_bf16 v[112:115], a[76:79], a[104:107], v[112:115]
  s_add_u32 s20, s20, 4096
  buffer_load_dwordx4 a[72:75], v208, s[8:11], s20 offen
  v_mfma_f32_16x16x32_bf16 v[116:119], a[76:79], a[108:111], v[116:119]
  v_and_b32 v243, s27, v244
  v_mfma_f32_16x16x32_bf16 v[120:123], a[76:79], a[112:115], v[120:123]
  v_fma_f32 v238, v242, v166, v238
  v_fma_f32 v239, v243, v167, v239
  v_mfma_f32_16x16x32_bf16 v[124:127], a[76:79], a[116:119], v[124:127]
  s_waitcnt vmcnt(23) lgkmcnt(0)
  v_mfma_f32_16x16x32_bf16 v[0:3], a[80:83], a[120:123], v[0:3]
  buffer_load_dwordx4 a[76:79], v208, s[8:11], s20 offen offset:1024
  v_mfma_f32_16x16x32_bf16 v[4:7], a[80:83], a[124:127], v[4:7]
  v_cvt_pk_bf16_f32 v233, v238, v239
  v_lshlrev_b32 v236, 16, v234
  v_mfma_f32_16x16x32_bf16 v[8:11], a[80:83], a[128:131], v[8:11]
  v_and_b32 v237, s27, v234
  v_accvgpr_read_b32 v244, a222
  v_mfma_f32_16x16x32_bf16 v[12:15], a[80:83], a[132:135], v[12:15]
  v_mfma_f32_16x16x32_bf16 v[16:19], a[84:87], a[120:123], v[16:19]
  buffer_load_dwordx4 a[80:83], v208, s[8:11], s20 offen offset:2048
  v_mfma_f32_16x16x32_bf16 v[20:23], a[84:87], a[124:127], v[20:23]
  ds_read_b128 a[104:107], v209 offset:32768
  v_lshlrev_b32 v240, 16, v244
  v_mfma_f32_16x16x32_bf16 v[24:27], a[84:87], a[128:131], v[24:27]
  v_and_b32 v241, s27, v244
  v_fma_f32 v236, v240, v180, v236
  v_mfma_f32_16x16x32_bf16 v[28:31], a[84:87], a[132:135], v[28:31]
  s_waitcnt vmcnt(23)
  v_mfma_f32_16x16x32_bf16 v[32:35], a[88:91], a[120:123], v[32:35]
  buffer_load_dwordx4 a[84:87], v208, s[8:11], s20 offen offset:3072
  v_mfma_f32_16x16x32_bf16 v[36:39], a[88:91], a[124:127], v[36:39]
  ds_read_b128 a[108:111], v209 offset:36864
  v_fma_f32 v237, v241, v181, v237
  v_mfma_f32_16x16x32_bf16 v[40:43], a[88:91], a[128:131], v[40:43]
  v_cvt_pk_bf16_f32 v234, v236, v237
  v_lshlrev_b32 v238, 16, v235
  v_mfma_f32_16x16x32_bf16 v[44:47], a[88:91], a[132:135], v[44:47]
  v_mfma_f32_16x16x32_bf16 v[48:51], a[92:95], a[120:123], v[48:51]
  s_add_u32 s20, s20, 4096
  buffer_load_dwordx4 a[88:91], v208, s[8:11], s20 offen
  v_mfma_f32_16x16x32_bf16 v[52:55], a[92:95], a[124:127], v[52:55]
  ds_read_b128 a[112:115], v209 offset:40960
  v_and_b32 v239, s27, v235
  v_mfma_f32_16x16x32_bf16 v[56:59], a[92:95], a[128:131], v[56:59]
  v_accvgpr_read_b32 v244, a223
  v_lshlrev_b32 v242, 16, v244
  v_mfma_f32_16x16x32_bf16 v[60:63], a[92:95], a[132:135], v[60:63]
  v_and_b32 v243, s27, v244
  s_waitcnt vmcnt(23)
  v_mfma_f32_16x16x32_bf16 v[64:67], a[96:99], a[120:123], v[64:67]
  buffer_load_dwordx4 a[92:95], v208, s[8:11], s20 offen offset:1024
  v_mfma_f32_16x16x32_bf16 v[68:71], a[96:99], a[124:127], v[68:71]
  ds_read_b128 a[116:119], v209 offset:45056
  v_fma_f32 v238, v242, v182, v238
  v_mfma_f32_16x16x32_bf16 v[72:75], a[96:99], a[128:131], v[72:75]
  v_fma_f32 v239, v243, v183, v239
  v_cvt_pk_bf16_f32 v235, v238, v239
  v_mfma_f32_16x16x32_bf16 v[76:79], a[96:99], a[132:135], v[76:79]
  v_mfma_f32_16x16x32_bf16 v[80:83], a[100:103], a[120:123], v[80:83]
  buffer_load_dwordx4 a[96:99], v208, s[8:11], s20 offen offset:2048
  v_mfma_f32_16x16x32_bf16 v[84:87], a[100:103], a[124:127], v[84:87]
  ds_write_b128 v222, v[232:235] offset:4096
  ds_read_b128 v[232:235], v222 offset:12288
  v_mfma_f32_16x16x32_bf16 v[88:91], a[100:103], a[128:131], v[88:91]
  v_lshlrev_b32 v236, 16, v228
  v_and_b32 v237, s27, v228
  v_mfma_f32_16x16x32_bf16 v[92:95], a[100:103], a[132:135], v[92:95]
  s_waitcnt vmcnt(23)
  v_mfma_f32_16x16x32_bf16 v[96:99], a[0:3], a[120:123], v[96:99]
  buffer_load_dwordx4 a[100:103], v208, s[8:11], s20 offen offset:3072
  v_mfma_f32_16x16x32_bf16 v[100:103], a[0:3], a[124:127], v[100:103]
  v_accvgpr_read_b32 v244, a224
  v_mfma_f32_16x16x32_bf16 v[104:107], a[0:3], a[128:131], v[104:107]
  v_lshlrev_b32 v240, 16, v244
  v_and_b32 v241, s27, v244
  v_mfma_f32_16x16x32_bf16 v[108:111], a[0:3], a[132:135], v[108:111]
  v_mfma_f32_16x16x32_bf16 v[112:115], a[4:7], a[120:123], v[112:115]
  s_add_u32 s20, s20, 4096
  buffer_load_dwordx4 a[0:3], v208, s[8:11], s20 offen
  v_mfma_f32_16x16x32_bf16 v[116:119], a[4:7], a[124:127], v[116:119]
  v_fma_f32 v236, v240, v168, v236
  v_mfma_f32_16x16x32_bf16 v[120:123], a[4:7], a[128:131], v[120:123]
  v_fma_f32 v237, v241, v169, v237
  v_cvt_pk_bf16_f32 v228, v236, v237
  v_mfma_f32_16x16x32_bf16 v[124:127], a[4:7], a[132:135], v[124:127]
  s_waitcnt vmcnt(23) lgkmcnt(2)
  v_mfma_f32_16x16x32_bf16 v[0:3], a[8:11], a[104:107], v[0:3]
  buffer_load_dwordx4 a[4:7], v208, s[8:11], s20 offen offset:1024
  v_mfma_f32_16x16x32_bf16 v[4:7], a[8:11], a[108:111], v[4:7]
  v_lshlrev_b32 v238, 16, v229
  v_and_b32 v239, s27, v229
  v_mfma_f32_16x16x32_bf16 v[8:11], a[8:11], a[112:115], v[8:11]
  v_accvgpr_read_b32 v244, a225
  v_lshlrev_b32 v242, 16, v244
  v_mfma_f32_16x16x32_bf16 v[12:15], a[8:11], a[116:119], v[12:15]
  v_mfma_f32_16x16x32_bf16 v[16:19], a[12:15], a[104:107], v[16:19]
  buffer_load_dwordx4 a[8:11], v208, s[8:11], s20 offen offset:2048
  v_mfma_f32_16x16x32_bf16 v[20:23], a[12:15], a[108:111], v[20:23]
  ds_read_b128 a[120:123], v210 offset:32768
  v_and_b32 v243, s27, v244
  v_mfma_f32_16x16x32_bf16 v[24:27], a[12:15], a[112:115], v[24:27]
  v_fma_f32 v238, v242, v170, v238
  v_fma_f32 v239, v243, v171, v239
  v_mfma_f32_16x16x32_bf16 v[28:31], a[12:15], a[116:119], v[28:31]
  s_waitcnt vmcnt(23)
  v_mfma_f32_16x16x32_bf16 v[32:35], a[16:19], a[104:107], v[32:35]
  buffer_load_dwordx4 a[12:15], v208, s[8:11], s20 offen offset:3072
  v_mfma_f32_16x16x32_bf16 v[36:39], a[16:19], a[108:111], v[36:39]
  ds_read_b128 a[124:127], v210 offset:36864
  v_cvt_pk_bf16_f32 v229, v238, v239
  v_mfma_f32_16x16x32_bf16 v[40:43], a[16:19], a[112:115], v[40:43]
  v_lshlrev_b32 v236, 16, v230
  v_and_b32 v237, s27, v230
  v_mfma_f32_16x16x32_bf16 v[44:47], a[16:19], a[116:119], v[44:47]
  v_mfma_f32_16x16x32_bf16 v[48:51], a[20:23], a[104:107], v[48:51]
  s_add_u32 s20, s20, 4096
  buffer_load_dwordx4 a[16:19], v208, s[8:11], s20 offen
  v_mfma_f32_16x16x32_bf16 v[52:55], a[20:23], a[108:111], v[52:55]
  ds_read_b128 a[128:131], v210 offset:40960
  v_accvgpr_read_b32 v244, a226
  v_mfma_f32_16x16x32_bf16 v[56:59], a[20:23], a[112:115], v[56:59]
  v_lshlrev_b32 v240, 16, v244
  v_and_b32 v241, s27, v244
  v_mfma_f32_16x16x32_bf16 v[60:63], a[20:23], a[116:119], v[60:63]
  v_fma_f32 v236, v240, v184, v236
  s_waitcnt vmcnt(23)
  v_mfma_f32_16x16x32_bf16 v[64:67], a[24:27], a[104:107], v[64:67]
  buffer_load_dwordx4 a[20:23], v208, s[8:11], s20 offen offset:1024
  v_mfma_f32_16x16x32_bf16 v[68:71], a[24:27], a[108:111], v[68:71]
  ds_read_b128 a[132:135], v210 offset:45056
  v_fma_f32 v237, v241, v185, v237
  v_mfma_f32_16x16x32_bf16 v[72:75], a[24:27], a[112:115], v[72:75]
  v_cvt_pk_bf16_f32 v230, v236, v237
  v_lshlrev_b32 v238, 16, v231
  v_mfma_f32_16x16x32_bf16 v[76:79], a[24:27], a[116:119], v[76:79]
  v_mfma_f32_16x16x32_bf16 v[80:83], a[28:31], a[104:107], v[80:83]
  buffer_load_dwordx4 a[24:27], v208, s[8:11], s20 offen offset:2048
  v_mfma_f32_16x16x32_bf16 v[84:87], a[28:31], a[108:111], v[84:87]
  v_and_b32 v239, s27, v231
  v_mfma_f32_16x16x32_bf16 v[88:91], a[28:31], a[112:115], v[88:91]
  v_accvgpr_read_b32 v244, a227
  v_lshlrev_b32 v242, 16, v244
  v_mfma_f32_16x16x32_bf16 v[92:95], a[28:31], a[116:119], v[92:95]
  s_waitcnt vmcnt(23)
  v_mfma_f32_16x16x32_bf16 v[96:99], a[32:35], a[104:107], v[96:99]
  buffer_load_dwordx4 a[28:31], v208, s[8:11], s20 offen offset:3072
  v_mfma_f32_16x16x32_bf16 v[100:103], a[32:35], a[108:111], v[100:103]
  v_and_b32 v243, s27, v244
  v_fma_f32 v238, v242, v186, v238
  v_mfma_f32_16x16x32_bf16 v[104:107], a[32:35], a[112:115], v[104:107]
  v_fma_f32 v239, v243, v187, v239
  v_cvt_pk_bf16_f32 v231, v238, v239
  v_mfma_f32_16x16x32_bf16 v[108:111], a[32:35], a[116:119], v[108:111]
  v_mfma_f32_16x16x32_bf16 v[112:115], a[36:39], a[104:107], v[112:115]
  s_add_u32 s20, s20, 4096
  buffer_load_dwordx4 a[32:35], v208, s[8:11], s20 offen
  v_mfma_f32_16x16x32_bf16 v[116:119], a[36:39], a[108:111], v[116:119]
  ds_write_b128 v222, v[228:231] offset:8192
  v_mfma_f32_16x16x32_bf16 v[120:123], a[36:39], a[112:115], v[120:123]
  ds_read_b64 v[228:229], v223
  s_waitcnt lgkmcnt(6)
  v_lshlrev_b32 v236, 16, v232
  v_mfma_f32_16x16x32_bf16 v[124:127], a[36:39], a[116:119], v[124:127]
  s_waitcnt vmcnt(23) lgkmcnt(2)
  v_mfma_f32_16x16x32_bf16 v[0:3], a[40:43], a[120:123], v[0:3]
  buffer_load_dwordx4 a[36:39], v208, s[8:11], s20 offen offset:1024
  v_mfma_f32_16x16x32_bf16 v[4:7], a[40:43], a[124:127], v[4:7]
  v_and_b32 v237, s27, v232
  v_mfma_f32_16x16x32_bf16 v[8:11], a[40:43], a[128:131], v[8:11]
  v_accvgpr_read_b32 v244, a228
  v_lshlrev_b32 v240, 16, v244
  v_mfma_f32_16x16x32_bf16 v[12:15], a[40:43], a[132:135], v[12:15]
  v_mfma_f32_16x16x32_bf16 v[16:19], a[44:47], a[120:123], v[16:19]
  buffer_load_dwordx4 a[40:43], v208, s[8:11], s20 offen offset:2048
  v_and_b32 v241, s27, v244
  v_mfma_f32_16x16x32_bf16 v[20:23], a[44:47], a[124:127], v[20:23]
  ds_read_b128 a[104:107], v211 offset:32768
  v_fma_f32 v236, v240, v172, v236
  v_mfma_f32_16x16x32_bf16 v[24:27], a[44:47], a[128:131], v[24:27]
  v_fma_f32 v237, v241, v173, v237
  v_cvt_pk_bf16_f32 v232, v236, v237
  v_mfma_f32_16x16x32_bf16 v[28:31], a[44:47], a[132:135], v[28:31]
  s_waitcnt vmcnt(23)
  v_mfma_f32_16x16x32_bf16 v[32:35], a[48:51], a[120:123], v[32:35]
  buffer_load_dwordx4 a[44:47], v208, s[8:11], s20 offen offset:3072
  v_mfma_f32_16x16x32_bf16 v[36:39], a[48:51], a[124:127], v[36:39]
  ds_read_b128 a[108:111], v211 offset:36864
  v_lshlrev_b32 v238, 16, v233
  v_mfma_f32_16x16x32_bf16 v[40:43], a[48:51], a[128:131], v[40:43]
  v_and_b32 v239, s27, v233
  v_accvgpr_read_b32 v244, a229
  v_mfma_f32_16x16x32_bf16 v[44:47], a[48:51], a[132:135], v[44:47]
  v_mfma_f32_16x16x32_bf16 v[48:51], a[52:55], a[120:123], v[48:51]
  s_add_u32 s20, s20, 4096
  buffer_load_dwordx4 a[48:51], v208, s[8:11], s20 offen
  v_mfma_f32_16x16x32_bf16 v[52:55], a[52:55], a[124:127], v[52:55]
  ds_read_b128 a[112:115], v211 offset:40960
  v_lshlrev_b32 v242, 16, v244
  v_mfma_f32_16x16x32_bf16 v[56:59], a[52:55], a[128:131], v[56:59]
  v_and_b32 v243, s27, v244
  v_fma_f32 v238, v242, v174, v238
  v_mfma_f32_16x16x32_bf16 v[60:63], a[52:55], a[132:135], v[60:63]
  v_fma_f32 v239, v243, v175, v239
  s_waitcnt vmcnt(23)
  v_mfma_f32_16x16x32_bf16 v[64:67], a[56:59], a[120:123], v[64:67]
  buffer_load_dwordx4 a[52:55], v208, s[8:11], s20 offen offset:1024
  v_mfma_f32_16x16x32_bf16 v[68:71], a[56:59], a[124:127], v[68:71]
  ds_read_b128 a[116:119], v211 offset:45056
  v_cvt_pk_bf16_f32 v233, v238, v239
  v_mfma_f32_16x16x32_bf16 v[72:75], a[56:59], a[128:131], v[72:75]
  v_lshlrev_b32 v236, 16, v234
  v_and_b32 v237, s27, v234
  v_mfma_f32_16x16x32_bf16 v[76:79], a[56:59], a[132:135], v[76:79]
  v_mfma_f32_16x16x32_bf16 v[80:83], a[60:63], a[120:123], v[80:83]
  buffer_load_dwordx4 a[56:59], v208, s[8:11], s20 offen offset:2048
  v_mfma_f32_16x16x32_bf16 v[84:87], a[60:63], a[124:127], v[84:87]
  v_accvgpr_read_b32 v244, a230
  v_mfma_f32_16x16x32_bf16 v[88:91], a[60:63], a[128:131], v[88:91]
  v_lshlrev_b32 v240, 16, v244
  v_and_b32 v241, s27, v244
  v_mfma_f32_16x16x32_bf16 v[92:95], a[60:63], a[132:135], v[92:95]
  s_waitcnt vmcnt(23)
  v_mfma_f32_16x16x32_bf16 v[96:99], a[64:67], a[120:123], v[96:99]
  buffer_load_dwordx4 a[60:63], v208, s[8:11], s20 offen offset:3072
  v_mfma_f32_16x16x32_bf16 v[100:103], a[64:67], a[124:127], v[100:103]
  v_fma_f32 v236, v240, v188, v236
  v_fma_f32 v237, v241, v189, v237
  v_mfma_f32_16x16x32_bf16 v[104:107], a[64:67], a[128:131], v[104:107]
  v_cvt_pk_bf16_f32 v234, v236, v237
  v_lshlrev_b32 v238, 16, v235
  v_mfma_f32_16x16x32_bf16 v[108:111], a[64:67], a[132:135], v[108:111]
  v_mfma_f32_16x16x32_bf16 v[112:115], a[68:71], a[120:123], v[112:115]
  s_add_u32 s20, s20, 4096
  buffer_load_dwordx4 a[64:67], v208, s[8:11], s20 offen
  v_mfma_f32_16x16x32_bf16 v[116:119], a[68:71], a[124:127], v[116:119]
  v_and_b32 v239, s27, v235
  v_mfma_f32_16x16x32_bf16 v[120:123], a[68:71], a[128:131], v[120:123]
  v_accvgpr_read_b32 v244, a231
  v_lshlrev_b32 v242, 16, v244
  v_mfma_f32_16x16x32_bf16 v[124:127], a[68:71], a[132:135], v[124:127]
  s_waitcnt vmcnt(23) lgkmcnt(0)
  v_mfma_f32_16x16x32_bf16 v[0:3], a[72:75], a[104:107], v[0:3]
  buffer_load_dwordx4 a[68:71], v208, s[8:11], s20 offen offset:1024
  v_mfma_f32_16x16x32_bf16 v[4:7], a[72:75], a[108:111], v[4:7]
  v_and_b32 v243, s27, v244
  v_mfma_f32_16x16x32_bf16 v[8:11], a[72:75], a[112:115], v[8:11]
  v_fma_f32 v238, v242, v190, v238
  v_fma_f32 v239, v243, v191, v239
  v_mfma_f32_16x16x32_bf16 v[12:15], a[72:75], a[116:119], v[12:15]
  v_mfma_f32_16x16x32_bf16 v[16:19], a[76:79], a[104:107], v[16:19]
  buffer_load_dwordx4 a[72:75], v208, s[8:11], s20 offen offset:2048
  v_cvt_pk_bf16_f32 v235, v238, v239
  v_mfma_f32_16x16x32_bf16 v[20:23], a[76:79], a[108:111], v[20:23]
  ds_read_b128 a[120:123], v212 offset:32768
  ds_write_b128 v222, v[232:235] offset:12288
  v_mfma_f32_16x16x32_bf16 v[24:27], a[76:79], a[112:115], v[24:27]
  ds_read_b64 v[232:233], v223 offset:4096
  v_lshlrev_b32 v236, 16, v228
  v_mfma_f32_16x16x32_bf16 v[28:31], a[76:79], a[116:119], v[28:31]
  s_waitcnt vmcnt(23)
  v_mfma_f32_16x16x32_bf16 v[32:35], a[80:83], a[104:107], v[32:35]
  buffer_load_dwordx4 a[76:79], v208, s[8:11], s20 offen offset:3072
  v_mfma_f32_16x16x32_bf16 v[36:39], a[80:83], a[108:111], v[36:39]
  ds_read_b128 a[124:127], v212 offset:36864
  v_and_b32 v237, s27, v228
  v_mfma_f32_16x16x32_bf16 v[40:43], a[80:83], a[112:115], v[40:43]
  v_accvgpr_read_b32 v244, a232
  v_lshlrev_b32 v240, 16, v244
  v_mfma_f32_16x16x32_bf16 v[44:47], a[80:83], a[116:119], v[44:47]
  v_mfma_f32_16x16x32_bf16 v[48:51], a[84:87], a[104:107], v[48:51]
  s_add_u32 s20, s20, 4096
  buffer_load_dwordx4 a[80:83], v208, s[8:11], s20 offen
  v_mfma_f32_16x16x32_bf16 v[52:55], a[84:87], a[108:111], v[52:55]
  ds_read_b128 a[128:131], v212 offset:40960
  v_and_b32 v241, s27, v244
  v_mfma_f32_16x16x32_bf16 v[56:59], a[84:87], a[112:115], v[56:59]
  v_fma_f32 v236, v240, v192, v236
  v_fma_f32 v237, v241, v193, v237
  v_mfma_f32_16x16x32_bf16 v[60:63], a[84:87], a[116:119], v[60:63]
  s_waitcnt vmcnt(23)
  v_mfma_f32_16x16x32_bf16 v[64:67], a[88:91], a[104:107], v[64:67]
  buffer_load_dwordx4 a[84:87], v208, s[8:11], s20 offen offset:1024
  v_cvt_pk_bf16_f32 v228, v236, v237
  v_mfma_f32_16x16x32_bf16 v[68:71], a[88:91], a[108:111], v[68:71]
  ds_read_b128 a[132:135], v212 offset:45056
  v_lshlrev_b32 v238, 16, v229
  v_mfma_f32_16x16x32_bf16 v[72:75], a[88:91], a[112:115], v[72:75]
  v_and_b32 v239, s27, v229
  v_accvgpr_read_b32 v244, a233
  v_mfma_f32_16x16x32_bf16 v[76:79], a[88:91], a[116:119], v[76:79]
  v_mfma_f32_16x16x32_bf16 v[80:83], a[92:95], a[104:107], v[80:83]
  buffer_load_dwordx4 a[88:91], v208, s[8:11], s20 offen offset:2048
  v_mfma_f32_16x16x32_bf16 v[84:87], a[92:95], a[108:111], v[84:87]
  v_lshlrev_b32 v242, 16, v244
  v_mfma_f32_16x16x32_bf16 v[88:91], a[92:95], a[112:115], v[88:91]
  v_and_b32 v243, s27, v244
  v_fma_f32 v238, v242, v194, v238
  v_mfma_f32_16x16x32_bf16 v[92:95], a[92:95], a[116:119], v[92:95]
  s_waitcnt vmcnt(23)
  v_mfma_f32_16x16x32_bf16 v[96:99], a[96:99], a[104:107], v[96:99]
  buffer_load_dwordx4 a[92:95], v208, s[8:11], s20 offen offset:3072
  v_mfma_f32_16x16x32_bf16 v[100:103], a[96:99], a[108:111], v[100:103]
  v_fma_f32 v239, v243, v195, v239
  v_mfma_f32_16x16x32_bf16 v[104:107], a[96:99], a[112:115], v[104:107]
  v_cvt_pk_bf16_f32 v229, v238, v239
  ds_write_b64 v223, v[228:229]
  v_mfma_f32_16x16x32_bf16 v[108:111], a[96:99], a[116:119], v[108:111]
  v_mfma_f32_16x16x32_bf16 v[112:115], a[100:103], a[104:107], v[112:115]
  s_add_u32 s20, s20, 4096
  buffer_load_dwordx4 a[96:99], v208, s[8:11], s20 offen
  v_mfma_f32_16x16x32_bf16 v[116:119], a[100:103], a[108:111], v[116:119]
  ds_read_b64 v[228:229], v223 offset:8192
  s_waitcnt lgkmcnt(5)
  v_lshlrev_b32 v236, 16, v232
  v_mfma_f32_16x16x32_bf16 v[120:123], a[100:103], a[112:115], v[120:123]
  v_and_b32 v237, s27, v232
  v_accvgpr_read_b32 v244, a234
  v_mfma_f32_16x16x32_bf16 v[124:127], a[100:103], a[116:119], v[124:127]
  s_waitcnt vmcnt(23) lgkmcnt(2)
  v_mfma_f32_16x16x32_bf16 v[0:3], a[0:3], a[120:123], v[0:3]
  buffer_load_dwordx4 a[100:103], v208, s[8:11], s20 offen offset:1024
  v_mfma_f32_16x16x32_bf16 v[4:7], a[0:3], a[124:127], v[4:7]
  v_lshlrev_b32 v240, 16, v244
  v_mfma_f32_16x16x32_bf16 v[8:11], a[0:3], a[128:131], v[8:11]
  v_and_b32 v241, s27, v244
  v_fma_f32 v236, v240, v196, v236
  v_mfma_f32_16x16x32_bf16 v[12:15], a[0:3], a[132:135], v[12:15]
  v_mfma_f32_16x16x32_bf16 v[16:19], a[4:7], a[120:123], v[16:19]
  buffer_load_dwordx4 a[0:3], v208, s[8:11], s20 offen offset:2048
  v_fma_f32 v237, v241, v197, v237
  v_mfma_f32_16x16x32_bf16 v[20:23], a[4:7], a[124:127], v[20:23]
  ds_read_b128 a[104:107], v209 offset:49152
  v_cvt_pk_bf16_f32 v232, v236, v237
  v_mfma_f32_16x16x32_bf16 v[24:27], a[4:7], a[128:131], v[24:27]
  v_lshlrev_b32 v238, 16, v233
  v_and_b32 v239, s27, v233
  v_mfma_f32_16x16x32_bf16 v[28:31], a[4:7], a[132:135], v[28:31]
  s_waitcnt vmcnt(23)
  v_mfma_f32_16x16x32_bf16 v[32:35], a[8:11], a[120:123], v[32:35]
  buffer_load_dwordx4 a[4:7], v208, s[8:11], s20 offen offset:3072
  v_mfma_f32_16x16x32_bf16 v[36:39], a[8:11], a[124:127], v[36:39]
  ds_read_b128 a[108:111], v209 offset:53248
  v_accvgpr_read_b32 v244, a235
  v_mfma_f32_16x16x32_bf16 v[40:43], a[8:11], a[128:131], v[40:43]
  v_lshlrev_b32 v242, 16, v244
  v_and_b32 v243, s27, v244
  v_mfma_f32_16x16x32_bf16 v[44:47], a[8:11], a[132:135], v[44:47]
  v_mfma_f32_16x16x32_bf16 v[48:51], a[12:15], a[120:123], v[48:51]
  s_add_u32 s20, s20, 4096
  buffer_load_dwordx4 a[8:11], v208, s[8:11], s20 offen
  v_mfma_f32_16x16x32_bf16 v[52:55], a[12:15], a[124:127], v[52:55]
  ds_read_b128 a[112:115], v209 offset:57344
  v_fma_f32 v238, v242, v198, v238
  v_mfma_f32_16x16x32_bf16 v[56:59], a[12:15], a[128:131], v[56:59]
  v_fma_f32 v239, v243, v199, v239
  v_cvt_pk_bf16_f32 v233, v238, v239
  v_mfma_f32_16x16x32_bf16 v[60:63], a[12:15], a[132:135], v[60:63]
  s_waitcnt vmcnt(23)
  v_mfma_f32_16x16x32_bf16 v[64:67], a[16:19], a[120:123], v[64:67]
  buffer_load_dwordx4 a[12:15], v208, s[8:11], s20 offen offset:1024
  ds_write_b64 v223, v[232:233] offset:4096
  v_mfma_f32_16x16x32_bf16 v[68:71], a[16:19], a[124:127], v[68:71]
  ds_read_b128 a[116:119], v209 offset:61440
  ds_read_b64 v[232:233], v223 offset:12288
  v_mfma_f32_16x16x32_bf16 v[72:75], a[16:19], a[128:131], v[72:75]
  s_waitcnt lgkmcnt(6)
  v_lshlrev_b32 v236, 16, v228
  v_and_b32 v237, s27, v228
  v_mfma_f32_16x16x32_bf16 v[76:79], a[16:19], a[132:135], v[76:79]
  v_mfma_f32_16x16x32_bf16 v[80:83], a[20:23], a[120:123], v[80:83]
  buffer_load_dwordx4 a[16:19], v208, s[8:11], s20 offen offset:2048
  v_mfma_f32_16x16x32_bf16 v[84:87], a[20:23], a[124:127], v[84:87]
  v_accvgpr_read_b32 v244, a236
  v_mfma_f32_16x16x32_bf16 v[88:91], a[20:23], a[128:131], v[88:91]
  v_lshlrev_b32 v240, 16, v244
  v_and_b32 v241, s27, v244
  v_mfma_f32_16x16x32_bf16 v[92:95], a[20:23], a[132:135], v[92:95]
  s_waitcnt vmcnt(23)
  v_mfma_f32_16x16x32_bf16 v[96:99], a[24:27], a[120:123], v[96:99]
  buffer_load_dwordx4 a[20:23], v208, s[8:11], s20 offen offset:3072
  v_mfma_f32_16x16x32_bf16 v[100:103], a[24:27], a[124:127], v[100:103]
  v_fma_f32 v236, v240, v200, v236
  v_mfma_f32_16x16x32_bf16 v[104:107], a[24:27], a[128:131], v[104:107]
  v_fma_f32 v237, v241, v201, v237
  v_cvt_pk_bf16_f32 v228, v236, v237
  v_mfma_f32_16x16x32_bf16 v[108:111], a[24:27], a[132:135], v[108:111]
  v_mfma_f32_16x16x32_bf16 v[112:115], a[28:31], a[120:123], v[112:115]
  s_add_u32 s20, s20, 4096
  buffer_load_dwordx4 a[24:27], v208, s[8:11], s20 offen
  v_mfma_f32_16x16x32_bf16 v[116:119], a[28:31], a[124:127], v[116:119]
  v_lshlrev_b32 v238, 16, v229
  v_and_b32 v239, s27, v229
  v_mfma_f32_16x16x32_bf16 v[120:123], a[28:31], a[128:131], v[120:123]
  v_accvgpr_read_b32 v244, a237
  v_lshlrev_b32 v242, 16, v244
  v_mfma_f32_16x16x32_bf16 v[124:127], a[28:31], a[132:135], v[124:127]
  s_waitcnt vmcnt(23) lgkmcnt(1)
  v_mfma_f32_16x16x32_bf16 v[0:3], a[32:35], a[104:107], v[0:3]
  buffer_load_dwordx4 a[28:31], v208, s[8:11], s20 offen offset:1024
  v_mfma_f32_16x16x32_bf16 v[4:7], a[32:35], a[108:111], v[4:7]
  v_and_b32 v243, s27, v244
  v_mfma_f32_16x16x32_bf16 v[8:11], a[32:35], a[112:115], v[8:11]
  v_fma_f32 v238, v242, v202, v238
  v_fma_f32 v239, v243, v203, v239
  v_mfma_f32_16x16x32_bf16 v[12:15], a[32:35], a[116:119], v[12:15]
  v_mfma_f32_16x16x32_bf16 v[16:19], a[36:39], a[104:107], v[16:19]
  buffer_load_dwordx4 a[32:35], v208, s[8:11], s20 offen offset:2048
  v_mfma_f32_16x16x32_bf16 v[20:23], a[36:39], a[108:111], v[20:23]
  ds_read_b128 a[120:123], v210 offset:49152
  v_cvt_pk_bf16_f32 v229, v238, v239
  v_mfma_f32_16x16x32_bf16 v[24:27], a[36:39], a[112:115], v[24:27]
  ds_write_b64 v223, v[228:229] offset:8192
  s_waitcnt lgkmcnt(2)
  v_lshlrev_b32 v236, 16, v232
  v_mfma_f32_16x16x32_bf16 v[28:31], a[36:39], a[116:119], v[28:31]
  s_waitcnt vmcnt(23)
  v_mfma_f32_16x16x32_bf16 v[32:35], a[40:43], a[104:107], v[32:35]
  buffer_load_dwordx4 a[36:39], v208, s[8:11], s20 offen offset:3072
  v_and_b32 v237, s27, v232
  v_mfma_f32_16x16x32_bf16 v[36:39], a[40:43], a[108:111], v[36:39]
  ds_read_b128 a[124:127], v210 offset:53248
  v_accvgpr_read_b32 v244, a238
  v_mfma_f32_16x16x32_bf16 v[40:43], a[40:43], a[112:115], v[40:43]
  v_lshlrev_b32 v240, 16, v244
  v_and_b32 v241, s27, v244
  v_mfma_f32_16x16x32_bf16 v[44:47], a[40:43], a[116:119], v[44:47]
  v_mfma_f32_16x16x32_bf16 v[48:51], a[44:47], a[104:107], v[48:51]
  s_add_u32 s20, s20, 4096
  buffer_load_dwordx4 a[40:43], v208, s[8:11], s20 offen
  v_mfma_f32_16x16x32_bf16 v[52:55], a[44:47], a[108:111], v[52:55]
  ds_read_b128 a[128:131], v210 offset:57344
  v_fma_f32 v236, v240, v204, v236
  v_mfma_f32_16x16x32_bf16 v[56:59], a[44:47], a[112:115], v[56:59]
  v_fma_f32 v237, v241, v205, v237
  v_cvt_pk_bf16_f32 v232, v236, v237
  v_mfma_f32_16x16x32_bf16 v[60:63], a[44:47], a[116:119], v[60:63]
  s_waitcnt vmcnt(23)
  v_mfma_f32_16x16x32_bf16 v[64:67], a[48:51], a[104:107], v[64:67]
  buffer_load_dwordx4 a[44:47], v208, s[8:11], s20 offen offset:1024
  v_mfma_f32_16x16x32_bf16 v[68:71], a[48:51], a[108:111], v[68:71]
  ds_read_b128 a[132:135], v210 offset:61440
  v_lshlrev_b32 v238, 16, v233
  v_mfma_f32_16x16x32_bf16 v[72:75], a[48:51], a[112:115], v[72:75]
  v_and_b32 v239, s27, v233
  v_accvgpr_read_b32 v244, a239
  v_mfma_f32_16x16x32_bf16 v[76:79], a[48:51], a[116:119], v[76:79]
  v_mfma_f32_16x16x32_bf16 v[80:83], a[52:55], a[104:107], v[80:83]
  buffer_load_dwordx4 a[48:51], v208, s[8:11], s20 offen offset:2048
  v_mfma_f32_16x16x32_bf16 v[84:87], a[52:55], a[108:111], v[84:87]
  v_lshlrev_b32 v242, 16, v244
  v_and_b32 v243, s27, v244
  v_mfma_f32_16x16x32_bf16 v[88:91], a[52:55], a[112:115], v[88:91]
  v_fma_f32 v238, v242, v206, v238
  v_fma_f32 v239, v243, v207, v239
  v_mfma_f32_16x16x32_bf16 v[92:95], a[52:55], a[116:119], v[92:95]
  s_waitcnt vmcnt(23)
  v_mfma_f32_16x16x32_bf16 v[96:99], a[56:59], a[104:107], v[96:99]
  buffer_load_dwordx4 a[52:55], v208, s[8:11], s20 offen offset:3072
  v_mfma_f32_16x16x32_bf16 v[100:103], a[56:59], a[108:111], v[100:103]
  v_cvt_pk_bf16_f32 v233, v238, v239
  v_mfma_f32_16x16x32_bf16 v[104:107], a[56:59], a[112:115], v[104:107]
  ds_write_b64 v223, v[232:233] offset:12288
  ds_read_b128 v[128:131], v226 offset:7168
  v_mfma_f32_16x16x32_bf16 v[108:111], a[56:59], a[116:119], v[108:111]
  v_mfma_f32_16x16x32_bf16 v[112:115], a[60:63], a[104:107], v[112:115]
  s_add_u32 s20, s20, 4096
  buffer_load_dwordx4 a[56:59], v208, s[8:11], s20 offen
  v_mfma_f32_16x16x32_bf16 v[116:119], a[60:63], a[108:111], v[116:119]
  ds_read_b128 v[144:147], v226 offset:7184
  ds_read_b128 v[160:163], v226 offset:7296
  v_mfma_f32_16x16x32_bf16 v[120:123], a[60:63], a[112:115], v[120:123]
  ds_read_b128 v[176:179], v226 offset:7312
  ds_read_b128 v[192:195], v227 offset:6656
  v_mfma_f32_16x16x32_bf16 v[124:127], a[60:63], a[116:119], v[124:127]
  s_waitcnt vmcnt(23) lgkmcnt(6)
  v_mfma_f32_16x16x32_bf16 v[0:3], a[64:67], a[120:123], v[0:3]
  buffer_load_dwordx4 a[60:63], v208, s[8:11], s20 offen offset:1024
  v_mfma_f32_16x16x32_bf16 v[4:7], a[64:67], a[124:127], v[4:7]
  v_mfma_f32_16x16x32_bf16 v[8:11], a[64:67], a[128:131], v[8:11]
  v_mfma_f32_16x16x32_bf16 v[12:15], a[64:67], a[132:135], v[12:15]
  v_mfma_f32_16x16x32_bf16 v[16:19], a[68:71], a[120:123], v[16:19]
  buffer_load_dwordx4 a[64:67], v208, s[8:11], s20 offen offset:2048
  v_mfma_f32_16x16x32_bf16 v[20:23], a[68:71], a[124:127], v[20:23]
  ds_read_b128 a[104:107], v211 offset:49152
  v_mfma_f32_16x16x32_bf16 v[24:27], a[68:71], a[128:131], v[24:27]
  v_mfma_f32_16x16x32_bf16 v[28:31], a[68:71], a[132:135], v[28:31]
  s_waitcnt vmcnt(23)
  v_mfma_f32_16x16x32_bf16 v[32:35], a[72:75], a[120:123], v[32:35]
  buffer_load_dwordx4 a[68:71], v208, s[8:11], s20 offen offset:3072
  v_mfma_f32_16x16x32_bf16 v[36:39], a[72:75], a[124:127], v[36:39]
  ds_read_b128 a[108:111], v211 offset:53248
  v_mfma_f32_16x16x32_bf16 v[40:43], a[72:75], a[128:131], v[40:43]
  v_mfma_f32_16x16x32_bf16 v[44:47], a[72:75], a[132:135], v[44:47]
  v_mfma_f32_16x16x32_bf16 v[48:51], a[76:79], a[120:123], v[48:51]
  s_add_u32 s20, s20, 4096
  buffer_load_dwordx4 a[72:75], v208, s[8:11], s20 offen
  v_mfma_f32_16x16x32_bf16 v[52:55], a[76:79], a[124:127], v[52:55]
  ds_read_b128 a[112:115], v211 offset:57344
  v_mfma_f32_16x16x32_bf16 v[56:59], a[76:79], a[128:131], v[56:59]
  v_mfma_f32_16x16x32_bf16 v[60:63], a[76:79], a[132:135], v[60:63]
  s_waitcnt vmcnt(23)
  v_mfma_f32_16x16x32_bf16 v[64:67], a[80:83], a[120:123], v[64:67]
  buffer_load_dwordx4 a[76:79], v208, s[8:11], s20 offen offset:1024
  v_mfma_f32_16x16x32_bf16 v[68:71], a[80:83], a[124:127], v[68:71]
  ds_read_b128 a[116:119], v211 offset:61440
  v_mfma_f32_16x16x32_bf16 v[72:75], a[80:83], a[128:131], v[72:75]
  v_mfma_f32_16x16x32_bf16 v[76:79], a[80:83], a[132:135], v[76:79]
  v_mfma_f32_16x16x32_bf16 v[80:83], a[84:87], a[120:123], v[80:83]
  buffer_load_dwordx4 a[80:83], v208, s[8:11], s20 offen offset:2048
  v_mfma_f32_16x16x32_bf16 v[84:87], a[84:87], a[124:127], v[84:87]
  v_mfma_f32_16x16x32_bf16 v[88:91], a[84:87], a[128:131], v[88:91]
  v_mfma_f32_16x16x32_bf16 v[92:95], a[84:87], a[132:135], v[92:95]
  s_waitcnt vmcnt(23)
  v_mfma_f32_16x16x32_bf16 v[96:99], a[88:91], a[120:123], v[96:99]
  buffer_load_dwordx4 a[84:87], v208, s[8:11], s20 offen offset:3072
  v_mfma_f32_16x16x32_bf16 v[100:103], a[88:91], a[124:127], v[100:103]
  v_mfma_f32_16x16x32_bf16 v[104:107], a[88:91], a[128:131], v[104:107]
  v_mfma_f32_16x16x32_bf16 v[108:111], a[88:91], a[132:135], v[108:111]
  v_mfma_f32_16x16x32_bf16 v[112:115], a[92:95], a[120:123], v[112:115]
  s_add_u32 s20, s20, 4096
  buffer_load_dwordx4 a[88:91], v208, s[8:11], s20 offen
  v_mfma_f32_16x16x32_bf16 v[116:119], a[92:95], a[124:127], v[116:119]
  v_mfma_f32_16x16x32_bf16 v[120:123], a[92:95], a[128:131], v[120:123]
  v_mfma_f32_16x16x32_bf16 v[124:127], a[92:95], a[132:135], v[124:127]
  s_waitcnt lgkmcnt(0)
  s_barrier
  s_waitcnt vmcnt(23)
  v_mfma_f32_16x16x32_bf16 v[0:3], a[96:99], a[104:107], v[0:3]
  buffer_load_dwordx4 a[92:95], v208, s[8:11], s20 offen offset:1024
  v_mfma_f32_16x16x32_bf16 v[4:7], a[96:99], a[108:111], v[4:7]
  v_mfma_f32_16x16x32_bf16 v[8:11], a[96:99], a[112:115], v[8:11]
  v_mfma_f32_16x16x32_bf16 v[12:15], a[96:99], a[116:119], v[12:15]
  v_mfma_f32_16x16x32_bf16 v[16:19], a[100:103], a[104:107], v[16:19]
  buffer_load_dwordx4 a[96:99], v208, s[8:11], s20 offen offset:2048
  v_mfma_f32_16x16x32_bf16 v[20:23], a[100:103], a[108:111], v[20:23]
  ds_read_b128 a[120:123], v212 offset:49152
  v_mfma_f32_16x16x32_bf16 v[24:27], a[100:103], a[112:115], v[24:27]
  v_mfma_f32_16x16x32_bf16 v[28:31], a[100:103], a[116:119], v[28:31]
  s_waitcnt vmcnt(23)
  v_mfma_f32_16x16x32_bf16 v[32:35], a[0:3], a[104:107], v[32:35]
  buffer_load_dwordx4 a[100:103], v208, s[8:11], s20 offen offset:3072
  v_mfma_f32_16x16x32_bf16 v[36:39], a[0:3], a[108:111], v[36:39]
  ds_read_b128 a[124:127], v212 offset:53248
  v_mfma_f32_16x16x32_bf16 v[40:43], a[0:3], a[112:115], v[40:43]
  v_mfma_f32_16x16x32_bf16 v[44:47], a[0:3], a[116:119], v[44:47]
  v_mfma_f32_16x16x32_bf16 v[48:51], a[4:7], a[104:107], v[48:51]
  s_add_u32 s20, s20, 4096
  buffer_load_dwordx4 a[0:3], v208, s[8:11], s20 offen
  v_mfma_f32_16x16x32_bf16 v[52:55], a[4:7], a[108:111], v[52:55]
  ds_read_b128 a[128:131], v212 offset:57344
  v_mfma_f32_16x16x32_bf16 v[56:59], a[4:7], a[112:115], v[56:59]
  v_mfma_f32_16x16x32_bf16 v[60:63], a[4:7], a[116:119], v[60:63]
  s_waitcnt vmcnt(23)
  v_mfma_f32_16x16x32_bf16 v[64:67], a[8:11], a[104:107], v[64:67]
  buffer_load_dwordx4 a[4:7], v208, s[8:11], s20 offen offset:1024
  v_mfma_f32_16x16x32_bf16 v[68:71], a[8:11], a[108:111], v[68:71]
  ds_read_b128 a[132:135], v212 offset:61440
  v_mfma_f32_16x16x32_bf16 v[72:75], a[8:11], a[112:115], v[72:75]
  v_mfma_f32_16x16x32_bf16 v[76:79], a[8:11], a[116:119], v[76:79]
  v_mfma_f32_16x16x32_bf16 v[80:83], a[12:15], a[104:107], v[80:83]
  buffer_load_dwordx4 a[8:11], v208, s[8:11], s20 offen offset:2048
  v_mfma_f32_16x16x32_bf16 v[84:87], a[12:15], a[108:111], v[84:87]
  v_mfma_f32_16x16x32_bf16 v[88:91], a[12:15], a[112:115], v[88:91]
  v_mfma_f32_16x16x32_bf16 v[92:95], a[12:15], a[116:119], v[92:95]
  s_waitcnt vmcnt(23)
  v_mfma_f32_16x16x32_bf16 v[96:99], a[16:19], a[104:107], v[96:99]
  buffer_load_dwordx4 a[12:15], v208, s[8:11], s20 offen offset:3072
  v_mfma_f32_16x16x32_bf16 v[100:103], a[16:19], a[108:111], v[100:103]
  v_mfma_f32_16x16x32_bf16 v[104:107], a[16:19], a[112:115], v[104:107]
  v_mfma_f32_16x16x32_bf16 v[108:111], a[16:19], a[116:119], v[108:111]
  v_mfma_f32_16x16x32_bf16 v[112:115], a[20:23], a[104:107], v[112:115]
  s_add_u32 s20, s20, 4096
  buffer_load_dwordx4 a[16:19], v208, s[8:11], s20 offen
  v_mfma_f32_16x16x32_bf16 v[116:119], a[20:23], a[108:111], v[116:119]
  v_mfma_f32_16x16x32_bf16 v[120:123], a[20:23], a[112:115], v[120:123]
  v_mfma_f32_16x16x32_bf16 v[124:127], a[20:23], a[116:119], v[124:127]
  s_waitcnt vmcnt(23) lgkmcnt(0)
  v_mfma_f32_16x16x32_bf16 v[0:3], a[24:27], a[120:123], v[0:3]
  buffer_load_dwordx4 a[20:23], v208, s[8:11], s20 offen offset:1024
  v_mfma_f32_16x16x32_bf16 v[4:7], a[24:27], a[124:127], v[4:7]
  v_mfma_f32_16x16x32_bf16 v[8:11], a[24:27], a[128:131], v[8:11]
  v_mfma_f32_16x16x32_bf16 v[12:15], a[24:27], a[132:135], v[12:15]
  v_mfma_f32_16x16x32_bf16 v[16:19], a[28:31], a[120:123], v[16:19]
  buffer_load_dwordx4 a[24:27], v208, s[8:11], s20 offen offset:2048
  v_mfma_f32_16x16x32_bf16 v[20:23], a[28:31], a[124:127], v[20:23]
  ds_read_b128 a[104:107], v213
  v_mfma_f32_16x16x32_bf16 v[24:27], a[28:31], a[128:131], v[24:27]
  v_mfma_f32_16x16x32_bf16 v[28:31], a[28:31], a[132:135], v[28:31]
  s_waitcnt vmcnt(23)
  v_mfma_f32_16x16x32_bf16 v[32:35], a[32:35], a[120:123], v[32:35]
  buffer_load_dwordx4 a[28:31], v208, s[8:11], s20 offen offset:3072
  v_mfma_f32_16x16x32_bf16 v[36:39], a[32:35], a[124:127], v[36:39]
  ds_read_b128 a[108:111], v213 offset:4096
  v_mfma_f32_16x16x32_bf16 v[40:43], a[32:35], a[128:131], v[40:43]
  v_mfma_f32_16x16x32_bf16 v[44:47], a[32:35], a[132:135], v[44:47]
  v_mfma_f32_16x16x32_bf16 v[48:51], a[36:39], a[120:123], v[48:51]
  s_add_u32 s20, s20, 4096
  buffer_load_dwordx4 a[32:35], v208, s[8:11], s20 offen
  v_mfma_f32_16x16x32_bf16 v[52:55], a[36:39], a[124:127], v[52:55]
  ds_read_b128 a[112:115], v213 offset:8192
  v_mfma_f32_16x16x32_bf16 v[56:59], a[36:39], a[128:131], v[56:59]
  v_mfma_f32_16x16x32_bf16 v[60:63], a[36:39], a[132:135], v[60:63]
  s_waitcnt vmcnt(23)
  v_mfma_f32_16x16x32_bf16 v[64:67], a[40:43], a[120:123], v[64:67]
  buffer_load_dwordx4 a[36:39], v208, s[8:11], s20 offen offset:1024
  v_mfma_f32_16x16x32_bf16 v[68:71], a[40:43], a[124:127], v[68:71]
  ds_read_b128 a[116:119], v213 offset:12288
  v_mfma_f32_16x16x32_bf16 v[72:75], a[40:43], a[128:131], v[72:75]
  v_mfma_f32_16x16x32_bf16 v[76:79], a[40:43], a[132:135], v[76:79]
  v_mfma_f32_16x16x32_bf16 v[80:83], a[44:47], a[120:123], v[80:83]
  buffer_load_dwordx4 a[40:43], v208, s[8:11], s20 offen offset:2048
  v_mfma_f32_16x16x32_bf16 v[84:87], a[44:47], a[124:127], v[84:87]
  v_mfma_f32_16x16x32_bf16 v[88:91], a[44:47], a[128:131], v[88:91]
  v_mfma_f32_16x16x32_bf16 v[92:95], a[44:47], a[132:135], v[92:95]
  s_waitcnt vmcnt(23)
  v_mfma_f32_16x16x32_bf16 v[96:99], a[48:51], a[120:123], v[96:99]
  buffer_load_dwordx4 a[44:47], v208, s[8:11], s20 offen offset:3072
  v_mfma_f32_16x16x32_bf16 v[100:103], a[48:51], a[124:127], v[100:103]
  v_mfma_f32_16x16x32_bf16 v[104:107], a[48:51], a[128:131], v[104:107]
  v_mfma_f32_16x16x32_bf16 v[108:111], a[48:51], a[132:135], v[108:111]
  v_mfma_f32_16x16x32_bf16 v[112:115], a[52:55], a[120:123], v[112:115]
  s_add_u32 s20, s20, 4096
  buffer_load_dwordx4 a[48:51], v208, s[8:11], s20 offen
  v_mfma_f32_16x16x32_bf16 v[116:119], a[52:55], a[124:127], v[116:119]
  v_mfma_f32_16x16x32_bf16 v[120:123], a[52:55], a[128:131], v[120:123]
  v_mfma_f32_16x16x32_bf16 v[124:127], a[52:55], a[132:135], v[124:127]
  s_waitcnt vmcnt(23) lgkmcnt(0)
  v_mfma_f32_16x16x32_bf16 v[0:3], a[56:59], a[104:107], v[0:3]
  buffer_load_dwordx4 a[52:55], v208, s[8:11], s20 offen offset:1024
  v_mfma_f32_16x16x32_bf16 v[4:7], a[56:59], a[108:111], v[4:7]
  v_mfma_f32_16x16x32_bf16 v[8:11], a[56:59], a[112:115], v[8:11]
  v_mfma_f32_16x16x32_bf16 v[12:15], a[56:59], a[116:119], v[12:15]
  v_mfma_f32_16x16x32_bf16 v[16:19], a[60:63], a[104:107], v[16:19]
  buffer_load_dwordx4 a[56:59], v208, s[8:11], s20 offen offset:2048
  v_mfma_f32_16x16x32_bf16 v[20:23], a[60:63], a[108:111], v[20:23]
  ds_read_b128 a[120:123], v214
  v_mfma_f32_16x16x32_bf16 v[24:27], a[60:63], a[112:115], v[24:27]
  v_mfma_f32_16x16x32_bf16 v[28:31], a[60:63], a[116:119], v[28:31]
  s_waitcnt vmcnt(23)
  v_mfma_f32_16x16x32_bf16 v[32:35], a[64:67], a[104:107], v[32:35]
  buffer_load_dwordx4 a[60:63], v208, s[8:11], s20 offen offset:3072
  v_mfma_f32_16x16x32_bf16 v[36:39], a[64:67], a[108:111], v[36:39]
  ds_read_b128 a[124:127], v214 offset:4096
  v_mfma_f32_16x16x32_bf16 v[40:43], a[64:67], a[112:115], v[40:43]
  v_mfma_f32_16x16x32_bf16 v[44:47], a[64:67], a[116:119], v[44:47]
  v_mfma_f32_16x16x32_bf16 v[48:51], a[68:71], a[104:107], v[48:51]
  s_add_u32 s20, s20, 4096
  buffer_load_dwordx4 a[64:67], v208, s[8:11], s20 offen
  v_mfma_f32_16x16x32_bf16 v[52:55], a[68:71], a[108:111], v[52:55]
  ds_read_b128 a[128:131], v214 offset:8192
  v_mfma_f32_16x16x32_bf16 v[56:59], a[68:71], a[112:115], v[56:59]
  v_mfma_f32_16x16x32_bf16 v[60:63], a[68:71], a[116:119], v[60:63]
  s_waitcnt vmcnt(23)
  v_mfma_f32_16x16x32_bf16 v[64:67], a[72:75], a[104:107], v[64:67]
  buffer_load_dwordx4 a[68:71], v208, s[8:11], s20 offen offset:1024
  v_mfma_f32_16x16x32_bf16 v[68:71], a[72:75], a[108:111], v[68:71]
  ds_read_b128 a[132:135], v214 offset:12288
  v_mfma_f32_16x16x32_bf16 v[72:75], a[72:75], a[112:115], v[72:75]
  v_mfma_f32_16x16x32_bf16 v[76:79], a[72:75], a[116:119], v[76:79]
  v_mfma_f32_16x16x32_bf16 v[80:83], a[76:79], a[104:107], v[80:83]
  buffer_load_dwordx4 a[72:75], v208, s[8:11], s20 offen offset:2048
  v_mfma_f32_16x16x32_bf16 v[84:87], a[76:79], a[108:111], v[84:87]
  v_mfma_f32_16x16x32_bf16 v[88:91], a[76:79], a[112:115], v[88:91]
  v_mfma_f32_16x16x32_bf16 v[92:95], a[76:79], a[116:119], v[92:95]
  s_waitcnt vmcnt(23)
  v_mfma_f32_16x16x32_bf16 v[96:99], a[80:83], a[104:107], v[96:99]
  buffer_load_dwordx4 a[76:79], v208, s[8:11], s20 offen offset:3072
  v_mfma_f32_16x16x32_bf16 v[100:103], a[80:83], a[108:111], v[100:103]
  v_mfma_f32_16x16x32_bf16 v[104:107], a[80:83], a[112:115], v[104:107]
  v_mfma_f32_16x16x32_bf16 v[108:111], a[80:83], a[116:119], v[108:111]
  v_mfma_f32_16x16x32_bf16 v[112:115], a[84:87], a[104:107], v[112:115]
  s_add_u32 s20, s20, 4096
  buffer_load_dwordx4 a[80:83], v208, s[8:11], s20 offen
  v_mfma_f32_16x16x32_bf16 v[116:119], a[84:87], a[108:111], v[116:119]
  v_mfma_f32_16x16x32_bf16 v[120:123], a[84:87], a[112:115], v[120:123]
  v_mfma_f32_16x16x32_bf16 v[124:127], a[84:87], a[116:119], v[124:127]
  s_waitcnt vmcnt(23) lgkmcnt(0)
  v_mfma_f32_16x16x32_bf16 v[0:3], a[88:91], a[120:123], v[0:3]
  buffer_load_dwordx4 a[84:87], v208, s[8:11], s20 offen offset:1024
  v_mfma_f32_16x16x32_bf16 v[4:7], a[88:91], a[124:127], v[4:7]
  v_mfma_f32_16x16x32_bf16 v[8:11], a[88:91], a[128:131], v[8:11]
  v_mfma_f32_16x16x32_bf16 v[12:15], a[88:91], a[132:135], v[12:15]
  v_mfma_f32_16x16x32_bf16 v[16:19], a[92:95], a[120:123], v[16:19]
  buffer_load_dwordx4 a[88:91], v208, s[8:11], s20 offen offset:2048
  v_mfma_f32_16x16x32_bf16 v[20:23], a[92:95], a[124:127], v[20:23]
  ds_read_b128 a[104:107], v215
  v_mfma_f32_16x16x32_bf16 v[24:27], a[92:95], a[128:131], v[24:27]
  v_mfma_f32_16x16x32_bf16 v[28:31], a[92:95], a[132:135], v[28:31]
  s_waitcnt vmcnt(23)
  v_mfma_f32_16x16x32_bf16 v[32:35], a[96:99], a[120:123], v[32:35]
  buffer_load_dwordx4 a[92:95], v208, s[8:11], s20 offen offset:3072
  v_mfma_f32_16x16x32_bf16 v[36:39], a[96:99], a[124:127], v[36:39]
  ds_read_b128 a[108:111], v215 offset:4096
  v_mfma_f32_16x16x32_bf16 v[40:43], a[96:99], a[128:131], v[40:43]
  v_mfma_f32_16x16x32_bf16 v[44:47], a[96:99], a[132:135], v[44:47]
  v_mfma_f32_16x16x32_bf16 v[48:51], a[100:103], a[120:123], v[48:51]
  s_add_u32 s20, s20, 4096
  buffer_load_dwordx4 a[96:99], v208, s[8:11], s20 offen
  v_mfma_f32_16x16x32_bf16 v[52:55], a[100:103], a[124:127], v[52:55]
  ds_read_b128 a[112:115], v215 offset:8192
  v_mfma_f32_16x16x32_bf16 v[56:59], a[100:103], a[128:131], v[56:59]
  v_mfma_f32_16x16x32_bf16 v[60:63], a[100:103], a[132:135], v[60:63]
  s_waitcnt vmcnt(23)
  v_mfma_f32_16x16x32_bf16 v[64:67], a[0:3], a[120:123], v[64:67]
  buffer_load_dwordx4 a[100:103], v208, s[8:11], s20 offen offset:1024
  v_mfma_f32_16x16x32_bf16 v[68:71], a[0:3], a[124:127], v[68:71]
  ds_read_b128 a[116:119], v215 offset:12288
  v_mfma_f32_16x16x32_bf16 v[72:75], a[0:3], a[128:131], v[72:75]
  v_mfma_f32_16x16x32_bf16 v[76:79], a[0:3], a[132:135], v[76:79]
  v_mfma_f32_16x16x32_bf16 v[80:83], a[4:7], a[120:123], v[80:83]
  buffer_load_dwordx4 a[0:3], v208, s[8:11], s20 offen offset:2048
  v_mfma_f32_16x16x32_bf16 v[84:87], a[4:7], a[124:127], v[84:87]
  v_mfma_f32_16x16x32_bf16 v[88:91], a[4:7], a[128:131], v[88:91]
  v_mfma_f32_16x16x32_bf16 v[92:95], a[4:7], a[132:135], v[92:95]
  s_waitcnt vmcnt(23)
  v_mfma_f32_16x16x32_bf16 v[96:99], a[8:11], a[120:123], v[96:99]
  buffer_load_dwordx4 a[4:7], v208, s[8:11], s20 offen offset:3072
  v_mfma_f32_16x16x32_bf16 v[100:103], a[8:11], a[124:127], v[100:103]
  v_mfma_f32_16x16x32_bf16 v[104:107], a[8:11], a[128:131], v[104:107]
  v_mfma_f32_16x16x32_bf16 v[108:111], a[8:11], a[132:135], v[108:111]
  v_mfma_f32_16x16x32_bf16 v[112:115], a[12:15], a[120:123], v[112:115]
  s_add_u32 s20, s20, 4096
  buffer_load_dwordx4 a[8:11], v208, s[8:11], s20 offen
  v_mfma_f32_16x16x32_bf16 v[116:119], a[12:15], a[124:127], v[116:119]
  v_mfma_f32_16x16x32_bf16 v[120:123], a[12:15], a[128:131], v[120:123]
  v_mfma_f32_16x16x32_bf16 v[124:127], a[12:15], a[132:135], v[124:127]
  s_waitcnt vmcnt(23) lgkmcnt(0)
  v_mfma_f32_16x16x32_bf16 v[0:3], a[16:19], a[104:107], v[0:3]
  buffer_load_dwordx4 a[12:15], v208, s[8:11], s20 offen offset:1024
  v_mfma_f32_16x16x32_bf16 v[4:7], a[16:19], a[108:111], v[4:7]
  v_mfma_f32_16x16x32_bf16 v[8:11], a[16:19], a[112:115], v[8:11]
  v_mfma_f32_16x16x32_bf16 v[12:15], a[16:19], a[116:119], v[12:15]
  v_mfma_f32_16x16x32_bf16 v[16:19], a[20:23], a[104:107], v[16:19]
  buffer_load_dwordx4 a[16:19], v208, s[8:11], s20 offen offset:2048
  v_mfma_f32_16x16x32_bf16 v[20:23], a[20:23], a[108:111], v[20:23]
  ds_read_b128 a[120:123], v216
  v_mfma_f32_16x16x32_bf16 v[24:27], a[20:23], a[112:115], v[24:27]
  v_mfma_f32_16x16x32_bf16 v[28:31], a[20:23], a[116:119], v[28:31]
  s_waitcnt vmcnt(23)
  v_mfma_f32_16x16x32_bf16 v[32:35], a[24:27], a[104:107], v[32:35]
  buffer_load_dwordx4 a[20:23], v208, s[8:11], s20 offen offset:3072
  v_mfma_f32_16x16x32_bf16 v[36:39], a[24:27], a[108:111], v[36:39]
  ds_read_b128 a[124:127], v216 offset:4096
  v_mfma_f32_16x16x32_bf16 v[40:43], a[24:27], a[112:115], v[40:43]
  v_mfma_f32_16x16x32_bf16 v[44:47], a[24:27], a[116:119], v[44:47]
  v_mfma_f32_16x16x32_bf16 v[48:51], a[28:31], a[104:107], v[48:51]
  s_add_u32 s20, s20, 4096
  buffer_load_dwordx4 a[24:27], v208, s[8:11], s20 offen
  v_mfma_f32_16x16x32_bf16 v[52:55], a[28:31], a[108:111], v[52:55]
  ds_read_b128 a[128:131], v216 offset:8192
  v_mfma_f32_16x16x32_bf16 v[56:59], a[28:31], a[112:115], v[56:59]
  v_mfma_f32_16x16x32_bf16 v[60:63], a[28:31], a[116:119], v[60:63]
  s_waitcnt vmcnt(23)
  v_mfma_f32_16x16x32_bf16 v[64:67], a[32:35], a[104:107], v[64:67]
  buffer_load_dwordx4 a[28:31], v208, s[8:11], s20 offen offset:1024
  v_mfma_f32_16x16x32_bf16 v[68:71], a[32:35], a[108:111], v[68:71]
  ds_read_b128 a[132:135], v216 offset:12288
  v_mfma_f32_16x16x32_bf16 v[72:75], a[32:35], a[112:115], v[72:75]
  v_mfma_f32_16x16x32_bf16 v[76:79], a[32:35], a[116:119], v[76:79]
  v_mfma_f32_16x16x32_bf16 v[80:83], a[36:39], a[104:107], v[80:83]
  buffer_load_dwordx4 a[32:35], v208, s[8:11], s20 offen offset:2048
  v_mfma_f32_16x16x32_bf16 v[84:87], a[36:39], a[108:111], v[84:87]
  v_mfma_f32_16x16x32_bf16 v[88:91], a[36:39], a[112:115], v[88:91]
  v_mfma_f32_16x16x32_bf16 v[92:95], a[36:39], a[116:119], v[92:95]
  s_waitcnt vmcnt(23)
  v_mfma_f32_16x16x32_bf16 v[96:99], a[40:43], a[104:107], v[96:99]
  buffer_load_dwordx4 a[36:39], v208, s[8:11], s20 offen offset:3072
  v_mfma_f32_16x16x32_bf16 v[100:103], a[40:43], a[108:111], v[100:103]
  v_mfma_f32_16x16x32_bf16 v[104:107], a[40:43], a[112:115], v[104:107]
  v_mfma_f32_16x16x32_bf16 v[108:111], a[40:43], a[116:119], v[108:111]
  v_mfma_f32_16x16x32_bf16 v[112:115], a[44:47], a[104:107], v[112:115]
  s_add_u32 s20, s20, 4096
  buffer_load_dwordx4 a[40:43], v208, s[8:11], s20 offen
  v_mfma_f32_16x16x32_bf16 v[116:119], a[44:47], a[108:111], v[116:119]
  v_mfma_f32_16x16x32_bf16 v[120:123], a[44:47], a[112:115], v[120:123]
  v_mfma_f32_16x16x32_bf16 v[124:127], a[44:47], a[116:119], v[124:127]
  s_waitcnt vmcnt(23) lgkmcnt(0)
  v_mfma_f32_16x16x32_bf16 v[0:3], a[48:51], a[120:123], v[0:3]
  buffer_load_dwordx4 a[44:47], v208, s[8:11], s20 offen offset:1024
  v_mfma_f32_16x16x32_bf16 v[4:7], a[48:51], a[124:127], v[4:7]
  v_mfma_f32_16x16x32_bf16 v[8:11], a[48:51], a[128:131], v[8:11]
  v_mfma_f32_16x16x32_bf16 v[12:15], a[48:51], a[132:135], v[12:15]
  v_mfma_f32_16x16x32_bf16 v[16:19], a[52:55], a[120:123], v[16:19]
  buffer_load_dwordx4 a[48:51], v208, s[8:11], s20 offen offset:2048
  v_mfma_f32_16x16x32_bf16 v[20:23], a[52:55], a[124:127], v[20:23]
  ds_read_b128 a[104:107], v213 offset:16384
  v_mfma_f32_16x16x32_bf16 v[24:27], a[52:55], a[128:131], v[24:27]
  v_mfma_f32_16x16x32_bf16 v[28:31], a[52:55], a[132:135], v[28:31]
  s_waitcnt vmcnt(23)
  v_mfma_f32_16x16x32_bf16 v[32:35], a[56:59], a[120:123], v[32:35]
  buffer_load_dwordx4 a[52:55], v208, s[8:11], s20 offen offset:3072
  v_mfma_f32_16x16x32_bf16 v[36:39], a[56:59], a[124:127], v[36:39]
  ds_read_b128 a[108:111], v213 offset:20480
  v_mfma_f32_16x16x32_bf16 v[40:43], a[56:59], a[128:131], v[40:43]
  v_mfma_f32_16x16x32_bf16 v[44:47], a[56:59], a[132:135], v[44:47]
  v_mfma_f32_16x16x32_bf16 v[48:51], a[60:63], a[120:123], v[48:51]
  s_add_u32 s20, s20, 4096
  buffer_load_dwordx4 a[56:59], v208, s[8:11], s20 offen
  v_mfma_f32_16x16x32_bf16 v[52:55], a[60:63], a[124:127], v[52:55]
  ds_read_b128 a[112:115], v213 offset:24576
  v_mfma_f32_16x16x32_bf16 v[56:59], a[60:63], a[128:131], v[56:59]
  v_mfma_f32_16x16x32_bf16 v[60:63], a[60:63], a[132:135], v[60:63]
  s_waitcnt vmcnt(23)
  v_mfma_f32_16x16x32_bf16 v[64:67], a[64:67], a[120:123], v[64:67]
  buffer_load_dwordx4 a[60:63], v208, s[8:11], s20 offen offset:1024
  v_mfma_f32_16x16x32_bf16 v[68:71], a[64:67], a[124:127], v[68:71]
  ds_read_b128 a[116:119], v213 offset:28672
  v_mfma_f32_16x16x32_bf16 v[72:75], a[64:67], a[128:131], v[72:75]
  v_mfma_f32_16x16x32_bf16 v[76:79], a[64:67], a[132:135], v[76:79]
  v_mfma_f32_16x16x32_bf16 v[80:83], a[68:71], a[120:123], v[80:83]
  buffer_load_dwordx4 a[64:67], v208, s[8:11], s20 offen offset:2048
  v_mfma_f32_16x16x32_bf16 v[84:87], a[68:71], a[124:127], v[84:87]
  v_mfma_f32_16x16x32_bf16 v[88:91], a[68:71], a[128:131], v[88:91]
  v_mfma_f32_16x16x32_bf16 v[92:95], a[68:71], a[132:135], v[92:95]
  s_waitcnt vmcnt(23)
  v_mfma_f32_16x16x32_bf16 v[96:99], a[72:75], a[120:123], v[96:99]
  buffer_load_dwordx4 a[68:71], v208, s[8:11], s20 offen offset:3072
  v_mfma_f32_16x16x32_bf16 v[100:103], a[72:75], a[124:127], v[100:103]
  v_mfma_f32_16x16x32_bf16 v[104:107], a[72:75], a[128:131], v[104:107]
  v_mfma_f32_16x16x32_bf16 v[108:111], a[72:75], a[132:135], v[108:111]
  v_mfma_f32_16x16x32_bf16 v[112:115], a[76:79], a[120:123], v[112:115]
  s_add_u32 s20, s20, 4096
  buffer_load_dwordx4 a[72:75], v208, s[8:11], s20 offen
  v_mfma_f32_16x16x32_bf16 v[116:119], a[76:79], a[124:127], v[116:119]
  v_mfma_f32_16x16x32_bf16 v[120:123], a[76:79], a[128:131], v[120:123]
  v_mfma_f32_16x16x32_bf16 v[124:127], a[76:79], a[132:135], v[124:127]
  s_waitcnt vmcnt(23) lgkmcnt(0)
  v_mfma_f32_16x16x32_bf16 v[0:3], a[80:83], a[104:107], v[0:3]
  buffer_load_dwordx4 a[76:79], v208, s[8:11], s20 offen offset:1024
  v_mfma_f32_16x16x32_bf16 v[4:7], a[80:83], a[108:111], v[4:7]
  v_mfma_f32_16x16x32_bf16 v[8:11], a[80:83], a[112:115], v[8:11]
  v_mfma_f32_16x16x32_bf16 v[12:15], a[80:83], a[116:119], v[12:15]
  v_mfma_f32_16x16x32_bf16 v[16:19], a[84:87], a[104:107], v[16:19]
  buffer_load_dwordx4 a[80:83], v208, s[8:11], s20 offen offset:2048
  v_mfma_f32_16x16x32_bf16 v[20:23], a[84:87], a[108:111], v[20:23]
  ds_read_b128 a[120:123], v214 offset:16384
  v_mfma_f32_16x16x32_bf16 v[24:27], a[84:87], a[112:115], v[24:27]
  v_mfma_f32_16x16x32_bf16 v[28:31], a[84:87], a[116:119], v[28:31]
  s_waitcnt vmcnt(23)
  v_mfma_f32_16x16x32_bf16 v[32:35], a[88:91], a[104:107], v[32:35]
  buffer_load_dwordx4 a[84:87], v208, s[8:11], s20 offen offset:3072
  v_mfma_f32_16x16x32_bf16 v[36:39], a[88:91], a[108:111], v[36:39]
  ds_read_b128 a[124:127], v214 offset:20480
  v_mfma_f32_16x16x32_bf16 v[40:43], a[88:91], a[112:115], v[40:43]
  v_mfma_f32_16x16x32_bf16 v[44:47], a[88:91], a[116:119], v[44:47]
  v_mfma_f32_16x16x32_bf16 v[48:51], a[92:95], a[104:107], v[48:51]
  s_add_u32 s20, s20, 4096
  buffer_load_dwordx4 a[88:91], v208, s[8:11], s20 offen
  v_mfma_f32_16x16x32_bf16 v[52:55], a[92:95], a[108:111], v[52:55]
  ds_read_b128 a[128:131], v214 offset:24576
  v_mfma_f32_16x16x32_bf16 v[56:59], a[92:95], a[112:115], v[56:59]
  v_mfma_f32_16x16x32_bf16 v[60:63], a[92:95], a[116:119], v[60:63]
  s_waitcnt vmcnt(23)
  v_mfma_f32_16x16x32_bf16 v[64:67], a[96:99], a[104:107], v[64:67]
  buffer_load_dwordx4 a[92:95], v208, s[8:11], s20 offen offset:1024
  v_mfma_f32_16x16x32_bf16 v[68:71], a[96:99], a[108:111], v[68:71]
  ds_read_b128 a[132:135], v214 offset:28672
  v_mfma_f32_16x16x32_bf16 v[72:75], a[96:99], a[112:115], v[72:75]
  v_mfma_f32_16x16x32_bf16 v[76:79], a[96:99], a[116:119], v[76:79]
  v_mfma_f32_16x16x32_bf16 v[80:83], a[100:103], a[104:107], v[80:83]
  buffer_load_dwordx4 a[96:99], v208, s[8:11], s20 offen offset:2048
  v_mfma_f32_16x16x32_bf16 v[84:87], a[100:103], a[108:111], v[84:87]
  v_mfma_f32_16x16x32_bf16 v[88:91], a[100:103], a[112:115], v[88:91]
  v_mfma_f32_16x16x32_bf16 v[92:95], a[100:103], a[116:119], v[92:95]
  s_waitcnt vmcnt(23)
  v_mfma_f32_16x16x32_bf16 v[96:99], a[0:3], a[104:107], v[96:99]
  buffer_load_dwordx4 a[100:103], v208, s[8:11], s20 offen offset:3072
  v_mfma_f32_16x16x32_bf16 v[100:103], a[0:3], a[108:111], v[100:103]
  v_mfma_f32_16x16x32_bf16 v[104:107], a[0:3], a[112:115], v[104:107]
  v_mfma_f32_16x16x32_bf16 v[108:111], a[0:3], a[116:119], v[108:111]
  v_mfma_f32_16x16x32_bf16 v[112:115], a[4:7], a[104:107], v[112:115]
  s_add_u32 s20, s20, 4096
  buffer_load_dwordx4 a[0:3], v208, s[8:11], s20 offen
  v_mfma_f32_16x16x32_bf16 v[116:119], a[4:7], a[108:111], v[116:119]
  v_mfma_f32_16x16x32_bf16 v[120:123], a[4:7], a[112:115], v[120:123]
  v_mfma_f32_16x16x32_bf16 v[124:127], a[4:7], a[116:119], v[124:127]
  s_waitcnt vmcnt(23) lgkmcnt(0)
  v_mfma_f32_16x16x32_bf16 v[0:3], a[8:11], a[120:123], v[0:3]
  buffer_load_dwordx4 a[4:7], v208, s[8:11], s20 offen offset:1024
  v_mfma_f32_16x16x32_bf16 v[4:7], a[8:11], a[124:127], v[4:7]
  v_mfma_f32_16x16x32_bf16 v[8:11], a[8:11], a[128:131], v[8:11]
  v_mfma_f32_16x16x32_bf16 v[12:15], a[8:11], a[132:135], v[12:15]
  v_mfma_f32_16x16x32_bf16 v[16:19], a[12:15], a[120:123], v[16:19]
  buffer_load_dwordx4 a[8:11], v208, s[8:11], s20 offen offset:2048
  v_mfma_f32_16x16x32_bf16 v[20:23], a[12:15], a[124:127], v[20:23]
  ds_read_b128 a[104:107], v215 offset:16384
  v_mfma_f32_16x16x32_bf16 v[24:27], a[12:15], a[128:131], v[24:27]
  v_mfma_f32_16x16x32_bf16 v[28:31], a[12:15], a[132:135], v[28:31]
  s_waitcnt vmcnt(23)
  v_mfma_f32_16x16x32_bf16 v[32:35], a[16:19], a[120:123], v[32:35]
  buffer_load_dwordx4 a[12:15], v208, s[8:11], s20 offen offset:3072
  v_mfma_f32_16x16x32_bf16 v[36:39], a[16:19], a[124:127], v[36:39]
  ds_read_b128 a[108:111], v215 offset:20480
  v_mfma_f32_16x16x32_bf16 v[40:43], a[16:19], a[128:131], v[40:43]
  v_mfma_f32_16x16x32_bf16 v[44:47], a[16:19], a[132:135], v[44:47]
  v_mfma_f32_16x16x32_bf16 v[48:51], a[20:23], a[120:123], v[48:51]
  s_add_u32 s20, s20, 4096
  buffer_load_dwordx4 a[16:19], v208, s[8:11], s20 offen
  v_mfma_f32_16x16x32_bf16 v[52:55], a[20:23], a[124:127], v[52:55]
  ds_read_b128 a[112:115], v215 offset:24576
  v_mfma_f32_16x16x32_bf16 v[56:59], a[20:23], a[128:131], v[56:59]
  v_mfma_f32_16x16x32_bf16 v[60:63], a[20:23], a[132:135], v[60:63]
  s_waitcnt vmcnt(23)
  v_mfma_f32_16x16x32_bf16 v[64:67], a[24:27], a[120:123], v[64:67]
  buffer_load_dwordx4 a[20:23], v208, s[8:11], s20 offen offset:1024
  v_mfma_f32_16x16x32_bf16 v[68:71], a[24:27], a[124:127], v[68:71]
  ds_read_b128 a[116:119], v215 offset:28672
  v_mfma_f32_16x16x32_bf16 v[72:75], a[24:27], a[128:131], v[72:75]
  v_mfma_f32_16x16x32_bf16 v[76:79], a[24:27], a[132:135], v[76:79]
  v_mfma_f32_16x16x32_bf16 v[80:83], a[28:31], a[120:123], v[80:83]
  buffer_load_dwordx4 a[24:27], v208, s[8:11], s20 offen offset:2048
  v_mfma_f32_16x16x32_bf16 v[84:87], a[28:31], a[124:127], v[84:87]
  v_mfma_f32_16x16x32_bf16 v[88:91], a[28:31], a[128:131], v[88:91]
  v_mfma_f32_16x16x32_bf16 v[92:95], a[28:31], a[132:135], v[92:95]
  s_waitcnt vmcnt(23)
  v_mfma_f32_16x16x32_bf16 v[96:99], a[32:35], a[120:123], v[96:99]
  buffer_load_dwordx4 a[28:31], v208, s[8:11], s20 offen offset:3072
  v_mfma_f32_16x16x32_bf16 v[100:103], a[32:35], a[124:127], v[100:103]
  v_mfma_f32_16x16x32_bf16 v[104:107], a[32:35], a[128:131], v[104:107]
  v_mfma_f32_16x16x32_bf16 v[108:111], a[32:35], a[132:135], v[108:111]
  v_mfma_f32_16x16x32_bf16 v[112:115], a[36:39], a[120:123], v[112:115]
  s_add_u32 s20, s20, 4096
  buffer_load_dwordx4 a[32:35], v208, s[8:11], s20 offen
  v_mfma_f32_16x16x32_bf16 v[116:119], a[36:39], a[124:127], v[116:119]
  v_mfma_f32_16x16x32_bf16 v[120:123], a[36:39], a[128:131], v[120:123]
  v_mfma_f32_16x16x32_bf16 v[124:127], a[36:39], a[132:135], v[124:127]
  s_waitcnt vmcnt(23) lgkmcnt(0)
  v_mfma_f32_16x16x32_bf16 v[0:3], a[40:43], a[104:107], v[0:3]
  buffer_load_dwordx4 a[36:39], v208, s[8:11], s20 offen offset:1024
  v_mfma_f32_16x16x32_bf16 v[4:7], a[40:43], a[108:111], v[4:7]
  v_mfma_f32_16x16x32_bf16 v[8:11], a[40:43], a[112:115], v[8:11]
  v_mfma_f32_16x16x32_bf16 v[12:15], a[40:43], a[116:119], v[12:15]
  v_mfma_f32_16x16x32_bf16 v[16:19], a[44:47], a[104:107], v[16:19]
  buffer_load_dwordx4 a[40:43], v208, s[8:11], s20 offen offset:2048
  v_mfma_f32_16x16x32_bf16 v[20:23], a[44:47], a[108:111], v[20:23]
  ds_read_b128 a[120:123], v216 offset:16384
  v_mfma_f32_16x16x32_bf16 v[24:27], a[44:47], a[112:115], v[24:27]
  v_mfma_f32_16x16x32_bf16 v[28:31], a[44:47], a[116:119], v[28:31]
  s_waitcnt vmcnt(23)
  v_mfma_f32_16x16x32_bf16 v[32:35], a[48:51], a[104:107], v[32:35]
  buffer_load_dwordx4 a[44:47], v208, s[8:11], s20 offen offset:3072
  v_mfma_f32_16x16x32_bf16 v[36:39], a[48:51], a[108:111], v[36:39]
  ds_read_b128 a[124:127], v216 offset:20480
  v_mfma_f32_16x16x32_bf16 v[40:43], a[48:51], a[112:115], v[40:43]
  v_mfma_f32_16x16x32_bf16 v[44:47], a[48:51], a[116:119], v[44:47]
  v_mfma_f32_16x16x32_bf16 v[48:51], a[52:55], a[104:107], v[48:51]
  s_add_u32 s20, s20, 4096
  buffer_load_dwordx4 a[48:51], v208, s[8:11], s20 offen
  v_mfma_f32_16x16x32_bf16 v[52:55], a[52:55], a[108:111], v[52:55]
  ds_read_b128 a[128:131], v216 offset:24576
  v_mfma_f32_16x16x32_bf16 v[56:59], a[52:55], a[112:115], v[56:59]
  v_mfma_f32_16x16x32_bf16 v[60:63], a[52:55], a[116:119], v[60:63]
  s_waitcnt vmcnt(23)
  v_mfma_f32_16x16x32_bf16 v[64:67], a[56:59], a[104:107], v[64:67]
  buffer_load_dwordx4 a[52:55], v208, s[8:11], s20 offen offset:1024
  v_mfma_f32_16x16x32_bf16 v[68:71], a[56:59], a[108:111], v[68:71]
  ds_read_b128 a[132:135], v216 offset:28672
  v_mfma_f32_16x16x32_bf16 v[72:75], a[56:59], a[112:115], v[72:75]
  v_mfma_f32_16x16x32_bf16 v[76:79], a[56:59], a[116:119], v[76:79]
  v_mfma_f32_16x16x32_bf16 v[80:83], a[60:63], a[104:107], v[80:83]
  buffer_load_dwordx4 a[56:59], v208, s[8:11], s20 offen offset:2048
  v_mfma_f32_16x16x32_bf16 v[84:87], a[60:63], a[108:111], v[84:87]
  v_mfma_f32_16x16x32_bf16 v[88:91], a[60:63], a[112:115], v[88:91]
  v_mfma_f32_16x16x32_bf16 v[92:95], a[60:63], a[116:119], v[92:95]
  s_waitcnt vmcnt(23)
  v_mfma_f32_16x16x32_bf16 v[96:99], a[64:67], a[104:107], v[96:99]
  buffer_load_dwordx4 a[60:63], v208, s[8:11], s20 offen offset:3072
  v_mfma_f32_16x16x32_bf16 v[100:103], a[64:67], a[108:111], v[100:103]
  v_mfma_f32_16x16x32_bf16 v[104:107], a[64:67], a[112:115], v[104:107]
  v_mfma_f32_16x16x32_bf16 v[108:111], a[64:67], a[116:119], v[108:111]
  v_mfma_f32_16x16x32_bf16 v[112:115], a[68:71], a[104:107], v[112:115]
  s_add_u32 s20, s20, 4096
  buffer_load_dwordx4 a[64:67], v208, s[8:11], s20 offen
  v_mfma_f32_16x16x32_bf16 v[116:119], a[68:71], a[108:111], v[116:119]
  v_mfma_f32_16x16x32_bf16 v[120:123], a[68:71], a[112:115], v[120:123]
  v_mfma_f32_16x16x32_bf16 v[124:127], a[68:71], a[116:119], v[124:127]
  s_waitcnt vmcnt(23) lgkmcnt(0)
  v_mfma_f32_16x16x32_bf16 v[0:3], a[72:75], a[120:123], v[0:3]
  buffer_load_dwordx4 a[68:71], v208, s[8:11], s20 offen offset:1024
  v_mfma_f32_16x16x32_bf16 v[4:7], a[72:75], a[124:127], v[4:7]
  v_mfma_f32_16x16x32_bf16 v[8:11], a[72:75], a[128:131], v[8:11]
  v_mfma_f32_16x16x32_bf16 v[12:15], a[72:75], a[132:135], v[12:15]
  v_mfma_f32_16x16x32_bf16 v[16:19], a[76:79], a[120:123], v[16:19]
  buffer_load_dwordx4 a[72:75], v208, s[8:11], s20 offen offset:2048
  v_mfma_f32_16x16x32_bf16 v[20:23], a[76:79], a[124:127], v[20:23]
  ds_read_b128 a[104:107], v213 offset:32768
  v_mfma_f32_16x16x32_bf16 v[24:27], a[76:79], a[128:131], v[24:27]
  v_mfma_f32_16x16x32_bf16 v[28:31], a[76:79], a[132:135], v[28:31]
  s_waitcnt vmcnt(23)
  v_mfma_f32_16x16x32_bf16 v[32:35], a[80:83], a[120:123], v[32:35]
  buffer_load_dwordx4 a[76:79], v208, s[8:11], s20 offen offset:3072
  v_mfma_f32_16x16x32_bf16 v[36:39], a[80:83], a[124:127], v[36:39]
  ds_read_b128 a[108:111], v213 offset:36864
  v_mfma_f32_16x16x32_bf16 v[40:43], a[80:83], a[128:131], v[40:43]
  v_mfma_f32_16x16x32_bf16 v[44:47], a[80:83], a[132:135], v[44:47]
  v_mfma_f32_16x16x32_bf16 v[48:51], a[84:87], a[120:123], v[48:51]
  s_add_u32 s20, s20, 4096
  buffer_load_dwordx4 a[80:83], v208, s[8:11], s20 offen
  v_mfma_f32_16x16x32_bf16 v[52:55], a[84:87], a[124:127], v[52:55]
  ds_read_b128 a[112:115], v213 offset:40960
  v_mfma_f32_16x16x32_bf16 v[56:59], a[84:87], a[128:131], v[56:59]
  v_mfma_f32_16x16x32_bf16 v[60:63], a[84:87], a[132:135], v[60:63]
  s_waitcnt vmcnt(23)
  v_mfma_f32_16x16x32_bf16 v[64:67], a[88:91], a[120:123], v[64:67]
  buffer_load_dwordx4 a[84:87], v208, s[8:11], s20 offen offset:1024
  v_mfma_f32_16x16x32_bf16 v[68:71], a[88:91], a[124:127], v[68:71]
  ds_read_b128 a[116:119], v213 offset:45056
  v_mfma_f32_16x16x32_bf16 v[72:75], a[88:91], a[128:131], v[72:75]
  v_mfma_f32_16x16x32_bf16 v[76:79], a[88:91], a[132:135], v[76:79]
  v_mfma_f32_16x16x32_bf16 v[80:83], a[92:95], a[120:123], v[80:83]
  buffer_load_dwordx4 a[88:91], v208, s[8:11], s20 offen offset:2048
  v_mfma_f32_16x16x32_bf16 v[84:87], a[92:95], a[124:127], v[84:87]
  v_mfma_f32_16x16x32_bf16 v[88:91], a[92:95], a[128:131], v[88:91]
  v_mfma_f32_16x16x32_bf16 v[92:95], a[92:95], a[132:135], v[92:95]
  s_waitcnt vmcnt(23)
  v_mfma_f32_16x16x32_bf16 v[96:99], a[96:99], a[120:123], v[96:99]
  buffer_load_dwordx4 a[92:95], v208, s[8:11], s20 offen offset:3072
  v_mfma_f32_16x16x32_bf16 v[100:103], a[96:99], a[124:127], v[100:103]
  v_mfma_f32_16x16x32_bf16 v[104:107], a[96:99], a[128:131], v[104:107]
  v_mfma_f32_16x16x32_bf16 v[108:111], a[96:99], a[132:135], v[108:111]
  v_mfma_f32_16x16x32_bf16 v[112:115], a[100:103], a[120:123], v[112:115]
  s_add_u32 s20, s20, 4096
  buffer_load_dwordx4 a[96:99], v208, s[8:11], s20 offen
  v_mfma_f32_16x16x32_bf16 v[116:119], a[100:103], a[124:127], v[116:119]
  v_mfma_f32_16x16x32_bf16 v[120:123], a[100:103], a[128:131], v[120:123]
  v_mfma_f32_16x16x32_bf16 v[124:127], a[100:103], a[132:135], v[124:127]
  s_waitcnt vmcnt(23) lgkmcnt(0)
  v_mfma_f32_16x16x32_bf16 v[0:3], a[0:3], a[104:107], v[0:3]
  buffer_load_dwordx4 a[100:103], v208, s[8:11], s20 offen offset:1024
  v_mfma_f32_16x16x32_bf16 v[4:7], a[0:3], a[108:111], v[4:7]
  v_mfma_f32_16x16x32_bf16 v[8:11], a[0:3], a[112:115], v[8:11]
  v_mfma_f32_16x16x32_bf16 v[12:15], a[0:3], a[116:119], v[12:15]
  v_mfma_f32_16x16x32_bf16 v[16:19], a[4:7], a[104:107], v[16:19]
  buffer_load_dwordx4 a[0:3], v208, s[8:11], s20 offen offset:2048
  v_mfma_f32_16x16x32_bf16 v[20:23], a[4:7], a[108:111], v[20:23]
  ds_read_b128 a[120:123], v214 offset:32768
  v_mfma_f32_16x16x32_bf16 v[24:27], a[4:7], a[112:115], v[24:27]
  v_mfma_f32_16x16x32_bf16 v[28:31], a[4:7], a[116:119], v[28:31]
  s_waitcnt vmcnt(23)
  v_mfma_f32_16x16x32_bf16 v[32:35], a[8:11], a[104:107], v[32:35]
  buffer_load_dwordx4 a[4:7], v208, s[8:11], s20 offen offset:3072
  v_mfma_f32_16x16x32_bf16 v[36:39], a[8:11], a[108:111], v[36:39]
  ds_read_b128 a[124:127], v214 offset:36864
  v_mfma_f32_16x16x32_bf16 v[40:43], a[8:11], a[112:115], v[40:43]
  v_mfma_f32_16x16x32_bf16 v[44:47], a[8:11], a[116:119], v[44:47]
  v_mfma_f32_16x16x32_bf16 v[48:51], a[12:15], a[104:107], v[48:51]
  s_add_u32 s20, s20, 4096
  buffer_load_dwordx4 a[8:11], v208, s[8:11], s20 offen
  v_mfma_f32_16x16x32_bf16 v[52:55], a[12:15], a[108:111], v[52:55]
  ds_read_b128 a[128:131], v214 offset:40960
  v_mfma_f32_16x16x32_bf16 v[56:59], a[12:15], a[112:115], v[56:59]
  v_mfma_f32_16x16x32_bf16 v[60:63], a[12:15], a[116:119], v[60:63]
  s_waitcnt vmcnt(23)
  v_mfma_f32_16x16x32_bf16 v[64:67], a[16:19], a[104:107], v[64:67]
  buffer_load_dwordx4 a[12:15], v208, s[8:11], s20 offen offset:1024
  v_mfma_f32_16x16x32_bf16 v[68:71], a[16:19], a[108:111], v[68:71]
  ds_read_b128 a[132:135], v214 offset:45056
  v_mfma_f32_16x16x32_bf16 v[72:75], a[16:19], a[112:115], v[72:75]
  v_mfma_f32_16x16x32_bf16 v[76:79], a[16:19], a[116:119], v[76:79]
  v_mfma_f32_16x16x32_bf16 v[80:83], a[20:23], a[104:107], v[80:83]
  buffer_load_dwordx4 a[16:19], v208, s[8:11], s20 offen offset:2048
  v_mfma_f32_16x16x32_bf16 v[84:87], a[20:23], a[108:111], v[84:87]
  v_mfma_f32_16x16x32_bf16 v[88:91], a[20:23], a[112:115], v[88:91]
  v_mfma_f32_16x16x32_bf16 v[92:95], a[20:23], a[116:119], v[92:95]
  s_waitcnt vmcnt(23)
  v_mfma_f32_16x16x32_bf16 v[96:99], a[24:27], a[104:107], v[96:99]
  buffer_load_dwordx4 a[20:23], v208, s[8:11], s20 offen offset:3072
  v_mfma_f32_16x16x32_bf16 v[100:103], a[24:27], a[108:111], v[100:103]
  v_mfma_f32_16x16x32_bf16 v[104:107], a[24:27], a[112:115], v[104:107]
  v_mfma_f32_16x16x32_bf16 v[108:111], a[24:27], a[116:119], v[108:111]
  v_mfma_f32_16x16x32_bf16 v[112:115], a[28:31], a[104:107], v[112:115]
  s_add_u32 s20, s20, 4096
  buffer_load_dwordx4 a[24:27], v208, s[8:11], s20 offen
  v_mfma_f32_16x16x32_bf16 v[116:119], a[28:31], a[108:111], v[116:119]
  v_mfma_f32_16x16x32_bf16 v[120:123], a[28:31], a[112:115], v[120:123]
  v_mfma_f32_16x16x32_bf16 v[124:127], a[28:31], a[116:119], v[124:127]
  s_waitcnt vmcnt(23) lgkmcnt(0)
  v_mfma_f32_16x16x32_bf16 v[0:3], a[32:35], a[120:123], v[0:3]
  buffer_load_dwordx4 a[28:31], v208, s[8:11], s20 offen offset:1024
  v_mfma_f32_16x16x32_bf16 v[4:7], a[32:35], a[124:127], v[4:7]
  v_mfma_f32_16x16x32_bf16 v[8:11], a[32:35], a[128:131], v[8:11]
  v_mfma_f32_16x16x32_bf16 v[12:15], a[32:35], a[132:135], v[12:15]
  v_mfma_f32_16x16x32_bf16 v[16:19], a[36:39], a[120:123], v[16:19]
  buffer_load_dwordx4 a[32:35], v208, s[8:11], s20 offen offset:2048
  v_mfma_f32_16x16x32_bf16 v[20:23], a[36:39], a[124:127], v[20:23]
  ds_read_b128 a[104:107], v209
  v_mfma_f32_16x16x32_bf16 v[24:27], a[36:39], a[128:131], v[24:27]
  v_mfma_f32_16x16x32_bf16 v[28:31], a[36:39], a[132:135], v[28:31]
  s_waitcnt vmcnt(23)
  v_mfma_f32_16x16x32_bf16 v[32:35], a[40:43], a[120:123], v[32:35]
  buffer_load_dwordx4 a[36:39], v208, s[8:11], s20 offen offset:3072
  v_mfma_f32_16x16x32_bf16 v[36:39], a[40:43], a[124:127], v[36:39]
  ds_read_b128 a[108:111], v209 offset:4096
  v_mfma_f32_16x16x32_bf16 v[40:43], a[40:43], a[128:131], v[40:43]
  v_mfma_f32_16x16x32_bf16 v[44:47], a[40:43], a[132:135], v[44:47]
  v_mfma_f32_16x16x32_bf16 v[48:51], a[44:47], a[120:123], v[48:51]
  s_add_u32 s20, s20, 4096
  buffer_load_dwordx4 a[40:43], v208, s[8:11], s20 offen
  v_mfma_f32_16x16x32_bf16 v[52:55], a[44:47], a[124:127], v[52:55]
  ds_read_b128 a[112:115], v209 offset:8192
  v_mfma_f32_16x16x32_bf16 v[56:59], a[44:47], a[128:131], v[56:59]
  v_mfma_f32_16x16x32_bf16 v[60:63], a[44:47], a[132:135], v[60:63]
  s_waitcnt vmcnt(23)
  v_mfma_f32_16x16x32_bf16 v[64:67], a[48:51], a[120:123], v[64:67]
  buffer_load_dwordx4 a[44:47], v208, s[8:11], s20 offen offset:1024
  v_mfma_f32_16x16x32_bf16 v[68:71], a[48:51], a[124:127], v[68:71]
  ds_read_b128 a[116:119], v209 offset:12288
  v_mfma_f32_16x16x32_bf16 v[72:75], a[48:51], a[128:131], v[72:75]
  v_mfma_f32_16x16x32_bf16 v[76:79], a[48:51], a[132:135], v[76:79]
  v_mfma_f32_16x16x32_bf16 v[80:83], a[52:55], a[120:123], v[80:83]
  buffer_load_dwordx4 a[48:51], v208, s[8:11], s20 offen offset:2048
  v_mfma_f32_16x16x32_bf16 v[84:87], a[52:55], a[124:127], v[84:87]
  v_mfma_f32_16x16x32_bf16 v[88:91], a[52:55], a[128:131], v[88:91]
  v_mfma_f32_16x16x32_bf16 v[92:95], a[52:55], a[132:135], v[92:95]
  s_waitcnt vmcnt(23)
  v_mfma_f32_16x16x32_bf16 v[96:99], a[56:59], a[120:123], v[96:99]
  buffer_load_dwordx4 a[52:55], v208, s[8:11], s20 offen offset:3072
  v_mfma_f32_16x16x32_bf16 v[100:103], a[56:59], a[124:127], v[100:103]
  v_mfma_f32_16x16x32_bf16 v[104:107], a[56:59], a[128:131], v[104:107]
  v_mfma_f32_16x16x32_bf16 v[108:111], a[56:59], a[132:135], v[108:111]
  v_mfma_f32_16x16x32_bf16 v[112:115], a[60:63], a[120:123], v[112:115]
  s_add_u32 s20, s20, 4096
  buffer_load_dwordx4 a[56:59], v208, s[8:11], s20 offen
  v_mfma_f32_16x16x32_bf16 v[116:119], a[60:63], a[124:127], v[116:119]
  v_mfma_f32_16x16x32_bf16 v[120:123], a[60:63], a[128:131], v[120:123]
  v_mfma_f32_16x16x32_bf16 v[124:127], a[60:63], a[132:135], v[124:127]
  s_waitcnt vmcnt(23) lgkmcnt(0)
  v_mfma_f32_16x16x32_bf16 v[140:143], a[64:67], a[116:119], v[128:131]
  buffer_load_dwordx4 a[60:63], v208, s[8:11], s20 offen offset:1024
  v_mfma_f32_16x16x32_bf16 v[136:139], a[64:67], a[112:115], v[128:131]
  ds_read_b128 v[228:231], v217
  ds_read_b128 v[232:235], v217 offset:4096
  v_mfma_f32_16x16x32_bf16 v[132:135], a[64:67], a[108:111], v[128:131]
  s_waitcnt lgkmcnt(1)
  v_lshlrev_b32 v236, 16, v228
  v_and_b32 v237, s27, v228
  v_mfma_f32_16x16x32_bf16 v[128:131], a[64:67], a[104:107], v[128:131]
  v_mfma_f32_16x16x32_bf16 v[156:159], a[68:71], a[116:119], v[144:147]
  buffer_load_dwordx4 a[64:67], v208, s[8:11], s20 offen offset:2048
  v_accvgpr_read_b32 v244, a136
  v_mfma_f32_16x16x32_bf16 v[152:155], a[68:71], a[112:115], v[144:147]
  ds_read_b128 a[120:123], v210
  v_lshlrev_b32 v240, 16, v244
  v_mfma_f32_16x16x32_bf16 v[148:151], a[68:71], a[108:111], v[144:147]
  v_and_b32 v241, s27, v244
  v_fma_f32 v236, v240, v0, v236
  v_mfma_f32_16x16x32_bf16 v[144:147], a[68:71], a[104:107], v[144:147]
  s_waitcnt vmcnt(23)
  v_mfma_f32_16x16x32_bf16 v[172:175], a[72:75], a[116:119], v[160:163]
  buffer_load_dwordx4 a[68:71], v208, s[8:11], s20 offen offset:3072
  v_fma_f32 v237, v241, v1, v237
  v_mfma_f32_16x16x32_bf16 v[168:171], a[72:75], a[112:115], v[160:163]
  ds_read_b128 a[124:127], v210 offset:4096
  v_cvt_pk_bf16_f32 v0, v236, v237
  v_mfma_f32_16x16x32_bf16 v[164:167], a[72:75], a[108:111], v[160:163]
  v_lshlrev_b32 v238, 16, v229
  v_and_b32 v239, s27, v229
  v_mfma_f32_16x16x32_bf16 v[160:163], a[72:75], a[104:107], v[160:163]
  v_mfma_f32_16x16x32_bf16 v[188:191], a[76:79], a[116:119], v[176:179]
  s_add_u32 s20, s20, 4096
  buffer_load_dwordx4 a[72:75], v208, s[8:11], s20 offen
  v_mfma_f32_16x16x32_bf16 v[184:187], a[76:79], a[112:115], v[176:179]
  ds_read_b128 a[128:131], v210 offset:8192
  v_accvgpr_read_b32 v244, a137
  v_mfma_f32_16x16x32_bf16 v[180:183], a[76:79], a[108:111], v[176:179]
  v_lshlrev_b32 v242, 16, v244
  v_and_b32 v243, s27, v244
  v_mfma_f32_16x16x32_bf16 v[176:179], a[76:79], a[104:107], v[176:179]
  v_fma_f32 v238, v242, v2, v238
  s_waitcnt vmcnt(23)
  v_mfma_f32_16x16x32_bf16 v[204:207], a[80:83], a[116:119], v[192:195]
  buffer_load_dwordx4 a[76:79], v208, s[8:11], s20 offen offset:1024
  v_fma_f32 v239, v243, v3, v239
  v_mfma_f32_16x16x32_bf16 v[200:203], a[80:83], a[112:115], v[192:195]
  ds_read_b128 a[132:135], v210 offset:12288
  v_cvt_pk_bf16_f32 v1, v238, v239
  v_mfma_f32_16x16x32_bf16 v[196:199], a[80:83], a[108:111], v[192:195]
  v_lshlrev_b32 v236, 16, v230
  v_and_b32 v237, s27, v230
  v_mfma_f32_16x16x32_bf16 v[192:195], a[80:83], a[104:107], v[192:195]
  s_waitcnt lgkmcnt(0)
  v_mfma_f32_16x16x32_bf16 v[128:131], a[84:87], a[120:123], v[128:131]
  buffer_load_dwordx4 a[80:83], v208, s[8:11], s20 offen offset:2048
  v_mfma_f32_16x16x32_bf16 v[132:135], a[84:87], a[124:127], v[132:135]
  v_accvgpr_read_b32 v244, a138
  v_lshlrev_b32 v240, 16, v244
  v_mfma_f32_16x16x32_bf16 v[136:139], a[84:87], a[128:131], v[136:139]
  v_and_b32 v241, s27, v244
  v_fma_f32 v236, v240, v16, v236
  v_mfma_f32_16x16x32_bf16 v[140:143], a[84:87], a[132:135], v[140:143]
  s_waitcnt vmcnt(23)
  v_mfma_f32_16x16x32_bf16 v[144:147], a[88:91], a[120:123], v[144:147]
  buffer_load_dwordx4 a[84:87], v208, s[8:11], s20 offen offset:3072
  v_fma_f32 v237, v241, v17, v237
  v_mfma_f32_16x16x32_bf16 v[148:151], a[88:91], a[124:127], v[148:151]
  ds_read_b128 a[104:107], v211
  v_cvt_pk_bf16_f32 v2, v236, v237
  v_mfma_f32_16x16x32_bf16 v[152:155], a[88:91], a[128:131], v[152:155]
  v_lshlrev_b32 v238, 16, v231
  v_and_b32 v239, s27, v231
  v_mfma_f32_16x16x32_bf16 v[156:159], a[88:91], a[132:135], v[156:159]
  v_mfma_f32_16x16x32_bf16 v[160:163], a[92:95], a[120:123], v[160:163]
  s_add_u32 s20, s20, 4096
  buffer_load_dwordx4 a[88:91], v208, s[8:11], s20 offen
  v_mfma_f32_16x16x32_bf16 v[164:167], a[92:95], a[124:127], v[164:167]
  ds_read_b128 a[108:111], v211 offset:4096
  v_accvgpr_read_b32 v244, a139
  v_mfma_f32_16x16x32_bf16 v[168:171], a[92:95], a[128:131], v[168:171]
  v_lshlrev_b32 v242, 16, v244
  v_and_b32 v243, s27, v244
  v_mfma_f32_16x16x32_bf16 v[172:175], a[92:95], a[132:135], v[172:175]
  v_fma_f32 v238, v242, v18, v238
  s_waitcnt vmcnt(23)
  v_mfma_f32_16x16x32_bf16 v[176:179], a[96:99], a[120:123], v[176:179]
  buffer_load_dwordx4 a[92:95], v208, s[8:11], s20 offen offset:1024
  v_fma_f32 v239, v243, v19, v239
  v_mfma_f32_16x16x32_bf16 v[180:183], a[96:99], a[124:127], v[180:183]
  ds_read_b128 a[112:115], v211 offset:8192
  v_cvt_pk_bf16_f32 v3, v238, v239
  v_mfma_f32_16x16x32_bf16 v[184:187], a[96:99], a[128:131], v[184:187]
  ds_read_b128 v[228:231], v217 offset:8192
  v_lshlrev_b32 v236, 16, v232
  v_mfma_f32_16x16x32_bf16 v[188:191], a[96:99], a[132:135], v[188:191]
  v_mfma_f32_16x16x32_bf16 v[192:195], a[100:103], a[120:123], v[192:195]
  buffer_load_dwordx4 a[96:99], v208, s[8:11], s20 offen offset:2048
  v_and_b32 v237, s27, v232
  v_mfma_f32_16x16x32_bf16 v[196:199], a[100:103], a[124:127], v[196:199]
  ds_read_b128 a[116:119], v211 offset:12288
  v_accvgpr_read_b32 v244, a140
  v_mfma_f32_16x16x32_bf16 v[200:203], a[100:103], a[128:131], v[200:203]
  v_lshlrev_b32 v240, 16, v244
  v_and_b32 v241, s27, v244
  v_mfma_f32_16x16x32_bf16 v[204:207], a[100:103], a[132:135], v[204:207]
  s_waitcnt vmcnt(23) lgkmcnt(0)
  v_mfma_f32_16x16x32_bf16 v[128:131], a[0:3], a[104:107], v[128:131]
  buffer_load_dwordx4 a[100:103], v208, s[8:11], s20 offen offset:3072
  v_mfma_f32_16x16x32_bf16 v[132:135], a[0:3], a[108:111], v[132:135]
  v_fma_f32 v236, v240, v4, v236
  v_fma_f32 v237, v241, v5, v237
  v_mfma_f32_16x16x32_bf16 v[136:139], a[0:3], a[112:115], v[136:139]
  v_cvt_pk_bf16_f32 v4, v236, v237
  v_lshlrev_b32 v238, 16, v233
  v_mfma_f32_16x16x32_bf16 v[140:143], a[0:3], a[116:119], v[140:143]
  v_mfma_f32_16x16x32_bf16 v[144:147], a[4:7], a[104:107], v[144:147]
  s_add_u32 s20, s20, 4096
  buffer_load_dwordx4 a[0:3], v208, s[8:11], s20 offen
  v_mfma_f32_16x16x32_bf16 v[148:151], a[4:7], a[108:111], v[148:151]
  ds_read_b128 a[120:123], v212
  v_and_b32 v239, s27, v233
  v_mfma_f32_16x16x32_bf16 v[152:155], a[4:7], a[112:115], v[152:155]
  v_accvgpr_read_b32 v244, a141
  v_lshlrev_b32 v242, 16, v244
  v_mfma_f32_16x16x32_bf16 v[156:159], a[4:7], a[116:119], v[156:159]
  v_and_b32 v243, s27, v244
  s_waitcnt vmcnt(23)
  v_mfma_f32_16x16x32_bf16 v[160:163], a[8:11], a[104:107], v[160:163]
  buffer_load_dwordx4 a[4:7], v208, s[8:11], s20 offen offset:1024
  v_fma_f32 v238, v242, v6, v238
  v_mfma_f32_16x16x32_bf16 v[164:167], a[8:11], a[108:111], v[164:167]
  ds_read_b128 a[124:127], v212 offset:4096
  v_fma_f32 v239, v243, v7, v239
  v_mfma_f32_16x16x32_bf16 v[168:171], a[8:11], a[112:115], v[168:171]
  v_cvt_pk_bf16_f32 v5, v238, v239
  v_lshlrev_b32 v236, 16, v234
  v_mfma_f32_16x16x32_bf16 v[172:175], a[8:11], a[116:119], v[172:175]
  v_mfma_f32_16x16x32_bf16 v[176:179], a[12:15], a[104:107], v[176:179]
  buffer_load_dwordx4 a[8:11], v208, s[8:11], s20 offen offset:2048
  v_and_b32 v237, s27, v234
  v_mfma_f32_16x16x32_bf16 v[180:183], a[12:15], a[108:111], v[180:183]
  ds_read_b128 a[128:131], v212 offset:8192
  v_accvgpr_read_b32 v244, a142
  v_mfma_f32_16x16x32_bf16 v[184:187], a[12:15], a[112:115], v[184:187]
  v_lshlrev_b32 v240, 16, v244
  v_and_b32 v241, s27, v244
  v_mfma_f32_16x16x32_bf16 v[188:191], a[12:15], a[116:119], v[188:191]
  s_waitcnt vmcnt(23)
  v_mfma_f32_16x16x32_bf16 v[192:195], a[16:19], a[104:107], v[192:195]
  buffer_load_dwordx4 a[12:15], v208, s[8:11], s20 offen offset:3072
  v_fma_f32 v236, v240, v20, v236
  v_mfma_f32_16x16x32_bf16 v[196:199], a[16:19], a[108:111], v[196:199]
  ds_read_b128 a[132:135], v212 offset:12288
  v_fma_f32 v237, v241, v21, v237
  v_mfma_f32_16x16x32_bf16 v[200:203], a[16:19], a[112:115], v[200:203]
  v_cvt_pk_bf16_f32 v6, v236, v237
  v_lshlrev_b32 v238, 16, v235
  v_mfma_f32_16x16x32_bf16 v[204:207], a[16:19], a[116:119], v[204:207]
  s_waitcnt lgkmcnt(0)
  v_mfma_f32_16x16x32_bf16 v[128:131], a[20:23], a[120:123], v[128:131]
  s_add_u32 s20, s20, 4096
  buffer_load_dwordx4 a[16:19], v208, s[8:11], s20 offen
  v_mfma_f32_16x16x32_bf16 v[132:135], a[20:23], a[124:127], v[132:135]
  v_and_b32 v239, s27, v235
  v_accvgpr_read_b32 v244, a143
  v_mfma_f32_16x16x32_bf16 v[136:139], a[20:23], a[128:131], v[136:139]
  v_lshlrev_b32 v242, 16, v244
  v_and_b32 v243, s27, v244
  v_mfma_f32_16x16x32_bf16 v[140:143], a[20:23], a[132:135], v[140:143]
  s_waitcnt vmcnt(23)
  v_mfma_f32_16x16x32_bf16 v[144:147], a[24:27], a[120:123], v[144:147]
  buffer_load_dwordx4 a[20:23], v208, s[8:11], s20 offen offset:1024
  v_fma_f32 v238, v242, v22, v238
  v_mfma_f32_16x16x32_bf16 v[148:151], a[24:27], a[124:127], v[148:151]
  ds_read_b128 a[104:107], v209 offset:16384
  v_fma_f32 v239, v243, v23, v239
  v_mfma_f32_16x16x32_bf16 v[152:155], a[24:27], a[128:131], v[152:155]
  v_cvt_pk_bf16_f32 v7, v238, v239
  ds_read_b128 v[232:235], v217 offset:12288
  v_mfma_f32_16x16x32_bf16 v[156:159], a[24:27], a[132:135], v[156:159]
  v_lshlrev_b32 v236, 16, v228
  v_mfma_f32_16x16x32_bf16 v[160:163], a[28:31], a[120:123], v[160:163]
  buffer_load_dwordx4 a[24:27], v208, s[8:11], s20 offen offset:2048
  v_and_b32 v237, s27, v228
  v_mfma_f32_16x16x32_bf16 v[164:167], a[28:31], a[124:127], v[164:167]
  ds_read_b128 a[108:111], v209 offset:20480
  v_accvgpr_read_b32 v244, a144
  v_mfma_f32_16x16x32_bf16 v[168:171], a[28:31], a[128:131], v[168:171]
  v_lshlrev_b32 v240, 16, v244
  v_and_b32 v241, s27, v244
  v_mfma_f32_16x16x32_bf16 v[172:175], a[28:31], a[132:135], v[172:175]
  s_waitcnt vmcnt(23)
  v_mfma_f32_16x16x32_bf16 v[176:179], a[32:35], a[120:123], v[176:179]
  buffer_load_dwordx4 a[28:31], v208, s[8:11], s20 offen offset:3072
  v_fma_f32 v236, v240, v8, v236
  v_mfma_f32_16x16x32_bf16 v[180:183], a[32:35], a[124:127], v[180:183]
  ds_read_b128 a[112:115], v209 offset:24576
  v_fma_f32 v237, v241, v9, v237
  v_mfma_f32_16x16x32_bf16 v[184:187], a[32:35], a[128:131], v[184:187]
  v_cvt_pk_bf16_f32 v8, v236, v237
  v_lshlrev_b32 v238, 16, v229
  v_mfma_f32_16x16x32_bf16 v[188:191], a[32:35], a[132:135], v[188:191]
  v_mfma_f32_16x16x32_bf16 v[192:195], a[36:39], a[120:123], v[192:195]
  s_add_u32 s20, s20, 4096
  buffer_load_dwordx4 a[32:35], v208, s[8:11], s20 offen
  v_mfma_f32_16x16x32_bf16 v[196:199], a[36:39], a[124:127], v[196:199]
  ds_read_b128 a[116:119], v209 offset:28672
  v_and_b32 v239, s27, v229
  v_mfma_f32_16x16x32_bf16 v[200:203], a[36:39], a[128:131], v[200:203]
  v_accvgpr_read_b32 v244, a145
  v_lshlrev_b32 v242, 16, v244
  v_mfma_f32_16x16x32_bf16 v[204:207], a[36:39], a[132:135], v[204:207]
  v_and_b32 v243, s27, v244
  s_waitcnt vmcnt(23) lgkmcnt(0)
  v_mfma_f32_16x16x32_bf16 v[128:131], a[40:43], a[104:107], v[128:131]
  buffer_load_dwordx4 a[36:39], v208, s[8:11], s20 offen offset:1024
  v_mfma_f32_16x16x32_bf16 v[132:135], a[40:43], a[108:111], v[132:135]
  v_fma_f32 v238, v242, v10, v238
  v_fma_f32 v239, v243, v11, v239
  v_mfma_f32_16x16x32_bf16 v[136:139], a[40:43], a[112:115], v[136:139]
  v_cvt_pk_bf16_f32 v9, v238, v239
  v_lshlrev_b32 v236, 16, v230
  v_mfma_f32_16x16x32_bf16 v[140:143], a[40:43], a[116:119], v[140:143]
  v_mfma_f32_16x16x32_bf16 v[144:147], a[44:47], a[104:107], v[144:147]
  buffer_load_dwordx4 a[40:43], v208, s[8:11], s20 offen offset:2048
  v_and_b32 v237, s27, v230
  v_mfma_f32_16x16x32_bf16 v[148:151], a[44:47], a[108:111], v[148:151]
  ds_read_b128 a[120:123], v210 offset:16384
  v_accvgpr_read_b32 v244, a146
  v_mfma_f32_16x16x32_bf16 v[152:155], a[44:47], a[112:115], v[152:155]
  v_lshlrev_b32 v240, 16, v244
  v_and_b32 v241, s27, v244
  v_mfma_f32_16x16x32_bf16 v[156:159], a[44:47], a[116:119], v[156:159]
  s_waitcnt vmcnt(23)
  v_mfma_f32_16x16x32_bf16 v[160:163], a[48:51], a[104:107], v[160:163]
  buffer_load_dwordx4 a[44:47], v208, s[8:11], s20 offen offset:3072
  v_fma_f32 v236, v240, v24, v236
  v_mfma_f32_16x16x32_bf16 v[164:167], a[48:51], a[108:111], v[164:167]
  ds_read_b128 a[124:127], v210 offset:20480
  v_fma_f32 v237, v241, v25, v237
  v_mfma_f32_16x16x32_bf16 v[168:171], a[48:51], a[112:115], v[168:171]
  v_cvt_pk_bf16_f32 v10, v236, v237
  v_lshlrev_b32 v238, 16, v231
  v_mfma_f32_16x16x32_bf16 v[172:175], a[48:51], a[116:119], v[172:175]
  v_mfma_f32_16x16x32_bf16 v[176:179], a[52:55], a[104:107], v[176:179]
  s_add_u32 s20, s20, 4096
  buffer_load_dwordx4 a[48:51], v208, s[8:11], s20 offen
  v_mfma_f32_16x16x32_bf16 v[180:183], a[52:55], a[108:111], v[180:183]
  ds_read_b128 a[128:131], v210 offset:24576
  v_and_b32 v239, s27, v231
  v_mfma_f32_16x16x32_bf16 v[184:187], a[52:55], a[112:115], v[184:187]
  v_accvgpr_read_b32 v244, a147
  v_lshlrev_b32 v242, 16, v244
  v_mfma_f32_16x16x32_bf16 v[188:191], a[52:55], a[116:119], v[188:191]
  v_and_b32 v243, s27, v244
  s_waitcnt vmcnt(23)
  v_mfma_f32_16x16x32_bf16 v[192:195], a[56:59], a[104:107], v[192:195]
  buffer_load_dwordx4 a[52:55], v208, s[8:11], s20 offen offset:1024
  v_fma_f32 v238, v242, v26, v238
  v_mfma_f32_16x16x32_bf16 v[196:199], a[56:59], a[108:111], v[196:199]
  ds_read_b128 a[132:135], v210 offset:28672
  v_fma_f32 v239, v243, v27, v239
  v_mfma_f32_16x16x32_bf16 v[200:203], a[56:59], a[112:115], v[200:203]
  v_cvt_pk_bf16_f32 v11, v238, v239
  ds_read_b128 v[228:231], v218
  v_mfma_f32_16x16x32_bf16 v[204:207], a[56:59], a[116:119], v[204:207]
  s_waitcnt lgkmcnt(1)
  v_mfma_f32_16x16x32_bf16 v[128:131], a[60:63], a[120:123], v[128:131]
  buffer_load_dwordx4 a[56:59], v208, s[8:11], s20 offen offset:2048
  v_mfma_f32_16x16x32_bf16 v[132:135], a[60:63], a[124:127], v[132:135]
  v_lshlrev_b32 v236, 16, v232
  v_and_b32 v237, s27, v232
  v_mfma_f32_16x16x32_bf16 v[136:139], a[60:63], a[128:131], v[136:139]
  v_accvgpr_read_b32 v244, a148
  v_lshlrev_b32 v240, 16, v244
  v_mfma_f32_16x16x32_bf16 v[140:143], a[60:63], a[132:135], v[140:143]
  s_waitcnt vmcnt(23)
  v_mfma_f32_16x16x32_bf16 v[144:147], a[64:67], a[120:123], v[144:147]
  buffer_load_dwordx4 a[60:63], v208, s[8:11], s20 offen offset:3072
  v_and_b32 v241, s27, v244
  v_mfma_f32_16x16x32_bf16 v[148:151], a[64:67], a[124:127], v[148:151]
  ds_read_b128 a[104:107], v211 offset:16384
  v_fma_f32 v236, v240, v12, v236
  v_mfma_f32_16x16x32_bf16 v[152:155], a[64:67], a[128:131], v[152:155]
  v_fma_f32 v237, v241, v13, v237
  v_cvt_pk_bf16_f32 v12, v236, v237
  v_mfma_f32_16x16x32_bf16 v[156:159], a[64:67], a[132:135], v[156:159]
  v_mfma_f32_16x16x32_bf16 v[160:163], a[68:71], a[120:123], v[160:163]
  s_add_u32 s20, s20, 4096
  buffer_load_dwordx4 a[64:67], v208, s[8:11], s20 offen
  v_mfma_f32_16x16x32_bf16 v[164:167], a[68:71], a[124:127], v[164:167]
  ds_read_b128 a[108:111], v211 offset:20480
  v_lshlrev_b32 v238, 16, v233
  v_mfma_f32_16x16x32_bf16 v[168:171], a[68:71], a[128:131], v[168:171]
  v_and_b32 v239, s27, v233
  v_accvgpr_read_b32 v244, a149
  v_mfma_f32_16x16x32_bf16 v[172:175], a[68:71], a[132:135], v[172:175]
  v_lshlrev_b32 v242, 16, v244
  s_waitcnt vmcnt(23)
  v_mfma_f32_16x16x32_bf16 v[176:179], a[72:75], a[120:123], v[176:179]
  buffer_load_dwordx4 a[68:71], v208, s[8:11], s20 offen offset:1024
  v_and_b32 v243, s27, v244
  v_mfma_f32_16x16x32_bf16 v[180:183], a[72:75], a[124:127], v[180:183]
  ds_read_b128 a[112:115], v211 offset:24576
  v_fma_f32 v238, v242, v14, v238
  v_mfma_f32_16x16x32_bf16 v[184:187], a[72:75], a[128:131], v[184:187]
  v_fma_f32 v239, v243, v15, v239
  v_cvt_pk_bf16_f32 v13, v238, v239
  v_mfma_f32_16x16x32_bf16 v[188:191], a[72:75], a[132:135], v[188:191]
  v_mfma_f32_16x16x32_bf16 v[192:195], a[76:79], a[120:123], v[192:195]
  buffer_load_dwordx4 a[72:75], v208, s[8:11], s20 offen offset:2048
  v_lshlrev_b32 v236, 16, v234
  v_mfma_f32_16x16x32_bf16 v[196:199], a[76:79], a[124:127], v[196:199]
  ds_read_b128 a[116:119], v211 offset:28672
  v_and_b32 v237, s27, v234
  v_mfma_f32_16x16x32_bf16 v[200:203], a[76:79], a[128:131], v[200:203]
  v_accvgpr_read_b32 v244, a150
  v_lshlrev_b32 v240, 16, v244
  v_mfma_f32_16x16x32_bf16 v[204:207], a[76:79], a[132:135], v[204:207]
  s_waitcnt vmcnt(23) lgkmcnt(0)
  v_mfma_f32_16x16x32_bf16 v[128:131], a[80:83], a[104:107], v[128:131]
  buffer_load_dwordx4 a[76:79], v208, s[8:11], s20 offen offset:3072
  v_mfma_f32_16x16x32_bf16 v[132:135], a[80:83], a[108:111], v[132:135]
  v_and_b32 v241, s27, v244
  v_fma_f32 v236, v240, v28, v236
  v_mfma_f32_16x16x32_bf16 v[136:139], a[80:83], a[112:115], v[136:139]
  v_fma_f32 v237, v241, v29, v237
  v_cvt_pk_bf16_f32 v14, v236, v237
  v_mfma_f32_16x16x32_bf16 v[140:143], a[80:83], a[116:119], v[140:143]
  v_mfma_f32_16x16x32_bf16 v[144:147], a[84:87], a[104:107], v[144:147]
  s_add_u32 s20, s20, 4096
  buffer_load_dwordx4 a[80:83], v208, s[8:11], s20 offen
  v_mfma_f32_16x16x32_bf16 v[148:151], a[84:87], a[108:111], v[148:151]
  ds_read_b128 a[120:123], v212 offset:16384
  v_lshlrev_b32 v238, 16, v235
  v_mfma_f32_16x16x32_bf16 v[152:155], a[84:87], a[112:115], v[152:155]
  v_and_b32 v239, s27, v235
  v_accvgpr_read_b32 v244, a151
  v_mfma_f32_16x16x32_bf16 v[156:159], a[84:87], a[116:119], v[156:159]
  v_lshlrev_b32 v242, 16, v244
  s_waitcnt vmcnt(23)
  v_mfma_f32_16x16x32_bf16 v[160:163], a[88:91], a[104:107], v[160:163]
  buffer_load_dwordx4 a[84:87], v208, s[8:11], s20 offen offset:1024
  v_and_b32 v243, s27, v244
  v_mfma_f32_16x16x32_bf16 v[164:167], a[88:91], a[108:111], v[164:167]
  ds_read_b128 a[124:127], v212 offset:20480
  v_fma_f32 v238, v242, v30, v238
  v_mfma_f32_16x16x32_bf16 v[168:171], a[88:91], a[112:115], v[168:171]
  v_fma_f32 v239, v243, v31, v239
  v_cvt_pk_bf16_f32 v15, v238, v239
  v_mfma_f32_16x16x32_bf16 v[172:175], a[88:91], a[116:119], v[172:175]
  ds_read_b128 v[232:235], v218 offset:4096
  v_mfma_f32_16x16x32_bf16 v[176:179], a[92:95], a[104:107], v[176:179]
  buffer_load_dwordx4 v[16:19], v208, s[8:11], s20 offen offset:2048
  buffer_load_dwordx4 v[20:23], v208, s[8:11], s20 offen offset:3072
  s_add_u32 s20, s20, 4096
  buffer_load_dwordx4 v[24:27], v208, s[8:11], s20 offen
  v_mfma_f32_16x16x32_bf16 v[180:183], a[92:95], a[108:111], v[180:183]
  ds_read_b128 a[128:131], v212 offset:24576
  v_lshlrev_b32 v236, 16, v228
  v_mfma_f32_16x16x32_bf16 v[184:187], a[92:95], a[112:115], v[184:187]
  v_and_b32 v237, s27, v228
  v_accvgpr_read_b32 v244, a152
  v_mfma_f32_16x16x32_bf16 v[188:191], a[92:95], a[116:119], v[188:191]
  v_lshlrev_b32 v240, 16, v244
  s_waitcnt vmcnt(25)
  v_mfma_f32_16x16x32_bf16 v[192:195], a[96:99], a[104:107], v[192:195]
  buffer_load_dwordx4 v[28:31], v208, s[8:11], s20 offen offset:1024
  buffer_load_dwordx4 a[88:91], v208, s[8:11], s20 offen offset:2048
  buffer_load_dwordx4 a[92:95], v208, s[8:11], s20 offen offset:3072
  v_mfma_f32_16x16x32_bf16 v[196:199], a[96:99], a[108:111], v[196:199]
  ds_read_b128 a[132:135], v212 offset:28672
  v_and_b32 v241, s27, v244
  v_mfma_f32_16x16x32_bf16 v[200:203], a[96:99], a[112:115], v[200:203]
  v_fma_f32 v236, v240, v32, v236
  v_fma_f32 v237, v241, v33, v237
  v_mfma_f32_16x16x32_bf16 v[204:207], a[96:99], a[116:119], v[204:207]
  v_cvt_pk_bf16_f32 v32, v236, v237
  s_waitcnt lgkmcnt(0)
  v_mfma_f32_16x16x32_bf16 v[128:131], a[100:103], a[120:123], v[128:131]
  s_add_u32 s20, s20, 4096
  buffer_load_dwordx4 a[96:99], v208, s[8:11], s20 offen
  v_mfma_f32_16x16x32_bf16 v[132:135], a[100:103], a[124:127], v[132:135]
  v_lshlrev_b32 v238, 16, v229
  v_and_b32 v239, s27, v229
  v_mfma_f32_16x16x32_bf16 v[136:139], a[100:103], a[128:131], v[136:139]
  v_accvgpr_read_b32 v244, a153
  v_lshlrev_b32 v242, 16, v244
  v_mfma_f32_16x16x32_bf16 v[140:143], a[100:103], a[132:135], v[140:143]
  s_waitcnt vmcnt(27)
  v_mfma_f32_16x16x32_bf16 v[144:147], a[0:3], a[120:123], v[144:147]
  buffer_load_dwordx4 a[100:103], v208, s[8:11], s20 offen offset:1024
  v_and_b32 v243, s27, v244
  v_mfma_f32_16x16x32_bf16 v[148:151], a[0:3], a[124:127], v[148:151]
  ds_read_b128 a[104:107], v209 offset:32768
  v_fma_f32 v238, v242, v34, v238
  v_mfma_f32_16x16x32_bf16 v[152:155], a[0:3], a[128:131], v[152:155]
  v_fma_f32 v239, v243, v35, v239
  v_cvt_pk_bf16_f32 v33, v238, v239
  v_mfma_f32_16x16x32_bf16 v[156:159], a[0:3], a[132:135], v[156:159]
  v_mfma_f32_16x16x32_bf16 v[160:163], a[4:7], a[120:123], v[160:163]
  buffer_load_dwordx4 a[0:3], v208, s[8:11], s20 offen offset:2048
  v_lshlrev_b32 v236, 16, v230
  v_mfma_f32_16x16x32_bf16 v[164:167], a[4:7], a[124:127], v[164:167]
  ds_read_b128 a[108:111], v209 offset:36864
  v_and_b32 v237, s27, v230
  v_mfma_f32_16x16x32_bf16 v[168:171], a[4:7], a[128:131], v[168:171]
  v_accvgpr_read_b32 v244, a154
  v_lshlrev_b32 v240, 16, v244
  v_mfma_f32_16x16x32_bf16 v[172:175], a[4:7], a[132:135], v[172:175]
  s_waitcnt vmcnt(27)
  v_mfma_f32_16x16x32_bf16 v[176:179], a[8:11], a[120:123], v[176:179]
  buffer_load_dwordx4 a[4:7], v208, s[8:11], s20 offen offset:3072
  v_and_b32 v241, s27, v244
  v_mfma_f32_16x16x32_bf16 v[180:183], a[8:11], a[124:127], v[180:183]
  ds_read_b128 a[112:115], v209 offset:40960
  v_fma_f32 v236, v240, v48, v236
  v_mfma_f32_16x16x32_bf16 v[184:187], a[8:11], a[128:131], v[184:187]
  v_fma_f32 v237, v241, v49, v237
  v_cvt_pk_bf16_f32 v34, v236, v237
  v_mfma_f32_16x16x32_bf16 v[188:191], a[8:11], a[132:135], v[188:191]
  v_mfma_f32_16x16x32_bf16 v[192:195], a[12:15], a[120:123], v[192:195]
  s_add_u32 s20, s20, 4096
  buffer_load_dwordx4 a[8:11], v208, s[8:11], s20 offen
  v_mfma_f32_16x16x32_bf16 v[196:199], a[12:15], a[124:127], v[196:199]
  ds_read_b128 a[116:119], v209 offset:45056
  v_lshlrev_b32 v238, 16, v231
  v_mfma_f32_16x16x32_bf16 v[200:203], a[12:15], a[128:131], v[200:203]
  v_and_b32 v239, s27, v231
  v_accvgpr_read_b32 v244, a155
  v_mfma_f32_16x16x32_bf16 v[204:207], a[12:15], a[132:135], v[204:207]
  v_lshlrev_b32 v242, 16, v244
  s_waitcnt vmcnt(27) lgkmcnt(0)
  v_mfma_f32_16x16x32_bf16 v[128:131], a[16:19], a[104:107], v[128:131]
  buffer_load_dwordx4 a[12:15], v208, s[8:11], s20 offen offset:1024
  v_mfma_f32_16x16x32_bf16 v[132:135], a[16:19], a[108:111], v[132:135]
  v_and_b32 v243, s27, v244
  v_fma_f32 v238, v242, v50, v238
  v_mfma_f32_16x16x32_bf16 v[136:139], a[16:19], a[112:115], v[136:139]
  v_fma_f32 v239, v243, v51, v239
  v_cvt_pk_bf16_f32 v35, v238, v239
  v_mfma_f32_16x16x32_bf16 v[140:143], a[16:19], a[116:119], v[140:143]
  v_mfma_f32_16x16x32_bf16 v[144:147], a[20:23], a[104:107], v[144:147]
  buffer_load_dwordx4 a[16:19], v208, s[8:11], s20 offen offset:2048
  ds_read_b128 v[228:231], v218 offset:8192
  v_mfma_f32_16x16x32_bf16 v[148:151], a[20:23], a[108:111], v[148:151]
  ds_read_b128 a[120:123], v210 offset:32768
  v_lshlrev_b32 v236, 16, v232
  v_mfma_f32_16x16x32_bf16 v[152:155], a[20:23], a[112:115], v[152:155]
  v_and_b32 v237, s27, v232
  v_accvgpr_read_b32 v244, a156
  v_mfma_f32_16x16x32_bf16 v[156:159], a[20:23], a[116:119], v[156:159]
  s_waitcnt vmcnt(27)
  v_mfma_f32_16x16x32_bf16 v[160:163], a[24:27], a[104:107], v[160:163]
  buffer_load_dwordx4 a[20:23], v208, s[8:11], s20 offen offset:3072
  v_lshlrev_b32 v240, 16, v244
  v_mfma_f32_16x16x32_bf16 v[164:167], a[24:27], a[108:111], v[164:167]
  ds_read_b128 a[124:127], v210 offset:36864
  v_and_b32 v241, s27, v244
  v_mfma_f32_16x16x32_bf16 v[168:171], a[24:27], a[112:115], v[168:171]
  v_fma_f32 v236, v240, v36, v236
  v_fma_f32 v237, v241, v37, v237
  v_mfma_f32_16x16x32_bf16 v[172:175], a[24:27], a[116:119], v[172:175]
  v_mfma_f32_16x16x32_bf16 v[176:179], a[28:31], a[104:107], v[176:179]
  s_add_u32 s20, s20, 4096
  buffer_load_dwordx4 a[24:27], v208, s[8:11], s20 offen
  v_mfma_f32_16x16x32_bf16 v[180:183], a[28:31], a[108:111], v[180:183]
  ds_read_b128 a[128:131], v210 offset:40960
  v_cvt_pk_bf16_f32 v36, v236, v237
  v_mfma_f32_16x16x32_bf16 v[184:187], a[28:31], a[112:115], v[184:187]
  v_lshlrev_b32 v238, 16, v233
  v_and_b32 v239, s27, v233
  v_mfma_f32_16x16x32_bf16 v[188:191], a[28:31], a[116:119], v[188:191]
  v_accvgpr_read_b32 v244, a157
  s_waitcnt vmcnt(27)
  v_mfma_f32_16x16x32_bf16 v[192:195], a[32:35], a[104:107], v[192:195]
  buffer_load_dwordx4 a[28:31], v208, s[8:11], s20 offen offset:1024
  v_lshlrev_b32 v242, 16, v244
  v_mfma_f32_16x16x32_bf16 v[196:199], a[32:35], a[108:111], v[196:199]
  ds_read_b128 a[132:135], v210 offset:45056
  v_and_b32 v243, s27, v244
  v_mfma_f32_16x16x32_bf16 v[200:203], a[32:35], a[112:115], v[200:203]
  v_fma_f32 v238, v242, v38, v238
  v_fma_f32 v239, v243, v39, v239
  v_mfma_f32_16x16x32_bf16 v[204:207], a[32:35], a[116:119], v[204:207]
  s_waitcnt lgkmcnt(0)
  v_mfma_f32_16x16x32_bf16 v[128:131], a[36:39], a[120:123], v[128:131]
  buffer_load_dwordx4 a[32:35], v208, s[8:11], s20 offen offset:2048
  v_mfma_f32_16x16x32_bf16 v[132:135], a[36:39], a[124:127], v[132:135]
  v_cvt_pk_bf16_f32 v37, v238, v239
  v_lshlrev_b32 v236, 16, v234
  v_mfma_f32_16x16x32_bf16 v[136:139], a[36:39], a[128:131], v[136:139]
  v_and_b32 v237, s27, v234
  v_accvgpr_read_b32 v244, a158
  v_mfma_f32_16x16x32_bf16 v[140:143], a[36:39], a[132:135], v[140:143]
  s_waitcnt vmcnt(27)
  v_mfma_f32_16x16x32_bf16 v[144:147], a[40:43], a[120:123], v[144:147]
  buffer_load_dwordx4 a[36:39], v208, s[8:11], s20 offen offset:3072
  v_lshlrev_b32 v240, 16, v244
  v_mfma_f32_16x16x32_bf16 v[148:151], a[40:43], a[124:127], v[148:151]
  ds_read_b128 a[104:107], v211 offset:32768
  v_and_b32 v241, s27, v244
  v_mfma_f32_16x16x32_bf16 v[152:155], a[40:43], a[128:131], v[152:155]
  v_fma_f32 v236, v240, v52, v236
  v_fma_f32 v237, v241, v53, v237
  v_mfma_f32_16x16x32_bf16 v[156:159], a[40:43], a[132:135], v[156:159]
  v_mfma_f32_16x16x32_bf16 v[160:163], a[44:47], a[120:123], v[160:163]
  s_add_u32 s20, s20, 4096
  buffer_load_dwordx4 a[40:43], v208, s[8:11], s20 offen
  v_mfma_f32_16x16x32_bf16 v[164:167], a[44:47], a[124:127], v[164:167]
  ds_read_b128 a[108:111], v211 offset:36864
  v_cvt_pk_bf16_f32 v38, v236, v237
  v_mfma_f32_16x16x32_bf16 v[168:171], a[44:47], a[128:131], v[168:171]
  v_lshlrev_b32 v238, 16, v235
  v_and_b32 v239, s27, v235
  v_mfma_f32_16x16x32_bf16 v[172:175], a[44:47], a[132:135], v[172:175]
  v_accvgpr_read_b32 v244, a159
  s_waitcnt vmcnt(27)
  v_mfma_f32_16x16x32_bf16 v[176:179], a[48:51], a[120:123], v[176:179]
  buffer_load_dwordx4 a[44:47], v208, s[8:11], s20 offen offset:1024
  v_lshlrev_b32 v242, 16, v244
  v_mfma_f32_16x16x32_bf16 v[180:183], a[48:51], a[124:127], v[180:183]
  ds_read_b128 a[112:115], v211 offset:40960
  v_and_b32 v243, s27, v244
  v_mfma_f32_16x16x32_bf16 v[184:187], a[48:51], a[128:131], v[184:187]
  v_fma_f32 v238, v242, v54, v238
  v_fma_f32 v239, v243, v55, v239
  v_mfma_f32_16x16x32_bf16 v[188:191], a[48:51], a[132:135], v[188:191]
  v_cvt_pk_bf16_f32 v39, v238, v239
  v_mfma_f32_16x16x32_bf16 v[192:195], a[52:55], a[120:123], v[192:195]
  buffer_load_dwordx4 a[48:51], v208, s[8:11], s20 offen offset:2048
  ds_read_b128 v[232:235], v218 offset:12288
  v_mfma_f32_16x16x32_bf16 v[196:199], a[52:55], a[124:127], v[196:199]
  ds_read_b128 a[116:119], v211 offset:45056
  v_lshlrev_b32 v236, 16, v228
  v_mfma_f32_16x16x32_bf16 v[200:203], a[52:55], a[128:131], v[200:203]
  v_and_b32 v237, s27, v228
  v_accvgpr_read_b32 v244, a160
  v_mfma_f32_16x16x32_bf16 v[204:207], a[52:55], a[132:135], v[204:207]
  s_waitcnt vmcnt(27) lgkmcnt(0)
  v_mfma_f32_16x16x32_bf16 v[128:131], a[56:59], a[104:107], v[128:131]
  buffer_load_dwordx4 a[52:55], v208, s[8:11], s20 offen offset:3072
  v_mfma_f32_16x16x32_bf16 v[132:135], a[56:59], a[108:111], v[132:135]
  v_lshlrev_b32 v240, 16, v244
  v_and_b32 v241, s27, v244
  v_mfma_f32_16x16x32_bf16 v[136:139], a[56:59], a[112:115], v[136:139]
  v_fma_f32 v236, v240, v40, v236
  v_fma_f32 v237, v241, v41, v237
  v_mfma_f32_16x16x32_bf16 v[140:143], a[56:59], a[116:119], v[140:143]
  v_mfma_f32_16x16x32_bf16 v[144:147], a[60:63], a[104:107], v[144:147]
  s_add_u32 s20, s20, 4096
  buffer_load_dwordx4 a[56:59], v208, s[8:11], s20 offen
  v_mfma_f32_16x16x32_bf16 v[148:151], a[60:63], a[108:111], v[148:151]
  ds_read_b128 a[120:123], v212 offset:32768
  v_cvt_pk_bf16_f32 v40, v236, v237
  v_mfma_f32_16x16x32_bf16 v[152:155], a[60:63], a[112:115], v[152:155]
  v_lshlrev_b32 v238, 16, v229
  v_and_b32 v239, s27, v229
  v_mfma_f32_16x16x32_bf16 v[156:159], a[60:63], a[116:119], v[156:159]
  v_accvgpr_read_b32 v244, a161
  s_waitcnt vmcnt(27)
  v_mfma_f32_16x16x32_bf16 v[160:163], a[64:67], a[104:107], v[160:163]
  buffer_load_dwordx4 a[60:63], v208, s[8:11], s20 offen offset:1024
  v_lshlrev_b32 v242, 16, v244
  v_mfma_f32_16x16x32_bf16 v[164:167], a[64:67], a[108:111], v[164:167]
  ds_read_b128 a[124:127], v212 offset:36864
  v_and_b32 v243, s27, v244
  v_mfma_f32_16x16x32_bf16 v[168:171], a[64:67], a[112:115], v[168:171]
  v_fma_f32 v238, v242, v42, v238
  v_fma_f32 v239, v243, v43, v239
  v_mfma_f32_16x16x32_bf16 v[172:175], a[64:67], a[116:119], v[172:175]
  v_mfma_f32_16x16x32_bf16 v[176:179], a[68:71], a[104:107], v[176:179]
  buffer_load_dwordx4 a[64:67], v208, s[8:11], s20 offen offset:2048
  v_cvt_pk_bf16_f32 v41, v238, v239
  v_mfma_f32_16x16x32_bf16 v[180:183], a[68:71], a[108:111], v[180:183]
  ds_read_b128 a[128:131], v212 offset:40960
  v_lshlrev_b32 v236, 16, v230
  v_mfma_f32_16x16x32_bf16 v[184:187], a[68:71], a[112:115], v[184:187]
  v_and_b32 v237, s27, v230
  v_accvgpr_read_b32 v244, a162
  v_mfma_f32_16x16x32_bf16 v[188:191], a[68:71], a[116:119], v[188:191]
  s_waitcnt vmcnt(27)
  v_mfma_f32_16x16x32_bf16 v[192:195], a[72:75], a[104:107], v[192:195]
  buffer_load_dwordx4 a[68:71], v208, s[8:11], s20 offen offset:3072
  v_lshlrev_b32 v240, 16, v244
  v_mfma_f32_16x16x32_bf16 v[196:199], a[72:75], a[108:111], v[196:199]
  ds_read_b128 a[132:135], v212 offset:45056
  v_and_b32 v241, s27, v244
  v_mfma_f32_16x16x32_bf16 v[200:203], a[72:75], a[112:115], v[200:203]
  v_fma_f32 v236, v240, v56, v236
  v_fma_f32 v237, v241, v57, v237
  v_mfma_f32_16x16x32_bf16 v[204:207], a[72:75], a[116:119], v[204:207]
  s_waitcnt lgkmcnt(0)
  v_mfma_f32_16x16x32_bf16 v[128:131], a[76:79], a[120:123], v[128:131]
  s_add_u32 s20, s20, 4096
  buffer_load_dwordx4 a[72:75], v208, s[8:11], s20 offen
  v_mfma_f32_16x16x32_bf16 v[132:135], a[76:79], a[124:127], v[132:135]
  v_cvt_pk_bf16_f32 v42, v236, v237
  v_lshlrev_b32 v238, 16, v231
  v_mfma_f32_16x16x32_bf16 v[136:139], a[76:79], a[128:131], v[136:139]
  v_and_b32 v239, s27, v231
  v_accvgpr_read_b32 v244, a163
  v_mfma_f32_16x16x32_bf16 v[140:143], a[76:79], a[132:135], v[140:143]
  s_waitcnt vmcnt(27)
  v_mfma_f32_16x16x32_bf16 v[144:147], a[80:83], a[120:123], v[144:147]
  buffer_load_dwordx4 a[76:79], v208, s[8:11], s20 offen offset:1024
  v_lshlrev_b32 v242, 16, v244
  v_mfma_f32_16x16x32_bf16 v[148:151], a[80:83], a[124:127], v[148:151]
  ds_read_b128 a[104:107], v209 offset:49152
  v_and_b32 v243, s27, v244
  v_mfma_f32_16x16x32_bf16 v[152:155], a[80:83], a[128:131], v[152:155]
  v_fma_f32 v238, v242, v58, v238
  v_fma_f32 v239, v243, v59, v239
  v_mfma_f32_16x16x32_bf16 v[156:159], a[80:83], a[132:135], v[156:159]
  v_mfma_f32_16x16x32_bf16 v[160:163], a[84:87], a[120:123], v[160:163]
  buffer_load_dwordx4 a[80:83], v208, s[8:11], s20 offen offset:2048
  v_cvt_pk_bf16_f32 v43, v238, v239
  v_mfma_f32_16x16x32_bf16 v[164:167], a[84:87], a[124:127], v[164:167]
  ds_read_b128 a[108:111], v209 offset:53248
  ds_read_b128 v[228:231], v219
  v_mfma_f32_16x16x32_bf16 v[168:171], a[84:87], a[128:131], v[168:171]
  v_lshlrev_b32 v236, 16, v232
  v_and_b32 v237, s27, v232
  v_mfma_f32_16x16x32_bf16 v[172:175], a[84:87], a[132:135], v[172:175]
  s_waitcnt vmcnt(27)
  v_mfma_f32_16x16x32_bf16 v[176:179], v[16:19], a[120:123], v[176:179]
  buffer_load_dwordx4 a[84:87], v208, s[8:11], s20 offen offset:3072
  v_accvgpr_read_b32 v244, a164
  v_mfma_f32_16x16x32_bf16 v[180:183], v[16:19], a[124:127], v[180:183]
  ds_read_b128 a[112:115], v209 offset:57344
  v_lshlrev_b32 v240, 16, v244
  v_mfma_f32_16x16x32_bf16 v[184:187], v[16:19], a[128:131], v[184:187]
  v_and_b32 v241, s27, v244
  v_fma_f32 v236, v240, v44, v236
  v_mfma_f32_16x16x32_bf16 v[188:191], v[16:19], a[132:135], v[188:191]
  v_mfma_f32_16x16x32_bf16 v[192:195], v[20:23], a[120:123], v[192:195]
  s_add_u32 s20, s20, 4096
  buffer_load_dwordx4 v[16:19], v208, s[8:11], s20 offen
  v_mfma_f32_16x16x32_bf16 v[196:199], v[20:23], a[124:127], v[196:199]
  ds_read_b128 a[116:119], v209 offset:61440
  v_fma_f32 v237, v241, v45, v237
  v_mfma_f32_16x16x32_bf16 v[200:203], v[20:23], a[128:131], v[200:203]
  v_cvt_pk_bf16_f32 v44, v236, v237
  v_lshlrev_b32 v238, 16, v233
  v_mfma_f32_16x16x32_bf16 v[204:207], v[20:23], a[132:135], v[204:207]
  v_and_b32 v239, s27, v233
  s_waitcnt vmcnt(27) lgkmcnt(0)
  v_mfma_f32_16x16x32_bf16 v[128:131], v[24:27], a[104:107], v[128:131]
  buffer_load_dwordx4 v[20:23], v208, s[8:11], s20 offen offset:1024
  v_mfma_f32_16x16x32_bf16 v[132:135], v[24:27], a[108:111], v[132:135]
  v_accvgpr_read_b32 v244, a165
  v_lshlrev_b32 v242, 16, v244
  v_mfma_f32_16x16x32_bf16 v[136:139], v[24:27], a[112:115], v[136:139]
  v_and_b32 v243, s27, v244
  v_fma_f32 v238, v242, v46, v238
  v_mfma_f32_16x16x32_bf16 v[140:143], v[24:27], a[116:119], v[140:143]
  v_mfma_f32_16x16x32_bf16 v[144:147], v[28:31], a[104:107], v[144:147]
  buffer_load_dwordx4 v[24:27], v208, s[8:11], s20 offen offset:2048
  v_fma_f32 v239, v243, v47, v239
  v_mfma_f32_16x16x32_bf16 v[148:151], v[28:31], a[108:111], v[148:151]
  ds_read_b128 a[120:123], v210 offset:49152
  v_cvt_pk_bf16_f32 v45, v238, v239
  v_mfma_f32_16x16x32_bf16 v[152:155], v[28:31], a[112:115], v[152:155]
  v_lshlrev_b32 v236, 16, v234
  v_and_b32 v237, s27, v234
  v_mfma_f32_16x16x32_bf16 v[156:159], v[28:31], a[116:119], v[156:159]
  s_waitcnt vmcnt(27)
  v_mfma_f32_16x16x32_bf16 v[160:163], a[88:91], a[104:107], v[160:163]
  buffer_load_dwordx4 v[28:31], v208, s[8:11], s20 offen offset:3072
  v_accvgpr_read_b32 v244, a166
  v_mfma_f32_16x16x32_bf16 v[164:167], a[88:91], a[108:111], v[164:167]
  ds_read_b128 a[124:127], v210 offset:53248
  v_lshlrev_b32 v240, 16, v244
  v_mfma_f32_16x16x32_bf16 v[168:171], a[88:91], a[112:115], v[168:171]
  v_and_b32 v241, s27, v244
  v_fma_f32 v236, v240, v60, v236
  v_mfma_f32_16x16x32_bf16 v[172:175], a[88:91], a[116:119], v[172:175]
  v_mfma_f32_16x16x32_bf16 v[176:179], a[92:95], a[104:107], v[176:179]
  s_add_u32 s20, s20, 4096
  buffer_load_dwordx4 a[88:91], v208, s[8:11], s20 offen
  v_mfma_f32_16x16x32_bf16 v[180:183], a[92:95], a[108:111], v[180:183]
  ds_read_b128 a[128:131], v210 offset:57344
  v_fma_f32 v237, v241, v61, v237
  v_mfma_f32_16x16x32_bf16 v[184:187], a[92:95], a[112:115], v[184:187]
  v_cvt_pk_bf16_f32 v46, v236, v237
  v_lshlrev_b32 v238, 16, v235
  v_mfma_f32_16x16x32_bf16 v[188:191], a[92:95], a[116:119], v[188:191]
  v_and_b32 v239, s27, v235
  s_waitcnt vmcnt(27)
  v_mfma_f32_16x16x32_bf16 v[192:195], a[96:99], a[104:107], v[192:195]
  buffer_load_dwordx4 a[92:95], v208, s[8:11], s20 offen offset:1024
  v_accvgpr_read_b32 v244, a167
  v_mfma_f32_16x16x32_bf16 v[196:199], a[96:99], a[108:111], v[196:199]
  ds_read_b128 a[132:135], v210 offset:61440
  v_lshlrev_b32 v242, 16, v244
  v_mfma_f32_16x16x32_bf16 v[200:203], a[96:99], a[112:115], v[200:203]
  v_and_b32 v243, s27, v244
  v_fma_f32 v238, v242, v62, v238
  v_mfma_f32_16x16x32_bf16 v[204:207], a[96:99], a[116:119], v[204:207]
  v_fma_f32 v239, v243, v63, v239
  s_waitcnt lgkmcnt(0)
  v_mfma_f32_16x16x32_bf16 v[128:131], a[100:103], a[120:123], v[128:131]
  buffer_load_dwordx4 a[96:99], v208, s[8:11], s20 offen offset:2048
  v_mfma_f32_16x16x32_bf16 v[132:135], a[100:103], a[124:127], v[132:135]
  v_cvt_pk_bf16_f32 v47, v238, v239
  ds_read_b128 v[232:235], v219 offset:4096
  v_mfma_f32_16x16x32_bf16 v[136:139], a[100:103], a[128:131], v[136:139]
  v_lshlrev_b32 v236, 16, v228
  v_and_b32 v237, s27, v228
  v_mfma_f32_16x16x32_bf16 v[140:143], a[100:103], a[132:135], v[140:143]
  s_waitcnt vmcnt(27)
  v_mfma_f32_16x16x32_bf16 v[144:147], a[0:3], a[120:123], v[144:147]
  buffer_load_dwordx4 v[48:51], v208, s[8:11], s20 offen offset:3072
  s_add_u32 s20, s20, 4096
  buffer_load_dwordx4 v[52:55], v208, s[8:11], s20 offen
  buffer_load_dwordx4 v[56:59], v208, s[8:11], s20 offen offset:1024
  v_mfma_f32_16x16x32_bf16 v[148:151], a[0:3], a[124:127], v[148:151]
  ds_read_b128 a[104:107], v211 offset:49152
  v_accvgpr_read_b32 v244, a168
  v_mfma_f32_16x16x32_bf16 v[152:155], a[0:3], a[128:131], v[152:155]
  v_lshlrev_b32 v240, 16, v244
  v_and_b32 v241, s27, v244
  v_mfma_f32_16x16x32_bf16 v[156:159], a[0:3], a[132:135], v[156:159]
  v_fma_f32 v236, v240, v64, v236
  v_mfma_f32_16x16x32_bf16 v[160:163], a[4:7], a[120:123], v[160:163]
  buffer_load_dwordx4 v[60:63], v208, s[8:11], s20 offen offset:2048
  buffer_load_dwordx4 a[100:103], v208, s[8:11], s20 offen offset:3072
  s_add_u32 s20, s20, 4096
  buffer_load_dwordx4 a[0:3], v208, s[8:11], s20 offen
  v_mfma_f32_16x16x32_bf16 v[164:167], a[4:7], a[124:127], v[164:167]
  ds_read_b128 a[108:111], v211 offset:53248
  v_fma_f32 v237, v241, v65, v237
  v_mfma_f32_16x16x32_bf16 v[168:171], a[4:7], a[128:131], v[168:171]
  v_cvt_pk_bf16_f32 v64, v236, v237
  v_lshlrev_b32 v238, 16, v229
  v_mfma_f32_16x16x32_bf16 v[172:175], a[4:7], a[132:135], v[172:175]
  v_and_b32 v239, s27, v229
  s_waitcnt vmcnt(31)
  v_mfma_f32_16x16x32_bf16 v[176:179], a[8:11], a[120:123], v[176:179]
  buffer_load_dwordx4 a[4:7], v208, s[8:11], s20 offen offset:1024
  v_accvgpr_read_b32 v244, a169
  v_mfma_f32_16x16x32_bf16 v[180:183], a[8:11], a[124:127], v[180:183]
  ds_read_b128 a[112:115], v211 offset:57344
  v_lshlrev_b32 v242, 16, v244
  v_mfma_f32_16x16x32_bf16 v[184:187], a[8:11], a[128:131], v[184:187]
  v_and_b32 v243, s27, v244
  v_fma_f32 v238, v242, v66, v238
  v_mfma_f32_16x16x32_bf16 v[188:191], a[8:11], a[132:135], v[188:191]
  v_mfma_f32_16x16x32_bf16 v[192:195], a[12:15], a[120:123], v[192:195]
  buffer_load_dwordx4 a[8:11], v208, s[8:11], s20 offen offset:2048
  v_fma_f32 v239, v243, v67, v239
  v_mfma_f32_16x16x32_bf16 v[196:199], a[12:15], a[124:127], v[196:199]
  ds_read_b128 a[116:119], v211 offset:61440
  v_cvt_pk_bf16_f32 v65, v238, v239
  v_mfma_f32_16x16x32_bf16 v[200:203], a[12:15], a[128:131], v[200:203]
  v_lshlrev_b32 v236, 16, v230
  v_and_b32 v237, s27, v230
  v_mfma_f32_16x16x32_bf16 v[204:207], a[12:15], a[132:135], v[204:207]
  s_waitcnt vmcnt(31) lgkmcnt(0)
  v_mfma_f32_16x16x32_bf16 v[128:131], a[16:19], a[104:107], v[128:131]
  buffer_load_dwordx4 a[12:15], v208, s[8:11], s20 offen offset:3072
  v_mfma_f32_16x16x32_bf16 v[132:135], a[16:19], a[108:111], v[132:135]
  v_accvgpr_read_b32 v244, a170
  v_lshlrev_b32 v240, 16, v244
  v_mfma_f32_16x16x32_bf16 v[136:139], a[16:19], a[112:115], v[136:139]
  v_and_b32 v241, s27, v244
  v_fma_f32 v236, v240, v80, v236
  v_mfma_f32_16x16x32_bf16 v[140:143], a[16:19], a[116:119], v[140:143]
  v_mfma_f32_16x16x32_bf16 v[144:147], a[20:23], a[104:107], v[144:147]
  s_add_u32 s20, s20, 4096
  buffer_load_dwordx4 a[16:19], v208, s[8:11], s20 offen
  v_mfma_f32_16x16x32_bf16 v[148:151], a[20:23], a[108:111], v[148:151]
  ds_read_b128 a[120:123], v212 offset:49152
  v_fma_f32 v237, v241, v81, v237
  v_mfma_f32_16x16x32_bf16 v[152:155], a[20:23], a[112:115], v[152:155]
  v_cvt_pk_bf16_f32 v66, v236, v237
  v_lshlrev_b32 v238, 16, v231
  v_mfma_f32_16x16x32_bf16 v[156:159], a[20:23], a[116:119], v[156:159]
  v_and_b32 v239, s27, v231
  s_waitcnt vmcnt(31)
  v_mfma_f32_16x16x32_bf16 v[160:163], a[24:27], a[104:107], v[160:163]
  buffer_load_dwordx4 a[20:23], v208, s[8:11], s20 offen offset:1024
  v_accvgpr_read_b32 v244, a171
  v_mfma_f32_16x16x32_bf16 v[164:167], a[24:27], a[108:111], v[164:167]
  ds_read_b128 a[124:127], v212 offset:53248
  v_lshlrev_b32 v242, 16, v244
  v_mfma_f32_16x16x32_bf16 v[168:171], a[24:27], a[112:115], v[168:171]
  v_and_b32 v243, s27, v244
  v_fma_f32 v238, v242, v82, v238
  v_mfma_f32_16x16x32_bf16 v[172:175], a[24:27], a[116:119], v[172:175]
  v_mfma_f32_16x16x32_bf16 v[176:179], a[28:31], a[104:107], v[176:179]
  buffer_load_dwordx4 a[24:27], v208, s[8:11], s20 offen offset:2048
  v_fma_f32 v239, v243, v83, v239
  v_mfma_f32_16x16x32_bf16 v[180:183], a[28:31], a[108:111], v[180:183]
  ds_read_b128 a[128:131], v212 offset:57344
  v_cvt_pk_bf16_f32 v67, v238, v239
  v_mfma_f32_16x16x32_bf16 v[184:187], a[28:31], a[112:115], v[184:187]
  ds_read_b128 v[228:231], v219 offset:8192
  v_lshlrev_b32 v236, 16, v232
  v_mfma_f32_16x16x32_bf16 v[188:191], a[28:31], a[116:119], v[188:191]
  s_waitcnt vmcnt(31)
  v_mfma_f32_16x16x32_bf16 v[192:195], a[32:35], a[104:107], v[192:195]
  buffer_load_dwordx4 a[28:31], v208, s[8:11], s20 offen offset:3072
  v_and_b32 v237, s27, v232
  v_mfma_f32_16x16x32_bf16 v[196:199], a[32:35], a[108:111], v[196:199]
  ds_read_b128 a[132:135], v212 offset:61440
  v_accvgpr_read_b32 v244, a172
  v_mfma_f32_16x16x32_bf16 v[200:203], a[32:35], a[112:115], v[200:203]
  v_lshlrev_b32 v240, 16, v244
  v_and_b32 v241, s27, v244
  v_mfma_f32_16x16x32_bf16 v[204:207], a[32:35], a[116:119], v[204:207]
  s_waitcnt lgkmcnt(0)
  v_mfma_f32_16x16x32_bf16 v[128:131], a[36:39], a[120:123], v[128:131]
  s_add_u32 s20, s20, 4096
  buffer_load_dwordx4 a[32:35], v208, s[8:11], s20 offen
  v_mfma_f32_16x16x32_bf16 v[132:135], a[36:39], a[124:127], v[132:135]
  v_fma_f32 v236, v240, v68, v236
  v_fma_f32 v237, v241, v69, v237
  v_mfma_f32_16x16x32_bf16 v[136:139], a[36:39], a[128:131], v[136:139]
  v_cvt_pk_bf16_f32 v68, v236, v237
  v_lshlrev_b32 v238, 16, v233
  v_mfma_f32_16x16x32_bf16 v[140:143], a[36:39], a[132:135], v[140:143]
  s_waitcnt vmcnt(31)
  v_mfma_f32_16x16x32_bf16 v[144:147], a[40:43], a[120:123], v[144:147]
  buffer_load_dwordx4 a[36:39], v208, s[8:11], s20 offen offset:1024
  v_and_b32 v239, s27, v233
  v_mfma_f32_16x16x32_bf16 v[148:151], a[40:43], a[124:127], v[148:151]
  ds_read_b128 a[104:107], v213
  v_accvgpr_read_b32 v244, a173
  v_mfma_f32_16x16x32_bf16 v[152:155], a[40:43], a[128:131], v[152:155]
  v_lshlrev_b32 v242, 16, v244
  v_and_b32 v243, s27, v244
  v_mfma_f32_16x16x32_bf16 v[156:159], a[40:43], a[132:135], v[156:159]
  v_mfma_f32_16x16x32_bf16 v[160:163], a[44:47], a[120:123], v[160:163]
  buffer_load_dwordx4 a[40:43], v208, s[8:11], s20 offen offset:2048
  v_fma_f32 v238, v242, v70, v238
  v_mfma_f32_16x16x32_bf16 v[164:167], a[44:47], a[124:127], v[164:167]
  ds_read_b128 a[108:111], v213 offset:4096
  v_fma_f32 v239, v243, v71, v239
  v_mfma_f32_16x16x32_bf16 v[168:171], a[44:47], a[128:131], v[168:171]
  v_cvt_pk_bf16_f32 v69, v238, v239
  v_lshlrev_b32 v236, 16, v234
  v_mfma_f32_16x16x32_bf16 v[172:175], a[44:47], a[132:135], v[172:175]
  s_waitcnt vmcnt(31)
  v_mfma_f32_16x16x32_bf16 v[176:179], a[48:51], a[120:123], v[176:179]
  buffer_load_dwordx4 a[44:47], v208, s[8:11], s20 offen offset:3072
  v_and_b32 v237, s27, v234
  v_mfma_f32_16x16x32_bf16 v[180:183], a[48:51], a[124:127], v[180:183]
  ds_read_b128 a[112:115], v213 offset:8192
  v_accvgpr_read_b32 v244, a174
  v_mfma_f32_16x16x32_bf16 v[184:187], a[48:51], a[128:131], v[184:187]
  v_lshlrev_b32 v240, 16, v244
  v_and_b32 v241, s27, v244
  v_mfma_f32_16x16x32_bf16 v[188:191], a[48:51], a[132:135], v[188:191]
  v_mfma_f32_16x16x32_bf16 v[192:195], a[52:55], a[120:123], v[192:195]
  s_add_u32 s20, s20, 4096
  buffer_load_dwordx4 a[48:51], v208, s[8:11], s20 offen
  v_mfma_f32_16x16x32_bf16 v[196:199], a[52:55], a[124:127], v[196:199]
  ds_read_b128 a[116:119], v213 offset:12288
  v_fma_f32 v236, v240, v84, v236
  v_mfma_f32_16x16x32_bf16 v[200:203], a[52:55], a[128:131], v[200:203]
  v_fma_f32 v237, v241, v85, v237
  v_cvt_pk_bf16_f32 v70, v236, v237
  v_mfma_f32_16x16x32_bf16 v[204:207], a[52:55], a[132:135], v[204:207]
  v_lshlrev_b32 v238, 16, v235
  s_waitcnt vmcnt(31) lgkmcnt(0)
  v_mfma_f32_16x16x32_bf16 v[128:131], a[56:59], a[104:107], v[128:131]
  buffer_load_dwordx4 a[52:55], v208, s[8:11], s20 offen offset:1024
  v_mfma_f32_16x16x32_bf16 v[132:135], a[56:59], a[108:111], v[132:135]
  v_and_b32 v239, s27, v235
  v_accvgpr_read_b32 v244, a175
  v_mfma_f32_16x16x32_bf16 v[136:139], a[56:59], a[112:115], v[136:139]
  v_lshlrev_b32 v242, 16, v244
  v_and_b32 v243, s27, v244
  v_mfma_f32_16x16x32_bf16 v[140:143], a[56:59], a[116:119], v[140:143]
  v_mfma_f32_16x16x32_bf16 v[144:147], a[60:63], a[104:107], v[144:147]
  buffer_load_dwordx4 a[56:59], v208, s[8:11], s20 offen offset:2048
  v_fma_f32 v238, v242, v86, v238
  v_mfma_f32_16x16x32_bf16 v[148:151], a[60:63], a[108:111], v[148:151]
  ds_read_b128 a[120:123], v214
  v_fma_f32 v239, v243, v87, v239
  v_mfma_f32_16x16x32_bf16 v[152:155], a[60:63], a[112:115], v[152:155]
  v_cvt_pk_bf16_f32 v71, v238, v239
  ds_read_b128 v[232:235], v219 offset:12288
  v_mfma_f32_16x16x32_bf16 v[156:159], a[60:63], a[116:119], v[156:159]
  v_lshlrev_b32 v236, 16, v228
  s_waitcnt vmcnt(31)
  v_mfma_f32_16x16x32_bf16 v[160:163], a[64:67], a[104:107], v[160:163]
  buffer_load_dwordx4 a[60:63], v208, s[8:11], s20 offen offset:3072
  v_and_b32 v237, s27, v228
  v_mfma_f32_16x16x32_bf16 v[164:167], a[64:67], a[108:111], v[164:167]
  ds_read_b128 a[124:127], v214 offset:4096
  v_accvgpr_read_b32 v244, a176
  v_mfma_f32_16x16x32_bf16 v[168:171], a[64:67], a[112:115], v[168:171]
  v_lshlrev_b32 v240, 16, v244
  v_and_b32 v241, s27, v244
  v_mfma_f32_16x16x32_bf16 v[172:175], a[64:67], a[116:119], v[172:175]
  v_mfma_f32_16x16x32_bf16 v[176:179], a[68:71], a[104:107], v[176:179]
  s_add_u32 s20, s20, 4096
  buffer_load_dwordx4 a[64:67], v208, s[8:11], s20 offen
  v_mfma_f32_16x16x32_bf16 v[180:183], a[68:71], a[108:111], v[180:183]
  ds_read_b128 a[128:131], v214 offset:8192
  v_fma_f32 v236, v240, v72, v236
  v_mfma_f32_16x16x32_bf16 v[184:187], a[68:71], a[112:115], v[184:187]
  v_fma_f32 v237, v241, v73, v237
  v_cvt_pk_bf16_f32 v72, v236, v237
  v_mfma_f32_16x16x32_bf16 v[188:191], a[68:71], a[116:119], v[188:191]
  v_lshlrev_b32 v238, 16, v229
  s_waitcnt vmcnt(31)
  v_mfma_f32_16x16x32_bf16 v[192:195], a[72:75], a[104:107], v[192:195]
  buffer_load_dwordx4 a[68:71], v208, s[8:11], s20 offen offset:1024
  v_and_b32 v239, s27, v229
  v_mfma_f32_16x16x32_bf16 v[196:199], a[72:75], a[108:111], v[196:199]
  ds_read_b128 a[132:135], v214 offset:12288
  v_accvgpr_read_b32 v244, a177
  v_mfma_f32_16x16x32_bf16 v[200:203], a[72:75], a[112:115], v[200:203]
  v_lshlrev_b32 v242, 16, v244
  v_and_b32 v243, s27, v244
  v_mfma_f32_16x16x32_bf16 v[204:207], a[72:75], a[116:119], v[204:207]
  s_waitcnt lgkmcnt(0)
  v_mfma_f32_16x16x32_bf16 v[128:131], a[76:79], a[120:123], v[128:131]
  buffer_load_dwordx4 a[72:75], v208, s[8:11], s20 offen offset:2048
  v_mfma_f32_16x16x32_bf16 v[132:135], a[76:79], a[124:127], v[132:135]
  v_fma_f32 v238, v242, v74, v238
  v_fma_f32 v239, v243, v75, v239
  v_mfma_f32_16x16x32_bf16 v[136:139], a[76:79], a[128:131], v[136:139]
  v_cvt_pk_bf16_f32 v73, v238, v239
  v_lshlrev_b32 v236, 16, v230
  v_mfma_f32_16x16x32_bf16 v[140:143], a[76:79], a[132:135], v[140:143]
  s_waitcnt vmcnt(31)
  v_mfma_f32_16x16x32_bf16 v[144:147], a[80:83], a[120:123], v[144:147]
  buffer_load_dwordx4 a[76:79], v208, s[8:11], s20 offen offset:3072
  v_and_b32 v237, s27, v230
  v_mfma_f32_16x16x32_bf16 v[148:151], a[80:83], a[124:127], v[148:151]
  ds_read_b128 a[104:107], v215
  v_accvgpr_read_b32 v244, a178
  v_mfma_f32_16x16x32_bf16 v[152:155], a[80:83], a[128:131], v[152:155]
  v_lshlrev_b32 v240, 16, v244
  v_and_b32 v241, s27, v244
  v_mfma_f32_16x16x32_bf16 v[156:159], a[80:83], a[132:135], v[156:159]
  v_mfma_f32_16x16x32_bf16 v[160:163], a[84:87], a[120:123], v[160:163]
  s_add_u32 s20, s20, 4096
  buffer_load_dwordx4 a[80:83], v208, s[8:11], s20 offen
  v_mfma_f32_16x16x32_bf16 v[164:167], a[84:87], a[124:127], v[164:167]
  ds_read_b128 a[108:111], v215 offset:4096
  v_fma_f32 v236, v240, v88, v236
  v_mfma_f32_16x16x32_bf16 v[168:171], a[84:87], a[128:131], v[168:171]
  v_fma_f32 v237, v241, v89, v237
  v_cvt_pk_bf16_f32 v74, v236, v237
  v_mfma_f32_16x16x32_bf16 v[172:175], a[84:87], a[132:135], v[172:175]
  v_lshlrev_b32 v238, 16, v231
  s_waitcnt vmcnt(31)
  v_mfma_f32_16x16x32_bf16 v[176:179], v[16:19], a[120:123], v[176:179]
  buffer_load_dwordx4 a[84:87], v208, s[8:11], s20 offen offset:1024
  v_and_b32 v239, s27, v231
  v_mfma_f32_16x16x32_bf16 v[180:183], v[16:19], a[124:127], v[180:183]
  ds_read_b128 a[112:115], v215 offset:8192
  v_accvgpr_read_b32 v244, a179
  v_mfma_f32_16x16x32_bf16 v[184:187], v[16:19], a[128:131], v[184:187]
  v_lshlrev_b32 v242, 16, v244
  v_and_b32 v243, s27, v244
  v_mfma_f32_16x16x32_bf16 v[188:191], v[16:19], a[132:135], v[188:191]
  v_mfma_f32_16x16x32_bf16 v[192:195], v[20:23], a[120:123], v[192:195]
  buffer_load_dwordx4 v[16:19], v208, s[8:11], s20 offen offset:2048
  v_fma_f32 v238, v242, v90, v238
  v_mfma_f32_16x16x32_bf16 v[196:199], v[20:23], a[124:127], v[196:199]
  ds_read_b128 a[116:119], v215 offset:12288
  v_fma_f32 v239, v243, v91, v239
  v_mfma_f32_16x16x32_bf16 v[200:203], v[20:23], a[128:131], v[200:203]
  v_cvt_pk_bf16_f32 v75, v238, v239
  ds_read_b128 v[228:231], v220
  v_mfma_f32_16x16x32_bf16 v[204:207], v[20:23], a[132:135], v[204:207]
  s_waitcnt vmcnt(31) lgkmcnt(1)
  v_mfma_f32_16x16x32_bf16 v[128:131], v[24:27], a[104:107], v[128:131]
  buffer_load_dwordx4 v[20:23], v208, s[8:11], s20 offen offset:3072
  v_mfma_f32_16x16x32_bf16 v[132:135], v[24:27], a[108:111], v[132:135]
  v_lshlrev_b32 v236, 16, v232
  v_and_b32 v237, s27, v232
  v_mfma_f32_16x16x32_bf16 v[136:139], v[24:27], a[112:115], v[136:139]
  v_accvgpr_read_b32 v244, a180
  v_lshlrev_b32 v240, 16, v244
  v_mfma_f32_16x16x32_bf16 v[140:143], v[24:27], a[116:119], v[140:143]
  v_mfma_f32_16x16x32_bf16 v[144:147], v[28:31], a[104:107], v[144:147]
  s_add_u32 s20, s20, 4096
  buffer_load_dwordx4 v[24:27], v208, s[8:11], s20 offen
  v_mfma_f32_16x16x32_bf16 v[148:151], v[28:31], a[108:111], v[148:151]
  ds_read_b128 a[120:123], v216
  v_and_b32 v241, s27, v244
  v_mfma_f32_16x16x32_bf16 v[152:155], v[28:31], a[112:115], v[152:155]
  v_fma_f32 v236, v240, v76, v236
  v_fma_f32 v237, v241, v77, v237
  v_mfma_f32_16x16x32_bf16 v[156:159], v[28:31], a[116:119], v[156:159]
  v_cvt_pk_bf16_f32 v76, v236, v237
  s_waitcnt vmcnt(31)
  v_mfma_f32_16x16x32_bf16 v[160:163], a[88:91], a[104:107], v[160:163]
  buffer_load_dwordx4 v[28:31], v208, s[8:11], s20 offen offset:1024
  v_lshlrev_b32 v238, 16, v233
  v_mfma_f32_16x16x32_bf16 v[164:167], a[88:91], a[108:111], v[164:167]
  ds_read_b128 a[124:127], v216 offset:4096
  v_and_b32 v239, s27, v233
  v_mfma_f32_16x16x32_bf16 v[168:171], a[88:91], a[112:115], v[168:171]
  v_accvgpr_read_b32 v244, a181
  v_lshlrev_b32 v242, 16, v244
  v_mfma_f32_16x16x32_bf16 v[172:175], a[88:91], a[116:119], v[172:175]
  v_mfma_f32_16x16x32_bf16 v[176:179], a[92:95], a[104:107], v[176:179]
  buffer_load_dwordx4 a[88:91], v208, s[8:11], s20 offen offset:2048
  v_and_b32 v243, s27, v244
  v_mfma_f32_16x16x32_bf16 v[180:183], a[92:95], a[108:111], v[180:183]
  ds_read_b128 a[128:131], v216 offset:8192
  v_fma_f32 v238, v242, v78, v238
  v_mfma_f32_16x16x32_bf16 v[184:187], a[92:95], a[112:115], v[184:187]
  v_fma_f32 v239, v243, v79, v239
  v_cvt_pk_bf16_f32 v77, v238, v239
  v_mfma_f32_16x16x32_bf16 v[188:191], a[92:95], a[116:119], v[188:191]
  s_waitcnt vmcnt(31)
  v_mfma_f32_16x16x32_bf16 v[192:195], a[96:99], a[104:107], v[192:195]
  buffer_load_dwordx4 a[92:95], v208, s[8:11], s20 offen offset:3072
  v_lshlrev_b32 v236, 16, v234
  v_mfma_f32_16x16x32_bf16 v[196:199], a[96:99], a[108:111], v[196:199]
  ds_read_b128 a[132:135], v216 offset:12288
  v_and_b32 v237, s27, v234
  v_mfma_f32_16x16x32_bf16 v[200:203], a[96:99], a[112:115], v[200:203]
  v_accvgpr_read_b32 v244, a182
  v_lshlrev_b32 v240, 16, v244
  v_mfma_f32_16x16x32_bf16 v[204:207], a[96:99], a[116:119], v[204:207]
  s_waitcnt lgkmcnt(0)
  v_mfma_f32_16x16x32_bf16 v[128:131], v[48:51], a[120:123], v[128:131]
  s_add_u32 s20, s20, 4096
  buffer_load_dwordx4 a[96:99], v208, s[8:11], s20 offen
  v_mfma_f32_16x16x32_bf16 v[132:135], v[48:51], a[124:127], v[132:135]
  v_and_b32 v241, s27, v244
  v_fma_f32 v236, v240, v92, v236
  v_mfma_f32_16x16x32_bf16 v[136:139], v[48:51], a[128:131], v[136:139]
  v_fma_f32 v237, v241, v93, v237
  v_cvt_pk_bf16_f32 v78, v236, v237
  v_mfma_f32_16x16x32_bf16 v[140:143], v[48:51], a[132:135], v[140:143]
  s_waitcnt vmcnt(31)
  v_mfma_f32_16x16x32_bf16 v[144:147], v[52:55], a[120:123], v[144:147]
  buffer_load_dwordx4 v[48:51], v208, s[8:11], s20 offen offset:1024
  v_lshlrev_b32 v238, 16, v235
  v_mfma_f32_16x16x32_bf16 v[148:151], v[52:55], a[124:127], v[148:151]
  ds_read_b128 a[104:107], v213 offset:16384
  v_and_b32 v239, s27, v235
  v_mfma_f32_16x16x32_bf16 v[152:155], v[52:55], a[128:131], v[152:155]
  v_accvgpr_read_b32 v244, a183
  v_lshlrev_b32 v242, 16, v244
  v_mfma_f32_16x16x32_bf16 v[156:159], v[52:55], a[132:135], v[156:159]
  v_mfma_f32_16x16x32_bf16 v[160:163], v[56:59], a[120:123], v[160:163]
  v_and_b32 v243, s27, v244
  v_fma_f32 v238, v242, v94, v238
  v_mfma_f32_16x16x32_bf16 v[164:167], v[56:59], a[124:127], v[164:167]
  ds_read_b128 a[108:111], v213 offset:20480
  buffer_store_dwordx4 v[0:3], v224, s[12:15], 0 offen
  v_mfma_f32_16x16x32_bf16 v[168:171], v[56:59], a[128:131], v[168:171]
  v_fma_f32 v239, v243, v95, v239
  v_cvt_pk_bf16_f32 v79, v238, v239
  v_mfma_f32_16x16x32_bf16 v[172:175], v[56:59], a[132:135], v[172:175]
  ds_read_b128 v[232:235], v220 offset:4096
  s_waitcnt vmcnt(31)
  v_mfma_f32_16x16x32_bf16 v[176:179], v[60:63], a[120:123], v[176:179]
  v_lshlrev_b32 v236, 16, v228
  v_mfma_f32_16x16x32_bf16 v[180:183], v[60:63], a[124:127], v[180:183]
  ds_read_b128 a[112:115], v213 offset:24576
  v_and_b32 v237, s27, v228
  v_mfma_f32_16x16x32_bf16 v[184:187], v[60:63], a[128:131], v[184:187]
  v_accvgpr_read_b32 v244, a184
  v_lshlrev_b32 v240, 16, v244
  v_mfma_f32_16x16x32_bf16 v[188:191], v[60:63], a[132:135], v[188:191]
  v_mfma_f32_16x16x32_bf16 v[192:195], a[100:103], a[120:123], v[192:195]
  v_and_b32 v241, s27, v244
  v_mfma_f32_16x16x32_bf16 v[196:199], a[100:103], a[124:127], v[196:199]
  ds_read_b128 a[116:119], v213 offset:28672
  v_fma_f32 v236, v240, v96, v236
  v_mfma_f32_16x16x32_bf16 v[200:203], a[100:103], a[128:131], v[200:203]
  v_fma_f32 v237, v241, v97, v237
  v_cvt_pk_bf16_f32 v96, v236, v237
  v_mfma_f32_16x16x32_bf16 v[204:207], a[100:103], a[132:135], v[204:207]
  s_waitcnt vmcnt(29) lgkmcnt(0)
  v_mfma_f32_16x16x32_bf16 v[128:131], a[0:3], a[104:107], v[128:131]
  v_lshlrev_b32 v238, 16, v229
  v_mfma_f32_16x16x32_bf16 v[132:135], a[0:3], a[108:111], v[132:135]
  buffer_store_dwordx4 v[4:7], v224, s[12:15], s24 offen
  v_and_b32 v239, s27, v229
  v_mfma_f32_16x16x32_bf16 v[136:139], a[0:3], a[112:115], v[136:139]
  v_accvgpr_read_b32 v244, a185
  v_lshlrev_b32 v242, 16, v244
  v_mfma_f32_16x16x32_bf16 v[140:143], a[0:3], a[116:119], v[140:143]
  v_mfma_f32_16x16x32_bf16 v[144:147], a[4:7], a[104:107], v[144:147]
  v_and_b32 v243, s27, v244
  v_mfma_f32_16x16x32_bf16 v[148:151], a[4:7], a[108:111], v[148:151]
  ds_read_b128 a[120:123], v214 offset:16384
  v_fma_f32 v238, v242, v98, v238
  v_mfma_f32_16x16x32_bf16 v[152:155], a[4:7], a[112:115], v[152:155]
  v_fma_f32 v239, v243, v99, v239
  v_cvt_pk_bf16_f32 v97, v238, v239
  v_mfma_f32_16x16x32_bf16 v[156:159], a[4:7], a[116:119], v[156:159]
  s_waitcnt vmcnt(28)
  v_mfma_f32_16x16x32_bf16 v[160:163], a[8:11], a[104:107], v[160:163]
  v_lshlrev_b32 v236, 16, v230
  v_mfma_f32_16x16x32_bf16 v[164:167], a[8:11], a[108:111], v[164:167]
  ds_read_b128 a[124:127], v214 offset:20480
  v_and_b32 v237, s27, v230
  v_mfma_f32_16x16x32_bf16 v[168:171], a[8:11], a[112:115], v[168:171]
  v_accvgpr_read_b32 v244, a186
  v_lshlrev_b32 v240, 16, v244
  v_mfma_f32_16x16x32_bf16 v[172:175], a[8:11], a[116:119], v[172:175]
  v_mfma_f32_16x16x32_bf16 v[176:179], a[12:15], a[104:107], v[176:179]
  v_and_b32 v241, s27, v244
  v_fma_f32 v236, v240, v112, v236
  v_mfma_f32_16x16x32_bf16 v[180:183], a[12:15], a[108:111], v[180:183]
  ds_read_b128 a[128:131], v214 offset:24576
  buffer_store_dwordx4 v[8:11], v224, s[12:15], s25 offen
  v_mfma_f32_16x16x32_bf16 v[184:187], a[12:15], a[112:115], v[184:187]
  v_fma_f32 v237, v241, v113, v237
  v_cvt_pk_bf16_f32 v98, v236, v237
  v_mfma_f32_16x16x32_bf16 v[188:191], a[12:15], a[116:119], v[188:191]
  s_waitcnt vmcnt(27)
  v_mfma_f32_16x16x32_bf16 v[192:195], a[16:19], a[104:107], v[192:195]
  v_lshlrev_b32 v238, 16, v231
  v_mfma_f32_16x16x32_bf16 v[196:199], a[16:19], a[108:111], v[196:199]
  ds_read_b128 a[132:135], v214 offset:28672
  v_and_b32 v239, s27, v231
  v_mfma_f32_16x16x32_bf16 v[200:203], a[16:19], a[112:115], v[200:203]
  v_accvgpr_read_b32 v244, a187
  v_lshlrev_b32 v242, 16, v244
  v_mfma_f32_16x16x32_bf16 v[204:207], a[16:19], a[116:119], v[204:207]
  s_waitcnt lgkmcnt(0)
  v_mfma_f32_16x16x32_bf16 v[128:131], a[20:23], a[120:123], v[128:131]
  v_mfma_f32_16x16x32_bf16 v[132:135], a[20:23], a[124:127], v[132:135]
  v_and_b32 v243, s27, v244
  v_fma_f32 v238, v242, v114, v238
  v_mfma_f32_16x16x32_bf16 v[136:139], a[20:23], a[128:131], v[136:139]
  v_fma_f32 v239, v243, v115, v239
  v_cvt_pk_bf16_f32 v99, v238, v239
  v_mfma_f32_16x16x32_bf16 v[140:143], a[20:23], a[132:135], v[140:143]
  s_waitcnt vmcnt(25)
  v_mfma_f32_16x16x32_bf16 v[144:147], a[24:27], a[120:123], v[144:147]
  ds_read_b128 v[228:231], v220 offset:8192
  v_lshlrev_b32 v236, 16, v232
  v_mfma_f32_16x16x32_bf16 v[148:151], a[24:27], a[124:127], v[148:151]
  ds_read_b128 a[104:107], v215 offset:16384
  buffer_store_dwordx4 v[12:15], v224, s[12:15], s26 offen
  v_mfma_f32_16x16x32_bf16 v[152:155], a[24:27], a[128:131], v[152:155]
  v_and_b32 v237, s27, v232
  v_accvgpr_read_b32 v244, a188
  v_mfma_f32_16x16x32_bf16 v[156:159], a[24:27], a[132:135], v[156:159]
  v_mfma_f32_16x16x32_bf16 v[160:163], a[28:31], a[120:123], v[160:163]
  v_lshlrev_b32 v240, 16, v244
  v_mfma_f32_16x16x32_bf16 v[164:167], a[28:31], a[124:127], v[164:167]
  ds_read_b128 a[108:111], v215 offset:20480
  v_and_b32 v241, s27, v244
  v_mfma_f32_16x16x32_bf16 v[168:171], a[28:31], a[128:131], v[168:171]
  v_fma_f32 v236, v240, v100, v236
  v_fma_f32 v237, v241, v101, v237
  v_mfma_f32_16x16x32_bf16 v[172:175], a[28:31], a[132:135], v[172:175]
  s_waitcnt vmcnt(24)
  v_mfma_f32_16x16x32_bf16 v[176:179], a[32:35], a[120:123], v[176:179]
  v_cvt_pk_bf16_f32 v100, v236, v237
  v_mfma_f32_16x16x32_bf16 v[180:183], a[32:35], a[124:127], v[180:183]
  ds_read_b128 a[112:115], v215 offset:24576
  v_lshlrev_b32 v238, 16, v233
  v_mfma_f32_16x16x32_bf16 v[184:187], a[32:35], a[128:131], v[184:187]
  v_and_b32 v239, s27, v233
  v_accvgpr_read_b32 v244, a189
  v_mfma_f32_16x16x32_bf16 v[188:191], a[32:35], a[132:135], v[188:191]
  v_mfma_f32_16x16x32_bf16 v[192:195], a[36:39], a[120:123], v[192:195]
  v_lshlrev_b32 v242, 16, v244
  v_and_b32 v243, s27, v244
  v_mfma_f32_16x16x32_bf16 v[196:199], a[36:39], a[124:127], v[196:199]
  ds_read_b128 a[116:119], v215 offset:28672
  buffer_store_dwordx4 v[32:35], v224, s[12:15], 0 offen offset:64
  v_mfma_f32_16x16x32_bf16 v[200:203], a[36:39], a[128:131], v[200:203]
  v_fma_f32 v238, v242, v102, v238
  v_fma_f32 v239, v243, v103, v239
  v_mfma_f32_16x16x32_bf16 v[204:207], a[36:39], a[132:135], v[204:207]
  s_waitcnt vmcnt(23) lgkmcnt(0)
  v_mfma_f32_16x16x32_bf16 v[128:131], a[40:43], a[104:107], v[128:131]
  v_mfma_f32_16x16x32_bf16 v[132:135], a[40:43], a[108:111], v[132:135]
  v_cvt_pk_bf16_f32 v101, v238, v239
  v_lshlrev_b32 v236, 16, v234
  v_mfma_f32_16x16x32_bf16 v[136:139], a[40:43], a[112:115], v[136:139]
  v_and_b32 v237, s27, v234
  v_accvgpr_read_b32 v244, a190
  v_mfma_f32_16x16x32_bf16 v[140:143], a[40:43], a[116:119], v[140:143]
  v_mfma_f32_16x16x32_bf16 v[144:147], a[44:47], a[104:107], v[144:147]
  v_lshlrev_b32 v240, 16, v244
  v_mfma_f32_16x16x32_bf16 v[148:151], a[44:47], a[108:111], v[148:151]
  ds_read_b128 a[120:123], v216 offset:16384
  v_and_b32 v241, s27, v244
  v_mfma_f32_16x16x32_bf16 v[152:155], a[44:47], a[112:115], v[152:155]
  v_fma_f32 v236, v240, v116, v236
  v_fma_f32 v237, v241, v117, v237
  v_mfma_f32_16x16x32_bf16 v[156:159], a[44:47], a[116:119], v[156:159]
  s_waitcnt vmcnt(21)
  v_mfma_f32_16x16x32_bf16 v[160:163], a[48:51], a[104:107], v[160:163]
  v_cvt_pk_bf16_f32 v102, v236, v237
  v_lshlrev_b32 v238, 16, v235
  v_mfma_f32_16x16x32_bf16 v[164:167], a[48:51], a[108:111], v[164:167]
  ds_read_b128 a[124:127], v216 offset:20480
  buffer_store_dwordx4 v[36:39], v224, s[12:15], s24 offen offset:64
  v_mfma_f32_16x16x32_bf16 v[168:171], a[48:51], a[112:115], v[168:171]
  v_and_b32 v239, s27, v235
  v_accvgpr_read_b32 v244, a191
  v_mfma_f32_16x16x32_bf16 v[172:175], a[48:51], a[116:119], v[172:175]
  v_mfma_f32_16x16x32_bf16 v[176:179], a[52:55], a[104:107], v[176:179]
  v_lshlrev_b32 v242, 16, v244
  v_and_b32 v243, s27, v244
  v_mfma_f32_16x16x32_bf16 v[180:183], a[52:55], a[108:111], v[180:183]
  ds_read_b128 a[128:131], v216 offset:24576
  v_fma_f32 v238, v242, v118, v238
  v_mfma_f32_16x16x32_bf16 v[184:187], a[52:55], a[112:115], v[184:187]
  v_fma_f32 v239, v243, v119, v239
  v_cvt_pk_bf16_f32 v103, v238, v239
  v_mfma_f32_16x16x32_bf16 v[188:191], a[52:55], a[116:119], v[188:191]
  s_waitcnt vmcnt(20)
  v_mfma_f32_16x16x32_bf16 v[192:195], a[56:59], a[104:107], v[192:195]
  ds_read_b128 v[232:235], v220 offset:12288
  v_mfma_f32_16x16x32_bf16 v[196:199], a[56:59], a[108:111], v[196:199]
  ds_read_b128 a[132:135], v216 offset:28672
  v_lshlrev_b32 v236, 16, v228
  v_mfma_f32_16x16x32_bf16 v[200:203], a[56:59], a[112:115], v[200:203]
  v_and_b32 v237, s27, v228
  v_accvgpr_read_b32 v244, a192
  v_mfma_f32_16x16x32_bf16 v[204:207], a[56:59], a[116:119], v[204:207]
  s_waitcnt lgkmcnt(0)
  v_mfma_f32_16x16x32_bf16 v[128:131], a[60:63], a[120:123], v[128:131]
  v_lshlrev_b32 v240, 16, v244
  v_mfma_f32_16x16x32_bf16 v[132:135], a[60:63], a[124:127], v[132:135]
  buffer_store_dwordx4 v[40:43], v224, s[12:15], s25 offen offset:64
  v_and_b32 v241, s27, v244
  v_mfma_f32_16x16x32_bf16 v[136:139], a[60:63], a[128:131], v[136:139]
  v_fma_f32 v236, v240, v104, v236
  v_fma_f32 v237, v241, v105, v237
  v_mfma_f32_16x16x32_bf16 v[140:143], a[60:63], a[132:135], v[140:143]
  s_waitcnt vmcnt(19)
  v_mfma_f32_16x16x32_bf16 v[144:147], a[64:67], a[120:123], v[144:147]
  v_cvt_pk_bf16_f32 v104, v236, v237
  v_mfma_f32_16x16x32_bf16 v[148:151], a[64:67], a[124:127], v[148:151]
  ds_read_b128 a[104:107], v213 offset:32768
  v_lshlrev_b32 v238, 16, v229
  v_mfma_f32_16x16x32_bf16 v[152:155], a[64:67], a[128:131], v[152:155]
  v_and_b32 v239, s27, v229
  v_accvgpr_read_b32 v244, a193
  v_mfma_f32_16x16x32_bf16 v[156:159], a[64:67], a[132:135], v[156:159]
  v_mfma_f32_16x16x32_bf16 v[160:163], a[68:71], a[120:123], v[160:163]
  v_lshlrev_b32 v242, 16, v244
  v_mfma_f32_16x16x32_bf16 v[164:167], a[68:71], a[124:127], v[164:167]
  ds_read_b128 a[108:111], v213 offset:36864
  v_and_b32 v243, s27, v244
  v_mfma_f32_16x16x32_bf16 v[168:171], a[68:71], a[128:131], v[168:171]
  v_fma_f32 v238, v242, v106, v238
  v_fma_f32 v239, v243, v107, v239
  v_mfma_f32_16x16x32_bf16 v[172:175], a[68:71], a[132:135], v[172:175]
  s_waitcnt vmcnt(17)
  v_mfma_f32_16x16x32_bf16 v[176:179], a[72:75], a[120:123], v[176:179]
  v_cvt_pk_bf16_f32 v105, v238, v239
  v_lshlrev_b32 v236, 16, v230
  v_mfma_f32_16x16x32_bf16 v[180:183], a[72:75], a[124:127], v[180:183]
  ds_read_b128 a[112:115], v213 offset:40960
  buffer_store_dwordx4 v[44:47], v224, s[12:15], s26 offen offset:64
  v_mfma_f32_16x16x32_bf16 v[184:187], a[72:75], a[128:131], v[184:187]
  v_and_b32 v237, s27, v230
  v_accvgpr_read_b32 v244, a194
  v_mfma_f32_16x16x32_bf16 v[188:191], a[72:75], a[132:135], v[188:191]
  v_mfma_f32_16x16x32_bf16 v[192:195], a[76:79], a[120:123], v[192:195]
  v_lshlrev_b32 v240, 16, v244
  v_mfma_f32_16x16x32_bf16 v[196:199], a[76:79], a[124:127], v[196:199]
  ds_read_b128 a[116:119], v213 offset:45056
  v_and_b32 v241, s27, v244
  v_mfma_f32_16x16x32_bf16 v[200:203], a[76:79], a[128:131], v[200:203]
  v_fma_f32 v236, v240, v120, v236
  v_fma_f32 v237, v241, v121, v237
  v_mfma_f32_16x16x32_bf16 v[204:207], a[76:79], a[132:135], v[204:207]
  s_waitcnt vmcnt(16) lgkmcnt(0)
  v_mfma_f32_16x16x32_bf16 v[128:131], a[80:83], a[104:107], v[128:131]
  v_mfma_f32_16x16x32_bf16 v[132:135], a[80:83], a[108:111], v[132:135]
  v_cvt_pk_bf16_f32 v106, v236, v237
  v_lshlrev_b32 v238, 16, v231
  v_mfma_f32_16x16x32_bf16 v[136:139], a[80:83], a[112:115], v[136:139]
  v_and_b32 v239, s27, v231
  v_accvgpr_read_b32 v244, a195
  v_mfma_f32_16x16x32_bf16 v[140:143], a[80:83], a[116:119], v[140:143]
  v_mfma_f32_16x16x32_bf16 v[144:147], a[84:87], a[104:107], v[144:147]
  v_lshlrev_b32 v242, 16, v244
  v_and_b32 v243, s27, v244
  v_mfma_f32_16x16x32_bf16 v[148:151], a[84:87], a[108:111], v[148:151]
  ds_read_b128 a[120:123], v214 offset:32768
  buffer_store_dwordx4 v[64:67], v224, s[12:15], 0 offen offset:128
  v_mfma_f32_16x16x32_bf16 v[152:155], a[84:87], a[112:115], v[152:155]
  v_fma_f32 v238, v242, v122, v238
  v_fma_f32 v239, v243, v123, v239
  v_mfma_f32_16x16x32_bf16 v[156:159], a[84:87], a[116:119], v[156:159]
  s_waitcnt vmcnt(15)
  v_mfma_f32_16x16x32_bf16 v[160:163], v[16:19], a[104:107], v[160:163]
  v_cvt_pk_bf16_f32 v107, v238, v239
  v_mfma_f32_16x16x32_bf16 v[164:167], v[16:19], a[108:111], v[164:167]
  ds_read_b128 a[124:127], v214 offset:36864
  v_lshlrev_b32 v236, 16, v232
  v_mfma_f32_16x16x32_bf16 v[168:171], v[16:19], a[112:115], v[168:171]
  v_and_b32 v237, s27, v232
  v_accvgpr_read_b32 v244, a196
  v_mfma_f32_16x16x32_bf16 v[172:175], v[16:19], a[116:119], v[172:175]
  v_mfma_f32_16x16x32_bf16 v[176:179], v[20:23], a[104:107], v[176:179]
  v_lshlrev_b32 v240, 16, v244
  v_mfma_f32_16x16x32_bf16 v[180:183], v[20:23], a[108:111], v[180:183]
  ds_read_b128 a[128:131], v214 offset:40960
  v_and_b32 v241, s27, v244
  v_mfma_f32_16x16x32_bf16 v[184:187], v[20:23], a[112:115], v[184:187]
  v_fma_f32 v236, v240, v108, v236
  v_fma_f32 v237, v241, v109, v237
  v_mfma_f32_16x16x32_bf16 v[188:191], v[20:23], a[116:119], v[188:191]
  s_waitcnt vmcnt(13)
  v_mfma_f32_16x16x32_bf16 v[192:195], v[24:27], a[104:107], v[192:195]
  v_cvt_pk_bf16_f32 v108, v236, v237
  v_lshlrev_b32 v238, 16, v233
  v_mfma_f32_16x16x32_bf16 v[196:199], v[24:27], a[108:111], v[196:199]
  ds_read_b128 a[132:135], v214 offset:45056
  buffer_store_dwordx4 v[68:71], v224, s[12:15], s24 offen offset:128
  v_mfma_f32_16x16x32_bf16 v[200:203], v[24:27], a[112:115], v[200:203]
  v_and_b32 v239, s27, v233
  v_accvgpr_read_b32 v244, a197
  v_mfma_f32_16x16x32_bf16 v[204:207], v[24:27], a[116:119], v[204:207]
  s_waitcnt lgkmcnt(0)
  v_mfma_f32_16x16x32_bf16 v[128:131], v[28:31], a[120:123], v[128:131]
  v_mfma_f32_16x16x32_bf16 v[132:135], v[28:31], a[124:127], v[132:135]
  v_lshlrev_b32 v242, 16, v244
  v_and_b32 v243, s27, v244
  v_mfma_f32_16x16x32_bf16 v[136:139], v[28:31], a[128:131], v[136:139]
  v_fma_f32 v238, v242, v110, v238
  v_fma_f32 v239, v243, v111, v239
  v_mfma_f32_16x16x32_bf16 v[140:143], v[28:31], a[132:135], v[140:143]
  s_waitcnt vmcnt(12)
  v_mfma_f32_16x16x32_bf16 v[144:147], a[88:91], a[120:123], v[144:147]
  v_mfma_f32_16x16x32_bf16 v[148:151], a[88:91], a[124:127], v[148:151]
  v_cvt_pk_bf16_f32 v109, v238, v239
  v_lshlrev_b32 v236, 16, v234
  v_mfma_f32_16x16x32_bf16 v[152:155], a[88:91], a[128:131], v[152:155]
  v_and_b32 v237, s27, v234
  v_accvgpr_read_b32 v244, a198
  v_mfma_f32_16x16x32_bf16 v[156:159], a[88:91], a[132:135], v[156:159]
  v_mfma_f32_16x16x32_bf16 v[160:163], a[92:95], a[120:123], v[160:163]
  v_lshlrev_b32 v240, 16, v244
  v_mfma_f32_16x16x32_bf16 v[164:167], a[92:95], a[124:127], v[164:167]
  buffer_store_dwordx4 v[72:75], v224, s[12:15], s25 offen offset:128
  v_and_b32 v241, s27, v244
  v_mfma_f32_16x16x32_bf16 v[168:171], a[92:95], a[128:131], v[168:171]
  v_fma_f32 v236, v240, v124, v236
  v_fma_f32 v237, v241, v125, v237
  v_mfma_f32_16x16x32_bf16 v[172:175], a[92:95], a[132:135], v[172:175]
  s_waitcnt vmcnt(11)
  v_mfma_f32_16x16x32_bf16 v[176:179], a[96:99], a[120:123], v[176:179]
  v_mfma_f32_16x16x32_bf16 v[180:183], a[96:99], a[124:127], v[180:183]
  v_cvt_pk_bf16_f32 v110, v236, v237
  v_lshlrev_b32 v238, 16, v235
  v_mfma_f32_16x16x32_bf16 v[184:187], a[96:99], a[128:131], v[184:187]
  v_and_b32 v239, s27, v235
  v_accvgpr_read_b32 v244, a199
  v_mfma_f32_16x16x32_bf16 v[188:191], a[96:99], a[132:135], v[188:191]
  v_mfma_f32_16x16x32_bf16 v[192:195], v[48:51], a[120:123], v[192:195]
  v_lshlrev_b32 v242, 16, v244
  v_mfma_f32_16x16x32_bf16 v[196:199], v[48:51], a[124:127], v[196:199]
  v_and_b32 v243, s27, v244
  v_fma_f32 v238, v242, v126, v238
  v_mfma_f32_16x16x32_bf16 v[200:203], v[48:51], a[128:131], v[200:203]
  v_fma_f32 v239, v243, v127, v239
  v_cvt_pk_bf16_f32 v111, v238, v239
  v_mfma_f32_16x16x32_bf16 v[204:207], v[48:51], a[132:135], v[204:207]
  buffer_store_dwordx4 v[76:79], v224, s[12:15], s26 offen offset:128
  buffer_store_dwordx4 v[96:99], v224, s[12:15], 0 offen offset:192
  buffer_store_dwordx4 v[100:103], v224, s[12:15], s24 offen offset:192
  buffer_store_dwordx4 v[104:107], v224, s[12:15], s25 offen offset:192
  buffer_store_dwordx4 v[108:111], v224, s[12:15], s26 offen offset:192
  ds_read_b128 v[228:231], v221
  ds_read_b128 v[232:235], v221 offset:4096
  s_waitcnt lgkmcnt(1)
  v_lshlrev_b32 v236, 16, v228
  v_and_b32 v237, s27, v228
  v_accvgpr_read_b32 v244, a200
  v_lshlrev_b32 v240, 16, v244
  v_and_b32 v241, s27, v244
  v_fma_f32 v236, v240, v128, v236
  v_fma_f32 v237, v241, v129, v237
  v_cvt_pk_bf16_f32 v228, v236, v237
  v_lshlrev_b32 v238, 16, v229
  v_and_b32 v239, s27, v229
  v_accvgpr_read_b32 v244, a201
  v_lshlrev_b32 v242, 16, v244
  v_and_b32 v243, s27, v244
  v_fma_f32 v238, v242, v130, v238
  v_fma_f32 v239, v243, v131, v239
  v_cvt_pk_bf16_f32 v229, v238, v239
  v_lshlrev_b32 v236, 16, v230
  v_and_b32 v237, s27, v230
  v_accvgpr_read_b32 v244, a202
  v_lshlrev_b32 v240, 16, v244
  v_and_b32 v241, s27, v244
  v_fma_f32 v236, v240, v144, v236
  v_fma_f32 v237, v241, v145, v237
  v_cvt_pk_bf16_f32 v230, v236, v237
  v_lshlrev_b32 v238, 16, v231
  v_and_b32 v239, s27, v231
  v_accvgpr_read_b32 v244, a203
  v_lshlrev_b32 v242, 16, v244
  v_and_b32 v243, s27, v244
  v_fma_f32 v238, v242, v146, v238
  v_fma_f32 v239, v243, v147, v239
  v_cvt_pk_bf16_f32 v231, v238, v239
  buffer_store_dwordx4 v[228:231], v224, s[12:15], 0 offen offset:256
  ds_read_b128 v[228:231], v221 offset:8192
  s_waitcnt lgkmcnt(1)
  v_lshlrev_b32 v236, 16, v232
  v_and_b32 v237, s27, v232
  v_accvgpr_read_b32 v244, a204
  v_lshlrev_b32 v240, 16, v244
  v_and_b32 v241, s27, v244
  v_fma_f32 v236, v240, v132, v236
  v_fma_f32 v237, v241, v133, v237
  v_cvt_pk_bf16_f32 v232, v236, v237
  v_lshlrev_b32 v238, 16, v233
  v_and_b32 v239, s27, v233
  v_accvgpr_read_b32 v244, a205
  v_lshlrev_b32 v242, 16, v244
  v_and_b32 v243, s27, v244
  v_fma_f32 v238, v242, v134, v238
  v_fma_f32 v239, v243, v135, v239
  v_cvt_pk_bf16_f32 v233, v238, v239
  v_lshlrev_b32 v236, 16, v234
  v_and_b32 v237, s27, v234
  v_accvgpr_read_b32 v244, a206
  v_lshlrev_b32 v240, 16, v244
  v_and_b32 v241, s27, v244
  v_fma_f32 v236, v240, v148, v236
  v_fma_f32 v237, v241, v149, v237
  v_cvt_pk_bf16_f32 v234, v236, v237
  v_lshlrev_b32 v238, 16, v235
  v_and_b32 v239, s27, v235
  v_accvgpr_read_b32 v244, a207
  v_lshlrev_b32 v242, 16, v244
  v_and_b32 v243, s27, v244
  v_fma_f32 v238, v242, v150, v238
  v_fma_f32 v239, v243, v151, v239
  v_cvt_pk_bf16_f32 v235, v238, v239
  buffer_store_dwordx4 v[232:235], v224, s[12:15], s24 offen offset:256
  ds_read_b128 v[232:235], v221 offset:12288
  s_waitcnt lgkmcnt(1)
  v_lshlrev_b32 v236, 16, v228
  v_and_b32 v237, s27, v228
  v_accvgpr_read_b32 v244, a208
  v_lshlrev_b32 v240, 16, v244
  v_and_b32 v241, s27, v244
  v_fma_f32 v236, v240, v136, v236
  v_fma_f32 v237, v241, v137, v237
  v_cvt_pk_bf16_f32 v228, v236, v237
  v_lshlrev_b32 v238, 16, v229
  v_and_b32 v239, s27, v229
  v_accvgpr_read_b32 v244, a209
  v_lshlrev_b32 v242, 16, v244
  v_and_b32 v243, s27, v244
  v_fma_f32 v238, v242, v138, v238
  v_fma_f32 v239, v243, v139, v239
  v_cvt_pk_bf16_f32 v229, v238, v239
  v_lshlrev_b32 v236, 16, v230
  v_and_b32 v237, s27, v230
  v_accvgpr_read_b32 v244, a210
  v_lshlrev_b32 v240, 16, v244
  v_and_b32 v241, s27, v244
  v_fma_f32 v236, v240, v152, v236
  v_fma_f32 v237, v241, v153, v237
  v_cvt_pk_bf16_f32 v230, v236, v237
  v_lshlrev_b32 v238, 16, v231
  v_and_b32 v239, s27, v231
  v_accvgpr_read_b32 v244, a211
  v_lshlrev_b32 v242, 16, v244
  v_and_b32 v243, s27, v244
  v_fma_f32 v238, v242, v154, v238
  v_fma_f32 v239, v243, v155, v239
  v_cvt_pk_bf16_f32 v231, v238, v239
  buffer_store_dwordx4 v[228:231], v224, s[12:15], s25 offen offset:256
  ds_read_b128 v[228:231], v222
  s_waitcnt lgkmcnt(1)
  v_lshlrev_b32 v236, 16, v232
  v_and_b32 v237, s27, v232
  v_accvgpr_read_b32 v244, a212
  v_lshlrev_b32 v240, 16, v244
  v_and_b32 v241, s27, v244
  v_fma_f32 v236, v240, v140, v236
  v_fma_f32 v237, v241, v141, v237
  v_cvt_pk_bf16_f32 v232, v236, v237
  v_lshlrev_b32 v238, 16, v233
  v_and_b32 v239, s27, v233
  v_accvgpr_read_b32 v244, a213
  v_lshlrev_b32 v242, 16, v244
  v_and_b32 v243, s27, v244
  v_fma_f32 v238, v242, v142, v238
  v_fma_f32 v239, v243, v143, v239
  v_cvt_pk_bf16_f32 v233, v238, v239
  v_lshlrev_b32 v236, 16, v234
  v_and_b32 v237, s27, v234
  v_accvgpr_read_b32 v244, a214
  v_lshlrev_b32 v240, 16, v244
  v_and_b32 v241, s27, v244
  v_fma_f32 v236, v240, v156, v236
  v_fma_f32 v237, v241, v157, v237
  v_cvt_pk_bf16_f32 v234, v236, v237
  v_lshlrev_b32 v238, 16, v235
  v_and_b32 v239, s27, v235
  v_accvgpr_read_b32 v244, a215
  v_lshlrev_b32 v242, 16, v244
  v_and_b32 v243, s27, v244
  v_fma_f32 v238, v242, v158, v238
  v_fma_f32 v239, v243, v159, v239
  v_cvt_pk_bf16_f32 v235, v238, v239
  buffer_store_dwordx4 v[232:235], v224, s[12:15], s26 offen offset:256
  ds_read_b128 v[232:235], v222 offset:4096
  s_waitcnt lgkmcnt(1)
  v_lshlrev_b32 v236, 16, v228
  v_and_b32 v237, s27, v228
  v_accvgpr_read_b32 v244, a216
  v_lshlrev_b32 v240, 16, v244
  v_and_b32 v241, s27, v244
  v_fma_f32 v236, v240, v160, v236
  v_fma_f32 v237, v241, v161, v237
  v_cvt_pk_bf16_f32 v228, v236, v237
  v_lshlrev_b32 v238, 16, v229
  v_and_b32 v239, s27, v229
  v_accvgpr_read_b32 v244, a217
  v_lshlrev_b32 v242, 16, v244
  v_and_b32 v243, s27, v244
  v_fma_f32 v238, v242, v162, v238
  v_fma_f32 v239, v243, v163, v239
  v_cvt_pk_bf16_f32 v229, v238, v239
  v_lshlrev_b32 v236, 16, v230
  v_and_b32 v237, s27, v230
  v_accvgpr_read_b32 v244, a218
  v_lshlrev_b32 v240, 16, v244
  v_and_b32 v241, s27, v244
  v_fma_f32 v236, v240, v176, v236
  v_fma_f32 v237, v241, v177, v237
  v_cvt_pk_bf16_f32 v230, v236, v237
  v_lshlrev_b32 v238, 16, v231
  v_and_b32 v239, s27, v231
  v_accvgpr_read_b32 v244, a219
  v_lshlrev_b32 v242, 16, v244
  v_and_b32 v243, s27, v244
  v_fma_f32 v238, v242, v178, v238
  v_fma_f32 v239, v243, v179, v239
  v_cvt_pk_bf16_f32 v231, v238, v239
  buffer_store_dwordx4 v[228:231], v224, s[12:15], 0 offen offset:320
  ds_read_b128 v[228:231], v222 offset:8192
  s_waitcnt lgkmcnt(1)
  v_lshlrev_b32 v236, 16, v232
  v_and_b32 v237, s27, v232
  v_accvgpr_read_b32 v244, a220
  v_lshlrev_b32 v240, 16, v244
  v_and_b32 v241, s27, v244
  v_fma_f32 v236, v240, v164, v236
  v_fma_f32 v237, v241, v165, v237
  v_cvt_pk_bf16_f32 v232, v236, v237
  v_lshlrev_b32 v238, 16, v233
  v_and_b32 v239, s27, v233
  v_accvgpr_read_b32 v244, a221
  v_lshlrev_b32 v242, 16, v244
  v_and_b32 v243, s27, v244
  v_fma_f32 v238, v242, v166, v238
  v_fma_f32 v239, v243, v167, v239
  v_cvt_pk_bf16_f32 v233, v238, v239
  v_lshlrev_b32 v236, 16, v234
  v_and_b32 v237, s27, v234
  v_accvgpr_read_b32 v244, a222
  v_lshlrev_b32 v240, 16, v244
  v_and_b32 v241, s27, v244
  v_fma_f32 v236, v240, v180, v236
  v_fma_f32 v237, v241, v181, v237
  v_cvt_pk_bf16_f32 v234, v236, v237
  v_lshlrev_b32 v238, 16, v235
  v_and_b32 v239, s27, v235
  v_accvgpr_read_b32 v244, a223
  v_lshlrev_b32 v242, 16, v244
  v_and_b32 v243, s27, v244
  v_fma_f32 v238, v242, v182, v238
  v_fma_f32 v239, v243, v183, v239
  v_cvt_pk_bf16_f32 v235, v238, v239
  buffer_store_dwordx4 v[232:235], v224, s[12:15], s24 offen offset:320
  ds_read_b128 v[232:235], v222 offset:12288
  s_waitcnt lgkmcnt(1)
  v_lshlrev_b32 v236, 16, v228
  v_and_b32 v237, s27, v228
  v_accvgpr_read_b32 v244, a224
  v_lshlrev_b32 v240, 16, v244
  v_and_b32 v241, s27, v244
  v_fma_f32 v236, v240, v168, v236
  v_fma_f32 v237, v241, v169, v237
  v_cvt_pk_bf16_f32 v228, v236, v237
  v_lshlrev_b32 v238, 16, v229
  v_and_b32 v239, s27, v229
  v_accvgpr_read_b32 v244, a225
  v_lshlrev_b32 v242, 16, v244
  v_and_b32 v243, s27, v244
  v_fma_f32 v238, v242, v170, v238
  v_fma_f32 v239, v243, v171, v239
  v_cvt_pk_bf16_f32 v229, v238, v239
  v_lshlrev_b32 v236, 16, v230
  v_and_b32 v237, s27, v230
  v_accvgpr_read_b32 v244, a226
  v_lshlrev_b32 v240, 16, v244
  v_and_b32 v241, s27, v244
  v_fma_f32 v236, v240, v184, v236
  v_fma_f32 v237, v241, v185, v237
  v_cvt_pk_bf16_f32 v230, v236, v237
  v_lshlrev_b32 v238, 16, v231
  v_and_b32 v239, s27, v231
  v_accvgpr_read_b32 v244, a227
  v_lshlrev_b32 v242, 16, v244
  v_and_b32 v243, s27, v244
  v_fma_f32 v238, v242, v186, v238
  v_fma_f32 v239, v243, v187, v239
  v_cvt_pk_bf16_f32 v231, v238, v239
  buffer_store_dwordx4 v[228:231], v224, s[12:15], s25 offen offset:320
  ds_read_b64 v[228:229], v223
  s_waitcnt lgkmcnt(1)
  v_lshlrev_b32 v236, 16, v232
  v_and_b32 v237, s27, v232
  v_accvgpr_read_b32 v244, a228
  v_lshlrev_b32 v240, 16, v244
  v_and_b32 v241, s27, v244
  v_fma_f32 v236, v240, v172, v236
  v_fma_f32 v237, v241, v173, v237
  v_cvt_pk_bf16_f32 v232, v236, v237
  v_lshlrev_b32 v238, 16, v233
  v_and_b32 v239, s27, v233
  v_accvgpr_read_b32 v244, a229
  v_lshlrev_b32 v242, 16, v244
  v_and_b32 v243, s27, v244
  v_fma_f32 v238, v242, v174, v238
  v_fma_f32 v239, v243, v175, v239
  v_cvt_pk_bf16_f32 v233, v238, v239
  v_lshlrev_b32 v236, 16, v234
  v_and_b32 v237, s27, v234
  v_accvgpr_read_b32 v244, a230
  v_lshlrev_b32 v240, 16, v244
  v_and_b32 v241, s27, v244
  v_fma_f32 v236, v240, v188, v236
  v_fma_f32 v237, v241, v189, v237
  v_cvt_pk_bf16_f32 v234, v236, v237
  v_lshlrev_b32 v238, 16, v235
  v_and_b32 v239, s27, v235
  v_accvgpr_read_b32 v244, a231
  v_lshlrev_b32 v242, 16, v244
  v_and_b32 v243, s27, v244
  v_fma_f32 v238, v242, v190, v238
  v_fma_f32 v239, v243, v191, v239
  v_cvt_pk_bf16_f32 v235, v238, v239
  buffer_store_dwordx4 v[232:235], v224, s[12:15], s26 offen offset:320
  ds_read_b64 v[232:233], v223 offset:4096
  s_waitcnt lgkmcnt(1)
  v_lshlrev_b32 v236, 16, v228
  v_and_b32 v237, s27, v228
  v_accvgpr_read_b32 v244, a232
  v_lshlrev_b32 v240, 16, v244
  v_and_b32 v241, s27, v244
  v_fma_f32 v236, v240, v192, v236
  v_fma_f32 v237, v241, v193, v237
  v_cvt_pk_bf16_f32 v228, v236, v237
  v_lshlrev_b32 v238, 16, v229
  v_and_b32 v239, s27, v229
  v_accvgpr_read_b32 v244, a233
  v_lshlrev_b32 v242, 16, v244
  v_and_b32 v243, s27, v244
  v_fma_f32 v238, v242, v194, v238
  v_fma_f32 v239, v243, v195, v239
  v_cvt_pk_bf16_f32 v229, v238, v239
  buffer_store_dwordx2 v[228:229], v225, s[12:15], 0 offen
  ds_read_b64 v[228:229], v223 offset:8192
  s_waitcnt lgkmcnt(1)
  v_lshlrev_b32 v236, 16, v232
  v_and_b32 v237, s27, v232
  v_accvgpr_read_b32 v244, a234
  v_lshlrev_b32 v240, 16, v244
  v_and_b32 v241, s27, v244
  v_fma_f32 v236, v240, v196, v236
  v_fma_f32 v237, v241, v197, v237
  v_cvt_pk_bf16_f32 v232, v236, v237
  v_lshlrev_b32 v238, 16, v233
  v_and_b32 v239, s27, v233
  v_accvgpr_read_b32 v244, a235
  v_lshlrev_b32 v242, 16, v244
  v_and_b32 v243, s27, v244
  v_fma_f32 v238, v242, v198, v238
  v_fma_f32 v239, v243, v199, v239
  v_cvt_pk_bf16_f32 v233, v238, v239
  buffer_store_dwordx2 v[232:233], v225, s[12:15], s24 offen
  ds_read_b64 v[232:233], v223 offset:12288
  s_waitcnt lgkmcnt(1)
  v_lshlrev_b32 v236, 16, v228
  v_and_b32 v237, s27, v228
  v_accvgpr_read_b32 v244, a236
  v_lshlrev_b32 v240, 16, v244
  v_and_b32 v241, s27, v244
  v_fma_f32 v236, v240, v200, v236
  v_fma_f32 v237, v241, v201, v237
  v_cvt_pk_bf16_f32 v228, v236, v237
  v_lshlrev_b32 v238, 16, v229
  v_and_b32 v239, s27, v229
  v_accvgpr_read_b32 v244, a237
  v_lshlrev_b32 v242, 16, v244
  v_and_b32 v243, s27, v244
  v_fma_f32 v238, v242, v202, v238
  v_fma_f32 v239, v243, v203, v239
  v_cvt_pk_bf16_f32 v229, v238, v239
  buffer_store_dwordx2 v[228:229], v225, s[12:15], s25 offen
  s_waitcnt lgkmcnt(0)
  v_lshlrev_b32 v236, 16, v232
  v_and_b32 v237, s27, v232
  v_accvgpr_read_b32 v244, a238
  v_lshlrev_b32 v240, 16, v244
  v_and_b32 v241, s27, v244
  v_fma_f32 v236, v240, v204, v236
  v_fma_f32 v237, v241, v205, v237
  v_cvt_pk_bf16_f32 v232, v236, v237
  v_lshlrev_b32 v238, 16, v233
  v_and_b32 v239, s27, v233
  v_accvgpr_read_b32 v244, a239
  v_lshlrev_b32 v242, 16, v244
  v_and_b32 v243, s27, v244
  v_fma_f32 v238, v242, v206, v238
  v_fma_f32 v239, v243, v207, v239
  v_cvt_pk_bf16_f32 v233, v238, v239
  buffer_store_dwordx2 v[232:233], v225, s[12:15], s26 offen
Lmain_end:
  s_endpgm
.section .rodata,"a"
.p2align 6

.amdhsa_kernel dcn_prep_kernel
  .amdhsa_next_free_vgpr 32
  .amdhsa_next_free_sgpr 56
  .amdhsa_accum_offset 32
  .amdhsa_group_segment_fixed_size 0
  .amdhsa_kernarg_size 48
  .amdhsa_user_sgpr_count 2
  .amdhsa_user_sgpr_kernarg_segment_ptr 1
  .amdhsa_system_sgpr_workgroup_id_x 1
  .amdhsa_system_sgpr_workgroup_id_y 1
.end_amdhsa_kernel
.p2align 6

.amdhsa_kernel standalone__cross_network_dcn__recsys_kernel
  .amdhsa_next_free_vgpr 512
  .amdhsa_next_free_sgpr 100
  .amdhsa_accum_offset 256
  .amdhsa_group_segment_fixed_size 0
  .amdhsa_kernarg_size 48
  .amdhsa_user_sgpr_count 2
  .amdhsa_user_sgpr_kernarg_segment_ptr 1
  .amdhsa_system_sgpr_workgroup_id_x 1
.end_amdhsa_kernel
```
